```python
import torch

def _softmax(x, axis=-1):
    return torch.softmax(x, dim=axis)
def _gelu(x):
    return torch.nn.functional.gelu(x, approximate="tanh")
def _silu(x):
    return torch.nn.functional.silu(x)
def _sigmoid(x):
    return torch.sigmoid(x)
def _layernorm(x, axis=-1, eps=1e-5):
    m = x.mean(dim=axis, keepdim=True)
    v = x.var(dim=axis, keepdim=True, unbiased=False)
    return (x - m) / torch.sqrt(v + eps)
def _scatter_add(tgt, idx, src, axis=0):
    return tgt.clone().index_add_(axis, idx, src)
def _segment_sum(src, seg, n):
    out = torch.zeros((n,) + src.shape[1:], dtype=src.dtype)
    return out.index_add_(0, seg, src)
def _pad(x, pw):
    flat = tuple(v for pair in reversed(pw) for v in pair)
    return torch.nn.functional.pad(x, flat)

kernel_name = 'gated_mix__spectral_gfnet__grouped_kv_mqa__prompt'

def setup_inputs():

    _w = (lambda a: (lambda t: t.to(torch.bfloat16) if t.is_floating_point() else t)(torch.as_tensor(a)))
    def _A_setup():
        B, S, D = 1, 2048, 576
        Df = D // 2 + 1
        return {
            "x": _w((lambda *s: torch.randn(*s, dtype=torch.bfloat16) * 0.05)(B, S, D)),
            "w_r": _w((lambda *s: torch.randn(*s, dtype=torch.bfloat16) * 0.8)(S, Df) * 0.02),
            "w_i": _w((lambda *s: torch.randn(*s, dtype=torch.bfloat16) * 0.8)(S, Df) * 0.02),
        }
    _A_in = _A_setup()

    def _B_setup():
        B, S, D, H = 1, 2048, 576, 32
        Dh = D // H
        return {
            "x": _w((lambda *s: torch.randn(*s, dtype=torch.bfloat16) * 0.05)(B, S, D)),
            "wq": _w((lambda *s: torch.randn(*s, dtype=torch.bfloat16) * 0.8)(D, H * Dh)),
            "wk": _w((lambda *s: torch.randn(*s, dtype=torch.bfloat16) * 0.8)(D, Dh)),
            "wv": _w((lambda *s: torch.randn(*s, dtype=torch.bfloat16) * 0.05)(D, Dh)),
            "wo": _w((lambda *s: torch.randn(*s, dtype=torch.bfloat16) * 0.05)(H * Dh, D)),
        }
    _B_in = _B_setup()

    return {
        "A_x": _A_in["x"],
        "A_w_r": _A_in["w_r"],
        "A_w_i": _A_in["w_i"],
        "B_x": _B_in["x"],
        "B_wq": _B_in["wq"],
        "B_wk": _B_in["wk"],
        "B_wv": _B_in["wv"],
        "B_wo": _B_in["wo"],
        "gate_w": _w((lambda *s: torch.randn(*s, dtype=torch.bfloat16) * 0.05)(576) * 16.0),
    }

def reference(A_x, A_w_r, A_w_i, B_x, B_wq, B_wk, B_wv, B_wo, gate_w):
    def _A_ref(x, w_r, w_i):
        B, S, D = x.shape
        X = (lambda x, axes=(-2,-1): torch.fft.rfft2(x.float(), dim=axes))(x, axes=(-2, -1))
        W = w_r + 1j * w_i
        X = X * W
        y = (lambda x, s, axes=(-2,-1): torch.fft.irfft2(x, s=s, dim=axes).to(torch.bfloat16))(X, (S, D), axes=(-2, -1))
        return y

    def _B_ref(x, wq, wk, wv, wo):
        B, S, D = x.shape
        H = 32
        Dh = D // H
        q = (lambda x, *d: x.permute(*d))((x @ wq).reshape(B, S, H, Dh), 0, 2, 1, 3)
        k = x @ wk
        v = x @ wv
        scores = torch.einsum("bhqd,bkd->bhqk", q, k) * (Dh ** -0.5)
        p = _softmax(scores, axis=-1)
        o = torch.einsum("bhqk,bkd->bhqd", p, v)
        return (lambda x, *d: x.permute(*d))(o, 0, 2, 1, 3).reshape(B, S, H * Dh) @ wo

    x = A_x
    g = _sigmoid((x * gate_w).sum(-1, keepdims=True))
    a = _A_ref(x, A_w_r, A_w_i)
    b = _B_ref(x, B_wq, B_wk, B_wv, B_wo)
    return g * a + (1 - g) * b
```

```asm
; @launch grid=(256,1,1) block=(512,1,1) lds=161536
.amdgcn_target "amdgcn-amd-amdhsa--gfx950"
.text
.globl gated_mix__spectral_gfnet__grouped_kv_mqa__prompt_kernel
.p2align 8
.type gated_mix__spectral_gfnet__grouped_kv_mqa__prompt_kernel,@function
gated_mix__spectral_gfnet__grouped_kv_mqa__prompt_kernel:
    s_cmp_ge_u32 s2, 256
    s_cbranch_scc1 k_end
    s_load_dwordx4 s[4:7], s[0:1], 0
    s_load_dwordx2 s[10:11], s[0:1], 88
    s_load_dwordx8 s[12:19], s[0:1], 32
    s_load_dwordx2 s[8:9], s[0:1], 16
    s_load_dwordx4 s[20:23], s[0:1], 64
    s_getpc_b64 s[44:45]
.Lpc0:
    s_lshr_b32 s54, s2, 3
    s_lshl_b32 s54, s54, 10
    v_lshlrev_b32 v254, 7, v0
    s_mov_b32 s46, k_end-.Lpc0
    s_mov_b32 s47, 0x20000
    v_cmp_gt_u32 vcc, 8, v0
    s_and_saveexec_b64 s[56:57], vcc
    s_cbranch_execz k_nc
    buffer_load_dword v255, v254, s[44:47], s54 offen
k_nc:
    s_mov_b64 exec, -1
    v_lshrrev_b32 v1, 6, v0
    s_and_b32 s52, s2, 7
    s_lshl_b32 s52, s52, 1
    s_bfe_u32 s53, s2, 0x10003
    s_or_b32 s52, s52, s53
    s_and_b32 s53, s2, 16
    s_or_b32 s52, s52, s53
    s_lshr_b32 s53, s2, 5
    v_readfirstlane_b32 s3, v1
    v_and_b32 v1, 63, v0
    v_lshlrev_b32 v254, 7, v1
    v_mov_b32 v10, 161280
    v_mov_b32 v11, 1
    s_waitcnt lgkmcnt(0)
    s_mov_b32 s0, 32768
    s_mov_b32 s24, s4
    s_mov_b32 s25, s5
    s_mov_b32 s26, 2359296
    s_mov_b32 s27, 0x20000
    s_mov_b32 s32, s10
    s_mov_b32 s33, s11
    s_mov_b32 s34, 12263424
    s_mov_b32 s35, 0x20000
    s_cmp_ge_u32 s3, 4
    s_cbranch_scc1 k_aux
    s_mul_i32 s60, s52, 73728
    s_mul_i32 s61, s53, 9216
    s_add_u32 s61, s61, s60
    s_mul_i32 s62, s3, 2304
    s_add_u32 s61, s61, s62
    s_mov_b64 exec, 0x3ffff
    buffer_load_dword v255, v254, s[24:27], s61 offen nt
    s_mov_b64 exec, -1
    s_lshr_b32 s61, s53, 1
    s_cmp_eq_u32 s61, s3
    s_cselect_b32 s99, 1, 0
    s_mov_b32 s98, 0
    v_lshlrev_b32 v8, 4, v1
    s_setprio 2
    s_cmp_eq_u32 s99, 1
    s_cbranch_scc0 m_nokv
    s_setprio 3
m_nokv:
    s_mul_i32 s61, s3, 18432
    s_add_u32 s56, s60, s61
    s_mul_i32 s57, s3, 10240
    s_add_u32 s57, s57, 120192
    v_and_b32 v2, 15, v1
    v_lshrrev_b32 v3, 4, v1
    v_xor_b32 v12, v2, v3
    v_lshlrev_b32 v12, 4, v12
    v_mul_u32_u24 v13, 1152, v3
    v_xor_b32 v20, 0, v12
    v_add_u32 v14, 0, v13
    v_add_u32 v16, v14, v20
    v_xor_b32 v21, 64, v12
    v_add_u32 v14, 4608, v13
    v_add_u32 v17, v14, v21
    v_xor_b32 v22, 128, v12
    v_add_u32 v14, 9216, v13
    v_add_u32 v18, v14, v22
    v_xor_b32 v23, 192, v12
    v_add_u32 v14, 13824, v13
    v_add_u32 v19, v14, v23
    v_lshrrev_b32 v13, 3, v1
    v_and_b32 v14, 7, v1
    v_xor_b32 v14, v14, v13
    v_mul_u32_u24 v13, 1152, v13
    v_lshl_add_u32 v24, v14, 4, v13
    v_and_b32 v2, 15, v1
    v_lshrrev_b32 v3, 4, v1
    s_lshl_b32 s60, s52, 6
    s_lshl_b32 s61, s3, 4
    s_add_u32 s60, s60, s61
    v_add_u32 v4, s60, v2
    v_mul_u32_u24 v5, 1152, v4
    v_lshl_add_u32 v6, v3, 4, v5
    s_cmp_eq_u32 s99, 1
    s_cbranch_scc0 m_nokv2
    s_add_u32 s58, s56, 0
    s_add_u32 m0, s57, 0
    s_nop 0
    buffer_load_dwordx4 v16, s[24:27], s58 offen lds
    s_add_u32 m0, s57, 1024
    s_nop 0
    buffer_load_dwordx4 v17, s[24:27], s58 offen lds
    s_add_u32 m0, s57, 2048
    s_nop 0
    buffer_load_dwordx4 v18, s[24:27], s58 offen lds
    s_add_u32 m0, s57, 3072
    s_nop 0
    buffer_load_dwordx4 v19, s[24:27], s58 offen lds
    s_add_u32 s58, s56, 256
    s_add_u32 m0, s57, 4096
    s_nop 0
    buffer_load_dwordx4 v16, s[24:27], s58 offen lds
    s_add_u32 m0, s57, 5120
    s_nop 0
    buffer_load_dwordx4 v17, s[24:27], s58 offen lds
    s_add_u32 m0, s57, 6144
    s_nop 0
    buffer_load_dwordx4 v18, s[24:27], s58 offen lds
    s_add_u32 m0, s57, 7168
    s_nop 0
    buffer_load_dwordx4 v19, s[24:27], s58 offen lds
    s_add_u32 s58, s56, 1024
    s_add_u32 m0, s57, 8192
    s_nop 0
    buffer_load_dwordx4 v24, s[24:27], s58 offen lds
    s_add_u32 s58, s56, 10240
    s_add_u32 m0, s57, 9216
    s_nop 0
    buffer_load_dwordx4 v24, s[24:27], s58 offen lds
    buffer_load_dwordx4 v[96:99], v6, s[24:27], 0 offen offset:512
    buffer_load_dwordx4 v[100:103], v6, s[24:27], 0 offen offset:576
    buffer_load_dwordx4 v[104:107], v6, s[24:27], 0 offen offset:640
    buffer_load_dwordx4 v[108:111], v6, s[24:27], 0 offen offset:704
    buffer_load_dwordx4 v[112:115], v6, s[24:27], 0 offen offset:768
    buffer_load_dwordx4 v[116:119], v6, s[24:27], 0 offen offset:832
    buffer_load_dwordx4 v[120:123], v6, s[24:27], 0 offen offset:896
    buffer_load_dwordx4 v[124:127], v6, s[24:27], 0 offen offset:960
m_nokv2:
    v_mov_b32 v12, 0
    v_lshl_add_u32 v13, v1, 2, v10
    ds_write_b32 v13, v12
    v_lshl_add_u32 v13, v2, 8, s57
    v_add_u32 v20, v20, v13
    v_add_u32 v21, v21, v13
    v_add_u32 v22, v22, v13
    v_add_u32 v23, v23, v13
    v_and_b32 v12, 7, v2
    v_xor_b32 v12, v12, v3
    v_lshlrev_b32 v12, 4, v12
    v_lshl_add_u32 v13, v2, 7, s57
    v_add_u32 v25, v12, v13
    v_xor_b32 v12, 64, v12
    v_add_u32 v26, v12, v13
    s_waitcnt lgkmcnt(0)
    s_barrier
    s_load_dword s100, s[10:11], 172032
    v_mul_u32_u24 v7, 23168, v3
    v_lshrrev_b32 v12, 2, v2
    v_mul_u32_u24 v12, 160, v12
    v_and_b32 v13, 3, v1
    v_lshl_add_u32 v12, v13, 3, v12
    v_add_u32 v12, 27648, v12
    v_add_u32 v7, v7, v12
    v_mov_b32 v27, v10
    s_cmp_eq_u32 s99, 1
    s_cbranch_scc1 m_kv
    s_lshr_b32 s62, s53, 1
    s_add_u32 s62, s62, 3
    s_and_b32 s62, s62, 3
    s_mul_i32 s62, s62, 10240
    s_add_u32 s62, s62, 120192
    s_mul_i32 s60, s3, 2560
    s_add_u32 s60, s60, s62
    v_mul_u32_u24 v12, 160, v2
    v_lshl_add_u32 v12, v3, 3, v12
    v_add_u32 v60, s60, v12
    s_mul_i32 s60, s53, 144
    s_min_u32 s61, s60, 992
    s_sub_u32 s60, s60, s61
    s_mul_i32 s61, s3, 36
    s_add_u32 s60, s60, s61
    s_add_u32 s60, s60, s62
    v_and_b32 v13, 31, v1
    v_lshrrev_b32 v14, 5, v1
    v_mul_u32_u24 v12, 160, v13
    v_lshl_add_u32 v12, v14, 4, v12
    v_add_u32 v61, s60, v12
    v_add_u32 v62, 5120, v61
    v_mul_u32_u24 v12, 160, v1
    v_add_u32 v63, s60, v12
    v_cmp_lt_u32 vcc, 18, v13
    v_mul_u32_u24 v12, 304, v14
    v_lshl_add_u32 v9, v13, 4, v12
    v_add_u32 v9, 4608, v9
    v_mov_b32 v12, 0x30000
    v_cndmask_b32 v9, v9, v12, vcc
    v_lshlrev_b32 v12, 4, v2
    v_lshl_add_u32 v12, v14, 10, v12
    v_and_b32 v13, 1, v3
    v_lshl_add_u32 v252, v13, 14, v12
    v_lshlrev_b32 v253, 2, v1
    s_lshl_b32 s60, s53, 2
    s_add_u32 s60, s60, s3
    s_lshr_b32 s48, s60, 3
    s_lshl_b32 s48, s48, 12
    s_and_b32 s62, s60, 1
    s_lshl_b32 s62, s62, 11
    s_add_u32 s48, s48, s62
    s_bfe_u32 s62, s60, 0x20001
    s_lshl_b32 s62, s62, 8
    s_add_u32 s48, s48, s62
    s_mul_i32 s51, s52, 73728
    s_add_u32 s51, s51, 458752
    s_add_u32 s48, s48, s51
    s_add_u32 s49, s48, 32768
    s_lshl_b32 s50, s60, 8
    s_add_u32 s50, s50, s51
    s_add_u32 s50, s50, 65536
    v_mov_b32 v200, 0
    v_mov_b32 v201, 0
    v_mov_b32 v202, 0
    v_mov_b32 v203, 0
    v_mov_b32 v204, 0
    v_mov_b32 v205, 0
    v_mov_b32 v206, 0
    v_mov_b32 v207, 0
    v_mov_b32 v208, 0
    v_mov_b32 v209, 0
    v_mov_b32 v210, 0
    v_mov_b32 v211, 0
    v_mov_b32 v212, 0
    v_mov_b32 v213, 0
    v_mov_b32 v214, 0
    v_mov_b32 v215, 0
    v_mov_b32 v216, 0
    v_mov_b32 v217, 0
    v_mov_b32 v218, 0
    v_mov_b32 v219, 0
    v_mov_b32 v220, 0
    v_mov_b32 v221, 0
    v_mov_b32 v222, 0
    v_mov_b32 v223, 0
    v_mov_b32 v224, 0
    v_mov_b32 v225, 0
    v_mov_b32 v226, 0
    v_mov_b32 v227, 0
    v_mov_b32 v228, 0
    v_mov_b32 v229, 0
    v_mov_b32 v230, 0
    v_mov_b32 v231, 0
    v_mov_b32 v244, 0
    v_mov_b32 v245, 0
    v_mov_b32 v246, 0
    v_mov_b32 v247, 0
    v_mov_b32 v29, 0
    v_mov_b32 v30, 0
    s_add_u32 s58, s56, 0
    s_add_u32 m0, s57, 0
    s_nop 0
    buffer_load_dwordx4 v16, s[24:27], s58 offen lds
    s_add_u32 m0, s57, 1024
    s_nop 0
    buffer_load_dwordx4 v17, s[24:27], s58 offen lds
    s_add_u32 m0, s57, 2048
    s_nop 0
    buffer_load_dwordx4 v18, s[24:27], s58 offen lds
    s_add_u32 m0, s57, 3072
    s_nop 0
    buffer_load_dwordx4 v19, s[24:27], s58 offen lds
    s_add_u32 s58, s56, 256
    s_add_u32 m0, s57, 4096
    s_nop 0
    buffer_load_dwordx4 v16, s[24:27], s58 offen lds
    s_add_u32 m0, s57, 5120
    s_nop 0
    buffer_load_dwordx4 v17, s[24:27], s58 offen lds
    s_add_u32 m0, s57, 6144
    s_nop 0
    buffer_load_dwordx4 v18, s[24:27], s58 offen lds
    s_add_u32 m0, s57, 7168
    s_nop 0
    buffer_load_dwordx4 v19, s[24:27], s58 offen lds
    s_add_u32 s58, s56, 1024
    s_add_u32 m0, s57, 8192
    s_nop 0
    buffer_load_dwordx4 v24, s[24:27], s58 offen lds
    s_add_u32 s58, s56, 10240
    s_add_u32 m0, s57, 9216
    s_nop 0
    buffer_load_dwordx4 v24, s[24:27], s58 offen lds
    s_waitcnt vmcnt(6)
    ds_read_b128 v[64:67], v20 offset:0
    ds_read_b128 v[68:71], v21 offset:0
    ds_read_b128 v[72:75], v22 offset:0
    ds_read_b128 v[76:79], v23 offset:0
    s_waitcnt lgkmcnt(0)
    s_add_u32 s58, s56, 512
    s_add_u32 m0, s57, 0
    s_nop 0
    buffer_load_dwordx4 v16, s[24:27], s58 offen lds
    s_add_u32 m0, s57, 1024
    s_nop 0
    buffer_load_dwordx4 v17, s[24:27], s58 offen lds
    s_add_u32 m0, s57, 2048
    s_nop 0
    buffer_load_dwordx4 v18, s[24:27], s58 offen lds
    s_add_u32 m0, s57, 3072
    s_nop 0
    buffer_load_dwordx4 v19, s[24:27], s58 offen lds
    s_waitcnt vmcnt(6)
    ds_read_b128 v[80:83], v20 offset:4096
    ds_read_b128 v[84:87], v21 offset:4096
    ds_read_b128 v[88:91], v22 offset:4096
    ds_read_b128 v[92:95], v23 offset:4096
    s_waitcnt lgkmcnt(0)
    s_add_u32 s58, s56, 768
    s_add_u32 m0, s57, 4096
    s_nop 0
    buffer_load_dwordx4 v16, s[24:27], s58 offen lds
    s_add_u32 m0, s57, 5120
    s_nop 0
    buffer_load_dwordx4 v17, s[24:27], s58 offen lds
    s_add_u32 m0, s57, 6144
    s_nop 0
    buffer_load_dwordx4 v18, s[24:27], s58 offen lds
    s_add_u32 m0, s57, 7168
    s_nop 0
    buffer_load_dwordx4 v19, s[24:27], s58 offen lds
    s_waitcnt vmcnt(8)
    ds_read_b128 v[128:131], v25 offset:8192
    ds_read_b128 v[132:135], v26 offset:8192
    s_branch gemm
m_kv:
    s_lshr_b32 s44, s52, 1
    s_mul_i32 s44, s44, 9472
    s_and_b32 s61, s52, 1
    s_lshl_b32 s61, s61, 2
    s_add_u32 s61, s61, s3
    s_mul_i32 s45, s61, 608
    s_add_u32 s45, s45, s44
    s_add_u32 s45, s45, 4608
    s_lshr_b32 s61, s61, 1
    s_lshl_b32 s61, s61, 10
    s_add_u32 s61, s61, s44
    s_bitcmp1_b32 s53, 0
    s_cselect_b32 s61, s45, s61
    s_add_u32 s47, s44, 4096
    s_lshr_b32 s46, s2, 2
    s_lshl_b32 s46, s46, 7
    s_and_b32 s62, s2, 3
    s_lshl_b32 s62, s62, 3
    s_add_u32 s46, s46, s62
    s_add_u32 s46, s46, 196608
    v_lshrrev_b32 v12, 2, v2
    v_lshl_add_u32 v12, v3, 3, v12
    v_mul_u32_u24 v12, 48, v12
    v_and_b32 v13, 3, v1
    v_lshl_add_u32 v15, v13, 3, v12
    v_bfe_u32 v12, v4, 5, 2
    v_and_b32 v41, 31, v4
    v_lshlrev_b32 v41, 4, v41
    v_lshl_add_u32 v40, v12, 10, v41
    v_lshl_add_u32 v41, v12, 2, v41
    v_lshrrev_b32 v12, 1, v3
    v_lshl_add_u32 v40, v12, 9, v40
    v_and_b32 v12, 1, v3
    v_lshl_add_u32 v40, v12, 3, v40
    v_bfe_u32 v42, v2, 2, 1
    v_mul_u32_u24 v42, 304, v42
    v_lshrrev_b32 v12, 3, v2
    v_lshl_add_u32 v42, v12, 3, v42
    v_lshl_add_u32 v42, v13, 1, v42
    v_lshl_add_u32 v43, v3, 6, v42
    v_bfe_u32 v44, v1, 2, 1
    v_mul_u32_u24 v44, 304, v44
    v_lshl_add_u32 v44, v13, 2, v44
    v_mov_b32 v45, 0x3f803f80
    v_mov_b32 v46, 0x7f800000
    v_mov_b32 v47, 0x3eae1a93
    s_waitcnt vmcnt(14)
    ds_read_b128 v[64:67], v20 offset:0
    ds_read_b128 v[68:71], v21 offset:0
    ds_read_b128 v[72:75], v22 offset:0
    ds_read_b128 v[76:79], v23 offset:0
    s_waitcnt vmcnt(10)
    ds_read_b128 v[80:83], v20 offset:4096
    ds_read_b128 v[84:87], v21 offset:4096
    ds_read_b128 v[88:91], v22 offset:4096
    ds_read_b128 v[92:95], v23 offset:4096
    s_waitcnt vmcnt(8)
    ds_read_b128 v[128:131], v25 offset:8192
    ds_read_b128 v[132:135], v26 offset:8192
    s_waitcnt vmcnt(0) lgkmcnt(0)
    s_mov_b64 exec, 1
    ds_add_u32 v10, v11 offset:108
    s_mov_b64 exec, -1
kv_in:
    ds_read_b32 v14, v10 offset:40
    s_waitcnt lgkmcnt(0)
    v_readfirstlane_b32 s66, v14
    s_cmp_ge_u32 s66, 4
    s_cbranch_scc1 kv_in_ok
    s_sleep 0
    s_sub_i32 s0, s0, 1
    s_cmp_lt_i32 s0, 0
    s_cbranch_scc0 kv_in
kv_in_ok:
    ds_read_b64_tr_b16 v[164:165], v15 offset:0
    ds_read_b64_tr_b16 v[166:167], v15 offset:192
    ds_read_b64_tr_b16 v[168:169], v15 offset:32
    ds_read_b64_tr_b16 v[170:171], v15 offset:224
    ds_read_b64_tr_b16 v[172:173], v15 offset:1536
    ds_read_b64_tr_b16 v[174:175], v15 offset:1728
    ds_read_b64_tr_b16 v[176:177], v15 offset:1568
    ds_read_b64_tr_b16 v[178:179], v15 offset:1760
    ds_read_b64_tr_b16 v[180:181], v15 offset:3072
    ds_read_b64_tr_b16 v[182:183], v15 offset:3264
    ds_read_b64_tr_b16 v[184:185], v15 offset:3104
    ds_read_b64_tr_b16 v[186:187], v15 offset:3296
    ds_read_b64_tr_b16 v[188:189], v15 offset:4608
    ds_read_b64_tr_b16 v[190:191], v15 offset:4800
    s_waitcnt lgkmcnt(12)
    v_mfma_f32_16x16x32_bf16 v[156:159], v[164:167], v[64:67], 0
    s_waitcnt lgkmcnt(10)
    ds_read_b64_tr_b16 v[192:193], v15 offset:4640
    ds_read_b64_tr_b16 v[194:195], v15 offset:4832
    v_mfma_f32_16x16x32_bf16 v[160:163], v[168:171], v[64:67], 0
    s_waitcnt lgkmcnt(10)
    ds_read_b64_tr_b16 v[164:165], v15 offset:6144
    ds_read_b64_tr_b16 v[166:167], v15 offset:6336
    v_mfma_f32_16x16x32_bf16 v[156:159], v[172:175], v[68:71], v[156:159]
    s_waitcnt lgkmcnt(10)
    ds_read_b64_tr_b16 v[168:169], v15 offset:6176
    ds_read_b64_tr_b16 v[170:171], v15 offset:6368
    v_mfma_f32_16x16x32_bf16 v[160:163], v[176:179], v[68:71], v[160:163]
    s_waitcnt lgkmcnt(10)
    ds_read_b64_tr_b16 v[172:173], v15 offset:7680
    ds_read_b64_tr_b16 v[174:175], v15 offset:7872
    v_mfma_f32_16x16x32_bf16 v[156:159], v[180:183], v[72:75], v[156:159]
    s_waitcnt lgkmcnt(10)
    ds_read_b64_tr_b16 v[176:177], v15 offset:7712
    ds_read_b64_tr_b16 v[178:179], v15 offset:7904
    v_mfma_f32_16x16x32_bf16 v[160:163], v[184:187], v[72:75], v[160:163]
    s_waitcnt lgkmcnt(10)
    ds_read_b64_tr_b16 v[180:181], v15 offset:9216
    ds_read_b64_tr_b16 v[182:183], v15 offset:9408
    v_mfma_f32_16x16x32_bf16 v[156:159], v[188:191], v[76:79], v[156:159]
    s_waitcnt lgkmcnt(10)
    ds_read_b64_tr_b16 v[184:185], v15 offset:9248
    ds_read_b64_tr_b16 v[186:187], v15 offset:9440
    v_mfma_f32_16x16x32_bf16 v[160:163], v[192:195], v[76:79], v[160:163]
    s_waitcnt lgkmcnt(10)
    ds_read_b64_tr_b16 v[188:189], v15 offset:10752
    ds_read_b64_tr_b16 v[190:191], v15 offset:10944
    v_mfma_f32_16x16x32_bf16 v[156:159], v[164:167], v[80:83], v[156:159]
    s_waitcnt lgkmcnt(10)
    ds_read_b64_tr_b16 v[192:193], v15 offset:10784
    ds_read_b64_tr_b16 v[194:195], v15 offset:10976
    v_mfma_f32_16x16x32_bf16 v[160:163], v[168:171], v[80:83], v[160:163]
    s_waitcnt lgkmcnt(10)
    ds_read_b64_tr_b16 v[164:165], v15 offset:12288
    ds_read_b64_tr_b16 v[166:167], v15 offset:12480
    v_mfma_f32_16x16x32_bf16 v[156:159], v[172:175], v[84:87], v[156:159]
    s_waitcnt lgkmcnt(10)
    ds_read_b64_tr_b16 v[168:169], v15 offset:12320
    ds_read_b64_tr_b16 v[170:171], v15 offset:12512
    v_mfma_f32_16x16x32_bf16 v[160:163], v[176:179], v[84:87], v[160:163]
    s_waitcnt lgkmcnt(10)
    ds_read_b64_tr_b16 v[172:173], v15 offset:13824
    ds_read_b64_tr_b16 v[174:175], v15 offset:14016
    v_mfma_f32_16x16x32_bf16 v[156:159], v[180:183], v[88:91], v[156:159]
    s_waitcnt lgkmcnt(10)
    ds_read_b64_tr_b16 v[176:177], v15 offset:13856
    ds_read_b64_tr_b16 v[178:179], v15 offset:14048
    v_mfma_f32_16x16x32_bf16 v[160:163], v[184:187], v[88:91], v[160:163]
    s_waitcnt lgkmcnt(10)
    ds_read_b64_tr_b16 v[180:181], v15 offset:15360
    ds_read_b64_tr_b16 v[182:183], v15 offset:15552
    v_mfma_f32_16x16x32_bf16 v[156:159], v[188:191], v[92:95], v[156:159]
    s_waitcnt lgkmcnt(10)
    ds_read_b64_tr_b16 v[184:185], v15 offset:15392
    ds_read_b64_tr_b16 v[186:187], v15 offset:15584
    v_mfma_f32_16x16x32_bf16 v[160:163], v[192:195], v[92:95], v[160:163]
    s_waitcnt lgkmcnt(10)
    ds_read_b64_tr_b16 v[188:189], v15 offset:16896
    ds_read_b64_tr_b16 v[190:191], v15 offset:17088
    v_mfma_f32_16x16x32_bf16 v[156:159], v[164:167], v[96:99], v[156:159]
    s_waitcnt lgkmcnt(10)
    ds_read_b64_tr_b16 v[192:193], v15 offset:16928
    ds_read_b64_tr_b16 v[194:195], v15 offset:17120
    v_mfma_f32_16x16x32_bf16 v[160:163], v[168:171], v[96:99], v[160:163]
    s_waitcnt lgkmcnt(10)
    ds_read_b64_tr_b16 v[164:165], v15 offset:18432
    ds_read_b64_tr_b16 v[166:167], v15 offset:18624
    v_mfma_f32_16x16x32_bf16 v[156:159], v[172:175], v[100:103], v[156:159]
    s_waitcnt lgkmcnt(10)
    ds_read_b64_tr_b16 v[168:169], v15 offset:18464
    ds_read_b64_tr_b16 v[170:171], v15 offset:18656
    v_mfma_f32_16x16x32_bf16 v[160:163], v[176:179], v[100:103], v[160:163]
    s_waitcnt lgkmcnt(10)
    ds_read_b64_tr_b16 v[172:173], v15 offset:19968
    ds_read_b64_tr_b16 v[174:175], v15 offset:20160
    v_mfma_f32_16x16x32_bf16 v[156:159], v[180:183], v[104:107], v[156:159]
    s_waitcnt lgkmcnt(10)
    ds_read_b64_tr_b16 v[176:177], v15 offset:20000
    ds_read_b64_tr_b16 v[178:179], v15 offset:20192
    v_mfma_f32_16x16x32_bf16 v[160:163], v[184:187], v[104:107], v[160:163]
    s_waitcnt lgkmcnt(10)
    ds_read_b64_tr_b16 v[180:181], v15 offset:21504
    ds_read_b64_tr_b16 v[182:183], v15 offset:21696
    v_mfma_f32_16x16x32_bf16 v[156:159], v[188:191], v[108:111], v[156:159]
    s_waitcnt lgkmcnt(10)
    ds_read_b64_tr_b16 v[184:185], v15 offset:21536
    ds_read_b64_tr_b16 v[186:187], v15 offset:21728
    v_mfma_f32_16x16x32_bf16 v[160:163], v[192:195], v[108:111], v[160:163]
    s_waitcnt lgkmcnt(10)
    ds_read_b64_tr_b16 v[188:189], v15 offset:23040
    ds_read_b64_tr_b16 v[190:191], v15 offset:23232
    v_mfma_f32_16x16x32_bf16 v[156:159], v[164:167], v[112:115], v[156:159]
    s_waitcnt lgkmcnt(10)
    ds_read_b64_tr_b16 v[192:193], v15 offset:23072
    ds_read_b64_tr_b16 v[194:195], v15 offset:23264
    v_mfma_f32_16x16x32_bf16 v[160:163], v[168:171], v[112:115], v[160:163]
    s_waitcnt lgkmcnt(10)
    ds_read_b64_tr_b16 v[164:165], v15 offset:24576
    ds_read_b64_tr_b16 v[166:167], v15 offset:24768
    v_mfma_f32_16x16x32_bf16 v[156:159], v[172:175], v[116:119], v[156:159]
    s_waitcnt lgkmcnt(10)
    ds_read_b64_tr_b16 v[168:169], v15 offset:24608
    ds_read_b64_tr_b16 v[170:171], v15 offset:24800
    v_mfma_f32_16x16x32_bf16 v[160:163], v[176:179], v[116:119], v[160:163]
    s_waitcnt lgkmcnt(10)
    ds_read_b64_tr_b16 v[172:173], v15 offset:26112
    ds_read_b64_tr_b16 v[174:175], v15 offset:26304
    v_mfma_f32_16x16x32_bf16 v[156:159], v[180:183], v[120:123], v[156:159]
    s_waitcnt lgkmcnt(10)
    ds_read_b64_tr_b16 v[176:177], v15 offset:26144
    ds_read_b64_tr_b16 v[178:179], v15 offset:26336
    v_mfma_f32_16x16x32_bf16 v[160:163], v[184:187], v[120:123], v[160:163]
    s_waitcnt lgkmcnt(10)
    v_mfma_f32_16x16x32_bf16 v[156:159], v[188:191], v[124:127], v[156:159]
    s_waitcnt lgkmcnt(8)
    v_mfma_f32_16x16x32_bf16 v[160:163], v[192:195], v[124:127], v[160:163]
    s_waitcnt lgkmcnt(6)
    v_mfma_f32_16x16x32_bf16 v[156:159], v[164:167], v[128:131], v[156:159]
    s_waitcnt lgkmcnt(4)
    v_mfma_f32_16x16x32_bf16 v[160:163], v[168:171], v[128:131], v[160:163]
    s_waitcnt lgkmcnt(2)
    v_mfma_f32_16x16x32_bf16 v[156:159], v[172:175], v[132:135], v[156:159]
    s_waitcnt lgkmcnt(0)
    v_mfma_f32_16x16x32_bf16 v[160:163], v[176:179], v[132:135], v[160:163]
    s_add_u32 s68, s100, 1
    v_cmp_eq_u32 vcc, 1, v3
    v_mov_b32 v14, 0
    s_bitcmp1_b32 s53, 0
    s_cbranch_scc1 kv_v
    s_nop 0
    v_mul_f32 v156, v47, v156
    v_mul_f32 v157, v47, v157
    v_mul_f32 v158, v47, v158
    v_mul_f32 v159, v47, v159
    v_mul_f32 v162, v47, v162
    v_mul_f32 v163, v47, v163
    v_cvt_pk_bf16_f32 v32, v156, v157
    v_cvt_pk_bf16_f32 v33, v158, v159
    v_cvt_pk_bf16_f32 v34, v162, v163
    buffer_store_dwordx2 v[32:33], v40, s[32:35], s44 offen sc1
    s_mov_b64 exec, 0xffff0000
    buffer_store_dword v34, v41, s[32:35], s47 offen sc1
    s_mov_b64 exec, -1
    v_mul_f32 v12, v156, v156
    v_fmac_f32 v12, v157, v157
    v_fmac_f32 v12, v158, v158
    v_fmac_f32 v12, v159, v159
    v_mul_f32 v13, v162, v162
    v_fmac_f32 v13, v163, v163
    v_cndmask_b32 v13, 0, v13, vcc
    v_add_f32 v12, v12, v13
    v_mov_b32 v13, v12
    s_nop 1
    v_permlane16_swap_b32 v12, v13
    v_add_f32 v12, v12, v13
    v_mov_b32 v13, v12
    s_nop 1
    v_permlane32_swap_b32 v12, v13
    v_add_f32 v12, v12, v13
    v_cmp_o_f32 vcc, v12, v12
    s_nop 1
    v_cndmask_b32 v12, v46, v12, vcc
    s_nop 1
    v_max_f32_dpp v12, v12, v12 row_ror:8 row_mask:0xf bank_mask:0xf
    s_nop 1
    v_max_f32_dpp v12, v12, v12 row_ror:4 row_mask:0xf bank_mask:0xf
    s_nop 1
    v_max_f32_dpp v12, v12, v12 row_ror:2 row_mask:0xf bank_mask:0xf
    s_nop 1
    v_max_f32_dpp v12, v12, v12 row_ror:1 row_mask:0xf bank_mask:0xf
    s_branch kv_done
kv_v:
    ds_write_b32 v44, v45 offset:288
    v_cvt_pk_bf16_f32 v32, v156, v157
    v_cvt_pk_bf16_f32 v33, v158, v159
    v_cvt_pk_bf16_f32 v34, v162, v163
    ds_write_b16 v43, v32 offset:0
    ds_write_b16_d16_hi v43, v32 offset:16
    ds_write_b16 v43, v33 offset:32
    ds_write_b16_d16_hi v43, v33 offset:48
    s_mov_b64 exec, 0xffff0000
    ds_write_b16 v42, v34 offset:256
    ds_write_b16_d16_hi v42, v34 offset:272
    s_mov_b64 exec, -1
    ds_read_b128 v[36:39], v8 offset:0
    v_max3_f32 v12, |v156|, |v157|, |v158|
    v_max3_f32 v13, |v159|, |v162|, |v163|
    v_cndmask_b32 v13, |v159|, v13, vcc
    v_max_f32 v12, v12, v13
    v_cmp_gt_f32 vcc, 0x5d800000, v12
    s_mov_b32 exec_hi, 0x3f
    s_waitcnt lgkmcnt(0)
    buffer_store_dwordx4 v[36:39], v8, s[32:35], s45 offen sc1
    s_mov_b64 exec, -1
    s_cmp_eq_u64 vcc, exec
    s_cselect_b32 s61, 0, 0x7f800000
    v_mov_b32 v12, s61
kv_done:
    v_mov_b32 v32, v12
    s_lshr_b32 s62, s53, 1
    s_add_u32 s62, s62, 3
    s_and_b32 s62, s62, 3
    s_mul_i32 s62, s62, 10240
    s_add_u32 s62, s62, 120192
    s_mul_i32 s60, s3, 2560
    s_add_u32 s60, s60, s62
    v_mul_u32_u24 v12, 160, v2
    v_lshl_add_u32 v12, v3, 3, v12
    v_add_u32 v60, s60, v12
    s_mul_i32 s60, s53, 144
    s_min_u32 s61, s60, 992
    s_sub_u32 s60, s60, s61
    s_mul_i32 s61, s3, 36
    s_add_u32 s60, s60, s61
    s_add_u32 s60, s60, s62
    v_and_b32 v13, 31, v1
    v_lshrrev_b32 v14, 5, v1
    v_mul_u32_u24 v12, 160, v13
    v_lshl_add_u32 v12, v14, 4, v12
    v_add_u32 v61, s60, v12
    v_add_u32 v62, 5120, v61
    v_mul_u32_u24 v12, 160, v1
    v_add_u32 v63, s60, v12
    v_cmp_lt_u32 vcc, 18, v13
    v_mul_u32_u24 v12, 304, v14
    v_lshl_add_u32 v9, v13, 4, v12
    v_add_u32 v9, 4608, v9
    v_mov_b32 v12, 0x30000
    v_cndmask_b32 v9, v9, v12, vcc
    v_lshlrev_b32 v12, 4, v2
    v_lshl_add_u32 v12, v14, 10, v12
    v_and_b32 v13, 1, v3
    v_lshl_add_u32 v252, v13, 14, v12
    v_lshlrev_b32 v253, 2, v1
    s_lshl_b32 s60, s53, 2
    s_add_u32 s60, s60, s3
    s_lshr_b32 s48, s60, 3
    s_lshl_b32 s48, s48, 12
    s_and_b32 s62, s60, 1
    s_lshl_b32 s62, s62, 11
    s_add_u32 s48, s48, s62
    s_bfe_u32 s62, s60, 0x20001
    s_lshl_b32 s62, s62, 8
    s_add_u32 s48, s48, s62
    s_mul_i32 s51, s52, 73728
    s_add_u32 s51, s51, 458752
    s_add_u32 s48, s48, s51
    s_add_u32 s49, s48, 32768
    s_lshl_b32 s50, s60, 8
    s_add_u32 s50, s50, s51
    s_add_u32 s50, s50, 65536
    v_mov_b32 v200, 0
    v_mov_b32 v201, 0
    v_mov_b32 v202, 0
    v_mov_b32 v203, 0
    v_mov_b32 v204, 0
    v_mov_b32 v205, 0
    v_mov_b32 v206, 0
    v_mov_b32 v207, 0
    v_mov_b32 v208, 0
    v_mov_b32 v209, 0
    v_mov_b32 v210, 0
    v_mov_b32 v211, 0
    v_mov_b32 v212, 0
    v_mov_b32 v213, 0
    v_mov_b32 v214, 0
    v_mov_b32 v215, 0
    v_mov_b32 v216, 0
    v_mov_b32 v217, 0
    v_mov_b32 v218, 0
    v_mov_b32 v219, 0
    v_mov_b32 v220, 0
    v_mov_b32 v221, 0
    v_mov_b32 v222, 0
    v_mov_b32 v223, 0
    v_mov_b32 v224, 0
    v_mov_b32 v225, 0
    v_mov_b32 v226, 0
    v_mov_b32 v227, 0
    v_mov_b32 v228, 0
    v_mov_b32 v229, 0
    v_mov_b32 v230, 0
    v_mov_b32 v231, 0
    v_mov_b32 v244, 0
    v_mov_b32 v245, 0
    v_mov_b32 v246, 0
    v_mov_b32 v247, 0
    v_mov_b32 v29, 0
    v_mov_b32 v30, 0
    v_mov_b32 v12, v32
    v_mov_b32 v14, 0
    v_mov_b32 v13, s68
    s_waitcnt vmcnt(0)
    s_mov_b64 exec, 1
    buffer_store_dwordx2 v[12:13], v14, s[32:35], s46 offen sc1
    s_mov_b64 exec, -1
    s_mov_b64 exec, 1
    ds_add_u32 v10, v11 offset:104
    s_mov_b64 exec, -1
    s_setprio 2
gemm:
    s_cmp_eq_u32 s98, 1
    s_cbranch_scc1 g_vm0
g_ch0:
    ds_read_b32 v14, v10 offset:44
    s_waitcnt lgkmcnt(0)
    v_readfirstlane_b32 s66, v14
    s_cmp_ge_u32 s66, 4
    s_cbranch_scc1 g_ch0_ok
    s_sleep 1
    s_sub_i32 s0, s0, 1
    s_cmp_lt_i32 s0, 0
    s_cbranch_scc0 g_ch0
g_ch0_ok:
    s_add_u32 s68, s100, 1
    s_branch g_go0
g_vm0:
    s_waitcnt vmcnt(20)
g_go0:
    ds_read_b64_tr_b16 v[164:165], v7 offset:0
    ds_read_b64_tr_b16 v[166:167], v7 offset:640
    ds_read_b64_tr_b16 v[168:169], v7 offset:32
    ds_read_b64_tr_b16 v[170:171], v7 offset:672
    ds_read_b64_tr_b16 v[172:173], v7 offset:64
    ds_read_b64_tr_b16 v[174:175], v7 offset:704
    ds_read_b64_tr_b16 v[176:177], v7 offset:96
    ds_read_b64_tr_b16 v[178:179], v7 offset:736
    ds_read_b64_tr_b16 v[180:181], v7 offset:128
    ds_read_b64_tr_b16 v[182:183], v7 offset:768
    ds_read_b64_tr_b16 v[184:185], v7 offset:1280
    ds_read_b64_tr_b16 v[186:187], v7 offset:1920
    ds_read_b64_tr_b16 v[188:189], v7 offset:1312
    ds_read_b64_tr_b16 v[190:191], v7 offset:1952
    s_waitcnt lgkmcnt(12)
    v_mfma_f32_16x16x32_bf16 v[136:139], v[164:167], v[64:67], 0
    s_waitcnt lgkmcnt(10)
    ds_read_b64_tr_b16 v[192:193], v7 offset:1344
    ds_read_b64_tr_b16 v[194:195], v7 offset:1984
    v_mfma_f32_16x16x32_bf16 v[140:143], v[168:171], v[64:67], 0
    s_waitcnt lgkmcnt(10)
    ds_read_b64_tr_b16 v[164:165], v7 offset:1376
    ds_read_b64_tr_b16 v[166:167], v7 offset:2016
    v_mfma_f32_16x16x32_bf16 v[144:147], v[172:175], v[64:67], 0
    s_waitcnt lgkmcnt(10)
    ds_read_b64_tr_b16 v[168:169], v7 offset:1408
    ds_read_b64_tr_b16 v[170:171], v7 offset:2048
    v_mfma_f32_16x16x32_bf16 v[148:151], v[176:179], v[64:67], 0
    s_waitcnt lgkmcnt(10)
    ds_read_b64_tr_b16 v[172:173], v7 offset:2560
    ds_read_b64_tr_b16 v[174:175], v7 offset:3200
    v_mfma_f32_16x16x32_bf16 v[152:155], v[180:183], v[64:67], 0
    s_waitcnt lgkmcnt(10)
    ds_read_b64_tr_b16 v[176:177], v7 offset:2592
    ds_read_b64_tr_b16 v[178:179], v7 offset:3232
    v_mfma_f32_16x16x32_bf16 v[136:139], v[184:187], v[68:71], v[136:139]
    s_waitcnt lgkmcnt(10)
    ds_read_b64_tr_b16 v[180:181], v7 offset:2624
    ds_read_b64_tr_b16 v[182:183], v7 offset:3264
    v_mfma_f32_16x16x32_bf16 v[140:143], v[188:191], v[68:71], v[140:143]
    s_waitcnt lgkmcnt(10)
    ds_read_b32 v14, v27 offset:48
    ds_read_b64_tr_b16 v[184:185], v7 offset:2656
    ds_read_b64_tr_b16 v[186:187], v7 offset:3296
    v_mfma_f32_16x16x32_bf16 v[144:147], v[192:195], v[68:71], v[144:147]
    s_waitcnt lgkmcnt(10)
    ds_read_b64_tr_b16 v[188:189], v7 offset:2688
    ds_read_b64_tr_b16 v[190:191], v7 offset:3328
    v_mfma_f32_16x16x32_bf16 v[148:151], v[164:167], v[68:71], v[148:151]
    s_waitcnt lgkmcnt(10)
    ds_read_b64_tr_b16 v[192:193], v7 offset:3840
    ds_read_b64_tr_b16 v[194:195], v7 offset:4480
    v_mfma_f32_16x16x32_bf16 v[152:155], v[168:171], v[68:71], v[152:155]
    s_waitcnt lgkmcnt(10)
    ds_read_b64_tr_b16 v[164:165], v7 offset:3872
    ds_read_b64_tr_b16 v[166:167], v7 offset:4512
    v_mfma_f32_16x16x32_bf16 v[136:139], v[172:175], v[72:75], v[136:139]
    s_waitcnt lgkmcnt(10)
    ds_read_b64_tr_b16 v[168:169], v7 offset:3904
    ds_read_b64_tr_b16 v[170:171], v7 offset:4544
    v_mfma_f32_16x16x32_bf16 v[140:143], v[176:179], v[72:75], v[140:143]
    s_waitcnt lgkmcnt(10)
    ds_read_b64_tr_b16 v[172:173], v7 offset:3936
    ds_read_b64_tr_b16 v[174:175], v7 offset:4576
    v_mfma_f32_16x16x32_bf16 v[144:147], v[180:183], v[72:75], v[144:147]
    s_waitcnt lgkmcnt(10)
    ds_read_b64_tr_b16 v[176:177], v7 offset:3968
    ds_read_b64_tr_b16 v[178:179], v7 offset:4608
    v_mfma_f32_16x16x32_bf16 v[148:151], v[184:187], v[72:75], v[148:151]
    s_waitcnt lgkmcnt(10)
    s_cmp_eq_u32 s98, 1
    s_cbranch_scc1 g_vm1
    v_readfirstlane_b32 s66, v14
    s_cmp_ge_u32 s66, 4
    s_cbranch_scc1 g_ch1_ok
g_ch1:
    ds_read_b32 v14, v10 offset:48
    s_waitcnt lgkmcnt(0)
    v_readfirstlane_b32 s66, v14
    s_cmp_ge_u32 s66, 4
    s_cbranch_scc1 g_ch1_ok
    s_sleep 1
    s_sub_i32 s0, s0, 1
    s_cmp_lt_i32 s0, 0
    s_cbranch_scc0 g_ch1
g_ch1_ok:
    s_branch g_go1
g_vm1:
    v_readfirstlane_b32 s66, v14
    s_cmp_ge_u32 s66, 1
    s_cbranch_scc1 g_ag_ok
g_ag:
    ds_read_b32 v14, v10 offset:88
    s_waitcnt lgkmcnt(0)
    v_readfirstlane_b32 s66, v14
    s_cmp_ge_u32 s66, 1
    s_cbranch_scc1 g_ag_ok
    s_sleep 1
    s_sub_i32 s0, s0, 1
    s_cmp_lt_i32 s0, 0
    s_cbranch_scc0 g_ag
g_ag_ok:
    buffer_load_dwordx2 v[48:49], v9, s[32:35], s58 offen offset:0 sc1
    buffer_load_dwordx2 v[50:51], v9, s[32:35], s58 offen offset:32 sc1
    buffer_load_dwordx2 v[52:53], v9, s[32:35], s58 offen offset:64 sc1
    buffer_load_dwordx2 v[54:55], v9, s[32:35], s58 offen offset:96 sc1
    buffer_load_dwordx2 v[56:57], v9, s[32:35], s58 offen offset:128 sc1
    buffer_load_dword v58, v15, s[32:35], s59 offen sc1
    s_waitcnt vmcnt(22)
g_go1:
    ds_read_b64_tr_b16 v[180:181], v7 offset:5120
    ds_read_b64_tr_b16 v[182:183], v7 offset:5760
    v_mfma_f32_16x16x32_bf16 v[152:155], v[188:191], v[72:75], v[152:155]
    s_waitcnt lgkmcnt(10)
    ds_read_b64_tr_b16 v[184:185], v7 offset:5152
    ds_read_b64_tr_b16 v[186:187], v7 offset:5792
    v_mfma_f32_16x16x32_bf16 v[136:139], v[192:195], v[76:79], v[136:139]
    s_waitcnt lgkmcnt(10)
    ds_read_b64_tr_b16 v[188:189], v7 offset:5184
    ds_read_b64_tr_b16 v[190:191], v7 offset:5824
    v_mfma_f32_16x16x32_bf16 v[140:143], v[164:167], v[76:79], v[140:143]
    s_waitcnt lgkmcnt(10)
    ds_read_b64_tr_b16 v[192:193], v7 offset:5216
    ds_read_b64_tr_b16 v[194:195], v7 offset:5856
    v_mfma_f32_16x16x32_bf16 v[144:147], v[168:171], v[76:79], v[144:147]
    s_waitcnt lgkmcnt(10)
    ds_read_b64_tr_b16 v[164:165], v7 offset:5248
    ds_read_b64_tr_b16 v[166:167], v7 offset:5888
    v_mfma_f32_16x16x32_bf16 v[148:151], v[172:175], v[76:79], v[148:151]
    s_waitcnt lgkmcnt(10)
    ds_read_b64_tr_b16 v[168:169], v7 offset:6400
    ds_read_b64_tr_b16 v[170:171], v7 offset:7040
    v_mfma_f32_16x16x32_bf16 v[152:155], v[176:179], v[76:79], v[152:155]
    s_waitcnt lgkmcnt(10)
    ds_read_b64_tr_b16 v[172:173], v7 offset:6432
    ds_read_b64_tr_b16 v[174:175], v7 offset:7072
    v_mfma_f32_16x16x32_bf16 v[136:139], v[180:183], v[80:83], v[136:139]
    s_waitcnt lgkmcnt(10)
    ds_read_b64_tr_b16 v[176:177], v7 offset:6464
    ds_read_b64_tr_b16 v[178:179], v7 offset:7104
    v_mfma_f32_16x16x32_bf16 v[140:143], v[184:187], v[80:83], v[140:143]
    s_waitcnt lgkmcnt(10)
    ds_read_b64_tr_b16 v[180:181], v7 offset:6496
    ds_read_b64_tr_b16 v[182:183], v7 offset:7136
    v_mfma_f32_16x16x32_bf16 v[144:147], v[188:191], v[80:83], v[144:147]
    s_waitcnt lgkmcnt(10)
    ds_read_b64_tr_b16 v[184:185], v7 offset:6528
    ds_read_b64_tr_b16 v[186:187], v7 offset:7168
    v_mfma_f32_16x16x32_bf16 v[148:151], v[192:195], v[80:83], v[148:151]
    s_waitcnt lgkmcnt(10)
    ds_read_b64_tr_b16 v[188:189], v7 offset:7680
    ds_read_b64_tr_b16 v[190:191], v7 offset:8320
    v_mfma_f32_16x16x32_bf16 v[152:155], v[164:167], v[80:83], v[152:155]
    s_waitcnt lgkmcnt(10)
    ds_read_b64_tr_b16 v[192:193], v7 offset:7712
    ds_read_b64_tr_b16 v[194:195], v7 offset:8352
    v_mfma_f32_16x16x32_bf16 v[136:139], v[168:171], v[84:87], v[136:139]
    s_waitcnt lgkmcnt(10)
    ds_read_b64_tr_b16 v[164:165], v7 offset:7744
    ds_read_b64_tr_b16 v[166:167], v7 offset:8384
    v_mfma_f32_16x16x32_bf16 v[140:143], v[172:175], v[84:87], v[140:143]
    s_waitcnt lgkmcnt(10)
    ds_read_b32 v14, v27 offset:52
    ds_read_b64_tr_b16 v[168:169], v7 offset:7776
    ds_read_b64_tr_b16 v[170:171], v7 offset:8416
    v_mfma_f32_16x16x32_bf16 v[144:147], v[176:179], v[84:87], v[144:147]
    s_waitcnt lgkmcnt(10)
    ds_read_b64_tr_b16 v[172:173], v7 offset:7808
    ds_read_b64_tr_b16 v[174:175], v7 offset:8448
    v_mfma_f32_16x16x32_bf16 v[148:151], v[180:183], v[84:87], v[148:151]
    s_waitcnt lgkmcnt(10)
    ds_read_b64_tr_b16 v[176:177], v7 offset:8960
    ds_read_b64_tr_b16 v[178:179], v7 offset:9600
    v_mfma_f32_16x16x32_bf16 v[152:155], v[184:187], v[84:87], v[152:155]
    s_waitcnt lgkmcnt(10)
    ds_read_b64_tr_b16 v[180:181], v7 offset:8992
    ds_read_b64_tr_b16 v[182:183], v7 offset:9632
    v_mfma_f32_16x16x32_bf16 v[136:139], v[188:191], v[88:91], v[136:139]
    s_waitcnt lgkmcnt(10)
    ds_read_b64_tr_b16 v[184:185], v7 offset:9024
    ds_read_b64_tr_b16 v[186:187], v7 offset:9664
    v_mfma_f32_16x16x32_bf16 v[140:143], v[192:195], v[88:91], v[140:143]
    s_waitcnt lgkmcnt(10)
    ds_read_b64_tr_b16 v[188:189], v7 offset:9056
    ds_read_b64_tr_b16 v[190:191], v7 offset:9696
    v_mfma_f32_16x16x32_bf16 v[144:147], v[164:167], v[88:91], v[144:147]
    s_waitcnt lgkmcnt(10)
    ds_read_b64_tr_b16 v[192:193], v7 offset:9088
    ds_read_b64_tr_b16 v[194:195], v7 offset:9728
    v_mfma_f32_16x16x32_bf16 v[148:151], v[168:171], v[88:91], v[148:151]
    s_waitcnt lgkmcnt(10)
    s_cmp_eq_u32 s98, 1
    s_cbranch_scc1 g_vm2
    v_readfirstlane_b32 s66, v14
    s_cmp_ge_u32 s66, 4
    s_cbranch_scc1 g_ch2_ok
g_ch2:
    ds_read_b32 v14, v10 offset:52
    s_waitcnt lgkmcnt(0)
    v_readfirstlane_b32 s66, v14
    s_cmp_ge_u32 s66, 4
    s_cbranch_scc1 g_ch2_ok
    s_sleep 1
    s_sub_i32 s0, s0, 1
    s_cmp_lt_i32 s0, 0
    s_cbranch_scc0 g_ch2
g_ch2_ok:
    s_cmp_eq_u32 s99, 1
    s_cbranch_scc1 g_x2
    s_waitcnt vmcnt(4)
    ds_read_b128 v[96:99], v20 offset:0
    ds_read_b128 v[100:103], v21 offset:0
    ds_read_b128 v[104:107], v22 offset:0
    ds_read_b128 v[108:111], v23 offset:0
g_x2:
    s_branch g_go2
g_vm2:
    s_waitcnt vmcnt(18)
g_go2:
    ds_read_b64_tr_b16 v[164:165], v7 offset:10240
    ds_read_b64_tr_b16 v[166:167], v7 offset:10880
    v_mfma_f32_16x16x32_bf16 v[152:155], v[172:175], v[88:91], v[152:155]
    s_waitcnt lgkmcnt(10)
    ds_read_b64_tr_b16 v[168:169], v7 offset:10272
    ds_read_b64_tr_b16 v[170:171], v7 offset:10912
    v_mfma_f32_16x16x32_bf16 v[136:139], v[176:179], v[92:95], v[136:139]
    s_waitcnt lgkmcnt(10)
    ds_read_b64_tr_b16 v[172:173], v7 offset:10304
    ds_read_b64_tr_b16 v[174:175], v7 offset:10944
    v_mfma_f32_16x16x32_bf16 v[140:143], v[180:183], v[92:95], v[140:143]
    s_waitcnt lgkmcnt(10)
    ds_read_b64_tr_b16 v[176:177], v7 offset:10336
    ds_read_b64_tr_b16 v[178:179], v7 offset:10976
    v_mfma_f32_16x16x32_bf16 v[144:147], v[184:187], v[92:95], v[144:147]
    s_waitcnt lgkmcnt(10)
    ds_read_b64_tr_b16 v[180:181], v7 offset:10368
    ds_read_b64_tr_b16 v[182:183], v7 offset:11008
    v_mfma_f32_16x16x32_bf16 v[148:151], v[188:191], v[92:95], v[148:151]
    s_waitcnt lgkmcnt(10)
    ds_read_b64_tr_b16 v[184:185], v7 offset:11520
    ds_read_b64_tr_b16 v[186:187], v7 offset:12160
    v_mfma_f32_16x16x32_bf16 v[152:155], v[192:195], v[92:95], v[152:155]
    s_waitcnt lgkmcnt(10)
    ds_read_b64_tr_b16 v[188:189], v7 offset:11552
    ds_read_b64_tr_b16 v[190:191], v7 offset:12192
    v_mfma_f32_16x16x32_bf16 v[136:139], v[164:167], v[96:99], v[136:139]
    s_waitcnt lgkmcnt(10)
    ds_read_b64_tr_b16 v[192:193], v7 offset:11584
    ds_read_b64_tr_b16 v[194:195], v7 offset:12224
    v_mfma_f32_16x16x32_bf16 v[140:143], v[168:171], v[96:99], v[140:143]
    s_waitcnt lgkmcnt(10)
    ds_read_b64_tr_b16 v[164:165], v7 offset:11616
    ds_read_b64_tr_b16 v[166:167], v7 offset:12256
    v_mfma_f32_16x16x32_bf16 v[144:147], v[172:175], v[96:99], v[144:147]
    s_waitcnt lgkmcnt(10)
    ds_read_b64_tr_b16 v[168:169], v7 offset:11648
    ds_read_b64_tr_b16 v[170:171], v7 offset:12288
    v_mfma_f32_16x16x32_bf16 v[148:151], v[176:179], v[96:99], v[148:151]
    s_waitcnt lgkmcnt(10)
    ds_read_b64_tr_b16 v[172:173], v7 offset:12800
    ds_read_b64_tr_b16 v[174:175], v7 offset:13440
    v_mfma_f32_16x16x32_bf16 v[152:155], v[180:183], v[96:99], v[152:155]
    s_waitcnt lgkmcnt(10)
    ds_read_b64_tr_b16 v[176:177], v7 offset:12832
    ds_read_b64_tr_b16 v[178:179], v7 offset:13472
    v_mfma_f32_16x16x32_bf16 v[136:139], v[184:187], v[100:103], v[136:139]
    s_waitcnt lgkmcnt(10)
    ds_read_b64_tr_b16 v[180:181], v7 offset:12864
    ds_read_b64_tr_b16 v[182:183], v7 offset:13504
    v_mfma_f32_16x16x32_bf16 v[140:143], v[188:191], v[100:103], v[140:143]
    s_waitcnt lgkmcnt(10)
    ds_read_b32 v14, v27 offset:56
    ds_read_b64_tr_b16 v[184:185], v7 offset:12896
    ds_read_b64_tr_b16 v[186:187], v7 offset:13536
    v_mfma_f32_16x16x32_bf16 v[144:147], v[192:195], v[100:103], v[144:147]
    s_waitcnt lgkmcnt(10)
    ds_read_b64_tr_b16 v[188:189], v7 offset:12928
    ds_read_b64_tr_b16 v[190:191], v7 offset:13568
    v_mfma_f32_16x16x32_bf16 v[148:151], v[164:167], v[100:103], v[148:151]
    s_waitcnt lgkmcnt(10)
    ds_read_b64_tr_b16 v[192:193], v7 offset:14080
    ds_read_b64_tr_b16 v[194:195], v7 offset:14720
    v_mfma_f32_16x16x32_bf16 v[152:155], v[168:171], v[100:103], v[152:155]
    s_waitcnt lgkmcnt(10)
    ds_read_b64_tr_b16 v[164:165], v7 offset:14112
    ds_read_b64_tr_b16 v[166:167], v7 offset:14752
    v_mfma_f32_16x16x32_bf16 v[136:139], v[172:175], v[104:107], v[136:139]
    s_waitcnt lgkmcnt(10)
    ds_read_b64_tr_b16 v[168:169], v7 offset:14144
    ds_read_b64_tr_b16 v[170:171], v7 offset:14784
    v_mfma_f32_16x16x32_bf16 v[140:143], v[176:179], v[104:107], v[140:143]
    s_waitcnt lgkmcnt(10)
    ds_read_b64_tr_b16 v[172:173], v7 offset:14176
    ds_read_b64_tr_b16 v[174:175], v7 offset:14816
    v_mfma_f32_16x16x32_bf16 v[144:147], v[180:183], v[104:107], v[144:147]
    s_waitcnt lgkmcnt(10)
    ds_read_b64_tr_b16 v[176:177], v7 offset:14208
    ds_read_b64_tr_b16 v[178:179], v7 offset:14848
    v_mfma_f32_16x16x32_bf16 v[148:151], v[184:187], v[104:107], v[148:151]
    s_waitcnt lgkmcnt(10)
    s_cmp_eq_u32 s98, 1
    s_cbranch_scc1 g_vm3
    v_readfirstlane_b32 s66, v14
    s_cmp_ge_u32 s66, 4
    s_cbranch_scc1 g_ch3_ok
g_ch3:
    ds_read_b32 v14, v10 offset:56
    s_waitcnt lgkmcnt(0)
    v_readfirstlane_b32 s66, v14
    s_cmp_ge_u32 s66, 4
    s_cbranch_scc1 g_ch3_ok
    s_sleep 1
    s_sub_i32 s0, s0, 1
    s_cmp_lt_i32 s0, 0
    s_cbranch_scc0 g_ch3
g_ch3_ok:
    s_cmp_eq_u32 s99, 1
    s_cbranch_scc1 g_x3
    s_waitcnt vmcnt(0)
    ds_read_b128 v[112:115], v20 offset:4096
    ds_read_b128 v[116:119], v21 offset:4096
    ds_read_b128 v[120:123], v22 offset:4096
    ds_read_b128 v[124:127], v23 offset:4096
g_x3:
    s_branch g_go3
g_vm3:
    s_waitcnt vmcnt(14)
g_go3:
    ds_read_b64_tr_b16 v[180:181], v7 offset:15360
    ds_read_b64_tr_b16 v[182:183], v7 offset:16000
    v_mfma_f32_16x16x32_bf16 v[152:155], v[188:191], v[104:107], v[152:155]
    s_waitcnt lgkmcnt(10)
    ds_read_b64_tr_b16 v[184:185], v7 offset:15392
    ds_read_b64_tr_b16 v[186:187], v7 offset:16032
    v_mfma_f32_16x16x32_bf16 v[136:139], v[192:195], v[108:111], v[136:139]
    s_waitcnt lgkmcnt(10)
    ds_read_b64_tr_b16 v[188:189], v7 offset:15424
    ds_read_b64_tr_b16 v[190:191], v7 offset:16064
    v_mfma_f32_16x16x32_bf16 v[140:143], v[164:167], v[108:111], v[140:143]
    s_waitcnt lgkmcnt(10)
    ds_read_b64_tr_b16 v[192:193], v7 offset:15456
    ds_read_b64_tr_b16 v[194:195], v7 offset:16096
    v_mfma_f32_16x16x32_bf16 v[144:147], v[168:171], v[108:111], v[144:147]
    s_waitcnt lgkmcnt(10)
    ds_read_b64_tr_b16 v[164:165], v7 offset:15488
    ds_read_b64_tr_b16 v[166:167], v7 offset:16128
    v_mfma_f32_16x16x32_bf16 v[148:151], v[172:175], v[108:111], v[148:151]
    s_waitcnt lgkmcnt(10)
    ds_read_b64_tr_b16 v[168:169], v7 offset:16640
    ds_read_b64_tr_b16 v[170:171], v7 offset:17280
    v_mfma_f32_16x16x32_bf16 v[152:155], v[176:179], v[108:111], v[152:155]
    s_waitcnt lgkmcnt(10)
    ds_read_b64_tr_b16 v[172:173], v7 offset:16672
    ds_read_b64_tr_b16 v[174:175], v7 offset:17312
    v_mfma_f32_16x16x32_bf16 v[136:139], v[180:183], v[112:115], v[136:139]
    s_waitcnt lgkmcnt(10)
    ds_read_b64_tr_b16 v[176:177], v7 offset:16704
    ds_read_b64_tr_b16 v[178:179], v7 offset:17344
    v_mfma_f32_16x16x32_bf16 v[140:143], v[184:187], v[112:115], v[140:143]
    s_waitcnt lgkmcnt(10)
    ds_read_b64_tr_b16 v[180:181], v7 offset:16736
    ds_read_b64_tr_b16 v[182:183], v7 offset:17376
    v_mfma_f32_16x16x32_bf16 v[144:147], v[188:191], v[112:115], v[144:147]
    s_waitcnt lgkmcnt(10)
    ds_read_b64_tr_b16 v[184:185], v7 offset:16768
    ds_read_b64_tr_b16 v[186:187], v7 offset:17408
    v_mfma_f32_16x16x32_bf16 v[148:151], v[192:195], v[112:115], v[148:151]
    s_waitcnt lgkmcnt(10)
    ds_read_b64_tr_b16 v[188:189], v7 offset:17920
    ds_read_b64_tr_b16 v[190:191], v7 offset:18560
    v_mfma_f32_16x16x32_bf16 v[152:155], v[164:167], v[112:115], v[152:155]
    s_waitcnt lgkmcnt(10)
    ds_read_b64_tr_b16 v[192:193], v7 offset:17952
    ds_read_b64_tr_b16 v[194:195], v7 offset:18592
    v_mfma_f32_16x16x32_bf16 v[136:139], v[168:171], v[116:119], v[136:139]
    s_waitcnt lgkmcnt(10)
    ds_read_b64_tr_b16 v[164:165], v7 offset:17984
    ds_read_b64_tr_b16 v[166:167], v7 offset:18624
    v_mfma_f32_16x16x32_bf16 v[140:143], v[172:175], v[116:119], v[140:143]
    s_waitcnt lgkmcnt(10)
    ds_read_b32 v14, v27 offset:60
    ds_read_b64_tr_b16 v[168:169], v7 offset:18016
    ds_read_b64_tr_b16 v[170:171], v7 offset:18656
    v_mfma_f32_16x16x32_bf16 v[144:147], v[176:179], v[116:119], v[144:147]
    s_waitcnt lgkmcnt(10)
    ds_read_b64_tr_b16 v[172:173], v7 offset:18048
    ds_read_b64_tr_b16 v[174:175], v7 offset:18688
    v_mfma_f32_16x16x32_bf16 v[148:151], v[180:183], v[116:119], v[148:151]
    s_waitcnt lgkmcnt(10)
    ds_read_b64_tr_b16 v[176:177], v7 offset:19200
    ds_read_b64_tr_b16 v[178:179], v7 offset:19840
    v_mfma_f32_16x16x32_bf16 v[152:155], v[184:187], v[116:119], v[152:155]
    s_waitcnt lgkmcnt(10)
    ds_read_b64_tr_b16 v[180:181], v7 offset:19232
    ds_read_b64_tr_b16 v[182:183], v7 offset:19872
    v_mfma_f32_16x16x32_bf16 v[136:139], v[188:191], v[120:123], v[136:139]
    s_waitcnt lgkmcnt(10)
    ds_read_b64_tr_b16 v[184:185], v7 offset:19264
    ds_read_b64_tr_b16 v[186:187], v7 offset:19904
    v_mfma_f32_16x16x32_bf16 v[140:143], v[192:195], v[120:123], v[140:143]
    s_waitcnt lgkmcnt(10)
    ds_read_b64_tr_b16 v[188:189], v7 offset:19296
    ds_read_b64_tr_b16 v[190:191], v7 offset:19936
    v_mfma_f32_16x16x32_bf16 v[144:147], v[164:167], v[120:123], v[144:147]
    s_waitcnt lgkmcnt(10)
    ds_read_b64_tr_b16 v[192:193], v7 offset:19328
    ds_read_b64_tr_b16 v[194:195], v7 offset:19968
    v_mfma_f32_16x16x32_bf16 v[148:151], v[168:171], v[120:123], v[148:151]
    s_waitcnt lgkmcnt(10)
    s_cmp_eq_u32 s98, 1
    s_cbranch_scc1 g_vm4
    v_readfirstlane_b32 s66, v14
    s_cmp_ge_u32 s66, 4
    s_cbranch_scc1 g_ch4_ok
g_ch4:
    ds_read_b32 v14, v10 offset:60
    s_waitcnt lgkmcnt(0)
    v_readfirstlane_b32 s66, v14
    s_cmp_ge_u32 s66, 4
    s_cbranch_scc1 g_ch4_ok
    s_sleep 1
    s_sub_i32 s0, s0, 1
    s_cmp_lt_i32 s0, 0
    s_cbranch_scc0 g_ch4
g_ch4_ok:
    s_mov_b64 exec, 1
    ds_add_u32 v10, v11 offset:100
    s_mov_b64 exec, -1
    s_branch g_go4
g_vm4:
    s_waitcnt vmcnt(6)
g_go4:
    ds_read_b64_tr_b16 v[164:165], v7 offset:20480
    ds_read_b64_tr_b16 v[166:167], v7 offset:21120
    v_mfma_f32_16x16x32_bf16 v[152:155], v[172:175], v[120:123], v[152:155]
    s_waitcnt lgkmcnt(10)
    ds_read_b64_tr_b16 v[168:169], v7 offset:20512
    ds_read_b64_tr_b16 v[170:171], v7 offset:21152
    v_mfma_f32_16x16x32_bf16 v[136:139], v[176:179], v[124:127], v[136:139]
    s_waitcnt lgkmcnt(10)
    ds_read_b64_tr_b16 v[172:173], v7 offset:20544
    ds_read_b64_tr_b16 v[174:175], v7 offset:21184
    v_mfma_f32_16x16x32_bf16 v[140:143], v[180:183], v[124:127], v[140:143]
    s_waitcnt lgkmcnt(10)
    ds_read_b64_tr_b16 v[176:177], v7 offset:20576
    ds_read_b64_tr_b16 v[178:179], v7 offset:21216
    v_mfma_f32_16x16x32_bf16 v[144:147], v[184:187], v[124:127], v[144:147]
    s_waitcnt lgkmcnt(10)
    ds_read_b64_tr_b16 v[180:181], v7 offset:20608
    ds_read_b64_tr_b16 v[182:183], v7 offset:21248
    v_mfma_f32_16x16x32_bf16 v[148:151], v[188:191], v[124:127], v[148:151]
    s_waitcnt lgkmcnt(10)
    ds_read_b64_tr_b16 v[184:185], v7 offset:21760
    ds_read_b64_tr_b16 v[186:187], v7 offset:22400
    v_mfma_f32_16x16x32_bf16 v[152:155], v[192:195], v[124:127], v[152:155]
    s_waitcnt lgkmcnt(10)
    ds_read_b64_tr_b16 v[188:189], v7 offset:21792
    ds_read_b64_tr_b16 v[190:191], v7 offset:22432
    v_mfma_f32_16x16x32_bf16 v[136:139], v[164:167], v[128:131], v[136:139]
    s_waitcnt lgkmcnt(10)
    ds_read_b64_tr_b16 v[192:193], v7 offset:21824
    ds_read_b64_tr_b16 v[194:195], v7 offset:22464
    v_mfma_f32_16x16x32_bf16 v[140:143], v[168:171], v[128:131], v[140:143]
    s_waitcnt lgkmcnt(10)
    ds_read_b64_tr_b16 v[164:165], v7 offset:21856
    ds_read_b64_tr_b16 v[166:167], v7 offset:22496
    v_mfma_f32_16x16x32_bf16 v[144:147], v[172:175], v[128:131], v[144:147]
    s_waitcnt lgkmcnt(10)
    ds_read_b32 v14, v10 offset:100
    ds_read_b64_tr_b16 v[168:169], v7 offset:21888
    ds_read_b64_tr_b16 v[170:171], v7 offset:22528
    v_mfma_f32_16x16x32_bf16 v[148:151], v[176:179], v[128:131], v[148:151]
    s_waitcnt lgkmcnt(10)
    v_mfma_f32_16x16x32_bf16 v[152:155], v[180:183], v[128:131], v[152:155]
    s_waitcnt lgkmcnt(8)
    v_mfma_f32_16x16x32_bf16 v[136:139], v[184:187], v[132:135], v[136:139]
    s_waitcnt lgkmcnt(6)
    v_mfma_f32_16x16x32_bf16 v[140:143], v[188:191], v[132:135], v[140:143]
    s_waitcnt lgkmcnt(4)
    v_mfma_f32_16x16x32_bf16 v[144:147], v[192:195], v[132:135], v[144:147]
    s_waitcnt lgkmcnt(2)
    v_mfma_f32_16x16x32_bf16 v[148:151], v[164:167], v[132:135], v[148:151]
    s_waitcnt lgkmcnt(0)
    v_mfma_f32_16x16x32_bf16 v[152:155], v[168:171], v[132:135], v[152:155]
    s_cmp_eq_u32 s98, 1
    s_cbranch_scc1 m_mix
    v_readfirstlane_b32 s66, v14
    s_cmp_ge_u32 s66, 4
    s_cbranch_scc1 m_xd_ok
m_xd:
    ds_read_b32 v14, v10 offset:100
    s_waitcnt lgkmcnt(0)
    v_readfirstlane_b32 s66, v14
    s_cmp_ge_u32 s66, 4
    s_cbranch_scc1 m_xd_ok
    s_sleep 1
    s_sub_i32 s0, s0, 1
    s_cmp_lt_i32 s0, 0
    s_cbranch_scc0 m_xd
m_xd_ok:
    v_cvt_pk_bf16_f32 v136, v136, v137
    v_cvt_pk_bf16_f32 v137, v138, v139
    ds_write_b64 v60, v[136:137] offset:0
    v_cvt_pk_bf16_f32 v140, v140, v141
    v_cvt_pk_bf16_f32 v141, v142, v143
    ds_write_b64 v60, v[140:141] offset:32
    v_cvt_pk_bf16_f32 v144, v144, v145
    v_cvt_pk_bf16_f32 v145, v146, v147
    ds_write_b64 v60, v[144:145] offset:64
    v_cvt_pk_bf16_f32 v148, v148, v149
    v_cvt_pk_bf16_f32 v149, v150, v151
    ds_write_b64 v60, v[148:149] offset:96
    v_cvt_pk_bf16_f32 v152, v152, v153
    v_cvt_pk_bf16_f32 v153, v154, v155
    ds_write_b64 v60, v[152:153] offset:128
    s_waitcnt lgkmcnt(0)
    s_mov_b64 exec, 1
    ds_add_u32 v10, v11 offset:64
    s_mov_b64 exec, -1
m_qd:
    ds_read_b32 v14, v10 offset:64
    s_waitcnt lgkmcnt(0)
    v_readfirstlane_b32 s66, v14
    s_cmp_ge_u32 s66, 4
    s_cbranch_scc1 m_qd_ok
    s_sleep 0
    s_sub_i32 s0, s0, 1
    s_cmp_lt_i32 s0, 0
    s_cbranch_scc0 m_qd
m_qd_ok:
    ds_read2_b32 v[96:97], v61 offset1:1
    ds_read2_b32 v[98:99], v61 offset0:2 offset1:3
    ds_read2_b32 v[100:101], v62 offset1:1
    ds_read2_b32 v[102:103], v62 offset0:2 offset1:3
    ds_read_b32 v28, v63 offset:32
    ds_read_b32 v14, v10 offset:0
    ds_read_b32 v15, v10 offset:96
    ds_read_b128 v[108:111], v8 offset:4096
    ds_read_b128 v[104:107], v8
    ds_read_b128 v[196:199], v9
    s_waitcnt lgkmcnt(5)
    s_mov_b64 exec, 1
    ds_add_u32 v10, v11 offset:68
    s_mov_b64 exec, -1
    v_mov_b32 v31, v28
    v_dot2_f32_bf16 v12, v96, v96, 0
    v_dot2_f32_bf16 v13, v100, v100, 0
    v_dot2_f32_bf16 v12, v97, v97, v12
    v_dot2_f32_bf16 v13, v101, v101, v13
    v_dot2_f32_bf16 v12, v98, v98, v12
    v_dot2_f32_bf16 v13, v102, v102, v13
    v_dot2_f32_bf16 v12, v99, v99, v12
    v_dot2_f32_bf16 v13, v103, v103, v13
    s_waitcnt lgkmcnt(0)
    v_readfirstlane_b32 s66, v14
    s_nop 0
    v_permlane32_swap_b32 v12, v13
    v_add_f32 v12, v12, v13
    v_dot2_f32_bf16 v12, v28, v28, v12
    s_cmp_ge_u32 s66, 1
    s_cbranch_scc1 m_l0_in
m_l0:
    ds_read_b32 v14, v10 offset:0
    s_waitcnt lgkmcnt(0)
    v_readfirstlane_b32 s66, v14
    s_cmp_ge_u32 s66, 1
    s_cbranch_scc1 m_l0_ok
    s_sleep 1
    s_sub_i32 s0, s0, 1
    s_cmp_lt_i32 s0, 0
    s_cbranch_scc0 m_l0
m_l0_ok:
    ds_read_b32 v14, v10 offset:0
    ds_read_b32 v15, v10 offset:96
    ds_read_b128 v[108:111], v8 offset:4096
    ds_read_b128 v[104:107], v8
    ds_read_b128 v[196:199], v9
    s_waitcnt lgkmcnt(0)
m_l0_in:
    v_mfma_f32_32x32x4_2b_bf16 v[32:63], v[108:109], v[28:29], 0 cbsz:1 abid:0
    s_nop 1
    v_mul_f32 v12, v15, v12
    v_cmp_ge_f32 vcc, 0x44c80000, v12
    s_nop 4
    s_cmp_eq_u64 vcc, exec
    s_cbranch_scc0 m_slow
    ds_read_b128 v[112:115], v8 offset:1024
    ds_read_b128 v[248:251], v9 offset:608
    s_waitcnt lgkmcnt(2)
    v_mov_b32 v120, 0
    v_mov_b32 v121, 0
    v_mov_b32 v122, 0
    v_mov_b32 v123, 0
    s_waitcnt lgkmcnt(0)
    v_mfma_f32_32x32x16_bf16 v[32:47], v[104:107], v[96:99], v[32:47]
    v_mfma_f32_32x32x16_bf16 v[48:63], v[104:107], v[100:103], v[48:63]
    ds_read_b128 v[104:107], v8 offset:2048
    ds_read_b128 v[116:119], v9 offset:1216
    v_mov_b32 v15, v10
    s_mov_b32 s60, 1
    s_mov_b32 s61, 0x0304
    s_mov_b32 s59, 0x07060302
    s_setprio 0
    s_nop 5
m_loop:
    v_mfma_f32_32x32x4_2b_bf16 v[64:95], v[108:109], v[30:31], 0 cbsz:1 abid:0
    v_exp_f32 v32, v32
    v_exp_f32 v33, v33
    v_exp_f32 v34, v34
    v_cvt_pk_bf16_f32 v232, v32, v33
    v_exp_f32 v35, v35
    v_exp_f32 v36, v36
    v_cvt_pk_bf16_f32 v233, v34, v35
    v_exp_f32 v37, v37
    v_exp_f32 v38, v38
    v_cvt_pk_bf16_f32 v234, v36, v37
    v_exp_f32 v39, v39
    v_mfma_f32_32x32x16_bf16 v[216:231], v[120:123], v[244:247], v[216:231]
    s_waitcnt lgkmcnt(4)
    ds_read_b128 v[120:123], v9 offset:1824
    v_exp_f32 v40, v40
    v_cvt_pk_bf16_f32 v235, v38, v39
    v_exp_f32 v41, v41
    v_exp_f32 v42, v42
    v_cvt_pk_bf16_f32 v236, v40, v41
    v_exp_f32 v43, v43
    v_mfma_f32_32x32x16_bf16 v[64:79], v[112:115], v[96:99], v[64:79]
    s_waitcnt lgkmcnt(4)
    v_exp_f32 v44, v44
    v_cvt_pk_bf16_f32 v237, v42, v43
    v_exp_f32 v45, v45
    v_exp_f32 v46, v46
    v_cvt_pk_bf16_f32 v238, v44, v45
    v_exp_f32 v47, v47
    v_mfma_f32_32x32x16_bf16 v[200:215], v[196:199], v[232:235], v[200:215]
    v_exp_f32 v48, v48
    v_cvt_pk_bf16_f32 v239, v46, v47
    v_exp_f32 v49, v49
    v_exp_f32 v50, v50
    v_cvt_pk_bf16_f32 v240, v48, v49
    v_exp_f32 v51, v51
    v_mfma_f32_32x32x16_bf16 v[80:95], v[112:115], v[100:103], v[80:95]
    s_waitcnt lgkmcnt(3)
    ds_read_b128 v[112:115], v8 offset:3072
    v_exp_f32 v52, v52
    v_cvt_pk_bf16_f32 v241, v50, v51
    v_exp_f32 v53, v53
    v_exp_f32 v54, v54
    v_cvt_pk_bf16_f32 v242, v52, v53
    v_exp_f32 v55, v55
    v_mfma_f32_32x32x16_bf16 v[200:215], v[248:251], v[236:239], v[200:215]
    v_exp_f32 v56, v56
    v_cvt_pk_bf16_f32 v243, v54, v55
    v_exp_f32 v57, v57
    v_exp_f32 v58, v58
    v_cvt_pk_bf16_f32 v244, v56, v57
    v_exp_f32 v59, v59
    v_mfma_f32_32x32x16_bf16 v[216:231], v[196:199], v[240:243], v[216:231]
    ds_read_b128 v[196:199], v9 offset:2432
    v_exp_f32 v60, v60
    v_cvt_pk_bf16_f32 v245, v58, v59
    v_exp_f32 v61, v61
    v_exp_f32 v62, v62
    v_exp_f32 v63, v63
    v_cvt_pk_bf16_f32 v246, v60, v61
    v_cvt_pk_bf16_f32 v247, v62, v63
    v_mfma_f32_32x32x4_2b_bf16 v[32:63], v[110:111], v[28:29], 0 cbsz:1 abid:0
    v_exp_f32 v64, v64
    v_exp_f32 v65, v65
    v_exp_f32 v66, v66
    v_cvt_pk_bf16_f32 v232, v64, v65
    v_exp_f32 v67, v67
    v_exp_f32 v68, v68
    v_cvt_pk_bf16_f32 v233, v66, v67
    v_exp_f32 v69, v69
    v_exp_f32 v70, v70
    v_cvt_pk_bf16_f32 v234, v68, v69
    v_exp_f32 v71, v71
    v_mfma_f32_32x32x16_bf16 v[216:231], v[248:251], v[244:247], v[216:231]
    s_waitcnt lgkmcnt(4)
    ds_read_b128 v[248:251], v9 offset:3040
    v_exp_f32 v72, v72
    v_cvt_pk_bf16_f32 v235, v70, v71
    v_exp_f32 v73, v73
    v_exp_f32 v74, v74
    v_cvt_pk_bf16_f32 v236, v72, v73
    v_exp_f32 v75, v75
    v_mfma_f32_32x32x16_bf16 v[32:47], v[104:107], v[96:99], v[32:47]
    s_waitcnt lgkmcnt(4)
    v_exp_f32 v76, v76
    v_cvt_pk_bf16_f32 v237, v74, v75
    v_exp_f32 v77, v77
    v_exp_f32 v78, v78
    v_cvt_pk_bf16_f32 v238, v76, v77
    v_exp_f32 v79, v79
    v_mfma_f32_32x32x16_bf16 v[200:215], v[116:119], v[232:235], v[200:215]
    v_exp_f32 v80, v80
    v_cvt_pk_bf16_f32 v239, v78, v79
    v_exp_f32 v81, v81
    v_exp_f32 v82, v82
    v_cvt_pk_bf16_f32 v240, v80, v81
    v_exp_f32 v83, v83
    v_mfma_f32_32x32x16_bf16 v[48:63], v[104:107], v[100:103], v[48:63]
    s_waitcnt lgkmcnt(3)
    ds_read_b128 v[104:107], v8 offset:9472
    v_exp_f32 v84, v84
    v_cvt_pk_bf16_f32 v241, v82, v83
    v_exp_f32 v85, v85
    v_exp_f32 v86, v86
    v_cvt_pk_bf16_f32 v242, v84, v85
    v_exp_f32 v87, v87
    v_mfma_f32_32x32x16_bf16 v[200:215], v[120:123], v[236:239], v[200:215]
    v_exp_f32 v88, v88
    v_cvt_pk_bf16_f32 v243, v86, v87
    v_exp_f32 v89, v89
    v_exp_f32 v90, v90
    v_cvt_pk_bf16_f32 v244, v88, v89
    v_exp_f32 v91, v91
    v_mfma_f32_32x32x16_bf16 v[216:231], v[116:119], v[240:243], v[216:231]
    ds_read_b128 v[116:119], v9 offset:3648
    v_exp_f32 v92, v92
    v_cvt_pk_bf16_f32 v245, v90, v91
    v_exp_f32 v93, v93
    v_exp_f32 v94, v94
    v_exp_f32 v95, v95
    v_cvt_pk_bf16_f32 v246, v92, v93
    v_cvt_pk_bf16_f32 v247, v94, v95
    v_mfma_f32_32x32x4_2b_bf16 v[64:95], v[110:111], v[30:31], 0 cbsz:1 abid:0
    v_exp_f32 v32, v32
    v_exp_f32 v33, v33
    v_exp_f32 v34, v34
    v_cvt_pk_bf16_f32 v232, v32, v33
    v_exp_f32 v35, v35
    v_exp_f32 v36, v36
    v_cvt_pk_bf16_f32 v233, v34, v35
    v_exp_f32 v37, v37
    v_exp_f32 v38, v38
    v_cvt_pk_bf16_f32 v234, v36, v37
    v_exp_f32 v39, v39
    v_mfma_f32_32x32x16_bf16 v[216:231], v[120:123], v[244:247], v[216:231]
    s_waitcnt lgkmcnt(4)
    ds_read_b128 v[120:123], v9 offset:4256
    v_exp_f32 v40, v40
    v_cvt_pk_bf16_f32 v235, v38, v39
    v_exp_f32 v41, v41
    v_exp_f32 v42, v42
    v_cvt_pk_bf16_f32 v236, v40, v41
    v_exp_f32 v43, v43
    v_mfma_f32_32x32x16_bf16 v[64:79], v[112:115], v[96:99], v[64:79]
    s_waitcnt lgkmcnt(4)
    ds_read_b128 v[108:111], v8 offset:13568
    v_exp_f32 v44, v44
    v_cvt_pk_bf16_f32 v237, v42, v43
    v_exp_f32 v45, v45
    v_exp_f32 v46, v46
    v_cvt_pk_bf16_f32 v238, v44, v45
    v_exp_f32 v47, v47
    v_mfma_f32_32x32x16_bf16 v[200:215], v[196:199], v[232:235], v[200:215]
    v_exp_f32 v48, v48
    v_cvt_pk_bf16_f32 v239, v46, v47
    v_exp_f32 v49, v49
    v_exp_f32 v50, v50
    v_cvt_pk_bf16_f32 v240, v48, v49
    v_exp_f32 v51, v51
    v_mfma_f32_32x32x16_bf16 v[80:95], v[112:115], v[100:103], v[80:95]
    s_waitcnt lgkmcnt(4)
    ds_read_b128 v[112:115], v8 offset:10496
    v_exp_f32 v52, v52
    v_cvt_pk_bf16_f32 v241, v50, v51
    v_exp_f32 v53, v53
    v_exp_f32 v54, v54
    v_cvt_pk_bf16_f32 v242, v52, v53
    v_exp_f32 v55, v55
    v_mfma_f32_32x32x16_bf16 v[200:215], v[248:251], v[236:239], v[200:215]
    v_exp_f32 v56, v56
    v_cvt_pk_bf16_f32 v243, v54, v55
    v_exp_f32 v57, v57
    v_exp_f32 v58, v58
    v_cvt_pk_bf16_f32 v244, v56, v57
    v_exp_f32 v59, v59
    v_mfma_f32_32x32x16_bf16 v[216:231], v[196:199], v[240:243], v[216:231]
    s_waitcnt lgkmcnt(1)
    ds_read_b128 v[196:199], v9 offset:9472
    v_exp_f32 v60, v60
    v_cvt_pk_bf16_f32 v245, v58, v59
    v_exp_f32 v61, v61
    v_exp_f32 v62, v62
    v_exp_f32 v63, v63
    v_cvt_pk_bf16_f32 v246, v60, v61
    v_cvt_pk_bf16_f32 v247, v62, v63
    v_mfma_f32_32x32x4_2b_bf16 v[32:63], v[108:109], v[28:29], 0 cbsz:1 abid:0
    v_exp_f32 v64, v64
    v_exp_f32 v65, v65
    v_exp_f32 v66, v66
    v_cvt_pk_bf16_f32 v232, v64, v65
    v_exp_f32 v67, v67
    v_exp_f32 v68, v68
    v_cvt_pk_bf16_f32 v233, v66, v67
    v_exp_f32 v69, v69
    v_exp_f32 v70, v70
    v_cvt_pk_bf16_f32 v234, v68, v69
    v_exp_f32 v71, v71
    v_mfma_f32_32x32x16_bf16 v[216:231], v[248:251], v[244:247], v[216:231]
    s_waitcnt lgkmcnt(5)
    ds_read_b128 v[248:251], v9 offset:10080
    v_exp_f32 v72, v72
    v_cvt_pk_bf16_f32 v235, v70, v71
    v_exp_f32 v73, v73
    v_exp_f32 v74, v74
    v_cvt_pk_bf16_f32 v236, v72, v73
    v_exp_f32 v75, v75
    v_mfma_f32_32x32x16_bf16 v[32:47], v[104:107], v[96:99], v[32:47]
    s_waitcnt lgkmcnt(5)
    v_exp_f32 v76, v76
    v_cvt_pk_bf16_f32 v237, v74, v75
    v_exp_f32 v77, v77
    v_exp_f32 v78, v78
    v_cvt_pk_bf16_f32 v238, v76, v77
    v_exp_f32 v79, v79
    v_mfma_f32_32x32x16_bf16 v[200:215], v[116:119], v[232:235], v[200:215]
    v_exp_f32 v80, v80
    v_cvt_pk_bf16_f32 v239, v78, v79
    v_exp_f32 v81, v81
    v_exp_f32 v82, v82
    v_cvt_pk_bf16_f32 v240, v80, v81
    v_exp_f32 v83, v83
    v_mfma_f32_32x32x16_bf16 v[48:63], v[104:107], v[100:103], v[48:63]
    s_waitcnt lgkmcnt(4)
    ds_read_b128 v[104:107], v8 offset:11520
    v_exp_f32 v84, v84
    v_cvt_pk_bf16_f32 v241, v82, v83
    v_exp_f32 v85, v85
    v_exp_f32 v86, v86
    v_cvt_pk_bf16_f32 v242, v84, v85
    v_exp_f32 v87, v87
    v_mfma_f32_32x32x16_bf16 v[200:215], v[120:123], v[236:239], v[200:215]
    v_exp_f32 v88, v88
    v_cvt_pk_bf16_f32 v243, v86, v87
    v_exp_f32 v89, v89
    v_exp_f32 v90, v90
    v_cvt_pk_bf16_f32 v244, v88, v89
    v_exp_f32 v91, v91
    v_mfma_f32_32x32x16_bf16 v[216:231], v[116:119], v[240:243], v[216:231]
    ds_read_b128 v[116:119], v9 offset:10688
    v_exp_f32 v92, v92
    v_cvt_pk_bf16_f32 v245, v90, v91
    v_exp_f32 v93, v93
    v_exp_f32 v94, v94
    v_exp_f32 v95, v95
    v_cvt_pk_bf16_f32 v246, v92, v93
    v_cvt_pk_bf16_f32 v247, v94, v95
    v_mfma_f32_32x32x4_2b_bf16 v[64:95], v[108:109], v[30:31], 0 cbsz:1 abid:0
    v_exp_f32 v32, v32
    v_exp_f32 v33, v33
    v_exp_f32 v34, v34
    v_cvt_pk_bf16_f32 v232, v32, v33
    v_exp_f32 v35, v35
    v_exp_f32 v36, v36
    v_cvt_pk_bf16_f32 v233, v34, v35
    v_exp_f32 v37, v37
    v_exp_f32 v38, v38
    v_cvt_pk_bf16_f32 v234, v36, v37
    v_exp_f32 v39, v39
    v_mfma_f32_32x32x16_bf16 v[216:231], v[120:123], v[244:247], v[216:231]
    s_waitcnt lgkmcnt(4)
    ds_read_b128 v[120:123], v9 offset:11296
    v_exp_f32 v40, v40
    v_cvt_pk_bf16_f32 v235, v38, v39
    v_exp_f32 v41, v41
    v_exp_f32 v42, v42
    v_cvt_pk_bf16_f32 v236, v40, v41
    v_exp_f32 v43, v43
    v_mfma_f32_32x32x16_bf16 v[64:79], v[112:115], v[96:99], v[64:79]
    s_waitcnt lgkmcnt(4)
    v_exp_f32 v44, v44
    v_cvt_pk_bf16_f32 v237, v42, v43
    v_exp_f32 v45, v45
    v_exp_f32 v46, v46
    v_cvt_pk_bf16_f32 v238, v44, v45
    v_exp_f32 v47, v47
    v_mfma_f32_32x32x16_bf16 v[200:215], v[196:199], v[232:235], v[200:215]
    v_exp_f32 v48, v48
    v_cvt_pk_bf16_f32 v239, v46, v47
    v_exp_f32 v49, v49
    v_exp_f32 v50, v50
    v_cvt_pk_bf16_f32 v240, v48, v49
    v_exp_f32 v51, v51
    v_mfma_f32_32x32x16_bf16 v[80:95], v[112:115], v[100:103], v[80:95]
    s_waitcnt lgkmcnt(3)
    ds_read_b128 v[112:115], v8 offset:12544
    v_exp_f32 v52, v52
    v_cvt_pk_bf16_f32 v241, v50, v51
    v_exp_f32 v53, v53
    v_exp_f32 v54, v54
    v_cvt_pk_bf16_f32 v242, v52, v53
    v_exp_f32 v55, v55
    v_mfma_f32_32x32x16_bf16 v[200:215], v[248:251], v[236:239], v[200:215]
    v_exp_f32 v56, v56
    v_cvt_pk_bf16_f32 v243, v54, v55
    v_exp_f32 v57, v57
    v_exp_f32 v58, v58
    v_cvt_pk_bf16_f32 v244, v56, v57
    v_exp_f32 v59, v59
    v_mfma_f32_32x32x16_bf16 v[216:231], v[196:199], v[240:243], v[216:231]
    ds_read_b128 v[196:199], v9 offset:11904
    v_exp_f32 v60, v60
    v_cvt_pk_bf16_f32 v245, v58, v59
    v_exp_f32 v61, v61
    v_exp_f32 v62, v62
    v_exp_f32 v63, v63
    v_cvt_pk_bf16_f32 v246, v60, v61
    v_cvt_pk_bf16_f32 v247, v62, v63
    v_mfma_f32_32x32x4_2b_bf16 v[32:63], v[110:111], v[28:29], 0 cbsz:1 abid:0
    v_exp_f32 v64, v64
    v_exp_f32 v65, v65
    v_exp_f32 v66, v66
    v_cvt_pk_bf16_f32 v232, v64, v65
    v_exp_f32 v67, v67
    v_exp_f32 v68, v68
    v_cvt_pk_bf16_f32 v233, v66, v67
    v_exp_f32 v69, v69
    v_exp_f32 v70, v70
    v_cvt_pk_bf16_f32 v234, v68, v69
    v_exp_f32 v71, v71
    v_mfma_f32_32x32x16_bf16 v[216:231], v[248:251], v[244:247], v[216:231]
    s_waitcnt lgkmcnt(4)
    ds_read_b128 v[248:251], v9 offset:12512
    v_exp_f32 v72, v72
    v_cvt_pk_bf16_f32 v235, v70, v71
    v_exp_f32 v73, v73
    v_exp_f32 v74, v74
    v_cvt_pk_bf16_f32 v236, v72, v73
    v_exp_f32 v75, v75
    v_mfma_f32_32x32x16_bf16 v[32:47], v[104:107], v[96:99], v[32:47]
    s_waitcnt lgkmcnt(4)
    v_exp_f32 v76, v76
    v_cvt_pk_bf16_f32 v237, v74, v75
    v_exp_f32 v77, v77
    v_exp_f32 v78, v78
    v_cvt_pk_bf16_f32 v238, v76, v77
    v_exp_f32 v79, v79
    v_mfma_f32_32x32x16_bf16 v[200:215], v[116:119], v[232:235], v[200:215]
    v_exp_f32 v80, v80
    v_cvt_pk_bf16_f32 v239, v78, v79
    v_exp_f32 v81, v81
    v_exp_f32 v82, v82
    v_cvt_pk_bf16_f32 v240, v80, v81
    v_exp_f32 v83, v83
    v_mfma_f32_32x32x16_bf16 v[48:63], v[104:107], v[100:103], v[48:63]
    s_waitcnt lgkmcnt(3)
    ds_read_b128 v[104:107], v8 offset:18944
    v_exp_f32 v84, v84
    v_cvt_pk_bf16_f32 v241, v82, v83
    v_exp_f32 v85, v85
    v_exp_f32 v86, v86
    v_cvt_pk_bf16_f32 v242, v84, v85
    v_exp_f32 v87, v87
    v_mfma_f32_32x32x16_bf16 v[200:215], v[120:123], v[236:239], v[200:215]
    v_exp_f32 v88, v88
    v_cvt_pk_bf16_f32 v243, v86, v87
    v_exp_f32 v89, v89
    v_exp_f32 v90, v90
    v_cvt_pk_bf16_f32 v244, v88, v89
    v_exp_f32 v91, v91
    v_mfma_f32_32x32x16_bf16 v[216:231], v[116:119], v[240:243], v[216:231]
    ds_read_b128 v[116:119], v9 offset:13120
    v_exp_f32 v92, v92
    v_cvt_pk_bf16_f32 v245, v90, v91
    v_exp_f32 v93, v93
    v_exp_f32 v94, v94
    v_exp_f32 v95, v95
    v_cvt_pk_bf16_f32 v246, v92, v93
    v_cvt_pk_bf16_f32 v247, v94, v95
    v_mfma_f32_32x32x4_2b_bf16 v[64:95], v[110:111], v[30:31], 0 cbsz:1 abid:0
    v_exp_f32 v32, v32
    v_exp_f32 v33, v33
    v_exp_f32 v34, v34
    v_cvt_pk_bf16_f32 v232, v32, v33
    v_exp_f32 v35, v35
    v_exp_f32 v36, v36
    v_cvt_pk_bf16_f32 v233, v34, v35
    v_exp_f32 v37, v37
    v_exp_f32 v38, v38
    v_cvt_pk_bf16_f32 v234, v36, v37
    v_exp_f32 v39, v39
    v_mfma_f32_32x32x16_bf16 v[216:231], v[120:123], v[244:247], v[216:231]
    s_waitcnt lgkmcnt(4)
    ds_read_b128 v[120:123], v9 offset:13728
    v_exp_f32 v40, v40
    v_cvt_pk_bf16_f32 v235, v38, v39
    v_exp_f32 v41, v41
    v_exp_f32 v42, v42
    v_cvt_pk_bf16_f32 v236, v40, v41
    v_exp_f32 v43, v43
    v_mfma_f32_32x32x16_bf16 v[64:79], v[112:115], v[96:99], v[64:79]
    s_waitcnt lgkmcnt(4)
    ds_read_b128 v[108:111], v8 offset:23040
    v_exp_f32 v44, v44
    v_cvt_pk_bf16_f32 v237, v42, v43
    v_exp_f32 v45, v45
    v_exp_f32 v46, v46
    v_cvt_pk_bf16_f32 v238, v44, v45
    v_exp_f32 v47, v47
    v_mfma_f32_32x32x16_bf16 v[200:215], v[196:199], v[232:235], v[200:215]
    v_exp_f32 v48, v48
    v_cvt_pk_bf16_f32 v239, v46, v47
    v_exp_f32 v49, v49
    v_exp_f32 v50, v50
    v_cvt_pk_bf16_f32 v240, v48, v49
    v_exp_f32 v51, v51
    v_mfma_f32_32x32x16_bf16 v[80:95], v[112:115], v[100:103], v[80:95]
    s_waitcnt lgkmcnt(4)
    ds_read_b128 v[112:115], v8 offset:19968
    v_exp_f32 v52, v52
    v_cvt_pk_bf16_f32 v241, v50, v51
    v_exp_f32 v53, v53
    v_exp_f32 v54, v54
    v_cvt_pk_bf16_f32 v242, v52, v53
    v_exp_f32 v55, v55
    v_mfma_f32_32x32x16_bf16 v[200:215], v[248:251], v[236:239], v[200:215]
    v_exp_f32 v56, v56
    v_cvt_pk_bf16_f32 v243, v54, v55
    v_exp_f32 v57, v57
    v_exp_f32 v58, v58
    v_cvt_pk_bf16_f32 v244, v56, v57
    v_exp_f32 v59, v59
    v_mfma_f32_32x32x16_bf16 v[216:231], v[196:199], v[240:243], v[216:231]
    s_waitcnt lgkmcnt(1)
    ds_read_b128 v[196:199], v9 offset:18944
    v_exp_f32 v60, v60
    v_cvt_pk_bf16_f32 v245, v58, v59
    v_exp_f32 v61, v61
    v_exp_f32 v62, v62
    v_exp_f32 v63, v63
    v_cvt_pk_bf16_f32 v246, v60, v61
    v_cvt_pk_bf16_f32 v247, v62, v63
    v_mfma_f32_32x32x4_2b_bf16 v[32:63], v[108:109], v[28:29], 0 cbsz:1 abid:0
    v_exp_f32 v64, v64
    v_exp_f32 v65, v65
    v_exp_f32 v66, v66
    v_cvt_pk_bf16_f32 v232, v64, v65
    v_exp_f32 v67, v67
    v_exp_f32 v68, v68
    v_cvt_pk_bf16_f32 v233, v66, v67
    v_exp_f32 v69, v69
    v_exp_f32 v70, v70
    v_cvt_pk_bf16_f32 v234, v68, v69
    v_exp_f32 v71, v71
    v_mfma_f32_32x32x16_bf16 v[216:231], v[248:251], v[244:247], v[216:231]
    s_waitcnt lgkmcnt(5)
    ds_read_b128 v[248:251], v9 offset:19552
    v_exp_f32 v72, v72
    v_cvt_pk_bf16_f32 v235, v70, v71
    v_exp_f32 v73, v73
    v_exp_f32 v74, v74
    v_cvt_pk_bf16_f32 v236, v72, v73
    v_exp_f32 v75, v75
    v_mfma_f32_32x32x16_bf16 v[32:47], v[104:107], v[96:99], v[32:47]
    s_waitcnt lgkmcnt(5)
    v_exp_f32 v76, v76
    v_cvt_pk_bf16_f32 v237, v74, v75
    v_exp_f32 v77, v77
    v_exp_f32 v78, v78
    v_cvt_pk_bf16_f32 v238, v76, v77
    v_exp_f32 v79, v79
    v_mfma_f32_32x32x16_bf16 v[200:215], v[116:119], v[232:235], v[200:215]
    s_sub_u32 s60, s60, 1
    v_exp_f32 v80, v80
    v_cvt_pk_bf16_f32 v239, v78, v79
    v_exp_f32 v81, v81
    v_exp_f32 v82, v82
    v_cvt_pk_bf16_f32 v240, v80, v81
    v_exp_f32 v83, v83
    v_mfma_f32_32x32x16_bf16 v[48:63], v[104:107], v[100:103], v[48:63]
    s_waitcnt lgkmcnt(4)
    ds_read_b128 v[104:107], v8 offset:20992
    v_exp_f32 v84, v84
    v_cvt_pk_bf16_f32 v241, v82, v83
    v_exp_f32 v85, v85
    v_exp_f32 v86, v86
    v_cvt_pk_bf16_f32 v242, v84, v85
    v_exp_f32 v87, v87
    v_mfma_f32_32x32x16_bf16 v[200:215], v[120:123], v[236:239], v[200:215]
    s_cmp_lg_u32 s60, 0
    v_exp_f32 v88, v88
    v_cvt_pk_bf16_f32 v243, v86, v87
    v_exp_f32 v89, v89
    v_exp_f32 v90, v90
    v_cvt_pk_bf16_f32 v244, v88, v89
    v_exp_f32 v91, v91
    v_mfma_f32_32x32x16_bf16 v[216:231], v[116:119], v[240:243], v[216:231]
    ds_read_b128 v[116:119], v9 offset:20160
    v_exp_f32 v92, v92
    v_cvt_pk_bf16_f32 v245, v90, v91
    v_exp_f32 v93, v93
    v_exp_f32 v94, v94
    v_exp_f32 v95, v95
    v_cvt_pk_bf16_f32 v246, v92, v93
    v_add_u32 v8, 18944, v8
    v_add_u32 v9, 18944, v9
    v_cvt_pk_bf16_f32 v247, v94, v95
    s_cbranch_scc1 m_loop
    s_cmp_eq_u32 s61, 0
    s_cbranch_scc1 m_done
    s_mov_b64 exec, 1
    ds_add_u32 v15, v11 offset:12
    s_mov_b64 exec, -1
    v_add_u32 v15, 4, v15
    s_and_b32 s60, s61, 0xff
    s_lshr_b32 s61, s61, 8
m_lv:
    ds_read_b32 v14, v15 offset:0
    s_waitcnt lgkmcnt(0)
    v_readfirstlane_b32 s66, v14
    s_cmp_ge_u32 s66, 4
    s_cbranch_scc1 m_lv_ok
    s_sleep 1
    s_sub_i32 s0, s0, 1
    s_cmp_lt_i32 s0, 0
    s_cbranch_scc0 m_lv
m_lv_ok:
    s_branch m_loop
m_done:
    s_setprio 2
    v_mfma_f32_32x32x16_bf16 v[216:231], v[120:123], v[244:247], v[216:231]
    v_mov_b32 v12, v210
    v_mov_b32 v13, v210
    s_nop 1
    v_permlane32_swap_b32 v12, v13
    v_rcp_f32 v12, v12
    s_nop 0
    v_mul_f32 v200, v12, v200
    v_mul_f32 v201, v12, v201
    v_mul_f32 v202, v12, v202
    v_mul_f32 v203, v12, v203
    v_mul_f32 v204, v12, v204
    v_mul_f32 v205, v12, v205
    v_mul_f32 v206, v12, v206
    v_mul_f32 v207, v12, v207
    v_mul_f32 v208, v12, v208
    v_mul_f32 v209, v12, v209
    v_cvt_pk_bf16_f32 v200, v200, v201
    v_cvt_pk_bf16_f32 v201, v202, v203
    v_cvt_pk_bf16_f32 v202, v204, v205
    v_cvt_pk_bf16_f32 v203, v206, v207
    v_cvt_pk_bf16_f32 v204, v208, v209
    v_permlane32_swap_b32 v200, v202
    v_permlane32_swap_b32 v201, v203
    buffer_store_dwordx4 v[200:203], v252, s[32:35], s48 offen sc1
    v_mov_b32 v12, v226
    v_mov_b32 v13, v226
    s_nop 1
    v_permlane32_swap_b32 v12, v13
    v_rcp_f32 v12, v12
    s_nop 0
    v_mul_f32 v216, v12, v216
    v_mul_f32 v217, v12, v217
    v_mul_f32 v218, v12, v218
    v_mul_f32 v219, v12, v219
    v_mul_f32 v220, v12, v220
    v_mul_f32 v221, v12, v221
    v_mul_f32 v222, v12, v222
    v_mul_f32 v223, v12, v223
    v_mul_f32 v224, v12, v224
    v_mul_f32 v225, v12, v225
    v_cvt_pk_bf16_f32 v216, v216, v217
    v_cvt_pk_bf16_f32 v217, v218, v219
    v_cvt_pk_bf16_f32 v218, v220, v221
    v_cvt_pk_bf16_f32 v219, v222, v223
    v_cvt_pk_bf16_f32 v220, v224, v225
    v_permlane32_swap_b32 v216, v218
    v_permlane32_swap_b32 v217, v219
    buffer_store_dwordx4 v[216:219], v252, s[32:35], s49 offen sc1
    v_permlane32_swap_b32 v204, v220
    buffer_store_dword v204, v253, s[32:35], s50 offen sc1
    v_subrev_u32 v7, 27648, v7
    s_lshl_b32 s63, s3, 14
    s_add_u32 s63, s63, s51
    v_lshlrev_b32 v8, 4, v1
    s_lshl_b32 s56, s3, 6
    s_add_u32 s56, s56, s51
    s_add_u32 s56, s56, 65536
    v_lshlrev_b32 v16, 2, v2
    v_lshl_add_u32 v16, v3, 11, v16
    s_mul_i32 s57, s53, 160
    s_min_u32 s57, s57, 992
    v_lshl_add_u32 v9, v3, 3, v5
    s_add_u32 s58, s57, 2818048
    s_mov_b32 s59, 393216
    s_mov_b32 s98, 1
    v_and_b32 v15, 31, v4
    v_bfe_u32 v12, v4, 7, 3
    v_lshl_add_u32 v15, v12, 5, v15
    v_lshlrev_b32 v15, 7, v15
    v_bfe_u32 v12, v4, 5, 2
    v_lshl_add_u32 v15, v12, 3, v15
    v_lshrrev_b32 v12, 10, v4
    v_lshl_add_u32 v15, v12, 2, v15
    s_lshl_b32 s60, s52, 10
    s_add_u32 s60, s60, 262144
    s_waitcnt vmcnt(0)
    s_mov_b64 exec, 1
    ds_add_rtn_u32 v14, v10, v11 offset:124
    s_mov_b64 exec, -1
    s_lshl_b32 s54, s53, 7
    s_add_u32 s54, s54, s60
    s_waitcnt lgkmcnt(0)
    v_readfirstlane_b32 s66, v14
    s_cmp_eq_u32 s66, 3
    s_cselect_b32 s101, 1, 0
    s_cmp_eq_u32 s101, 1
    s_cbranch_scc0 m_ar5
    s_mov_b64 exec, 1
    v_mov_b32 v12, s68
    v_mov_b32 v13, 0
    buffer_store_dword v12, v13, s[32:35], s54 offen sc1
    s_mov_b64 exec, -1
    s_mov_b64 exec, 1
    ds_add_u32 v10, v11 offset:124
    s_mov_b64 exec, -1
m_ar5:
    v_add_u32 v27, 40, v10
    s_lshl_b32 s61, s53, 2
    s_add_u32 s61, s61, s3
    s_mul_i32 s61, s61, 2304
    s_add_u32 s61, s61, s51
    s_cmp_eq_u32 s101, 1
    s_cbranch_scc0 m_go5
    s_mov_b32 s67, 32768
    s_mov_b64 exec, 0xff
m_f5:
    buffer_load_dword v13, v254, s[32:35], s60 offen sc1
    s_waitcnt vmcnt(0)
    v_cmp_eq_u32 vcc, s68, v13
    s_sub_u32 s67, s67, 1
    s_cbranch_scc1 m_f5_ok
    s_nop 1
    s_cmp_eq_u64 vcc, exec
    s_cbranch_scc0 m_f5
m_f5_ok:
    s_mov_b64 exec, 1
    ds_add_u32 v10, v11 offset:128
    s_mov_b64 exec, -1
    s_branch m_go5_ok
m_go5:
    ds_read_b32 v14, v10 offset:128
    s_waitcnt lgkmcnt(0)
    v_readfirstlane_b32 s66, v14
    s_cmp_ge_u32 s66, 1
    s_cbranch_scc1 m_go5_ok
    s_sleep 1
    s_sub_i32 s0, s0, 1
    s_cmp_lt_i32 s0, 0
    s_cbranch_scc0 m_go5
m_go5_ok:
    buffer_load_dwordx4 v[64:67], v8, s[32:35], s63 offen offset:0 sc1
    buffer_load_dwordx4 v[68:71], v8, s[32:35], s63 offen offset:1024 sc1
    buffer_load_dwordx4 v[72:75], v8, s[32:35], s63 offen offset:2048 sc1
    buffer_load_dwordx4 v[76:79], v8, s[32:35], s63 offen offset:3072 sc1
    s_add_u32 s63, s63, 4096
    buffer_load_dwordx4 v[80:83], v8, s[32:35], s63 offen offset:0 sc1
    buffer_load_dwordx4 v[84:87], v8, s[32:35], s63 offen offset:1024 sc1
    buffer_load_dwordx4 v[88:91], v8, s[32:35], s63 offen offset:2048 sc1
    buffer_load_dwordx4 v[92:95], v8, s[32:35], s63 offen offset:3072 sc1
    s_add_u32 s63, s63, 4096
    buffer_load_dwordx4 v[96:99], v8, s[32:35], s63 offen offset:0 sc1
    buffer_load_dwordx4 v[100:103], v8, s[32:35], s63 offen offset:1024 sc1
    buffer_load_dwordx4 v[104:107], v8, s[32:35], s63 offen offset:2048 sc1
    buffer_load_dwordx4 v[108:111], v8, s[32:35], s63 offen offset:3072 sc1
    s_add_u32 s63, s63, 4096
    buffer_load_dwordx4 v[112:115], v8, s[32:35], s63 offen offset:0 sc1
    buffer_load_dwordx4 v[116:119], v8, s[32:35], s63 offen offset:1024 sc1
    buffer_load_dwordx4 v[120:123], v8, s[32:35], s63 offen offset:2048 sc1
    buffer_load_dwordx4 v[124:127], v8, s[32:35], s63 offen offset:3072 sc1
    buffer_load_dword v128, v16, s[32:35], s56 offen offset:0 sc1
    buffer_load_dword v129, v16, s[32:35], s56 offen offset:256 sc1
    buffer_load_dword v130, v16, s[32:35], s56 offen offset:512 sc1
    buffer_load_dword v131, v16, s[32:35], s56 offen offset:768 sc1
    buffer_load_dword v132, v16, s[32:35], s56 offen offset:1024 sc1
    buffer_load_dword v133, v16, s[32:35], s56 offen offset:1280 sc1
    buffer_load_dword v134, v16, s[32:35], s56 offen offset:1536 sc1
    buffer_load_dword v135, v16, s[32:35], s56 offen offset:1792 sc1
m_wok:
    ds_read_b32 v14, v10 offset:84
    s_waitcnt lgkmcnt(0)
    v_readfirstlane_b32 s66, v14
    s_cmp_ge_u32 s66, 4
    s_cbranch_scc1 m_wok_ok
    s_sleep 1
    s_sub_i32 s0, s0, 1
    s_cmp_lt_i32 s0, 0
    s_cbranch_scc0 m_wok
m_wok_ok:
    s_branch gemm
m_mix:
    s_mov_b32 s44, s22
    s_mov_b32 s45, s23
    s_mov_b32 s46, 2359296
    s_mov_b32 s47, 0x20000
    s_waitcnt vmcnt(0)
    v_sub_f32 v60, 1.0, v58
    v_mov_b32 v59, v58
    v_mov_b32 v61, v60
    v_and_b32 v62, 1, v3
    v_mul_u32_u24 v62, 24, v62
    v_add_u32 v62, v62, v9
    v_lshlrev_b32 v12, 16, v48
    v_and_b32 v13, 0xffff0000, v48
    v_pk_mul_f32 v[12:13], v[12:13], v[58:59]
    v_pk_fma_f32 v[12:13], v[136:137], v[60:61], v[12:13]
    v_cvt_pk_bf16_f32 v48, v12, v13
    v_lshlrev_b32 v12, 16, v49
    v_and_b32 v13, 0xffff0000, v49
    v_pk_mul_f32 v[12:13], v[12:13], v[58:59]
    v_pk_fma_f32 v[12:13], v[138:139], v[60:61], v[12:13]
    v_cvt_pk_bf16_f32 v49, v12, v13
    v_lshlrev_b32 v12, 16, v50
    v_and_b32 v13, 0xffff0000, v50
    v_pk_mul_f32 v[12:13], v[12:13], v[58:59]
    v_pk_fma_f32 v[12:13], v[140:141], v[60:61], v[12:13]
    v_cvt_pk_bf16_f32 v50, v12, v13
    v_lshlrev_b32 v12, 16, v51
    v_and_b32 v13, 0xffff0000, v51
    v_pk_mul_f32 v[12:13], v[12:13], v[58:59]
    v_pk_fma_f32 v[12:13], v[142:143], v[60:61], v[12:13]
    v_cvt_pk_bf16_f32 v51, v12, v13
    s_nop 1
    v_permlane16_swap_b32 v48, v50
    v_permlane16_swap_b32 v49, v51
    buffer_store_dwordx4 v[48:51], v62, s[44:47], s57 offen offset:0
    v_lshlrev_b32 v12, 16, v52
    v_and_b32 v13, 0xffff0000, v52
    v_pk_mul_f32 v[12:13], v[12:13], v[58:59]
    v_pk_fma_f32 v[12:13], v[144:145], v[60:61], v[12:13]
    v_cvt_pk_bf16_f32 v52, v12, v13
    v_lshlrev_b32 v12, 16, v53
    v_and_b32 v13, 0xffff0000, v53
    v_pk_mul_f32 v[12:13], v[12:13], v[58:59]
    v_pk_fma_f32 v[12:13], v[146:147], v[60:61], v[12:13]
    v_cvt_pk_bf16_f32 v53, v12, v13
    v_lshlrev_b32 v12, 16, v54
    v_and_b32 v13, 0xffff0000, v54
    v_pk_mul_f32 v[12:13], v[12:13], v[58:59]
    v_pk_fma_f32 v[12:13], v[148:149], v[60:61], v[12:13]
    v_cvt_pk_bf16_f32 v54, v12, v13
    v_lshlrev_b32 v12, 16, v55
    v_and_b32 v13, 0xffff0000, v55
    v_pk_mul_f32 v[12:13], v[12:13], v[58:59]
    v_pk_fma_f32 v[12:13], v[150:151], v[60:61], v[12:13]
    v_cvt_pk_bf16_f32 v55, v12, v13
    s_nop 1
    v_permlane16_swap_b32 v52, v54
    v_permlane16_swap_b32 v53, v55
    buffer_store_dwordx4 v[52:55], v62, s[44:47], s57 offen offset:64
    v_lshlrev_b32 v12, 16, v56
    v_and_b32 v13, 0xffff0000, v56
    v_pk_mul_f32 v[12:13], v[12:13], v[58:59]
    v_pk_fma_f32 v[12:13], v[152:153], v[60:61], v[12:13]
    v_cvt_pk_bf16_f32 v56, v12, v13
    v_lshlrev_b32 v12, 16, v57
    v_and_b32 v13, 0xffff0000, v57
    v_pk_mul_f32 v[12:13], v[12:13], v[58:59]
    v_pk_fma_f32 v[12:13], v[154:155], v[60:61], v[12:13]
    v_cvt_pk_bf16_f32 v57, v12, v13
    buffer_store_dwordx2 v[56:57], v9, s[44:47], s57 offen offset:128
    s_endpgm
m_slow:
m_fb1:
    ds_read_b32 v14, v10 offset:4
    s_waitcnt lgkmcnt(0)
    v_readfirstlane_b32 s66, v14
    s_cmp_ge_u32 s66, 4
    s_cbranch_scc1 m_fb1_ok
    s_sleep 1
    s_sub_i32 s0, s0, 1
    s_cmp_lt_i32 s0, 0
    s_cbranch_scc0 m_fb1
m_fb1_ok:
m_fb2:
    ds_read_b32 v14, v10 offset:8
    s_waitcnt lgkmcnt(0)
    v_readfirstlane_b32 s66, v14
    s_cmp_ge_u32 s66, 4
    s_cbranch_scc1 m_fb2_ok
    s_sleep 1
    s_sub_i32 s0, s0, 1
    s_cmp_lt_i32 s0, 0
    s_cbranch_scc0 m_fb2
m_fb2_ok:
    v_mov_b32 v12, 0xff800000
    v_mov_b32 v13, 0xff800000
    s_mov_b32 s60, 16
m_fbl:
    ds_read_b128 v[108:111], v8 offset:4096
    ds_read_b128 v[104:107], v8 offset:0
    s_waitcnt lgkmcnt(0)
    v_mfma_f32_32x32x4_2b_bf16 v[32:63], v[108:109], v[28:29], 0 cbsz:1 abid:0
    s_nop 15
    s_nop 1
    v_mfma_f32_32x32x16_bf16 v[32:47], v[104:107], v[96:99], v[32:47]
    v_mfma_f32_32x32x16_bf16 v[48:63], v[104:107], v[100:103], v[48:63]
    s_nop 10
    v_max3_f32 v12, v12, v32, v33
    v_max3_f32 v12, v12, v34, v35
    v_max3_f32 v12, v12, v36, v37
    v_max3_f32 v12, v12, v38, v39
    v_max3_f32 v12, v12, v40, v41
    v_max3_f32 v12, v12, v42, v43
    v_max3_f32 v12, v12, v44, v45
    v_max3_f32 v12, v12, v46, v47
    v_max3_f32 v13, v13, v48, v49
    v_max3_f32 v13, v13, v50, v51
    v_max3_f32 v13, v13, v52, v53
    v_max3_f32 v13, v13, v54, v55
    v_max3_f32 v13, v13, v56, v57
    v_max3_f32 v13, v13, v58, v59
    v_max3_f32 v13, v13, v60, v61
    v_max3_f32 v13, v13, v62, v63
    ds_read_b128 v[104:107], v8 offset:1024
    s_waitcnt lgkmcnt(0)
    v_mfma_f32_32x32x4_2b_bf16 v[32:63], v[108:109], v[30:31], 0 cbsz:1 abid:0
    s_nop 15
    s_nop 1
    v_mfma_f32_32x32x16_bf16 v[32:47], v[104:107], v[96:99], v[32:47]
    v_mfma_f32_32x32x16_bf16 v[48:63], v[104:107], v[100:103], v[48:63]
    s_nop 10
    v_max3_f32 v12, v12, v32, v33
    v_max3_f32 v12, v12, v34, v35
    v_max3_f32 v12, v12, v36, v37
    v_max3_f32 v12, v12, v38, v39
    v_max3_f32 v12, v12, v40, v41
    v_max3_f32 v12, v12, v42, v43
    v_max3_f32 v12, v12, v44, v45
    v_max3_f32 v12, v12, v46, v47
    v_max3_f32 v13, v13, v48, v49
    v_max3_f32 v13, v13, v50, v51
    v_max3_f32 v13, v13, v52, v53
    v_max3_f32 v13, v13, v54, v55
    v_max3_f32 v13, v13, v56, v57
    v_max3_f32 v13, v13, v58, v59
    v_max3_f32 v13, v13, v60, v61
    v_max3_f32 v13, v13, v62, v63
    ds_read_b128 v[104:107], v8 offset:2048
    s_waitcnt lgkmcnt(0)
    v_mfma_f32_32x32x4_2b_bf16 v[32:63], v[110:111], v[28:29], 0 cbsz:1 abid:0
    s_nop 15
    s_nop 1
    v_mfma_f32_32x32x16_bf16 v[32:47], v[104:107], v[96:99], v[32:47]
    v_mfma_f32_32x32x16_bf16 v[48:63], v[104:107], v[100:103], v[48:63]
    s_nop 10
    v_max3_f32 v12, v12, v32, v33
    v_max3_f32 v12, v12, v34, v35
    v_max3_f32 v12, v12, v36, v37
    v_max3_f32 v12, v12, v38, v39
    v_max3_f32 v12, v12, v40, v41
    v_max3_f32 v12, v12, v42, v43
    v_max3_f32 v12, v12, v44, v45
    v_max3_f32 v12, v12, v46, v47
    v_max3_f32 v13, v13, v48, v49
    v_max3_f32 v13, v13, v50, v51
    v_max3_f32 v13, v13, v52, v53
    v_max3_f32 v13, v13, v54, v55
    v_max3_f32 v13, v13, v56, v57
    v_max3_f32 v13, v13, v58, v59
    v_max3_f32 v13, v13, v60, v61
    v_max3_f32 v13, v13, v62, v63
    ds_read_b128 v[104:107], v8 offset:3072
    s_waitcnt lgkmcnt(0)
    v_mfma_f32_32x32x4_2b_bf16 v[32:63], v[110:111], v[30:31], 0 cbsz:1 abid:0
    s_nop 15
    s_nop 1
    v_mfma_f32_32x32x16_bf16 v[32:47], v[104:107], v[96:99], v[32:47]
    v_mfma_f32_32x32x16_bf16 v[48:63], v[104:107], v[100:103], v[48:63]
    s_nop 10
    v_max3_f32 v12, v12, v32, v33
    v_max3_f32 v12, v12, v34, v35
    v_max3_f32 v12, v12, v36, v37
    v_max3_f32 v12, v12, v38, v39
    v_max3_f32 v12, v12, v40, v41
    v_max3_f32 v12, v12, v42, v43
    v_max3_f32 v12, v12, v44, v45
    v_max3_f32 v12, v12, v46, v47
    v_max3_f32 v13, v13, v48, v49
    v_max3_f32 v13, v13, v50, v51
    v_max3_f32 v13, v13, v52, v53
    v_max3_f32 v13, v13, v54, v55
    v_max3_f32 v13, v13, v56, v57
    v_max3_f32 v13, v13, v58, v59
    v_max3_f32 v13, v13, v60, v61
    v_max3_f32 v13, v13, v62, v63
    v_add_u32 v8, 9472, v8
    s_sub_u32 s60, s60, 1
    s_cmp_lg_u32 s60, 0
    s_cbranch_scc1 m_fbl
    v_lshlrev_b32 v8, 4, v1
    v_mov_b32 v14, v12
    v_mov_b32 v15, v13
    s_nop 0
    v_permlane32_swap_b32 v12, v14
    v_permlane32_swap_b32 v13, v15
    v_max_f32 v12, v12, v14
    v_max_f32 v13, v13, v15
    v_sub_f32 v144, 0, v12
    v_sub_f32 v160, 0, v13
    v_sub_f32 v145, 0, v12
    v_sub_f32 v161, 0, v13
    v_sub_f32 v146, 0, v12
    v_sub_f32 v162, 0, v13
    v_sub_f32 v147, 0, v12
    v_sub_f32 v163, 0, v13
    v_sub_f32 v148, 0, v12
    v_sub_f32 v164, 0, v13
    v_sub_f32 v149, 0, v12
    v_sub_f32 v165, 0, v13
    v_sub_f32 v150, 0, v12
    v_sub_f32 v166, 0, v13
    v_sub_f32 v151, 0, v12
    v_sub_f32 v167, 0, v13
    v_sub_f32 v152, 0, v12
    v_sub_f32 v168, 0, v13
    v_sub_f32 v153, 0, v12
    v_sub_f32 v169, 0, v13
    v_sub_f32 v154, 0, v12
    v_sub_f32 v170, 0, v13
    v_sub_f32 v155, 0, v12
    v_sub_f32 v171, 0, v13
    v_sub_f32 v156, 0, v12
    v_sub_f32 v172, 0, v13
    v_sub_f32 v157, 0, v12
    v_sub_f32 v173, 0, v13
    v_sub_f32 v158, 0, v12
    v_sub_f32 v174, 0, v13
    v_sub_f32 v159, 0, v12
    v_sub_f32 v175, 0, v13
    ds_read_b128 v[108:111], v8 offset:4096
    ds_read_b128 v[104:107], v8
    ds_read_b128 v[112:115], v8 offset:1024
    ds_read_b128 v[248:251], v9 offset:608
    s_waitcnt lgkmcnt(2)
    v_mfma_f32_32x32x4_2b_bf16 v[32:63], v[108:109], v[28:29], v[144:175] cbsz:1 abid:0
    v_mov_b32 v120, 0
    v_mov_b32 v121, 0
    v_mov_b32 v122, 0
    v_mov_b32 v123, 0
    s_waitcnt lgkmcnt(0)
    s_nop 12
    v_mfma_f32_32x32x16_bf16 v[32:47], v[104:107], v[96:99], v[32:47]
    v_mfma_f32_32x32x16_bf16 v[48:63], v[104:107], v[100:103], v[48:63]
    ds_read_b128 v[104:107], v8 offset:2048
    ds_read_b128 v[116:119], v9 offset:1216
    v_mov_b32 v15, v10
    s_mov_b32 s60, 1
    s_mov_b32 s61, 0x0304
    s_mov_b32 s59, 0x07060302
    s_setprio 0
    s_nop 5
f_loop:
    v_mfma_f32_32x32x4_2b_bf16 v[64:95], v[108:109], v[30:31], v[144:175] cbsz:1 abid:0
    v_exp_f32 v32, v32
    v_exp_f32 v33, v33
    v_exp_f32 v34, v34
    v_cvt_pk_bf16_f32 v232, v32, v33
    v_exp_f32 v35, v35
    v_exp_f32 v36, v36
    v_cvt_pk_bf16_f32 v233, v34, v35
    v_exp_f32 v37, v37
    v_exp_f32 v38, v38
    v_cvt_pk_bf16_f32 v234, v36, v37
    v_exp_f32 v39, v39
    v_mfma_f32_32x32x16_bf16 v[216:231], v[120:123], v[244:247], v[216:231]
    s_waitcnt lgkmcnt(4)
    ds_read_b128 v[120:123], v9 offset:1824
    v_exp_f32 v40, v40
    v_cvt_pk_bf16_f32 v235, v38, v39
    v_exp_f32 v41, v41
    v_exp_f32 v42, v42
    v_cvt_pk_bf16_f32 v236, v40, v41
    v_exp_f32 v43, v43
    v_mfma_f32_32x32x16_bf16 v[64:79], v[112:115], v[96:99], v[64:79]
    s_waitcnt lgkmcnt(4)
    v_exp_f32 v44, v44
    v_cvt_pk_bf16_f32 v237, v42, v43
    v_exp_f32 v45, v45
    v_exp_f32 v46, v46
    v_cvt_pk_bf16_f32 v238, v44, v45
    v_exp_f32 v47, v47
    v_mfma_f32_32x32x16_bf16 v[200:215], v[196:199], v[232:235], v[200:215]
    v_exp_f32 v48, v48
    v_cvt_pk_bf16_f32 v239, v46, v47
    v_exp_f32 v49, v49
    v_exp_f32 v50, v50
    v_cvt_pk_bf16_f32 v240, v48, v49
    v_exp_f32 v51, v51
    v_mfma_f32_32x32x16_bf16 v[80:95], v[112:115], v[100:103], v[80:95]
    s_waitcnt lgkmcnt(3)
    ds_read_b128 v[112:115], v8 offset:3072
    v_exp_f32 v52, v52
    v_cvt_pk_bf16_f32 v241, v50, v51
    v_exp_f32 v53, v53
    v_exp_f32 v54, v54
    v_cvt_pk_bf16_f32 v242, v52, v53
    v_exp_f32 v55, v55
    v_mfma_f32_32x32x16_bf16 v[200:215], v[248:251], v[236:239], v[200:215]
    v_exp_f32 v56, v56
    v_cvt_pk_bf16_f32 v243, v54, v55
    v_exp_f32 v57, v57
    v_exp_f32 v58, v58
    v_cvt_pk_bf16_f32 v244, v56, v57
    v_exp_f32 v59, v59
    v_mfma_f32_32x32x16_bf16 v[216:231], v[196:199], v[240:243], v[216:231]
    ds_read_b128 v[196:199], v9 offset:2432
    v_exp_f32 v60, v60
    v_cvt_pk_bf16_f32 v245, v58, v59
    v_exp_f32 v61, v61
    v_exp_f32 v62, v62
    v_exp_f32 v63, v63
    v_cvt_pk_bf16_f32 v246, v60, v61
    v_cvt_pk_bf16_f32 v247, v62, v63
    v_mfma_f32_32x32x4_2b_bf16 v[32:63], v[110:111], v[28:29], v[144:175] cbsz:1 abid:0
    v_exp_f32 v64, v64
    v_exp_f32 v65, v65
    v_exp_f32 v66, v66
    v_cvt_pk_bf16_f32 v232, v64, v65
    v_exp_f32 v67, v67
    v_exp_f32 v68, v68
    v_cvt_pk_bf16_f32 v233, v66, v67
    v_exp_f32 v69, v69
    v_exp_f32 v70, v70
    v_cvt_pk_bf16_f32 v234, v68, v69
    v_exp_f32 v71, v71
    v_mfma_f32_32x32x16_bf16 v[216:231], v[248:251], v[244:247], v[216:231]
    s_waitcnt lgkmcnt(4)
    ds_read_b128 v[248:251], v9 offset:3040
    v_exp_f32 v72, v72
    v_cvt_pk_bf16_f32 v235, v70, v71
    v_exp_f32 v73, v73
    v_exp_f32 v74, v74
    v_cvt_pk_bf16_f32 v236, v72, v73
    v_exp_f32 v75, v75
    v_mfma_f32_32x32x16_bf16 v[32:47], v[104:107], v[96:99], v[32:47]
    s_waitcnt lgkmcnt(4)
    v_exp_f32 v76, v76
    v_cvt_pk_bf16_f32 v237, v74, v75
    v_exp_f32 v77, v77
    v_exp_f32 v78, v78
    v_cvt_pk_bf16_f32 v238, v76, v77
    v_exp_f32 v79, v79
    v_mfma_f32_32x32x16_bf16 v[200:215], v[116:119], v[232:235], v[200:215]
    v_exp_f32 v80, v80
    v_cvt_pk_bf16_f32 v239, v78, v79
    v_exp_f32 v81, v81
    v_exp_f32 v82, v82
    v_cvt_pk_bf16_f32 v240, v80, v81
    v_exp_f32 v83, v83
    v_mfma_f32_32x32x16_bf16 v[48:63], v[104:107], v[100:103], v[48:63]
    s_waitcnt lgkmcnt(3)
    ds_read_b128 v[104:107], v8 offset:9472
    v_exp_f32 v84, v84
    v_cvt_pk_bf16_f32 v241, v82, v83
    v_exp_f32 v85, v85
    v_exp_f32 v86, v86
    v_cvt_pk_bf16_f32 v242, v84, v85
    v_exp_f32 v87, v87
    v_mfma_f32_32x32x16_bf16 v[200:215], v[120:123], v[236:239], v[200:215]
    v_exp_f32 v88, v88
    v_cvt_pk_bf16_f32 v243, v86, v87
    v_exp_f32 v89, v89
    v_exp_f32 v90, v90
    v_cvt_pk_bf16_f32 v244, v88, v89
    v_exp_f32 v91, v91
    v_mfma_f32_32x32x16_bf16 v[216:231], v[116:119], v[240:243], v[216:231]
    ds_read_b128 v[116:119], v9 offset:3648
    v_exp_f32 v92, v92
    v_cvt_pk_bf16_f32 v245, v90, v91
    v_exp_f32 v93, v93
    v_exp_f32 v94, v94
    v_exp_f32 v95, v95
    v_cvt_pk_bf16_f32 v246, v92, v93
    v_cvt_pk_bf16_f32 v247, v94, v95
    v_mfma_f32_32x32x4_2b_bf16 v[64:95], v[110:111], v[30:31], v[144:175] cbsz:1 abid:0
    v_exp_f32 v32, v32
    v_exp_f32 v33, v33
    v_exp_f32 v34, v34
    v_cvt_pk_bf16_f32 v232, v32, v33
    v_exp_f32 v35, v35
    v_exp_f32 v36, v36
    v_cvt_pk_bf16_f32 v233, v34, v35
    v_exp_f32 v37, v37
    v_exp_f32 v38, v38
    v_cvt_pk_bf16_f32 v234, v36, v37
    v_exp_f32 v39, v39
    v_mfma_f32_32x32x16_bf16 v[216:231], v[120:123], v[244:247], v[216:231]
    s_waitcnt lgkmcnt(4)
    ds_read_b128 v[120:123], v9 offset:4256
    v_exp_f32 v40, v40
    v_cvt_pk_bf16_f32 v235, v38, v39
    v_exp_f32 v41, v41
    v_exp_f32 v42, v42
    v_cvt_pk_bf16_f32 v236, v40, v41
    v_exp_f32 v43, v43
    v_mfma_f32_32x32x16_bf16 v[64:79], v[112:115], v[96:99], v[64:79]
    s_waitcnt lgkmcnt(4)
    ds_read_b128 v[108:111], v8 offset:13568
    v_exp_f32 v44, v44
    v_cvt_pk_bf16_f32 v237, v42, v43
    v_exp_f32 v45, v45
    v_exp_f32 v46, v46
    v_cvt_pk_bf16_f32 v238, v44, v45
    v_exp_f32 v47, v47
    v_mfma_f32_32x32x16_bf16 v[200:215], v[196:199], v[232:235], v[200:215]
    v_exp_f32 v48, v48
    v_cvt_pk_bf16_f32 v239, v46, v47
    v_exp_f32 v49, v49
    v_exp_f32 v50, v50
    v_cvt_pk_bf16_f32 v240, v48, v49
    v_exp_f32 v51, v51
    v_mfma_f32_32x32x16_bf16 v[80:95], v[112:115], v[100:103], v[80:95]
    s_waitcnt lgkmcnt(4)
    ds_read_b128 v[112:115], v8 offset:10496
    v_exp_f32 v52, v52
    v_cvt_pk_bf16_f32 v241, v50, v51
    v_exp_f32 v53, v53
    v_exp_f32 v54, v54
    v_cvt_pk_bf16_f32 v242, v52, v53
    v_exp_f32 v55, v55
    v_mfma_f32_32x32x16_bf16 v[200:215], v[248:251], v[236:239], v[200:215]
    v_exp_f32 v56, v56
    v_cvt_pk_bf16_f32 v243, v54, v55
    v_exp_f32 v57, v57
    v_exp_f32 v58, v58
    v_cvt_pk_bf16_f32 v244, v56, v57
    v_exp_f32 v59, v59
    v_mfma_f32_32x32x16_bf16 v[216:231], v[196:199], v[240:243], v[216:231]
    s_waitcnt lgkmcnt(1)
    ds_read_b128 v[196:199], v9 offset:9472
    v_exp_f32 v60, v60
    v_cvt_pk_bf16_f32 v245, v58, v59
    v_exp_f32 v61, v61
    v_exp_f32 v62, v62
    v_exp_f32 v63, v63
    v_cvt_pk_bf16_f32 v246, v60, v61
    v_cvt_pk_bf16_f32 v247, v62, v63
    v_mfma_f32_32x32x4_2b_bf16 v[32:63], v[108:109], v[28:29], v[144:175] cbsz:1 abid:0
    v_exp_f32 v64, v64
    v_exp_f32 v65, v65
    v_exp_f32 v66, v66
    v_cvt_pk_bf16_f32 v232, v64, v65
    v_exp_f32 v67, v67
    v_exp_f32 v68, v68
    v_cvt_pk_bf16_f32 v233, v66, v67
    v_exp_f32 v69, v69
    v_exp_f32 v70, v70
    v_cvt_pk_bf16_f32 v234, v68, v69
    v_exp_f32 v71, v71
    v_mfma_f32_32x32x16_bf16 v[216:231], v[248:251], v[244:247], v[216:231]
    s_waitcnt lgkmcnt(5)
    ds_read_b128 v[248:251], v9 offset:10080
    v_exp_f32 v72, v72
    v_cvt_pk_bf16_f32 v235, v70, v71
    v_exp_f32 v73, v73
    v_exp_f32 v74, v74
    v_cvt_pk_bf16_f32 v236, v72, v73
    v_exp_f32 v75, v75
    v_mfma_f32_32x32x16_bf16 v[32:47], v[104:107], v[96:99], v[32:47]
    s_waitcnt lgkmcnt(5)
    v_exp_f32 v76, v76
    v_cvt_pk_bf16_f32 v237, v74, v75
    v_exp_f32 v77, v77
    v_exp_f32 v78, v78
    v_cvt_pk_bf16_f32 v238, v76, v77
    v_exp_f32 v79, v79
    v_mfma_f32_32x32x16_bf16 v[200:215], v[116:119], v[232:235], v[200:215]
    v_exp_f32 v80, v80
    v_cvt_pk_bf16_f32 v239, v78, v79
    v_exp_f32 v81, v81
    v_exp_f32 v82, v82
    v_cvt_pk_bf16_f32 v240, v80, v81
    v_exp_f32 v83, v83
    v_mfma_f32_32x32x16_bf16 v[48:63], v[104:107], v[100:103], v[48:63]
    s_waitcnt lgkmcnt(4)
    ds_read_b128 v[104:107], v8 offset:11520
    v_exp_f32 v84, v84
    v_cvt_pk_bf16_f32 v241, v82, v83
    v_exp_f32 v85, v85
    v_exp_f32 v86, v86
    v_cvt_pk_bf16_f32 v242, v84, v85
    v_exp_f32 v87, v87
    v_mfma_f32_32x32x16_bf16 v[200:215], v[120:123], v[236:239], v[200:215]
    v_exp_f32 v88, v88
    v_cvt_pk_bf16_f32 v243, v86, v87
    v_exp_f32 v89, v89
    v_exp_f32 v90, v90
    v_cvt_pk_bf16_f32 v244, v88, v89
    v_exp_f32 v91, v91
    v_mfma_f32_32x32x16_bf16 v[216:231], v[116:119], v[240:243], v[216:231]
    ds_read_b128 v[116:119], v9 offset:10688
    v_exp_f32 v92, v92
    v_cvt_pk_bf16_f32 v245, v90, v91
    v_exp_f32 v93, v93
    v_exp_f32 v94, v94
    v_exp_f32 v95, v95
    v_cvt_pk_bf16_f32 v246, v92, v93
    v_cvt_pk_bf16_f32 v247, v94, v95
    v_mfma_f32_32x32x4_2b_bf16 v[64:95], v[108:109], v[30:31], v[144:175] cbsz:1 abid:0
    v_exp_f32 v32, v32
    v_exp_f32 v33, v33
    v_exp_f32 v34, v34
    v_cvt_pk_bf16_f32 v232, v32, v33
    v_exp_f32 v35, v35
    v_exp_f32 v36, v36
    v_cvt_pk_bf16_f32 v233, v34, v35
    v_exp_f32 v37, v37
    v_exp_f32 v38, v38
    v_cvt_pk_bf16_f32 v234, v36, v37
    v_exp_f32 v39, v39
    v_mfma_f32_32x32x16_bf16 v[216:231], v[120:123], v[244:247], v[216:231]
    s_waitcnt lgkmcnt(4)
    ds_read_b128 v[120:123], v9 offset:11296
    v_exp_f32 v40, v40
    v_cvt_pk_bf16_f32 v235, v38, v39
    v_exp_f32 v41, v41
    v_exp_f32 v42, v42
    v_cvt_pk_bf16_f32 v236, v40, v41
    v_exp_f32 v43, v43
    v_mfma_f32_32x32x16_bf16 v[64:79], v[112:115], v[96:99], v[64:79]
    s_waitcnt lgkmcnt(4)
    v_exp_f32 v44, v44
    v_cvt_pk_bf16_f32 v237, v42, v43
    v_exp_f32 v45, v45
    v_exp_f32 v46, v46
    v_cvt_pk_bf16_f32 v238, v44, v45
    v_exp_f32 v47, v47
    v_mfma_f32_32x32x16_bf16 v[200:215], v[196:199], v[232:235], v[200:215]
    v_exp_f32 v48, v48
    v_cvt_pk_bf16_f32 v239, v46, v47
    v_exp_f32 v49, v49
    v_exp_f32 v50, v50
    v_cvt_pk_bf16_f32 v240, v48, v49
    v_exp_f32 v51, v51
    v_mfma_f32_32x32x16_bf16 v[80:95], v[112:115], v[100:103], v[80:95]
    s_waitcnt lgkmcnt(3)
    ds_read_b128 v[112:115], v8 offset:12544
    v_exp_f32 v52, v52
    v_cvt_pk_bf16_f32 v241, v50, v51
    v_exp_f32 v53, v53
    v_exp_f32 v54, v54
    v_cvt_pk_bf16_f32 v242, v52, v53
    v_exp_f32 v55, v55
    v_mfma_f32_32x32x16_bf16 v[200:215], v[248:251], v[236:239], v[200:215]
    v_exp_f32 v56, v56
    v_cvt_pk_bf16_f32 v243, v54, v55
    v_exp_f32 v57, v57
    v_exp_f32 v58, v58
    v_cvt_pk_bf16_f32 v244, v56, v57
    v_exp_f32 v59, v59
    v_mfma_f32_32x32x16_bf16 v[216:231], v[196:199], v[240:243], v[216:231]
    ds_read_b128 v[196:199], v9 offset:11904
    v_exp_f32 v60, v60
    v_cvt_pk_bf16_f32 v245, v58, v59
    v_exp_f32 v61, v61
    v_exp_f32 v62, v62
    v_exp_f32 v63, v63
    v_cvt_pk_bf16_f32 v246, v60, v61
    v_cvt_pk_bf16_f32 v247, v62, v63
    v_mfma_f32_32x32x4_2b_bf16 v[32:63], v[110:111], v[28:29], v[144:175] cbsz:1 abid:0
    v_exp_f32 v64, v64
    v_exp_f32 v65, v65
    v_exp_f32 v66, v66
    v_cvt_pk_bf16_f32 v232, v64, v65
    v_exp_f32 v67, v67
    v_exp_f32 v68, v68
    v_cvt_pk_bf16_f32 v233, v66, v67
    v_exp_f32 v69, v69
    v_exp_f32 v70, v70
    v_cvt_pk_bf16_f32 v234, v68, v69
    v_exp_f32 v71, v71
    v_mfma_f32_32x32x16_bf16 v[216:231], v[248:251], v[244:247], v[216:231]
    s_waitcnt lgkmcnt(4)
    ds_read_b128 v[248:251], v9 offset:12512
    v_exp_f32 v72, v72
    v_cvt_pk_bf16_f32 v235, v70, v71
    v_exp_f32 v73, v73
    v_exp_f32 v74, v74
    v_cvt_pk_bf16_f32 v236, v72, v73
    v_exp_f32 v75, v75
    v_mfma_f32_32x32x16_bf16 v[32:47], v[104:107], v[96:99], v[32:47]
    s_waitcnt lgkmcnt(4)
    v_exp_f32 v76, v76
    v_cvt_pk_bf16_f32 v237, v74, v75
    v_exp_f32 v77, v77
    v_exp_f32 v78, v78
    v_cvt_pk_bf16_f32 v238, v76, v77
    v_exp_f32 v79, v79
    v_mfma_f32_32x32x16_bf16 v[200:215], v[116:119], v[232:235], v[200:215]
    v_exp_f32 v80, v80
    v_cvt_pk_bf16_f32 v239, v78, v79
    v_exp_f32 v81, v81
    v_exp_f32 v82, v82
    v_cvt_pk_bf16_f32 v240, v80, v81
    v_exp_f32 v83, v83
    v_mfma_f32_32x32x16_bf16 v[48:63], v[104:107], v[100:103], v[48:63]
    s_waitcnt lgkmcnt(3)
    ds_read_b128 v[104:107], v8 offset:18944
    v_exp_f32 v84, v84
    v_cvt_pk_bf16_f32 v241, v82, v83
    v_exp_f32 v85, v85
    v_exp_f32 v86, v86
    v_cvt_pk_bf16_f32 v242, v84, v85
    v_exp_f32 v87, v87
    v_mfma_f32_32x32x16_bf16 v[200:215], v[120:123], v[236:239], v[200:215]
    v_exp_f32 v88, v88
    v_cvt_pk_bf16_f32 v243, v86, v87
    v_exp_f32 v89, v89
    v_exp_f32 v90, v90
    v_cvt_pk_bf16_f32 v244, v88, v89
    v_exp_f32 v91, v91
    v_mfma_f32_32x32x16_bf16 v[216:231], v[116:119], v[240:243], v[216:231]
    ds_read_b128 v[116:119], v9 offset:13120
    v_exp_f32 v92, v92
    v_cvt_pk_bf16_f32 v245, v90, v91
    v_exp_f32 v93, v93
    v_exp_f32 v94, v94
    v_exp_f32 v95, v95
    v_cvt_pk_bf16_f32 v246, v92, v93
    v_cvt_pk_bf16_f32 v247, v94, v95
    v_mfma_f32_32x32x4_2b_bf16 v[64:95], v[110:111], v[30:31], v[144:175] cbsz:1 abid:0
    v_exp_f32 v32, v32
    v_exp_f32 v33, v33
    v_exp_f32 v34, v34
    v_cvt_pk_bf16_f32 v232, v32, v33
    v_exp_f32 v35, v35
    v_exp_f32 v36, v36
    v_cvt_pk_bf16_f32 v233, v34, v35
    v_exp_f32 v37, v37
    v_exp_f32 v38, v38
    v_cvt_pk_bf16_f32 v234, v36, v37
    v_exp_f32 v39, v39
    v_mfma_f32_32x32x16_bf16 v[216:231], v[120:123], v[244:247], v[216:231]
    s_waitcnt lgkmcnt(4)
    ds_read_b128 v[120:123], v9 offset:13728
    v_exp_f32 v40, v40
    v_cvt_pk_bf16_f32 v235, v38, v39
    v_exp_f32 v41, v41
    v_exp_f32 v42, v42
    v_cvt_pk_bf16_f32 v236, v40, v41
    v_exp_f32 v43, v43
    v_mfma_f32_32x32x16_bf16 v[64:79], v[112:115], v[96:99], v[64:79]
    s_waitcnt lgkmcnt(4)
    ds_read_b128 v[108:111], v8 offset:23040
    v_exp_f32 v44, v44
    v_cvt_pk_bf16_f32 v237, v42, v43
    v_exp_f32 v45, v45
    v_exp_f32 v46, v46
    v_cvt_pk_bf16_f32 v238, v44, v45
    v_exp_f32 v47, v47
    v_mfma_f32_32x32x16_bf16 v[200:215], v[196:199], v[232:235], v[200:215]
    v_exp_f32 v48, v48
    v_cvt_pk_bf16_f32 v239, v46, v47
    v_exp_f32 v49, v49
    v_exp_f32 v50, v50
    v_cvt_pk_bf16_f32 v240, v48, v49
    v_exp_f32 v51, v51
    v_mfma_f32_32x32x16_bf16 v[80:95], v[112:115], v[100:103], v[80:95]
    s_waitcnt lgkmcnt(4)
    ds_read_b128 v[112:115], v8 offset:19968
    v_exp_f32 v52, v52
    v_cvt_pk_bf16_f32 v241, v50, v51
    v_exp_f32 v53, v53
    v_exp_f32 v54, v54
    v_cvt_pk_bf16_f32 v242, v52, v53
    v_exp_f32 v55, v55
    v_mfma_f32_32x32x16_bf16 v[200:215], v[248:251], v[236:239], v[200:215]
    v_exp_f32 v56, v56
    v_cvt_pk_bf16_f32 v243, v54, v55
    v_exp_f32 v57, v57
    v_exp_f32 v58, v58
    v_cvt_pk_bf16_f32 v244, v56, v57
    v_exp_f32 v59, v59
    v_mfma_f32_32x32x16_bf16 v[216:231], v[196:199], v[240:243], v[216:231]
    s_waitcnt lgkmcnt(1)
    ds_read_b128 v[196:199], v9 offset:18944
    v_exp_f32 v60, v60
    v_cvt_pk_bf16_f32 v245, v58, v59
    v_exp_f32 v61, v61
    v_exp_f32 v62, v62
    v_exp_f32 v63, v63
    v_cvt_pk_bf16_f32 v246, v60, v61
    v_cvt_pk_bf16_f32 v247, v62, v63
    v_mfma_f32_32x32x4_2b_bf16 v[32:63], v[108:109], v[28:29], v[144:175] cbsz:1 abid:0
    v_exp_f32 v64, v64
    v_exp_f32 v65, v65
    v_exp_f32 v66, v66
    v_cvt_pk_bf16_f32 v232, v64, v65
    v_exp_f32 v67, v67
    v_exp_f32 v68, v68
    v_cvt_pk_bf16_f32 v233, v66, v67
    v_exp_f32 v69, v69
    v_exp_f32 v70, v70
    v_cvt_pk_bf16_f32 v234, v68, v69
    v_exp_f32 v71, v71
    v_mfma_f32_32x32x16_bf16 v[216:231], v[248:251], v[244:247], v[216:231]
    s_waitcnt lgkmcnt(5)
    ds_read_b128 v[248:251], v9 offset:19552
    v_exp_f32 v72, v72
    v_cvt_pk_bf16_f32 v235, v70, v71
    v_exp_f32 v73, v73
    v_exp_f32 v74, v74
    v_cvt_pk_bf16_f32 v236, v72, v73
    v_exp_f32 v75, v75
    v_mfma_f32_32x32x16_bf16 v[32:47], v[104:107], v[96:99], v[32:47]
    s_waitcnt lgkmcnt(5)
    v_exp_f32 v76, v76
    v_cvt_pk_bf16_f32 v237, v74, v75
    v_exp_f32 v77, v77
    v_exp_f32 v78, v78
    v_cvt_pk_bf16_f32 v238, v76, v77
    v_exp_f32 v79, v79
    v_mfma_f32_32x32x16_bf16 v[200:215], v[116:119], v[232:235], v[200:215]
    s_sub_u32 s60, s60, 1
    v_exp_f32 v80, v80
    v_cvt_pk_bf16_f32 v239, v78, v79
    v_exp_f32 v81, v81
    v_exp_f32 v82, v82
    v_cvt_pk_bf16_f32 v240, v80, v81
    v_exp_f32 v83, v83
    v_mfma_f32_32x32x16_bf16 v[48:63], v[104:107], v[100:103], v[48:63]
    s_waitcnt lgkmcnt(4)
    ds_read_b128 v[104:107], v8 offset:20992
    v_exp_f32 v84, v84
    v_cvt_pk_bf16_f32 v241, v82, v83
    v_exp_f32 v85, v85
    v_exp_f32 v86, v86
    v_cvt_pk_bf16_f32 v242, v84, v85
    v_exp_f32 v87, v87
    v_mfma_f32_32x32x16_bf16 v[200:215], v[120:123], v[236:239], v[200:215]
    s_cmp_lg_u32 s60, 0
    v_exp_f32 v88, v88
    v_cvt_pk_bf16_f32 v243, v86, v87
    v_exp_f32 v89, v89
    v_exp_f32 v90, v90
    v_cvt_pk_bf16_f32 v244, v88, v89
    v_exp_f32 v91, v91
    v_mfma_f32_32x32x16_bf16 v[216:231], v[116:119], v[240:243], v[216:231]
    ds_read_b128 v[116:119], v9 offset:20160
    v_exp_f32 v92, v92
    v_cvt_pk_bf16_f32 v245, v90, v91
    v_exp_f32 v93, v93
    v_exp_f32 v94, v94
    v_exp_f32 v95, v95
    v_cvt_pk_bf16_f32 v246, v92, v93
    v_add_u32 v8, 18944, v8
    v_add_u32 v9, 18944, v9
    v_cvt_pk_bf16_f32 v247, v94, v95
    s_cbranch_scc1 f_loop
    s_cmp_eq_u32 s61, 0
    s_cbranch_scc1 m_done
    s_mov_b64 exec, 1
    ds_add_u32 v15, v11 offset:12
    s_mov_b64 exec, -1
    v_add_u32 v15, 4, v15
    s_and_b32 s60, s61, 0xff
    s_lshr_b32 s61, s61, 8
f_lv:
    ds_read_b32 v14, v15 offset:0
    s_waitcnt lgkmcnt(0)
    v_readfirstlane_b32 s66, v14
    s_cmp_ge_u32 s66, 4
    s_cbranch_scc1 f_lv_ok
    s_sleep 1
    s_sub_i32 s0, s0, 1
    s_cmp_lt_i32 s0, 0
    s_cbranch_scc0 f_lv
f_lv_ok:
    s_branch f_loop
k_aux:
    s_load_dword s100, s[10:11], 172032
    s_sub_u32 s3, s3, 4
    s_and_b32 s58, s2, 7
    s_lshr_b32 s59, s2, 3
    s_mov_b32 s28, s12
    s_mov_b32 s29, s13
    s_mov_b32 s30, 663552
    s_mov_b32 s31, 0x20000
    s_bitcmp1_b32 s53, 0
    s_cselect_b32 s40, s16, s14
    s_cselect_b32 s41, s17, s15
    s_mov_b32 s42, 20736
    s_mov_b32 s43, 0x20000
    s_and_b32 s54, s59, 3
    s_lshr_b32 s55, s59, 3
    s_lshl_b32 s55, s55, 2
    s_add_u32 s54, s54, s55
    s_mul_i32 s54, s54, 1408
    s_mul_i32 s55, s3, 384
    s_add_u32 s54, s54, s55
    s_mov_b64 exec, 0x7
    buffer_load_dword v255, v254, s[40:43], s54 offen
    s_mov_b64 exec, -1
    s_getpc_b64 s[36:37]
    s_add_u32 s36, s36, tbl_blob@rel32@lo+4
    s_addc_u32 s37, s37, tbl_blob@rel32@hi+12
    s_mov_b32 s38, 145408
    s_mov_b32 s39, 0x20000
    s_lshl_b32 s62, s58, 5
    s_add_u32 s62, s62, s59
    s_mov_b32 s48, s20
    s_mov_b32 s49, s21
    s_mov_b32 s50, 1152
    s_mov_b32 s51, 0x20000
    s_lshl_b32 s54, s59, 2
    s_add_u32 s54, s54, s3
    s_lshl_b32 s54, s54, 7
    s_cmp_ge_u32 s54, 12288
    s_cselect_b32 s44, s48, s36
    s_cselect_b32 s45, s49, s37
    s_cselect_b32 s46, s50, s38
    s_cselect_b32 s55, 12288, 0
    s_mov_b32 s47, 0x20000
    s_sub_u32 s54, s54, s55
    s_mov_b64 exec, 0x1
    buffer_load_dword v255, v254, s[44:47], s54 offen
    s_mov_b64 exec, -1
    v_lshlrev_b32 v8, 4, v1
    v_and_b32 v2, 31, v1
    v_lshrrev_b32 v3, 5, v1
    s_lshl_b32 s54, s3, 6
    v_add_u32 v12, s54, v1
    v_mul_u32_u24 v13, 21846, v12
    v_lshrrev_b32 v13, 16, v13
    v_mul_u32_u24 v14, 3, v13
    v_sub_u32 v14, v12, v14
    v_lshlrev_b32 v14, 4, v14
    v_min_u32 v14, 20, v14
    v_mad_u32_u24 v24, v13, 36, v14
    v_add_u32 v12, 256, v12
    v_mul_u32_u24 v13, 21846, v12
    v_lshrrev_b32 v13, 16, v13
    v_mul_u32_u24 v14, 3, v13
    v_sub_u32 v14, v12, v14
    v_lshlrev_b32 v14, 4, v14
    v_min_u32 v14, 20, v14
    v_mad_u32_u24 v25, v13, 36, v14
    v_add_u32 v12, 256, v12
    v_mul_u32_u24 v13, 21846, v12
    v_lshrrev_b32 v13, 16, v13
    v_mul_u32_u24 v14, 3, v13
    v_sub_u32 v14, v12, v14
    v_lshlrev_b32 v14, 4, v14
    v_min_u32 v14, 20, v14
    v_mad_u32_u24 v26, v13, 36, v14
    s_lshl_b32 s54, s3, 10
    s_mov_b32 s55, 0
    s_add_u32 m0, s54, 0
    s_nop 0
    buffer_load_dwordx4 v24, s[40:43], s55 offen lds
    s_mov_b32 s55, 0
    s_add_u32 m0, s54, 4096
    s_nop 0
    buffer_load_dwordx4 v25, s[40:43], s55 offen lds
    s_mov_b32 s55, 0
    s_add_u32 m0, s54, 8192
    s_nop 0
    buffer_load_dwordx4 v26, s[40:43], s55 offen lds
    s_mov_b32 s55, 9216
    s_add_u32 m0, s54, 12288
    s_nop 0
    buffer_load_dwordx4 v24, s[40:43], s55 offen lds
    s_mov_b32 s55, 9216
    s_add_u32 m0, s54, 16384
    s_nop 0
    buffer_load_dwordx4 v25, s[40:43], s55 offen lds
    s_mov_b32 s55, 9216
    s_add_u32 m0, s54, 20480
    s_nop 0
    buffer_load_dwordx4 v26, s[40:43], s55 offen lds
    s_mov_b32 s55, 18432
    s_cmp_eq_u32 s3, 3
    s_cbranch_scc1 a_kw
    s_add_u32 m0, s54, 24576
    s_nop 0
    buffer_load_dwordx4 v24, s[40:43], s55 offen lds
a_kw:
    s_barrier
    s_mul_i32 s54, s2, 2592
    s_mul_i32 s55, s3, 768
    s_add_u32 s54, s54, s55
    s_mov_b64 exec, 0x3f
    buffer_load_dword v255, v254, s[28:31], s54 offen
    s_mov_b64 exec, -1
    v_add_u32 v12, 0, v1
    v_mul_u32_u24 v13, 6554, v12
    v_lshrrev_b32 v13, 16, v13
    v_mul_u32_u24 v14, 10, v13
    v_sub_u32 v12, v12, v14
    v_lshrrev_b32 v14, 3, v13
    v_mad_u32_u24 v13, v14, 24, v13
    v_mul_u32_u24 v13, 1152, v13
    v_lshl_add_u32 v16, v12, 4, v13
    v_add_u32 v12, 64, v1
    v_mul_u32_u24 v13, 6554, v12
    v_lshrrev_b32 v13, 16, v13
    v_mul_u32_u24 v14, 10, v13
    v_sub_u32 v12, v12, v14
    v_lshrrev_b32 v14, 3, v13
    v_mad_u32_u24 v13, v14, 24, v13
    v_mul_u32_u24 v13, 1152, v13
    v_lshl_add_u32 v17, v12, 4, v13
    v_subrev_u32 v17, 1024, v17
    v_add_u32 v12, 128, v1
    v_mul_u32_u24 v13, 6554, v12
    v_lshrrev_b32 v13, 16, v13
    v_mul_u32_u24 v14, 10, v13
    v_sub_u32 v12, v12, v14
    v_lshrrev_b32 v14, 3, v13
    v_mad_u32_u24 v13, v14, 24, v13
    v_mul_u32_u24 v13, 1152, v13
    v_lshl_add_u32 v18, v12, 4, v13
    v_subrev_u32 v18, 2048, v18
    v_add_u32 v12, 192, v1
    v_mul_u32_u24 v13, 6554, v12
    v_lshrrev_b32 v13, 16, v13
    v_mul_u32_u24 v14, 10, v13
    v_sub_u32 v12, v12, v14
    v_lshrrev_b32 v14, 3, v13
    v_mad_u32_u24 v13, v14, 24, v13
    v_mul_u32_u24 v13, 1152, v13
    v_lshl_add_u32 v19, v12, 4, v13
    v_subrev_u32 v19, 3072, v19
    v_add_u32 v12, 256, v1
    v_mul_u32_u24 v13, 6554, v12
    v_lshrrev_b32 v13, 16, v13
    v_mul_u32_u24 v14, 10, v13
    v_sub_u32 v12, v12, v14
    v_lshrrev_b32 v14, 3, v13
    v_mad_u32_u24 v13, v14, 24, v13
    v_mul_u32_u24 v13, 1152, v13
    v_lshl_add_u32 v20, v12, 4, v13
    s_mul_i32 s57, s53, 144
    s_min_u32 s57, s57, 992
    s_lshl_b32 s60, s58, 7
    s_lshl_b32 s54, s3, 5
    s_add_u32 s60, s60, s54
    s_add_u32 s60, s60, s59
    v_add_u32 v248, 1179520, v8
    v_add_u32 v13, 1024, v8
    v_cmp_gt_u32 vcc, 8, v1
    v_add_u32 v249, 1180544, v8
    s_mul_i32 s54, s60, 1152
    v_cndmask_b32 v248, v248, v13, vcc
    s_lshr_b32 s44, s53, 1
    s_add_u32 s44, s44, 0
    s_and_b32 s44, s44, 3
    s_mul_i32 s44, s44, 10240
    s_add_u32 s44, s44, 120192
    s_lshr_b32 s45, s53, 1
    s_add_u32 s45, s45, 1
    s_and_b32 s45, s45, 3
    s_mul_i32 s45, s45, 10240
    s_add_u32 s45, s45, 120192
    s_lshr_b32 s46, s53, 1
    s_add_u32 s46, s46, 2
    s_and_b32 s46, s46, 3
    s_mul_i32 s46, s46, 10240
    s_add_u32 s46, s46, 120192
    s_mul_i32 s61, s3, 2304
    s_add_u32 s44, s44, s61
    v_mul_u32_u24 v155, 48, v2
    s_mov_b32 s47, s44
    s_waitcnt vmcnt(1)
    s_mov_b64 exec, 1
    ds_add_u32 v10, v11 offset:40
    s_mov_b64 exec, -1
    s_mul_i32 s63, s3, 23168
    s_add_u32 s63, s63, 27648
    s_mul_i32 s64, s3, 9216
    s_add_u32 s64, s64, s57
    s_add_u32 m0, s63, 0
    s_nop 0
    buffer_load_dwordx4 v16, s[28:31], s64 offen offset:0 lds
    buffer_load_dwordx4 v17, s[28:31], s64 offen offset:1024 lds
    buffer_load_dwordx4 v18, s[28:31], s64 offen offset:2048 lds
    buffer_load_dwordx4 v19, s[28:31], s64 offen offset:3072 lds
    s_add_u32 m0, s63, 4096
    s_nop 0
    buffer_load_dwordx4 v20, s[28:31], s64 offen offset:0 lds
    s_add_u32 s64, s64, 147456
    s_add_u32 m0, s63, 5120
    s_nop 0
    buffer_load_dwordx4 v16, s[28:31], s64 offen offset:0 lds
    buffer_load_dwordx4 v17, s[28:31], s64 offen offset:1024 lds
    buffer_load_dwordx4 v18, s[28:31], s64 offen offset:2048 lds
    buffer_load_dwordx4 v19, s[28:31], s64 offen offset:3072 lds
    s_add_u32 m0, s63, 9216
    s_nop 0
    buffer_load_dwordx4 v20, s[28:31], s64 offen offset:0 lds
    s_add_u32 s64, s64, 147456
    s_waitcnt vmcnt(5)
    s_mov_b64 exec, 1
    ds_add_u32 v10, v11 offset:44
    s_mov_b64 exec, -1
    s_add_u32 m0, s63, 10240
    s_nop 0
    buffer_load_dwordx4 v16, s[28:31], s64 offen offset:0 lds
    buffer_load_dwordx4 v17, s[28:31], s64 offen offset:1024 lds
    buffer_load_dwordx4 v18, s[28:31], s64 offen offset:2048 lds
    buffer_load_dwordx4 v19, s[28:31], s64 offen offset:3072 lds
    s_add_u32 m0, s63, 14336
    s_nop 0
    buffer_load_dwordx4 v20, s[28:31], s64 offen offset:0 lds
    s_add_u32 s64, s64, 147456
    s_add_u32 m0, s63, 15360
    s_nop 0
    buffer_load_dwordx4 v16, s[28:31], s64 offen offset:0 lds
    buffer_load_dwordx4 v17, s[28:31], s64 offen offset:1024 lds
    buffer_load_dwordx4 v18, s[28:31], s64 offen offset:2048 lds
    buffer_load_dwordx4 v19, s[28:31], s64 offen offset:3072 lds
    s_add_u32 m0, s63, 19456
    s_nop 0
    buffer_load_dwordx4 v20, s[28:31], s64 offen offset:0 lds
    s_add_u32 s64, s64, 147456
    s_waitcnt vmcnt(10)
    s_mov_b64 exec, 1
    ds_add_u32 v10, v11 offset:48
    s_mov_b64 exec, -1
    s_add_u32 m0, s63, 20480
    s_nop 0
    buffer_load_dwordx4 v16, s[28:31], s64 offen offset:0 lds
    buffer_load_dwordx4 v17, s[28:31], s64 offen offset:1024 lds
    s_mov_b64 exec, 0xffffffff
    buffer_load_dwordx4 v18, s[28:31], s64 offen offset:2048 lds
    s_mov_b64 exec, -1
a_xk:
    ds_read_b32 v14, v10 offset:108
    s_waitcnt lgkmcnt(0)
    v_readfirstlane_b32 s66, v14
    s_cmp_ge_u32 s66, 1
    s_cbranch_scc1 a_xk_ok
    s_sleep 1
    s_sub_i32 s0, s0, 1
    s_cmp_lt_i32 s0, 0
    s_cbranch_scc0 a_xk
a_xk_ok:
    s_add_u32 s68, s100, 1
    s_sub_u32 s99, 4, s3
    s_cmp_ge_u32 s3, 2
    s_cselect_b32 s99, s99, 0
    s_waitcnt vmcnt(8)
    s_mov_b64 exec, 1
    ds_add_u32 v10, v11 offset:52
    s_mov_b64 exec, -1
    s_cmp_eq_u32 s3, 3
    s_cbranch_scc0 a_rows
    s_waitcnt vmcnt(3)
    s_mov_b64 exec, 1
    ds_add_u32 v10, v11 offset:56
    s_mov_b64 exec, -1
    s_waitcnt vmcnt(0)
    s_mov_b64 exec, 1
    ds_add_u32 v10, v11 offset:60
    s_mov_b64 exec, -1
    s_branch a_sync
a_rows:
    s_setprio 1
    s_mov_b32 m0, s44
    s_nop 0
    buffer_load_dwordx4 v8, s[24:27], s54 offen lds
    s_add_u32 m0, s44, 1024
    s_nop 0
    buffer_load_dwordx4 v248, s[24:27], s54 offen lds
    s_add_u32 m0, s44, 2048
    s_mov_b64 exec, 0xffff
    buffer_load_dwordx4 v249, s[24:27], s54 offen lds
    s_mov_b64 exec, -1
    s_mov_b32 s55, 0
    buffer_load_dwordx4 v[28:31], v8, s[36:39], s55 offen offset:0
    buffer_load_dwordx4 v[32:35], v8, s[36:39], s55 offen offset:1024
    buffer_load_dwordx4 v[36:39], v8, s[36:39], s55 offen offset:2048
    buffer_load_dwordx4 v[40:43], v8, s[36:39], s55 offen offset:3072
    s_mov_b32 s55, 4096
    buffer_load_dwordx4 v[44:47], v8, s[36:39], s55 offen offset:0
    buffer_load_dwordx4 v[48:51], v8, s[36:39], s55 offen offset:1024
    buffer_load_dwordx4 v[52:55], v8, s[36:39], s55 offen offset:2048
    buffer_load_dwordx4 v[56:59], v8, s[36:39], s55 offen offset:3072
    s_mov_b32 s55, 8192
    buffer_load_dwordx4 v[60:63], v8, s[36:39], s55 offen offset:0
    buffer_load_dwordx4 v[64:67], v8, s[36:39], s55 offen offset:1024
    buffer_load_dwordx4 v[68:71], v8, s[36:39], s55 offen offset:2048
    buffer_load_dwordx4 v[72:75], v8, s[36:39], s55 offen offset:3072
    buffer_load_dwordx4 v[100:103], v155, s[48:51], 0 offen offset:0
    buffer_load_dwordx4 v[104:107], v155, s[48:51], 0 offen offset:16
    buffer_load_dwordx4 v[108:111], v155, s[48:51], 0 offen offset:32
    s_waitcnt vmcnt(21)
    s_mov_b64 exec, 1
    ds_add_u32 v10, v11 offset:56
    s_mov_b64 exec, -1
    s_waitcnt vmcnt(18)
    s_mov_b64 exec, 1
    ds_add_u32 v10, v11 offset:60
    s_mov_b64 exec, -1
    s_cmp_eq_u32 s3, 2
    s_cbranch_scc0 a_one
    s_add_u32 s54, s54, 36864
    s_add_u32 s44, s44, 2304
    s_mov_b32 m0, s44
    s_nop 0
    buffer_load_dwordx4 v8, s[24:27], s54 offen lds
    s_add_u32 m0, s44, 1024
    s_nop 0
    buffer_load_dwordx4 v248, s[24:27], s54 offen lds
    s_add_u32 m0, s44, 2048
    s_mov_b64 exec, 0xffff
    buffer_load_dwordx4 v249, s[24:27], s54 offen lds
    s_mov_b64 exec, -1
a_one:
    s_mul_i32 s61, s3, 2304
    v_bfe_u32 v13, v1, 2, 2
    v_lshl_add_u32 v13, v3, 2, v13
    v_mul_u32_u24 v13, 48, v13
    v_bfe_u32 v12, v1, 4, 1
    v_lshl_add_u32 v13, v12, 5, v13
    v_and_b32 v12, 3, v1
    v_lshl_add_u32 v13, v12, 3, v13
    v_add_u32 v152, s47, v13
    v_mul_u32_u24 v13, 1152, v3
    v_add3_u32 v153, v13, v155, s47
    v_lshl_add_u32 v5, v3, 3, v155
    s_add_u32 s55, s61, 151552
    v_add_u32 v5, s55, v5
    v_add_u32 v9, s55, v8
    v_add_u32 v170, s61, v8
    v_add_u32 v171, s45, v170
    v_lshlrev_b32 v172, 2, v3
    v_mul_u32_u24 v13, 1536, v3
    v_lshl_add_u32 v13, v2, 4, v13
    v_lshl_add_u32 v13, s3, 2, v13
    v_add_u32 v156, s45, v13
    v_add_u32 v251, 151552, v13
    v_add_u32 v12, 0, v1
    v_mul_u32_u24 v13, 6554, v12
    v_lshrrev_b32 v13, 16, v13
    v_mul_u32_u24 v14, 10, v13
    v_sub_u32 v12, v12, v14
    s_and_b32 s55, s3, 1
    s_lshl_b32 s55, s55, 2
    v_lshrrev_b32 v14, 2, v13
    v_add_u32 v14, s55, v14
    v_sub_u32 v12, v12, v14
    v_add_u32 v14, 10, v12
    v_min_u32 v12, v12, v14
    v_mul_u32_u24 v13, 578, v13
    v_lshl_add_u32 v161, v12, 4, v13
    v_add_u32 v12, 64, v1
    v_mul_u32_u24 v13, 6554, v12
    v_lshrrev_b32 v13, 16, v13
    v_mul_u32_u24 v14, 10, v13
    v_sub_u32 v12, v12, v14
    s_and_b32 s55, s3, 1
    s_lshl_b32 s55, s55, 2
    v_lshrrev_b32 v14, 2, v13
    v_add_u32 v14, s55, v14
    v_sub_u32 v12, v12, v14
    v_add_u32 v14, 10, v12
    v_min_u32 v12, v12, v14
    v_mul_u32_u24 v13, 578, v13
    v_lshl_add_u32 v162, v12, 4, v13
    v_add_u32 v12, 128, v1
    v_mul_u32_u24 v13, 6554, v12
    v_lshrrev_b32 v13, 16, v13
    v_mul_u32_u24 v14, 10, v13
    v_sub_u32 v12, v12, v14
    s_and_b32 s55, s3, 1
    s_lshl_b32 s55, s55, 2
    v_lshrrev_b32 v14, 2, v13
    v_add_u32 v14, s55, v14
    v_sub_u32 v12, v12, v14
    v_add_u32 v14, 10, v12
    v_min_u32 v12, v12, v14
    v_mul_u32_u24 v13, 578, v13
    v_lshl_add_u32 v163, v12, 4, v13
    s_lshl_b32 s55, s3, 6
    v_add_u32 v174, s55, v1
    s_and_b32 s55, s62, 3
    s_cmp_eq_u32 s55, 3
    s_cselect_b32 s55, 7, 0
    v_add_u32 v12, 0, v174
    v_and_b32 v13, 7, v12
    v_lshrrev_b32 v12, 3, v12
    v_lshlrev_b32 v14, 13, v12
    v_lshl_add_u32 v167, v13, 4, v14
    v_add_u32 v12, s55, v12
    v_lshrrev_b32 v14, 3, v12
    v_add_u32 v14, v14, v13
    v_subrev_u32 v175, 10, v14
    v_min_u32 v14, v14, v175
    v_and_b32 v12, 7, v12
    v_lshlrev_b32 v12, 1, v12
    v_lshl_add_u32 v12, v14, 4, v12
    v_mul_u32_u24 v13, 640, v13
    v_add3_u32 v164, v12, v13, s46
    v_add_u32 v12, 256, v174
    v_and_b32 v13, 7, v12
    v_lshrrev_b32 v12, 3, v12
    v_lshlrev_b32 v14, 13, v12
    v_lshl_add_u32 v168, v13, 4, v14
    v_add_u32 v12, s55, v12
    v_lshrrev_b32 v14, 3, v12
    v_add_u32 v14, v14, v13
    v_subrev_u32 v175, 10, v14
    v_min_u32 v14, v14, v175
    v_and_b32 v12, 7, v12
    v_lshlrev_b32 v12, 1, v12
    v_lshl_add_u32 v12, v14, 4, v12
    v_mul_u32_u24 v13, 640, v13
    v_add3_u32 v165, v12, v13, s46
    v_add_u32 v12, 512, v174
    v_and_b32 v13, 7, v12
    v_lshrrev_b32 v12, 3, v12
    v_lshlrev_b32 v14, 13, v12
    v_lshl_add_u32 v169, v13, 4, v14
    v_add_u32 v12, s55, v12
    v_lshrrev_b32 v14, 3, v12
    v_add_u32 v14, v14, v13
    v_subrev_u32 v175, 10, v14
    v_min_u32 v14, v14, v175
    v_and_b32 v12, 7, v12
    v_lshlrev_b32 v12, 1, v12
    v_lshl_add_u32 v12, v14, 4, v12
    v_mul_u32_u24 v13, 640, v13
    v_add3_u32 v166, v12, v13, s46
    v_cmp_gt_u32 vcc, 72, v174
    v_mov_b32 v12, 0x7ffffff0
    s_nop 0
    v_cndmask_b32 v169, v12, v169, vcc
    s_and_b32 s57, s3, 1
    s_lshr_b32 s56, s3, 1
    s_mul_i32 s64, s56, -151552
    s_add_u32 s64, s64, 151552
    s_lshl_b32 s65, s57, 12
    s_sub_u32 s66, 4096, s65
    s_add_u32 s51, s65, s64
    s_add_u32 s66, s66, s64
    v_add_u32 v6, s51, v8
    v_add_u32 v7, s66, v8
    s_lshl_b32 s64, s56, 2
    v_add_u32 v15, s64, v10
    v_mul_u32_u24 v253, 9216, v1
    v_lshrrev_b32 v12, 2, v2
    v_lshlrev_b32 v12, 4, v12
    v_and_b32 v13, 3, v2
    v_lshl_add_u32 v12, v13, 1, v12
    v_lshl_add_u32 v4, v3, 10, v12
    v_lshlrev_b32 v12, 4, v2
    v_lshl_add_u32 v252, v3, 9, v12
    s_mul_i32 s55, s3, 144
    v_add_u32 v12, s55, v1
    v_lshlrev_b32 v250, 12, v12
    s_cmp_ge_u32 s3, 2
    s_cselect_b32 s40, s8, s6
    s_cselect_b32 s41, s9, s7
    s_mov_b32 s42, 1183744
    s_lshr_b32 s61, s62, 2
    s_lshl_b32 s61, s61, 1
    s_add_u32 s61, s61, s57
    s_mul_i32 s61, s61, 9248
    s_and_b32 s55, s62, 3
    s_mul_i32 s55, s55, 144
    s_min_u32 s55, s55, 418
    s_add_u32 s61, s61, s55
    v_add_u32 v12, 0, v1
    v_mul_u32_u24 v13, 6554, v12
    v_lshrrev_b32 v13, 16, v13
    v_mul_u32_u24 v14, 10, v13
    v_sub_u32 v12, v12, v14
    v_lshrrev_b32 v14, 4, v13
    v_lshl_add_u32 v13, v14, 1, v13
    v_mul_u32_u24 v13, 1152, v13
    v_lshl_add_u32 v240, v12, 4, v13
    v_add_u32 v12, 64, v1
    v_mul_u32_u24 v13, 6554, v12
    v_lshrrev_b32 v13, 16, v13
    v_mul_u32_u24 v14, 10, v13
    v_sub_u32 v12, v12, v14
    v_lshrrev_b32 v14, 4, v13
    v_lshl_add_u32 v13, v14, 1, v13
    v_mul_u32_u24 v13, 1152, v13
    v_lshl_add_u32 v241, v12, 4, v13
    v_subrev_u32 v241, 1024, v241
    v_add_u32 v12, 128, v1
    v_mul_u32_u24 v13, 6554, v12
    v_lshrrev_b32 v13, 16, v13
    v_mul_u32_u24 v14, 10, v13
    v_sub_u32 v12, v12, v14
    v_lshrrev_b32 v14, 4, v13
    v_lshl_add_u32 v13, v14, 1, v13
    v_mul_u32_u24 v13, 1152, v13
    v_lshl_add_u32 v242, v12, 4, v13
    v_subrev_u32 v242, 2048, v242
    v_add_u32 v12, 192, v1
    v_mul_u32_u24 v13, 6554, v12
    v_lshrrev_b32 v13, 16, v13
    v_mul_u32_u24 v14, 10, v13
    v_sub_u32 v12, v12, v14
    v_lshrrev_b32 v14, 4, v13
    v_lshl_add_u32 v13, v14, 1, v13
    v_mul_u32_u24 v13, 1152, v13
    v_lshl_add_u32 v243, v12, 4, v13
    v_subrev_u32 v243, 3072, v243
    v_add_u32 v12, 256, v1
    v_mul_u32_u24 v13, 6554, v12
    v_lshrrev_b32 v13, 16, v13
    v_mul_u32_u24 v14, 10, v13
    v_sub_u32 v12, v12, v14
    v_lshrrev_b32 v14, 4, v13
    v_lshl_add_u32 v13, v14, 1, v13
    v_mul_u32_u24 v13, 1152, v13
    v_lshl_add_u32 v244, v12, 4, v13
    v_add_u32 v12, 0, v1
    v_mul_u32_u24 v13, 6554, v12
    v_lshrrev_b32 v13, 16, v13
    v_mul_u32_u24 v14, 10, v13
    v_sub_u32 v12, v12, v14
    v_lshrrev_b32 v14, 1, v13
    v_lshl_add_u32 v13, v14, 4, v13
    v_add_u32 v13, 16, v13
    v_mul_u32_u24 v13, 1152, v13
    v_lshl_add_u32 v245, v12, 4, v13
    v_add_u32 v12, 64, v1
    v_mul_u32_u24 v13, 6554, v12
    v_lshrrev_b32 v13, 16, v13
    v_mul_u32_u24 v14, 10, v13
    v_sub_u32 v12, v12, v14
    v_lshrrev_b32 v14, 1, v13
    v_lshl_add_u32 v13, v14, 4, v13
    v_add_u32 v13, 16, v13
    v_mul_u32_u24 v13, 1152, v13
    v_lshl_add_u32 v246, v12, 4, v13
    v_subrev_u32 v246, 1024, v246
    v_add_u32 v12, 128, v1
    v_mul_u32_u24 v13, 6554, v12
    v_lshrrev_b32 v13, 16, v13
    v_mul_u32_u24 v14, 10, v13
    v_sub_u32 v12, v12, v14
    v_lshrrev_b32 v14, 1, v13
    v_lshl_add_u32 v13, v14, 4, v13
    v_add_u32 v13, 16, v13
    v_mul_u32_u24 v13, 1152, v13
    v_lshl_add_u32 v247, v12, 4, v13
    v_subrev_u32 v247, 2048, v247
    s_waitcnt vmcnt(3)
    s_cmp_eq_u32 s3, 2
    s_cbranch_scc1 a_row
    s_waitcnt vmcnt(0)
a_row:
    ds_read_b64_tr_b16 v[16:17], v152 offset:0
    ds_read_b64_tr_b16 v[18:19], v152 offset:384
    ds_read_b64_tr_b16 v[20:21], v152 offset:768
    ds_read_b64_tr_b16 v[22:23], v152 offset:1152
    ds_read_b64_tr_b16 v[24:25], v152 offset:1536
    ds_read_b64_tr_b16 v[26:27], v152 offset:1920
    ds_read_b128 v[76:79], v153 offset:0
    ds_read_b128 v[80:83], v153 offset:16
    ds_read_b128 v[84:87], v153 offset:32
    s_waitcnt lgkmcnt(7)
    v_mfma_f32_32x32x16_bf16 v[112:127], v[16:19], v[28:31], 0
    v_mfma_f32_32x32x16_bf16 v[128:143], v[16:19], v[40:43], 0
    s_waitcnt lgkmcnt(5)
    v_mfma_f32_32x32x16_bf16 v[112:127], v[20:23], v[32:35], v[112:127]
    v_mfma_f32_32x32x16_bf16 v[128:143], v[20:23], v[44:47], v[128:143]
    s_waitcnt lgkmcnt(3)
    v_mfma_f32_32x32x16_bf16 v[112:127], v[24:27], v[36:39], v[112:127]
    v_mfma_f32_32x32x16_bf16 v[128:143], v[24:27], v[48:51], v[128:143]
    s_waitcnt lgkmcnt(0)
    v_cmp_gt_u32 vcc, 24, v2
    v_dot2_f32_bf16 v160, v76, v100, 0
    v_dot2_f32_bf16 v160, v77, v101, v160
    v_dot2_f32_bf16 v160, v78, v102, v160
    v_dot2_f32_bf16 v160, v79, v103, v160
    v_dot2_f32_bf16 v160, v80, v104, v160
    v_dot2_f32_bf16 v160, v81, v105, v160
    v_dot2_f32_bf16 v160, v82, v106, v160
    v_dot2_f32_bf16 v160, v83, v107, v160
    v_dot2_f32_bf16 v160, v84, v108, v160
    v_dot2_f32_bf16 v160, v85, v109, v160
    v_dot2_f32_bf16 v160, v86, v110, v160
    v_dot2_f32_bf16 v160, v87, v111, v160
    v_pk_mul_f32 v[144:145], v[112:113], v[52:53]
    v_pk_mul_f32 v[146:147], v[128:129], v[52:53]
    v_pk_fma_f32 v[144:145], v[128:129], v[64:65], v[144:145]
    v_pk_fma_f32 v[146:147], v[112:113], v[64:65], v[146:147] neg_lo:[1,0,0] neg_hi:[1,0,0]
    v_cvt_pk_bf16_f32 v88, v144, v145
    v_cvt_pk_bf16_f32 v94, v146, v147
    v_pk_mul_f32 v[148:149], v[114:115], v[54:55]
    v_pk_mul_f32 v[150:151], v[130:131], v[54:55]
    v_pk_fma_f32 v[148:149], v[130:131], v[66:67], v[148:149]
    v_pk_fma_f32 v[150:151], v[114:115], v[66:67], v[150:151] neg_lo:[1,0,0] neg_hi:[1,0,0]
    v_cvt_pk_bf16_f32 v89, v148, v149
    v_cvt_pk_bf16_f32 v95, v150, v151
    v_pk_mul_f32 v[144:145], v[116:117], v[56:57]
    v_pk_mul_f32 v[146:147], v[132:133], v[56:57]
    v_pk_fma_f32 v[144:145], v[132:133], v[68:69], v[144:145]
    v_pk_fma_f32 v[146:147], v[116:117], v[68:69], v[146:147] neg_lo:[1,0,0] neg_hi:[1,0,0]
    v_cvt_pk_bf16_f32 v90, v144, v145
    v_cvt_pk_bf16_f32 v96, v146, v147
    v_pk_mul_f32 v[148:149], v[118:119], v[58:59]
    v_pk_mul_f32 v[150:151], v[134:135], v[58:59]
    v_pk_fma_f32 v[148:149], v[134:135], v[70:71], v[148:149]
    v_pk_fma_f32 v[150:151], v[118:119], v[70:71], v[150:151] neg_lo:[1,0,0] neg_hi:[1,0,0]
    v_cvt_pk_bf16_f32 v91, v148, v149
    v_cvt_pk_bf16_f32 v97, v150, v151
    v_pk_mul_f32 v[144:145], v[120:121], v[60:61]
    v_pk_mul_f32 v[146:147], v[136:137], v[60:61]
    v_pk_fma_f32 v[144:145], v[136:137], v[72:73], v[144:145]
    v_pk_fma_f32 v[146:147], v[120:121], v[72:73], v[146:147] neg_lo:[1,0,0] neg_hi:[1,0,0]
    v_cvt_pk_bf16_f32 v92, v144, v145
    v_cvt_pk_bf16_f32 v98, v146, v147
    v_pk_mul_f32 v[148:149], v[122:123], v[62:63]
    v_pk_mul_f32 v[150:151], v[138:139], v[62:63]
    v_pk_fma_f32 v[148:149], v[138:139], v[74:75], v[148:149]
    v_pk_fma_f32 v[150:151], v[122:123], v[74:75], v[150:151] neg_lo:[1,0,0] neg_hi:[1,0,0]
    v_cvt_pk_bf16_f32 v93, v148, v149
    v_cvt_pk_bf16_f32 v99, v150, v151
    v_mfma_f32_32x32x16_bf16 v[112:127], v[28:31], v[88:91], 0
    v_mfma_f32_32x32x16_bf16 v[128:143], v[40:43], v[88:91], 0
    v_mfma_f32_32x32x16_bf16 v[112:127], v[32:35], v[92:95], v[112:127]
    v_mfma_f32_32x32x16_bf16 v[128:143], v[44:47], v[92:95], v[128:143]
    v_mfma_f32_32x32x16_bf16 v[112:127], v[36:39], v[96:99], v[112:127]
    v_mfma_f32_32x32x16_bf16 v[128:143], v[48:51], v[96:99], v[128:143]
    v_cndmask_b32 v160, 0, v160, vcc
    s_nop 1
    v_add_f32_dpp v160, v160, v160 row_shr:1 row_mask:0xf bank_mask:0xf bound_ctrl:0
    s_nop 1
    v_add_f32_dpp v160, v160, v160 row_shr:2 row_mask:0xf bank_mask:0xf bound_ctrl:0
    s_nop 1
    v_add_f32_dpp v160, v160, v160 row_shr:4 row_mask:0xf bank_mask:0xf bound_ctrl:0
    s_nop 1
    v_add_f32_dpp v160, v160, v160 row_shr:8 row_mask:0xf bank_mask:0xf bound_ctrl:0
    s_nop 1
    v_add_f32_dpp v160, v160, v160 row_bcast:15 row_mask:0xa bank_mask:0xf
    v_mul_f32 v160, 0xbfb8aa3b, v160
    v_exp_f32 v160, v160
    s_nop 0
    v_add_f32 v160, 1.0, v160
    v_rcp_f32 v160, v160
a_xd:
    ds_read_b32 v14, v10 offset:100
    s_waitcnt lgkmcnt(0)
    v_readfirstlane_b32 s66, v14
    s_cmp_ge_u32 s66, 4
    s_cbranch_scc1 a_xd_ok
    s_sleep 1
    s_sub_i32 s0, s0, 1
    s_cmp_lt_i32 s0, 0
    s_cbranch_scc0 a_xd
a_xd_ok:
    s_mov_b32 exec_lo, 0x00ffffff
    s_mov_b32 exec_hi, 0x00ffffff
    v_cvt_pk_bf16_f32 v88, v112, v128
    ds_write_b32 v156, v88 offset:0
    v_cvt_pk_bf16_f32 v89, v113, v129
    ds_write_b32 v156, v89 offset:384
    v_cvt_pk_bf16_f32 v90, v114, v130
    ds_write_b32 v156, v90 offset:768
    v_cvt_pk_bf16_f32 v91, v115, v131
    ds_write_b32 v156, v91 offset:1152
    v_cvt_pk_bf16_f32 v92, v116, v132
    ds_write_b32 v156, v92 offset:3072
    v_cvt_pk_bf16_f32 v93, v117, v133
    ds_write_b32 v156, v93 offset:3456
    v_cvt_pk_bf16_f32 v94, v118, v134
    ds_write_b32 v156, v94 offset:3840
    v_cvt_pk_bf16_f32 v95, v119, v135
    ds_write_b32 v156, v95 offset:4224
    v_cvt_pk_bf16_f32 v96, v120, v136
    ds_write_b32 v156, v96 offset:6144
    v_cvt_pk_bf16_f32 v97, v121, v137
    ds_write_b32 v156, v97 offset:6528
    v_cvt_pk_bf16_f32 v98, v122, v138
    ds_write_b32 v156, v98 offset:6912
    v_cvt_pk_bf16_f32 v99, v123, v139
    ds_write_b32 v156, v99 offset:7296
    s_mov_b64 exec, -1
    s_waitcnt lgkmcnt(0)
    s_mov_b64 exec, 1
    ds_add_u32 v10, v11 offset:76
    s_mov_b64 exec, -1
    s_cmp_eq_u32 s99, 3
    s_cbranch_scc1 a_l2
    s_branch a_dmas
a_sync:
    s_setprio 3
a_f1s:
    ds_read_b32 v14, v10 offset:104
    s_waitcnt lgkmcnt(0)
    v_readfirstlane_b32 s66, v14
    s_cmp_ge_u32 s66, 1
    s_cbranch_scc1 a_f1s_ok
    s_sleep 1
    s_sub_i32 s0, s0, 1
    s_cmp_lt_i32 s0, 0
    s_cbranch_scc0 a_f1s
a_f1s_ok:
    s_mov_b32 s65, 196608
    s_mov_b32 s67, 32768
a_f1:
    buffer_load_dwordx4 v[16:19], v254, s[32:35], s65 offen sc1
    buffer_load_dwordx4 v[20:23], v254, s[32:35], s65 offen offset:16 sc1
    s_waitcnt vmcnt(0)
    v_xor_b32 v17, s68, v17
    v_xor_b32 v19, s68, v19
    v_xor_b32 v21, s68, v21
    v_xor_b32 v23, s68, v23
    v_or3_b32 v17, v17, v19, v21
    v_or_b32 v17, v17, v23
    v_cmp_eq_u32 vcc, 0, v17
    s_sub_u32 s67, s67, 1
    s_cbranch_scc1 a_f1_ok
    s_nop 1
    s_cmp_eq_u64 vcc, exec
    s_cbranch_scc1 a_f1_ok
    s_sleep 1
    s_branch a_f1
a_f1_ok:
    s_add_u32 s55, 0, 0
    s_mov_b32 m0, s55
    s_nop 0
    buffer_load_dwordx4 v8, s[32:35], s55 offen offset:0 sc1 lds
    buffer_load_dwordx4 v8, s[32:35], s55 offen offset:1024 sc1 lds
    buffer_load_dwordx4 v8, s[32:35], s55 offen offset:2048 sc1 lds
    buffer_load_dwordx4 v8, s[32:35], s55 offen offset:3072 sc1 lds
    s_add_u32 s55, 0, 4096
    s_mov_b32 m0, s55
    s_nop 0
    buffer_load_dwordx4 v8, s[32:35], s55 offen offset:0 sc1 lds
    buffer_load_dwordx4 v8, s[32:35], s55 offen offset:1024 sc1 lds
    buffer_load_dwordx4 v8, s[32:35], s55 offen offset:2048 sc1 lds
    buffer_load_dwordx4 v8, s[32:35], s55 offen offset:3072 sc1 lds
    s_add_u32 s55, 0, 8192
    s_mov_b32 m0, s55
    s_nop 0
    buffer_load_dwordx4 v8, s[32:35], s55 offen offset:0 sc1 lds
    buffer_load_dwordx4 v8, s[32:35], s55 offen offset:1024 sc1 lds
    buffer_load_dwordx4 v8, s[32:35], s55 offen offset:2048 sc1 lds
    buffer_load_dwordx4 v8, s[32:35], s55 offen offset:3072 sc1 lds
    s_add_u32 s55, 0, 12288
    s_mov_b32 m0, s55
    s_nop 0
    buffer_load_dwordx4 v8, s[32:35], s55 offen offset:0 sc1 lds
    buffer_load_dwordx4 v8, s[32:35], s55 offen offset:1024 sc1 lds
    buffer_load_dwordx4 v8, s[32:35], s55 offen offset:2048 sc1 lds
    buffer_load_dwordx4 v8, s[32:35], s55 offen offset:3072 sc1 lds
    s_add_u32 s55, 0, 16384
    s_mov_b32 m0, s55
    s_nop 0
    buffer_load_dwordx4 v8, s[32:35], s55 offen offset:0 sc1 lds
    buffer_load_dwordx4 v8, s[32:35], s55 offen offset:1024 sc1 lds
    buffer_load_dwordx4 v8, s[32:35], s55 offen offset:2048 sc1 lds
    buffer_load_dwordx4 v8, s[32:35], s55 offen offset:3072 sc1 lds
    s_add_u32 s55, 0, 20480
    s_mov_b32 m0, s55
    s_nop 0
    buffer_load_dwordx4 v8, s[32:35], s55 offen offset:0 sc1 lds
    buffer_load_dwordx4 v8, s[32:35], s55 offen offset:1024 sc1 lds
    buffer_load_dwordx4 v8, s[32:35], s55 offen offset:2048 sc1 lds
    buffer_load_dwordx4 v8, s[32:35], s55 offen offset:3072 sc1 lds
    s_add_u32 s55, 0, 24576
    s_mov_b32 m0, s55
    s_nop 0
    buffer_load_dwordx4 v8, s[32:35], s55 offen offset:0 sc1 lds
    buffer_load_dwordx4 v8, s[32:35], s55 offen offset:1024 sc1 lds
    buffer_load_dwordx4 v8, s[32:35], s55 offen offset:2048 sc1 lds
    s_mul_i32 s61, s3, 2304
    v_bfe_u32 v13, v1, 2, 2
    v_lshl_add_u32 v13, v3, 2, v13
    v_mul_u32_u24 v13, 48, v13
    v_bfe_u32 v12, v1, 4, 1
    v_lshl_add_u32 v13, v12, 5, v13
    v_and_b32 v12, 3, v1
    v_lshl_add_u32 v13, v12, 3, v13
    v_add_u32 v152, s47, v13
    v_mul_u32_u24 v13, 1152, v3
    v_add3_u32 v153, v13, v155, s47
    v_lshl_add_u32 v5, v3, 3, v155
    s_add_u32 s55, s61, 151552
    v_add_u32 v5, s55, v5
    v_add_u32 v9, s55, v8
    v_add_u32 v170, s61, v8
    v_add_u32 v171, s45, v170
    v_lshlrev_b32 v172, 2, v3
    v_mul_u32_u24 v13, 1536, v3
    v_lshl_add_u32 v13, v2, 4, v13
    v_lshl_add_u32 v13, s3, 2, v13
    v_add_u32 v156, s45, v13
    v_add_u32 v251, 151552, v13
    v_add_u32 v12, 0, v1
    v_mul_u32_u24 v13, 6554, v12
    v_lshrrev_b32 v13, 16, v13
    v_mul_u32_u24 v14, 10, v13
    v_sub_u32 v12, v12, v14
    s_and_b32 s55, s3, 1
    s_lshl_b32 s55, s55, 2
    v_lshrrev_b32 v14, 2, v13
    v_add_u32 v14, s55, v14
    v_sub_u32 v12, v12, v14
    v_add_u32 v14, 10, v12
    v_min_u32 v12, v12, v14
    v_mul_u32_u24 v13, 578, v13
    v_lshl_add_u32 v161, v12, 4, v13
    v_add_u32 v12, 64, v1
    v_mul_u32_u24 v13, 6554, v12
    v_lshrrev_b32 v13, 16, v13
    v_mul_u32_u24 v14, 10, v13
    v_sub_u32 v12, v12, v14
    s_and_b32 s55, s3, 1
    s_lshl_b32 s55, s55, 2
    v_lshrrev_b32 v14, 2, v13
    v_add_u32 v14, s55, v14
    v_sub_u32 v12, v12, v14
    v_add_u32 v14, 10, v12
    v_min_u32 v12, v12, v14
    v_mul_u32_u24 v13, 578, v13
    v_lshl_add_u32 v162, v12, 4, v13
    v_add_u32 v12, 128, v1
    v_mul_u32_u24 v13, 6554, v12
    v_lshrrev_b32 v13, 16, v13
    v_mul_u32_u24 v14, 10, v13
    v_sub_u32 v12, v12, v14
    s_and_b32 s55, s3, 1
    s_lshl_b32 s55, s55, 2
    v_lshrrev_b32 v14, 2, v13
    v_add_u32 v14, s55, v14
    v_sub_u32 v12, v12, v14
    v_add_u32 v14, 10, v12
    v_min_u32 v12, v12, v14
    v_mul_u32_u24 v13, 578, v13
    v_lshl_add_u32 v163, v12, 4, v13
    s_lshl_b32 s55, s3, 6
    v_add_u32 v174, s55, v1
    s_and_b32 s55, s62, 3
    s_cmp_eq_u32 s55, 3
    s_cselect_b32 s55, 7, 0
    v_add_u32 v12, 0, v174
    v_and_b32 v13, 7, v12
    v_lshrrev_b32 v12, 3, v12
    v_lshlrev_b32 v14, 13, v12
    v_lshl_add_u32 v167, v13, 4, v14
    v_add_u32 v12, s55, v12
    v_lshrrev_b32 v14, 3, v12
    v_add_u32 v14, v14, v13
    v_subrev_u32 v175, 10, v14
    v_min_u32 v14, v14, v175
    v_and_b32 v12, 7, v12
    v_lshlrev_b32 v12, 1, v12
    v_lshl_add_u32 v12, v14, 4, v12
    v_mul_u32_u24 v13, 640, v13
    v_add3_u32 v164, v12, v13, s46
    v_add_u32 v12, 256, v174
    v_and_b32 v13, 7, v12
    v_lshrrev_b32 v12, 3, v12
    v_lshlrev_b32 v14, 13, v12
    v_lshl_add_u32 v168, v13, 4, v14
    v_add_u32 v12, s55, v12
    v_lshrrev_b32 v14, 3, v12
    v_add_u32 v14, v14, v13
    v_subrev_u32 v175, 10, v14
    v_min_u32 v14, v14, v175
    v_and_b32 v12, 7, v12
    v_lshlrev_b32 v12, 1, v12
    v_lshl_add_u32 v12, v14, 4, v12
    v_mul_u32_u24 v13, 640, v13
    v_add3_u32 v165, v12, v13, s46
    v_add_u32 v12, 512, v174
    v_and_b32 v13, 7, v12
    v_lshrrev_b32 v12, 3, v12
    v_lshlrev_b32 v14, 13, v12
    v_lshl_add_u32 v169, v13, 4, v14
    v_add_u32 v12, s55, v12
    v_lshrrev_b32 v14, 3, v12
    v_add_u32 v14, v14, v13
    v_subrev_u32 v175, 10, v14
    v_min_u32 v14, v14, v175
    v_and_b32 v12, 7, v12
    v_lshlrev_b32 v12, 1, v12
    v_lshl_add_u32 v12, v14, 4, v12
    v_mul_u32_u24 v13, 640, v13
    v_add3_u32 v166, v12, v13, s46
    v_cmp_gt_u32 vcc, 72, v174
    v_mov_b32 v12, 0x7ffffff0
    s_nop 0
    v_cndmask_b32 v169, v12, v169, vcc
    s_and_b32 s57, s3, 1
    s_lshr_b32 s56, s3, 1
    s_mul_i32 s64, s56, -151552
    s_add_u32 s64, s64, 151552
    s_lshl_b32 s65, s57, 12
    s_sub_u32 s66, 4096, s65
    s_add_u32 s51, s65, s64
    s_add_u32 s66, s66, s64
    v_add_u32 v6, s51, v8
    v_add_u32 v7, s66, v8
    s_lshl_b32 s64, s56, 2
    v_add_u32 v15, s64, v10
    v_mul_u32_u24 v253, 9216, v1
    v_lshrrev_b32 v12, 2, v2
    v_lshlrev_b32 v12, 4, v12
    v_and_b32 v13, 3, v2
    v_lshl_add_u32 v12, v13, 1, v12
    v_lshl_add_u32 v4, v3, 10, v12
    v_lshlrev_b32 v12, 4, v2
    v_lshl_add_u32 v252, v3, 9, v12
    s_mul_i32 s55, s3, 144
    v_add_u32 v12, s55, v1
    v_lshlrev_b32 v250, 12, v12
    s_cmp_ge_u32 s3, 2
    s_cselect_b32 s40, s8, s6
    s_cselect_b32 s41, s9, s7
    s_mov_b32 s42, 1183744
    s_lshr_b32 s61, s62, 2
    s_lshl_b32 s61, s61, 1
    s_add_u32 s61, s61, s57
    s_mul_i32 s61, s61, 9248
    s_and_b32 s55, s62, 3
    s_mul_i32 s55, s55, 144
    s_min_u32 s55, s55, 418
    s_add_u32 s61, s61, s55
    v_max3_f32 v16, v16, v18, v20
    v_max_f32 v16, v16, v22
    s_nop 1
    v_max_f32_dpp v16, v16, v16 row_ror:8 row_mask:0xf bank_mask:0xf
    s_nop 1
    v_max_f32_dpp v16, v16, v16 row_ror:4 row_mask:0xf bank_mask:0xf
    s_nop 1
    v_max_f32_dpp v16, v16, v16 row_ror:2 row_mask:0xf bank_mask:0xf
    s_nop 1
    v_max_f32_dpp v16, v16, v16 row_ror:1 row_mask:0xf bank_mask:0xf
    s_nop 1
    v_max_f32_dpp v16, v16, v16 row_bcast:15 row_mask:0xa bank_mask:0xf
    s_nop 1
    v_max_f32_dpp v16, v16, v16 row_bcast:31 row_mask:0xc bank_mask:0xf
    s_mov_b32 exec_lo, 0
    s_mov_b32 exec_hi, 0x80000000
    ds_write_b32 v10, v16 offset:96
    s_mov_b64 exec, -1
    s_waitcnt vmcnt(0) lgkmcnt(0)
    s_mov_b64 exec, 1
    ds_add_u32 v10, v11 offset:0
    s_mov_b64 exec, -1
    v_add_u32 v12, 0, v1
    v_mul_u32_u24 v13, 6554, v12
    v_lshrrev_b32 v13, 16, v13
    v_mul_u32_u24 v14, 10, v13
    v_sub_u32 v12, v12, v14
    v_lshrrev_b32 v14, 4, v13
    v_lshl_add_u32 v13, v14, 1, v13
    v_mul_u32_u24 v13, 1152, v13
    v_lshl_add_u32 v240, v12, 4, v13
    v_add_u32 v12, 64, v1
    v_mul_u32_u24 v13, 6554, v12
    v_lshrrev_b32 v13, 16, v13
    v_mul_u32_u24 v14, 10, v13
    v_sub_u32 v12, v12, v14
    v_lshrrev_b32 v14, 4, v13
    v_lshl_add_u32 v13, v14, 1, v13
    v_mul_u32_u24 v13, 1152, v13
    v_lshl_add_u32 v241, v12, 4, v13
    v_subrev_u32 v241, 1024, v241
    v_add_u32 v12, 128, v1
    v_mul_u32_u24 v13, 6554, v12
    v_lshrrev_b32 v13, 16, v13
    v_mul_u32_u24 v14, 10, v13
    v_sub_u32 v12, v12, v14
    v_lshrrev_b32 v14, 4, v13
    v_lshl_add_u32 v13, v14, 1, v13
    v_mul_u32_u24 v13, 1152, v13
    v_lshl_add_u32 v242, v12, 4, v13
    v_subrev_u32 v242, 2048, v242
    v_add_u32 v12, 192, v1
    v_mul_u32_u24 v13, 6554, v12
    v_lshrrev_b32 v13, 16, v13
    v_mul_u32_u24 v14, 10, v13
    v_sub_u32 v12, v12, v14
    v_lshrrev_b32 v14, 4, v13
    v_lshl_add_u32 v13, v14, 1, v13
    v_mul_u32_u24 v13, 1152, v13
    v_lshl_add_u32 v243, v12, 4, v13
    v_subrev_u32 v243, 3072, v243
    v_add_u32 v12, 256, v1
    v_mul_u32_u24 v13, 6554, v12
    v_lshrrev_b32 v13, 16, v13
    v_mul_u32_u24 v14, 10, v13
    v_sub_u32 v12, v12, v14
    v_lshrrev_b32 v14, 4, v13
    v_lshl_add_u32 v13, v14, 1, v13
    v_mul_u32_u24 v13, 1152, v13
    v_lshl_add_u32 v244, v12, 4, v13
    v_add_u32 v12, 0, v1
    v_mul_u32_u24 v13, 6554, v12
    v_lshrrev_b32 v13, 16, v13
    v_mul_u32_u24 v14, 10, v13
    v_sub_u32 v12, v12, v14
    v_lshrrev_b32 v14, 1, v13
    v_lshl_add_u32 v13, v14, 4, v13
    v_add_u32 v13, 16, v13
    v_mul_u32_u24 v13, 1152, v13
    v_lshl_add_u32 v245, v12, 4, v13
    v_add_u32 v12, 64, v1
    v_mul_u32_u24 v13, 6554, v12
    v_lshrrev_b32 v13, 16, v13
    v_mul_u32_u24 v14, 10, v13
    v_sub_u32 v12, v12, v14
    v_lshrrev_b32 v14, 1, v13
    v_lshl_add_u32 v13, v14, 4, v13
    v_add_u32 v13, 16, v13
    v_mul_u32_u24 v13, 1152, v13
    v_lshl_add_u32 v246, v12, 4, v13
    v_subrev_u32 v246, 1024, v246
    v_add_u32 v12, 128, v1
    v_mul_u32_u24 v13, 6554, v12
    v_lshrrev_b32 v13, 16, v13
    v_mul_u32_u24 v14, 10, v13
    v_sub_u32 v12, v12, v14
    v_lshrrev_b32 v14, 1, v13
    v_lshl_add_u32 v13, v14, 4, v13
    v_add_u32 v13, 16, v13
    v_mul_u32_u24 v13, 1152, v13
    v_lshl_add_u32 v247, v12, 4, v13
    v_subrev_u32 v247, 2048, v247
a_dmas:
a_l0:
    ds_read_b32 v14, v10 offset:0
    s_waitcnt lgkmcnt(0)
    v_readfirstlane_b32 s66, v14
    s_cmp_ge_u32 s66, 1
    s_cbranch_scc1 a_l0_ok
    s_sleep 2
    s_sub_i32 s0, s0, 1
    s_cmp_lt_i32 s0, 0
    s_cbranch_scc0 a_l0
a_l0_ok:
    s_mul_i32 s54, s3, 2560
    s_add_u32 s54, s54, s46
    s_add_u32 m0, s54, 0
    s_nop 0
    buffer_load_dwordx4 v161, s[40:43], s61 offen lds
    s_add_u32 m0, s54, 1024
    s_nop 0
    buffer_load_dwordx4 v162, s[40:43], s61 offen lds
    s_add_u32 m0, s54, 2048
    s_mov_b64 exec, 0xffffffff
    buffer_load_dwordx4 v163, s[40:43], s61 offen lds
    s_mov_b64 exec, -1
    s_lshl_b32 s63, s3, 12
    s_cmp_eq_u32 s99, 2
    s_cbranch_scc0 a_l1
    s_mov_b32 s99, 3
    v_mov_b32 v173, v160
    s_mov_b64 exec, 1
    ds_add_u32 v10, v11 offset:4
    s_mov_b64 exec, -1
    v_add_u32 v152, 2304, v152
    v_add_u32 v153, 2304, v153
    v_add_u32 v156, 4, v156
    s_waitcnt vmcnt(3)
    s_branch a_row
a_l2:
    s_waitcnt vmcnt(0)
    s_mov_b64 exec, 1
    ds_add_u32 v10, v11 offset:72
    s_mov_b64 exec, -1
    s_branch a_wj
a_l1:
a_qd2:
    ds_read_b32 v14, v10 offset:64
    s_waitcnt lgkmcnt(0)
    v_readfirstlane_b32 s66, v14
    s_cmp_ge_u32 s66, 4
    s_cbranch_scc1 a_qd2_ok
    s_sleep 1
    s_sub_i32 s0, s0, 1
    s_cmp_lt_i32 s0, 0
    s_cbranch_scc0 a_qd2
a_qd2_ok:
    s_min_u32 s64, s63, 8192
    s_add_u32 s55, s64, 27648
    s_mov_b32 m0, s55
    s_nop 0
    buffer_load_dwordx4 v8, s[32:35], s55 offen offset:0 sc1 lds
    buffer_load_dwordx4 v8, s[32:35], s55 offen offset:1024 sc1 lds
    buffer_load_dwordx4 v8, s[32:35], s55 offen offset:2048 sc1 lds
    buffer_load_dwordx4 v8, s[32:35], s55 offen offset:3072 sc1 lds
    s_add_u32 s55, s64, 39936
    s_mov_b32 m0, s55
    s_nop 0
    buffer_load_dwordx4 v8, s[32:35], s55 offen offset:0 sc1 lds
    buffer_load_dwordx4 v8, s[32:35], s55 offen offset:1024 sc1 lds
    buffer_load_dwordx4 v8, s[32:35], s55 offen offset:2048 sc1 lds
    buffer_load_dwordx4 v8, s[32:35], s55 offen offset:3072 sc1 lds
    s_add_u32 s55, s64, 52224
    s_mov_b32 m0, s55
    s_nop 0
    buffer_load_dwordx4 v8, s[32:35], s55 offen offset:0 sc1 lds
    buffer_load_dwordx4 v8, s[32:35], s55 offen offset:1024 sc1 lds
    buffer_load_dwordx4 v8, s[32:35], s55 offen offset:2048 sc1 lds
    buffer_load_dwordx4 v8, s[32:35], s55 offen offset:3072 sc1 lds
    s_add_u32 s55, s64, 64512
    s_mov_b32 m0, s55
    s_nop 0
    buffer_load_dwordx4 v8, s[32:35], s55 offen offset:0 sc1 lds
    buffer_load_dwordx4 v8, s[32:35], s55 offen offset:1024 sc1 lds
    buffer_load_dwordx4 v8, s[32:35], s55 offen offset:2048 sc1 lds
    buffer_load_dwordx4 v8, s[32:35], s55 offen offset:3072 sc1 lds
    s_add_u32 s55, s64, 76800
    s_mov_b32 m0, s55
    s_nop 0
    buffer_load_dwordx4 v8, s[32:35], s55 offen offset:0 sc1 lds
    buffer_load_dwordx4 v8, s[32:35], s55 offen offset:1024 sc1 lds
    buffer_load_dwordx4 v8, s[32:35], s55 offen offset:2048 sc1 lds
    buffer_load_dwordx4 v8, s[32:35], s55 offen offset:3072 sc1 lds
    s_add_u32 s55, s64, 89088
    s_mov_b32 m0, s55
    s_nop 0
    buffer_load_dwordx4 v8, s[32:35], s55 offen offset:0 sc1 lds
    buffer_load_dwordx4 v8, s[32:35], s55 offen offset:1024 sc1 lds
    buffer_load_dwordx4 v8, s[32:35], s55 offen offset:2048 sc1 lds
    buffer_load_dwordx4 v8, s[32:35], s55 offen offset:3072 sc1 lds
    s_add_u32 s55, s64, 101376
    s_mov_b32 m0, s55
    s_nop 0
    buffer_load_dwordx4 v8, s[32:35], s55 offen offset:0 sc1 lds
    buffer_load_dwordx4 v8, s[32:35], s55 offen offset:1024 sc1 lds
    buffer_load_dwordx4 v8, s[32:35], s55 offen offset:2048 sc1 lds
    buffer_load_dwordx4 v8, s[32:35], s55 offen offset:3072 sc1 lds
    s_waitcnt vmcnt(28)
    s_mov_b64 exec, 1
    ds_add_u32 v10, v11 offset:72
    s_mov_b64 exec, -1
    s_mul_i32 s54, s59, 4224
    s_lshr_b32 s55, s64, 12
    s_mul_i32 s55, s55, 1408
    s_add_u32 s54, s54, s55
    s_add_u32 s54, s54, 12288
    s_mov_b64 exec, 0x7ff
    buffer_load_dword v255, v254, s[36:39], s54 offen
    s_mov_b64 exec, -1
    s_waitcnt vmcnt(1)
    s_mov_b64 exec, 1
    ds_add_u32 v10, v11 offset:4
    s_mov_b64 exec, -1
a_wj:
a_win:
    ds_read_b32 v14, v10 offset:72
    s_waitcnt lgkmcnt(0)
    v_readfirstlane_b32 s66, v14
    s_cmp_ge_u32 s66, 4
    s_cbranch_scc1 a_win_ok
    s_sleep 2
    s_sub_i32 s0, s0, 1
    s_cmp_lt_i32 s0, 0
    s_cbranch_scc0 a_win
a_win_ok:
    ds_read_u16 v32, v164 offset:0
    ds_read_u16_d16_hi v72, v164 offset:160
    ds_read_u16 v33, v164 offset:320
    ds_read_u16_d16_hi v73, v164 offset:480
    ds_read_u16 v34, v164 offset:5120
    ds_read_u16_d16_hi v74, v164 offset:5280
    ds_read_u16 v35, v164 offset:5440
    ds_read_u16_d16_hi v75, v164 offset:5600
    s_waitcnt lgkmcnt(0)
    ds_read_u16 v36, v165 offset:0
    ds_read_u16_d16_hi v76, v165 offset:160
    ds_read_u16 v37, v165 offset:320
    ds_read_u16_d16_hi v77, v165 offset:480
    ds_read_u16 v38, v165 offset:5120
    ds_read_u16_d16_hi v78, v165 offset:5280
    ds_read_u16 v39, v165 offset:5440
    ds_read_u16_d16_hi v79, v165 offset:5600
    ds_read_u16 v40, v166 offset:0
    ds_read_u16_d16_hi v80, v166 offset:160
    ds_read_u16 v41, v166 offset:320
    ds_read_u16_d16_hi v81, v166 offset:480
    ds_read_u16 v42, v166 offset:5120
    ds_read_u16_d16_hi v82, v166 offset:5280
    ds_read_u16 v43, v166 offset:5440
    ds_read_u16_d16_hi v83, v166 offset:5600
    s_lshr_b32 s54, s62, 2
    s_lshl_b32 s54, s54, 7
    s_and_b32 s55, s62, 3
    s_mul_i32 s55, s55, 589824
    s_add_u32 s54, s54, s55
    s_add_u32 s54, s54, 9895936
    v_or_b32 v32, v32, v72
    v_or_b32 v33, v33, v73
    v_or_b32 v34, v34, v74
    v_or_b32 v35, v35, v75
    buffer_store_dwordx4 v[32:35], v167, s[32:35], s54 offen sc1
    s_waitcnt lgkmcnt(8)
    v_or_b32 v36, v36, v76
    v_or_b32 v37, v37, v77
    v_or_b32 v38, v38, v78
    v_or_b32 v39, v39, v79
    buffer_store_dwordx4 v[36:39], v168, s[32:35], s54 offen sc1
    s_waitcnt lgkmcnt(0)
    v_or_b32 v40, v40, v80
    v_or_b32 v41, v41, v81
    v_or_b32 v42, v42, v82
    v_or_b32 v43, v43, v83
    buffer_store_dwordx4 v[40:43], v169, s[32:35], s54 offen sc1
a_xt:
    ds_read_b32 v14, v10 offset:76
    s_waitcnt lgkmcnt(0)
    v_readfirstlane_b32 s66, v14
    s_cmp_ge_u32 s66, 4
    s_cbranch_scc1 a_xt_ok
    s_sleep 1
    s_sub_i32 s0, s0, 1
    s_cmp_lt_i32 s0, 0
    s_cbranch_scc0 a_xt
a_xt_ok:
    ds_read_b128 v[16:19], v171 offset:0
    ds_read_b128 v[20:23], v171 offset:1024
    ds_read_b128 v[24:27], v171 offset:2048
    s_lshl_b32 s54, s62, 4
    s_add_u32 s54, s54, s3
    s_lshl_b32 s54, s54, 3
    s_add_u32 s54, s54, 393216
    s_cmp_eq_u32 s99, 1
    s_cbranch_scc1 a_nog
    s_mov_b32 exec_lo, 0x80000000
    s_mov_b32 exec_hi, 0x80000000
    s_cmp_eq_u32 s99, 3
    s_cbranch_scc0 a_oneg
    buffer_store_dword v173, v172, s[32:35], s54 offen sc1
    s_add_u32 s54, s54, 8
a_oneg:
    buffer_store_dword v160, v172, s[32:35], s54 offen sc1
a_nog:
    s_mov_b64 exec, -1
    s_mul_i32 s54, s62, 9216
    s_add_u32 s54, s54, 5177344
    s_waitcnt lgkmcnt(2)
    buffer_store_dwordx4 v[16:19], v170, s[32:35], s54 offen offset:0 sc1
    s_waitcnt lgkmcnt(1)
    buffer_store_dwordx4 v[20:23], v170, s[32:35], s54 offen offset:1024 sc1
    s_waitcnt lgkmcnt(0)
    s_mov_b64 exec, 0xffff
    buffer_store_dwordx4 v[24:27], v170, s[32:35], s54 offen offset:2048 sc1
    s_mov_b64 exec, -1
    s_waitcnt vmcnt(0)
    s_mov_b64 exec, 1
    ds_add_rtn_u32 v14, v10, v11 offset:112
    s_mov_b64 exec, -1
    s_lshr_b32 s54, s2, 2
    s_lshl_b32 s54, s54, 7
    s_and_b32 s66, s2, 3
    s_lshl_b32 s66, s66, 2
    s_add_u32 s54, s54, s66
    s_add_u32 s54, s54, 204800
    s_waitcnt lgkmcnt(0)
    v_readfirstlane_b32 s66, v14
    s_cmp_eq_u32 s66, 3
    s_cselect_b32 s101, 1, 0
    s_cmp_eq_u32 s101, 1
    s_cbranch_scc0 a_ar2
    s_mov_b64 exec, 1
    v_mov_b32 v12, s68
    v_mov_b32 v13, 0
    buffer_store_dword v12, v13, s[32:35], s54 offen sc1
    s_mov_b64 exec, -1
    s_mov_b64 exec, 1
    ds_add_u32 v10, v11 offset:112
    s_mov_b64 exec, -1
a_ar2:
    s_lshl_b32 s61, s58, 2
    s_add_u32 s61, s61, s59
    s_cmp_eq_u32 s2, 32
    s_cselect_b32 s61, 32, s61
    s_add_u32 s61, s61, 256
    s_cmp_gt_u32 s2, 32
    s_cselect_b32 s61, 999, s61
    s_cmp_eq_u32 s56, 0
    s_cselect_b32 s50, s62, s61
    s_cmp_gt_u32 s50, 288
    s_cselect_b32 s43, 1, 0
    s_cmp_eq_u32 s43, 1
    s_cbranch_scc1 a_notab
a_pub2:
    ds_read_b32 v14, v10 offset:112
    s_waitcnt lgkmcnt(0)
    v_readfirstlane_b32 s66, v14
    s_cmp_ge_u32 s66, 5
    s_cbranch_scc1 a_pub2_ok
    s_sleep 1
    s_sub_i32 s0, s0, 1
    s_cmp_lt_i32 s0, 0
    s_cbranch_scc0 a_pub2
a_pub2_ok:
    s_lshl_b32 s64, s57, 14
    s_add_u32 s64, s64, 24576
    s_lshl_b32 s44, s57, 12
    s_sub_u32 s45, 4096, s44
    s_add_u32 s44, s44, s64
    s_add_u32 s45, s45, s64
    s_add_u32 s46, s44, 8192
    s_add_u32 s47, s45, 8192
    buffer_load_dwordx4 v[48:51], v8, s[36:39], s44 offen offset:0
    buffer_load_dwordx4 v[52:55], v8, s[36:39], s44 offen offset:1024
    buffer_load_dwordx4 v[56:59], v8, s[36:39], s44 offen offset:2048
    buffer_load_dwordx4 v[60:63], v8, s[36:39], s44 offen offset:3072
    buffer_load_dwordx4 v[64:67], v8, s[36:39], s45 offen offset:0
    buffer_load_dwordx4 v[68:71], v8, s[36:39], s45 offen offset:1024
    buffer_load_dwordx4 v[72:75], v8, s[36:39], s45 offen offset:2048
    buffer_load_dwordx4 v[76:79], v8, s[36:39], s45 offen offset:3072
    buffer_load_dwordx4 v[80:83], v8, s[36:39], s46 offen offset:0
    buffer_load_dwordx4 v[84:87], v8, s[36:39], s46 offen offset:1024
    buffer_load_dwordx4 v[88:91], v8, s[36:39], s46 offen offset:2048
    buffer_load_dwordx4 v[92:95], v8, s[36:39], s46 offen offset:3072
    buffer_load_dwordx4 v[96:99], v8, s[36:39], s47 offen offset:0
    buffer_load_dwordx4 v[100:103], v8, s[36:39], s47 offen offset:1024
    buffer_load_dwordx4 v[104:107], v8, s[36:39], s47 offen offset:2048
    buffer_load_dwordx4 v[108:111], v8, s[36:39], s47 offen offset:3072
    s_lshl_b32 s64, s57, 13
    s_add_u32 s64, s64, 63488
    buffer_load_dwordx4 v[144:147], v8, s[36:39], s64 offen offset:0
    buffer_load_dwordx4 v[148:151], v8, s[36:39], s64 offen offset:1024
    buffer_load_dwordx4 v[152:155], v8, s[36:39], s64 offen offset:2048
    buffer_load_dwordx4 v[156:159], v8, s[36:39], s64 offen offset:3072
    s_add_u32 s64, s64, 4096
    buffer_load_dwordx4 v[160:163], v8, s[36:39], s64 offen offset:0
    buffer_load_dwordx4 v[164:167], v8, s[36:39], s64 offen offset:1024
    buffer_load_dwordx4 v[168:171], v8, s[36:39], s64 offen offset:2048
    buffer_load_dwordx4 v[172:175], v8, s[36:39], s64 offen offset:3072
    s_mov_b32 s64, 57344
    buffer_load_dwordx4 v[176:179], v8, s[36:39], s64 offen offset:0
    buffer_load_dwordx4 v[180:183], v8, s[36:39], s64 offen offset:1024
    buffer_load_dwordx4 v[184:187], v8, s[36:39], s64 offen offset:2048
    buffer_load_dwordx4 v[188:191], v8, s[36:39], s64 offen offset:3072
    s_add_u32 s64, s64, 4096
    buffer_load_dwordx4 v[192:195], v8, s[36:39], s64 offen offset:0
    buffer_load_dwordx4 v[196:199], v8, s[36:39], s64 offen offset:1024
a_notab:
    s_cmp_gt_u32 s2, 32
    s_cselect_b32 s66, 1, 0
    s_cmp_eq_u32 s3, 3
    s_cselect_b32 s65, 1, 0
    s_cmp_eq_u32 s66, 1
    s_cselect_b32 s101, s65, s101
    s_cmp_eq_u32 s101, 1
    s_cbranch_scc0 a_f2_w
a_f2_own:
    ds_read_b32 v14, v10 offset:112
    s_waitcnt lgkmcnt(0)
    v_readfirstlane_b32 s66, v14
    s_cmp_ge_u32 s66, 5
    s_cbranch_scc1 a_f2_own_ok
    s_sleep 4
    s_sub_i32 s0, s0, 1
    s_cmp_lt_i32 s0, 0
    s_cbranch_scc0 a_f2_own
a_f2_own_ok:
    s_lshl_b32 s54, s58, 7
    s_add_u32 s54, s54, 303104
    s_cmp_ge_u32 s2, 248
    s_cbranch_scc0 a_f2_f
    s_mov_b32 s65, 204800
    s_mov_b32 s67, 32768
a_f2:
    buffer_load_dwordx4 v[16:19], v254, s[32:35], s65 offen sc1
    s_waitcnt vmcnt(0)
    v_xor_b32 v16, s68, v16
    v_xor_b32 v17, s68, v17
    v_xor_b32 v18, s68, v18
    v_xor_b32 v19, s68, v19
    v_or3_b32 v16, v16, v17, v18
    v_or_b32 v16, v16, v19
    v_cmp_eq_u32 vcc, 0, v16
    s_sub_u32 s67, s67, 1
    s_cbranch_scc1 a_f2_ok
    s_nop 1
    s_cmp_eq_u64 vcc, exec
    s_cbranch_scc1 a_f2_ok
    s_sleep 1
    s_branch a_f2
a_f2_ok:
    s_mov_b64 exec, 1
    v_mov_b32 v12, s68
    v_mov_b32 v13, 0
    buffer_store_dword v12, v13, s[32:35], s54 offen sc1
    s_mov_b64 exec, -1
    s_branch a_f2_g_ok
a_f2_f:
    s_mov_b32 s67, 32768
    v_mov_b32 v13, 0
a_f2_g:
    buffer_load_dword v12, v13, s[32:35], s54 offen sc1
    s_waitcnt vmcnt(0)
    v_readfirstlane_b32 s66, v12
    s_sub_u32 s67, s67, 1
    s_cbranch_scc1 a_f2_g_ok
    s_cmp_eq_u32 s66, s68
    s_cbranch_scc1 a_f2_g_ok
    s_sleep 2
    s_branch a_f2_g
a_f2_g_ok:
    s_mov_b64 exec, 1
    ds_add_u32 v10, v11 offset:80
    s_mov_b64 exec, -1
a_f2_w:
a_go2:
    ds_read_b32 v14, v10 offset:80
    s_waitcnt lgkmcnt(0)
    v_readfirstlane_b32 s66, v14
    s_cmp_ge_u32 s66, 1
    s_cbranch_scc1 a_go2_ok
    s_sleep 6
    s_sub_i32 s0, s0, 1
    s_cmp_lt_i32 s0, 0
    s_cbranch_scc0 a_go2
a_go2_ok:
    s_cmp_eq_u32 s43, 1
    s_cbranch_scc1 a_defer
a_qr2:
    ds_read_b32 v14, v10 offset:68
    s_waitcnt lgkmcnt(0)
    v_readfirstlane_b32 s66, v14
    s_cmp_ge_u32 s66, 4
    s_cbranch_scc1 a_qr2_ok
    s_sleep 1
    s_sub_i32 s0, s0, 1
    s_cmp_lt_i32 s0, 0
    s_cbranch_scc0 a_qr2
a_qr2_ok:
    s_mov_b32 s42, 0
    s_cmp_eq_u32 s56, 0
    s_cbranch_scc1 a_pg0_ok
    ds_read_b32 v14, v10 offset:12
    s_waitcnt lgkmcnt(0)
    v_readfirstlane_b32 s66, v14
    s_cmp_ge_u32 s66, 4
    s_cbranch_scc1 a_pg0_ok
    s_mov_b32 s42, 1
    s_add_u32 s55, s63, 113664
    s_mov_b32 m0, s55
    s_nop 0
    buffer_load_dwordx4 v8, s[32:35], s55 offen offset:0 sc1 lds
    buffer_load_dwordx4 v8, s[32:35], s55 offen offset:1024 sc1 lds
    buffer_load_dwordx4 v8, s[32:35], s55 offen offset:2048 sc1 lds
    buffer_load_dwordx4 v8, s[32:35], s55 offen offset:3072 sc1 lds
    s_add_u32 s55, s63, 130048
    s_mov_b32 m0, s55
    s_nop 0
    buffer_load_dwordx4 v8, s[32:35], s55 offen offset:0 sc1 lds
    buffer_load_dwordx4 v8, s[32:35], s55 offen offset:1024 sc1 lds
    buffer_load_dwordx4 v8, s[32:35], s55 offen offset:2048 sc1 lds
    buffer_load_dwordx4 v8, s[32:35], s55 offen offset:3072 sc1 lds
    s_lshl_b32 s65, s3, 10
    s_add_u32 s55, s65, 146432
    s_mov_b32 m0, s55
    s_nop 0
    buffer_load_dwordx4 v8, s[32:35], s55 offen offset:0 sc1 lds
    buffer_load_dwordx4 v8, s[32:35], s55 offen offset:1024 sc1 lds
    s_waitcnt vmcnt(0)
    s_mov_b64 exec, 1
    ds_add_u32 v10, v11 offset:8
    s_mov_b64 exec, -1
a_pg0:
    ds_read_b32 v14, v10 offset:12
    s_waitcnt lgkmcnt(0)
    v_readfirstlane_b32 s66, v14
    s_cmp_ge_u32 s66, 4
    s_cbranch_scc1 a_pg0_ok
    s_sleep 8
    s_sub_i32 s0, s0, 1
    s_cmp_lt_i32 s0, 0
    s_cbranch_scc0 a_pg0
a_pg0_ok:
    s_sub_u32 s61, 576, s50
    s_cmp_eq_u32 s50, 0
    s_cselect_b32 s61, 0, s61
    s_cmp_eq_u32 s57, 0
    s_cselect_b32 s55, s50, s61
    s_lshl_b32 s64, s55, 4
    s_add_u32 s64, s64, 5177344
    s_add_u32 m0, s51, 0
    s_nop 0
    buffer_load_dwordx4 v253, s[32:35], s64 offen sc1 lds
    s_add_u32 s64, s64, 589824
    s_add_u32 m0, s51, 1024
    s_nop 0
    buffer_load_dwordx4 v253, s[32:35], s64 offen sc1 lds
    s_add_u32 s64, s64, 589824
    s_add_u32 m0, s51, 2048
    s_nop 0
    buffer_load_dwordx4 v253, s[32:35], s64 offen sc1 lds
    s_add_u32 s64, s64, 589824
    s_add_u32 m0, s51, 3072
    s_nop 0
    buffer_load_dwordx4 v253, s[32:35], s64 offen sc1 lds
    s_add_u32 s64, s64, 589824
    s_mov_b32 s48, s55
    s_add_u32 s55, s63, 113664
    s_mov_b32 m0, s55
    s_nop 0
    buffer_load_dwordx4 v8, s[32:35], s55 offen offset:0 sc1 lds
    buffer_load_dwordx4 v8, s[32:35], s55 offen offset:1024 sc1 lds
    buffer_load_dwordx4 v8, s[32:35], s55 offen offset:2048 sc1 lds
    buffer_load_dwordx4 v8, s[32:35], s55 offen offset:3072 sc1 lds
    s_add_u32 s55, s63, 130048
    s_mov_b32 m0, s55
    s_nop 0
    buffer_load_dwordx4 v8, s[32:35], s55 offen offset:0 sc1 lds
    buffer_load_dwordx4 v8, s[32:35], s55 offen offset:1024 sc1 lds
    buffer_load_dwordx4 v8, s[32:35], s55 offen offset:2048 sc1 lds
    buffer_load_dwordx4 v8, s[32:35], s55 offen offset:3072 sc1 lds
    s_lshl_b32 s65, s3, 10
    s_add_u32 s55, s65, 146432
    s_mov_b32 m0, s55
    s_nop 0
    buffer_load_dwordx4 v8, s[32:35], s55 offen offset:0 sc1 lds
    buffer_load_dwordx4 v8, s[32:35], s55 offen offset:1024 sc1 lds
    s_mov_b32 s55, s48
    s_cmp_eq_u32 s50, s61
    s_cselect_b32 s64, 2, s57
    s_lshl_b32 s64, s64, 14
    s_add_u32 s64, s64, 96256
    s_lshl_b32 s44, s57, 12
    s_sub_u32 s45, 4096, s44
    s_add_u32 s44, s44, s64
    s_add_u32 s45, s45, s64
    s_add_u32 s46, s44, 8192
    s_add_u32 s47, s45, 8192
    s_lshl_b32 s48, s57, 13
    s_add_u32 s48, s48, 79872
    s_add_u32 s49, s48, 4096
    s_lshl_b32 s64, s50, 13
    s_lshl_b32 s65, s57, 7
    s_add_u32 s64, s64, s65
    s_add_u32 s64, s64, 9895936
    s_add_u32 s65, s64, 4096
    s_waitcnt vmcnt(10)
    s_mov_b64 exec, 1
    ds_add_u32 v15, v11 offset:20
    s_mov_b64 exec, -1
a_xin:
    ds_read_b32 v14, v15 offset:20
    s_waitcnt lgkmcnt(0)
    v_readfirstlane_b32 s66, v14
    s_cmp_ge_u32 s66, 2
    s_cbranch_scc1 a_xin_ok
    s_sleep 1
    s_sub_i32 s0, s0, 1
    s_cmp_lt_i32 s0, 0
    s_cbranch_scc0 a_xin
a_xin_ok:
    ds_read_b128 v[16:19], v6 offset:0
    ds_read_b128 v[20:23], v6 offset:1024
    ds_read_b128 v[24:27], v6 offset:2048
    ds_read_b128 v[28:31], v6 offset:3072
    ds_read_b128 v[32:35], v7 offset:0
    ds_read_b128 v[36:39], v7 offset:1024
    ds_read_b128 v[40:43], v7 offset:2048
    ds_read_b128 v[44:47], v7 offset:3072
    s_waitcnt lgkmcnt(7)
    v_mfma_f32_32x32x16_bf16 v[112:127], v[16:19], v[48:51], 0
    buffer_load_dwordx4 v[48:51], v8, s[36:39], s44 offen offset:0
    v_mfma_f32_32x32x16_bf16 v[128:143], v[16:19], v[80:83], 0
    buffer_load_dwordx4 v[80:83], v8, s[36:39], s46 offen offset:0
    buffer_load_dwordx4 v[16:19], v8, s[36:39], s48 offen offset:0
    s_waitcnt lgkmcnt(6)
    v_mfma_f32_32x32x16_bf16 v[112:127], v[20:23], v[52:55], v[112:127]
    buffer_load_dwordx4 v[52:55], v8, s[36:39], s44 offen offset:1024
    v_mfma_f32_32x32x16_bf16 v[128:143], v[20:23], v[84:87], v[128:143]
    buffer_load_dwordx4 v[84:87], v8, s[36:39], s46 offen offset:1024
    buffer_load_dwordx4 v[20:23], v8, s[36:39], s48 offen offset:1024
    s_waitcnt lgkmcnt(5)
    v_mfma_f32_32x32x16_bf16 v[112:127], v[24:27], v[56:59], v[112:127]
    buffer_load_dwordx4 v[56:59], v8, s[36:39], s44 offen offset:2048
    v_mfma_f32_32x32x16_bf16 v[128:143], v[24:27], v[88:91], v[128:143]
    buffer_load_dwordx4 v[88:91], v8, s[36:39], s46 offen offset:2048
    buffer_load_dwordx4 v[24:27], v8, s[36:39], s48 offen offset:2048
    s_waitcnt lgkmcnt(4)
    v_mfma_f32_32x32x16_bf16 v[112:127], v[28:31], v[60:63], v[112:127]
    buffer_load_dwordx4 v[60:63], v8, s[36:39], s44 offen offset:3072
    v_mfma_f32_32x32x16_bf16 v[128:143], v[28:31], v[92:95], v[128:143]
    buffer_load_dwordx4 v[92:95], v8, s[36:39], s46 offen offset:3072
    buffer_load_dwordx4 v[28:31], v8, s[36:39], s48 offen offset:3072
    s_waitcnt lgkmcnt(3)
    v_mfma_f32_32x32x16_bf16 v[112:127], v[32:35], v[64:67], v[112:127]
    buffer_load_dwordx4 v[64:67], v8, s[36:39], s45 offen offset:0
    v_mfma_f32_32x32x16_bf16 v[128:143], v[32:35], v[96:99], v[128:143]
    buffer_load_dwordx4 v[96:99], v8, s[36:39], s47 offen offset:0
    buffer_load_dwordx4 v[32:35], v8, s[36:39], s49 offen offset:0
    s_waitcnt lgkmcnt(2)
    v_mfma_f32_32x32x16_bf16 v[112:127], v[36:39], v[68:71], v[112:127]
    buffer_load_dwordx4 v[68:71], v8, s[36:39], s45 offen offset:1024
    v_mfma_f32_32x32x16_bf16 v[128:143], v[36:39], v[100:103], v[128:143]
    buffer_load_dwordx4 v[100:103], v8, s[36:39], s47 offen offset:1024
    buffer_load_dwordx4 v[36:39], v8, s[36:39], s49 offen offset:1024
    s_waitcnt lgkmcnt(1)
    v_mfma_f32_32x32x16_bf16 v[112:127], v[40:43], v[72:75], v[112:127]
    buffer_load_dwordx4 v[72:75], v8, s[36:39], s45 offen offset:2048
    v_mfma_f32_32x32x16_bf16 v[128:143], v[40:43], v[104:107], v[128:143]
    buffer_load_dwordx4 v[104:107], v8, s[36:39], s47 offen offset:2048
    buffer_load_dwordx4 v[40:43], v8, s[36:39], s49 offen offset:2048
    s_waitcnt lgkmcnt(0)
    v_mfma_f32_32x32x16_bf16 v[112:127], v[44:47], v[76:79], v[112:127]
    buffer_load_dwordx4 v[76:79], v8, s[36:39], s45 offen offset:3072
    v_mfma_f32_32x32x16_bf16 v[128:143], v[44:47], v[108:111], v[128:143]
    buffer_load_dwordx4 v[108:111], v8, s[36:39], s47 offen offset:3072
    buffer_load_dwordx4 v[44:47], v8, s[36:39], s49 offen offset:3072
    s_mov_b64 exec, 1
    ds_add_u32 v15, v11 offset:20
    s_mov_b64 exec, -1
    s_nop 4
    v_pk_mul_f32 v[232:233], v[112:113], v[144:145]
    s_nop 0
    v_pk_mul_f32 v[234:235], v[128:129], v[144:145]
    v_pk_fma_f32 v[232:233], v[128:129], v[160:161], v[232:233]
    v_pk_fma_f32 v[234:235], v[112:113], v[160:161], v[234:235] neg_lo:[1,0,0] neg_hi:[1,0,0]
    v_cvt_pk_bf16_f32 v216, v232, v233
    v_cvt_pk_bf16_f32 v224, v234, v235
    buffer_load_short_d16_hi v144, v4, s[32:35], s64 offen offset:0 sc1
    buffer_load_short_d16_hi v160, v4, s[32:35], s64 offen offset:8 sc1
    buffer_load_short_d16_hi v145, v4, s[32:35], s64 offen offset:256 sc1
    buffer_load_short_d16_hi v161, v4, s[32:35], s64 offen offset:264 sc1
    v_pk_mul_f32 v[236:237], v[114:115], v[146:147]
    v_pk_mul_f32 v[238:239], v[130:131], v[146:147]
    v_pk_fma_f32 v[236:237], v[130:131], v[162:163], v[236:237]
    v_pk_fma_f32 v[238:239], v[114:115], v[162:163], v[238:239] neg_lo:[1,0,0] neg_hi:[1,0,0]
    v_cvt_pk_bf16_f32 v217, v236, v237
    v_cvt_pk_bf16_f32 v225, v238, v239
    buffer_load_short_d16_hi v146, v4, s[32:35], s64 offen offset:512 sc1
    buffer_load_short_d16_hi v162, v4, s[32:35], s64 offen offset:520 sc1
    buffer_load_short_d16_hi v147, v4, s[32:35], s64 offen offset:768 sc1
    buffer_load_short_d16_hi v163, v4, s[32:35], s64 offen offset:776 sc1
    v_pk_mul_f32 v[232:233], v[116:117], v[148:149]
    v_pk_mul_f32 v[234:235], v[132:133], v[148:149]
    v_pk_fma_f32 v[232:233], v[132:133], v[164:165], v[232:233]
    v_pk_fma_f32 v[234:235], v[116:117], v[164:165], v[234:235] neg_lo:[1,0,0] neg_hi:[1,0,0]
    v_cvt_pk_bf16_f32 v218, v232, v233
    v_cvt_pk_bf16_f32 v226, v234, v235
    buffer_load_short_d16_hi v148, v4, s[32:35], s64 offen offset:2048 sc1
    buffer_load_short_d16_hi v164, v4, s[32:35], s64 offen offset:2056 sc1
    buffer_load_short_d16_hi v149, v4, s[32:35], s64 offen offset:2304 sc1
    buffer_load_short_d16_hi v165, v4, s[32:35], s64 offen offset:2312 sc1
    v_pk_mul_f32 v[236:237], v[118:119], v[150:151]
    v_pk_mul_f32 v[238:239], v[134:135], v[150:151]
    v_pk_fma_f32 v[236:237], v[134:135], v[166:167], v[236:237]
    v_pk_fma_f32 v[238:239], v[118:119], v[166:167], v[238:239] neg_lo:[1,0,0] neg_hi:[1,0,0]
    v_cvt_pk_bf16_f32 v219, v236, v237
    v_cvt_pk_bf16_f32 v227, v238, v239
    buffer_load_short_d16_hi v150, v4, s[32:35], s64 offen offset:2560 sc1
    buffer_load_short_d16_hi v166, v4, s[32:35], s64 offen offset:2568 sc1
    buffer_load_short_d16_hi v151, v4, s[32:35], s64 offen offset:2816 sc1
    buffer_load_short_d16_hi v167, v4, s[32:35], s64 offen offset:2824 sc1
    v_pk_mul_f32 v[232:233], v[120:121], v[152:153]
    v_pk_mul_f32 v[234:235], v[136:137], v[152:153]
    v_pk_fma_f32 v[232:233], v[136:137], v[168:169], v[232:233]
    v_pk_fma_f32 v[234:235], v[120:121], v[168:169], v[234:235] neg_lo:[1,0,0] neg_hi:[1,0,0]
    v_cvt_pk_bf16_f32 v220, v232, v233
    v_cvt_pk_bf16_f32 v228, v234, v235
    buffer_load_short_d16_hi v152, v4, s[32:35], s65 offen offset:0 sc1
    buffer_load_short_d16_hi v168, v4, s[32:35], s65 offen offset:8 sc1
    buffer_load_short_d16_hi v153, v4, s[32:35], s65 offen offset:256 sc1
    buffer_load_short_d16_hi v169, v4, s[32:35], s65 offen offset:264 sc1
    v_pk_mul_f32 v[236:237], v[122:123], v[154:155]
    v_pk_mul_f32 v[238:239], v[138:139], v[154:155]
    v_pk_fma_f32 v[236:237], v[138:139], v[170:171], v[236:237]
    v_pk_fma_f32 v[238:239], v[122:123], v[170:171], v[238:239] neg_lo:[1,0,0] neg_hi:[1,0,0]
    v_cvt_pk_bf16_f32 v221, v236, v237
    v_cvt_pk_bf16_f32 v229, v238, v239
    buffer_load_short_d16_hi v154, v4, s[32:35], s65 offen offset:512 sc1
    buffer_load_short_d16_hi v170, v4, s[32:35], s65 offen offset:520 sc1
    buffer_load_short_d16_hi v155, v4, s[32:35], s65 offen offset:768 sc1
    buffer_load_short_d16_hi v171, v4, s[32:35], s65 offen offset:776 sc1
    v_pk_mul_f32 v[232:233], v[124:125], v[156:157]
    v_pk_mul_f32 v[234:235], v[140:141], v[156:157]
    v_pk_fma_f32 v[232:233], v[140:141], v[172:173], v[232:233]
    v_pk_fma_f32 v[234:235], v[124:125], v[172:173], v[234:235] neg_lo:[1,0,0] neg_hi:[1,0,0]
    v_cvt_pk_bf16_f32 v222, v232, v233
    v_cvt_pk_bf16_f32 v230, v234, v235
    buffer_load_short_d16_hi v156, v4, s[32:35], s65 offen offset:2048 sc1
    buffer_load_short_d16_hi v172, v4, s[32:35], s65 offen offset:2056 sc1
    buffer_load_short_d16_hi v157, v4, s[32:35], s65 offen offset:2304 sc1
    buffer_load_short_d16_hi v173, v4, s[32:35], s65 offen offset:2312 sc1
    v_pk_mul_f32 v[236:237], v[126:127], v[158:159]
    v_pk_mul_f32 v[238:239], v[142:143], v[158:159]
    v_pk_fma_f32 v[236:237], v[142:143], v[174:175], v[236:237]
    v_pk_fma_f32 v[238:239], v[126:127], v[174:175], v[238:239] neg_lo:[1,0,0] neg_hi:[1,0,0]
    v_cvt_pk_bf16_f32 v223, v236, v237
    v_cvt_pk_bf16_f32 v231, v238, v239
    buffer_load_short_d16_hi v158, v4, s[32:35], s65 offen offset:2560 sc1
    buffer_load_short_d16_hi v174, v4, s[32:35], s65 offen offset:2568 sc1
    buffer_load_short_d16_hi v159, v4, s[32:35], s65 offen offset:2816 sc1
    buffer_load_short_d16_hi v175, v4, s[32:35], s65 offen offset:2824 sc1
    v_mfma_f32_32x32x16_bf16 v[112:127], v[176:179], v[216:219], 0
    v_mfma_f32_32x32x16_bf16 v[128:143], v[176:179], v[224:227], 0
    v_mfma_f32_32x32x16_bf16 v[112:127], v[180:183], v[220:223], v[112:127]
    v_mfma_f32_32x32x16_bf16 v[128:143], v[180:183], v[228:231], v[128:143]
    v_mfma_f32_32x32x16_bf16 v[112:127], v[184:187], v[224:227], v[112:127]
    v_mfma_f32_32x32x16_bf16 v[128:143], v[192:195], v[216:219], v[128:143]
    v_mfma_f32_32x32x16_bf16 v[112:127], v[188:191], v[228:231], v[112:127]
    v_mfma_f32_32x32x16_bf16 v[128:143], v[196:199], v[220:223], v[128:143]
    s_waitcnt vmcnt(0)
    s_cmp_eq_u32 s42, 1
    s_cbranch_scc1 a_l2d
    s_mov_b64 exec, 1
    ds_add_u32 v10, v11 offset:8
    s_mov_b64 exec, -1
a_l2d:
    s_nop 7
    v_pk_mul_f32 v[232:233], v[112:113], v[144:145]
    v_pk_mul_f32 v[234:235], v[128:129], v[144:145]
    v_pk_fma_f32 v[232:233], v[128:129], v[160:161], v[232:233] neg_lo:[1,0,0] neg_hi:[1,0,0]
    v_pk_fma_f32 v[234:235], v[112:113], v[160:161], v[234:235]
    v_cvt_pk_bf16_f32 v216, v232, v233
    v_cvt_pk_bf16_f32 v224, v234, v235
    v_pk_mul_f32 v[236:237], v[114:115], v[146:147]
    v_pk_mul_f32 v[238:239], v[130:131], v[146:147]
    v_pk_fma_f32 v[236:237], v[130:131], v[162:163], v[236:237] neg_lo:[1,0,0] neg_hi:[1,0,0]
    v_pk_fma_f32 v[238:239], v[114:115], v[162:163], v[238:239]
    v_cvt_pk_bf16_f32 v217, v236, v237
    v_cvt_pk_bf16_f32 v225, v238, v239
    v_pk_mul_f32 v[232:233], v[116:117], v[148:149]
    v_pk_mul_f32 v[234:235], v[132:133], v[148:149]
    v_pk_fma_f32 v[232:233], v[132:133], v[164:165], v[232:233] neg_lo:[1,0,0] neg_hi:[1,0,0]
    v_pk_fma_f32 v[234:235], v[116:117], v[164:165], v[234:235]
    v_cvt_pk_bf16_f32 v218, v232, v233
    v_cvt_pk_bf16_f32 v226, v234, v235
    v_pk_mul_f32 v[236:237], v[118:119], v[150:151]
    v_pk_mul_f32 v[238:239], v[134:135], v[150:151]
    v_pk_fma_f32 v[236:237], v[134:135], v[166:167], v[236:237] neg_lo:[1,0,0] neg_hi:[1,0,0]
    v_pk_fma_f32 v[238:239], v[118:119], v[166:167], v[238:239]
    v_cvt_pk_bf16_f32 v219, v236, v237
    v_cvt_pk_bf16_f32 v227, v238, v239
    v_pk_mul_f32 v[232:233], v[120:121], v[152:153]
    v_pk_mul_f32 v[234:235], v[136:137], v[152:153]
    v_pk_fma_f32 v[232:233], v[136:137], v[168:169], v[232:233] neg_lo:[1,0,0] neg_hi:[1,0,0]
    v_pk_fma_f32 v[234:235], v[120:121], v[168:169], v[234:235]
    v_cvt_pk_bf16_f32 v220, v232, v233
    v_cvt_pk_bf16_f32 v228, v234, v235
    v_pk_mul_f32 v[236:237], v[122:123], v[154:155]
    v_pk_mul_f32 v[238:239], v[138:139], v[154:155]
    v_pk_fma_f32 v[236:237], v[138:139], v[170:171], v[236:237] neg_lo:[1,0,0] neg_hi:[1,0,0]
    v_pk_fma_f32 v[238:239], v[122:123], v[170:171], v[238:239]
    v_cvt_pk_bf16_f32 v221, v236, v237
    v_cvt_pk_bf16_f32 v229, v238, v239
    v_pk_mul_f32 v[232:233], v[124:125], v[156:157]
    v_pk_mul_f32 v[234:235], v[140:141], v[156:157]
    v_pk_fma_f32 v[232:233], v[140:141], v[172:173], v[232:233] neg_lo:[1,0,0] neg_hi:[1,0,0]
    v_pk_fma_f32 v[234:235], v[124:125], v[172:173], v[234:235]
    v_cvt_pk_bf16_f32 v222, v232, v233
    v_cvt_pk_bf16_f32 v230, v234, v235
    v_pk_mul_f32 v[236:237], v[126:127], v[158:159]
    v_pk_mul_f32 v[238:239], v[142:143], v[158:159]
    v_pk_fma_f32 v[236:237], v[142:143], v[174:175], v[236:237] neg_lo:[1,0,0] neg_hi:[1,0,0]
    v_pk_fma_f32 v[238:239], v[126:127], v[174:175], v[238:239]
    v_cvt_pk_bf16_f32 v223, v236, v237
    v_cvt_pk_bf16_f32 v231, v238, v239
    v_mfma_f32_32x32x16_bf16 v[112:127], v[216:219], v[176:179], 0
    v_mfma_f32_32x32x16_bf16 v[128:143], v[224:227], v[176:179], 0
    v_mfma_f32_32x32x16_bf16 v[112:127], v[220:223], v[180:183], v[112:127]
    v_mfma_f32_32x32x16_bf16 v[128:143], v[228:231], v[180:183], v[128:143]
    v_mfma_f32_32x32x16_bf16 v[112:127], v[224:227], v[192:195], v[112:127]
    v_mfma_f32_32x32x16_bf16 v[128:143], v[216:219], v[184:187], v[128:143]
    v_mfma_f32_32x32x16_bf16 v[112:127], v[228:231], v[196:199], v[112:127]
    v_mfma_f32_32x32x16_bf16 v[128:143], v[220:223], v[188:191], v[128:143]
    s_nop 10
    v_pk_mul_f32 v[232:233], v[112:113], v[16:17]
    v_pk_mul_f32 v[234:235], v[128:129], v[16:17]
    v_pk_fma_f32 v[232:233], v[128:129], v[32:33], v[232:233]
    v_pk_fma_f32 v[234:235], v[112:113], v[32:33], v[234:235] neg_lo:[1,0,0] neg_hi:[1,0,0]
    v_cvt_pk_bf16_f32 v216, v232, v233
    v_cvt_pk_bf16_f32 v224, v234, v235
    v_pk_mul_f32 v[236:237], v[114:115], v[18:19]
    v_pk_mul_f32 v[238:239], v[130:131], v[18:19]
    v_pk_fma_f32 v[236:237], v[130:131], v[34:35], v[236:237]
    v_pk_fma_f32 v[238:239], v[114:115], v[34:35], v[238:239] neg_lo:[1,0,0] neg_hi:[1,0,0]
    v_cvt_pk_bf16_f32 v217, v236, v237
    v_cvt_pk_bf16_f32 v225, v238, v239
    v_pk_mul_f32 v[232:233], v[116:117], v[20:21]
    v_pk_mul_f32 v[234:235], v[132:133], v[20:21]
    v_pk_fma_f32 v[232:233], v[132:133], v[36:37], v[232:233]
    v_pk_fma_f32 v[234:235], v[116:117], v[36:37], v[234:235] neg_lo:[1,0,0] neg_hi:[1,0,0]
    v_cvt_pk_bf16_f32 v218, v232, v233
    v_cvt_pk_bf16_f32 v226, v234, v235
    v_pk_mul_f32 v[236:237], v[118:119], v[22:23]
    v_pk_mul_f32 v[238:239], v[134:135], v[22:23]
    v_pk_fma_f32 v[236:237], v[134:135], v[38:39], v[236:237]
    v_pk_fma_f32 v[238:239], v[118:119], v[38:39], v[238:239] neg_lo:[1,0,0] neg_hi:[1,0,0]
    v_cvt_pk_bf16_f32 v219, v236, v237
    v_cvt_pk_bf16_f32 v227, v238, v239
    v_pk_mul_f32 v[232:233], v[120:121], v[24:25]
    v_pk_mul_f32 v[234:235], v[136:137], v[24:25]
    v_pk_fma_f32 v[232:233], v[136:137], v[40:41], v[232:233]
    v_pk_fma_f32 v[234:235], v[120:121], v[40:41], v[234:235] neg_lo:[1,0,0] neg_hi:[1,0,0]
    v_cvt_pk_bf16_f32 v220, v232, v233
    v_cvt_pk_bf16_f32 v228, v234, v235
    v_pk_mul_f32 v[236:237], v[122:123], v[26:27]
    v_pk_mul_f32 v[238:239], v[138:139], v[26:27]
    v_pk_fma_f32 v[236:237], v[138:139], v[42:43], v[236:237]
    v_pk_fma_f32 v[238:239], v[122:123], v[42:43], v[238:239] neg_lo:[1,0,0] neg_hi:[1,0,0]
    v_cvt_pk_bf16_f32 v221, v236, v237
    v_cvt_pk_bf16_f32 v229, v238, v239
    v_pk_mul_f32 v[232:233], v[124:125], v[28:29]
    v_pk_mul_f32 v[234:235], v[140:141], v[28:29]
    v_pk_fma_f32 v[232:233], v[140:141], v[44:45], v[232:233]
    v_pk_fma_f32 v[234:235], v[124:125], v[44:45], v[234:235] neg_lo:[1,0,0] neg_hi:[1,0,0]
    v_cvt_pk_bf16_f32 v222, v232, v233
    v_cvt_pk_bf16_f32 v230, v234, v235
    v_pk_mul_f32 v[236:237], v[126:127], v[30:31]
    v_pk_mul_f32 v[238:239], v[142:143], v[30:31]
    v_pk_fma_f32 v[236:237], v[142:143], v[46:47], v[236:237]
    v_pk_fma_f32 v[238:239], v[126:127], v[46:47], v[238:239] neg_lo:[1,0,0] neg_hi:[1,0,0]
    v_cvt_pk_bf16_f32 v223, v236, v237
    v_cvt_pk_bf16_f32 v231, v238, v239
a_xrd:
    ds_read_b32 v14, v15 offset:20
    s_waitcnt lgkmcnt(0)
    v_readfirstlane_b32 s66, v14
    s_cmp_ge_u32 s66, 4
    s_cbranch_scc1 a_xrd_ok
    s_sleep 1
    s_sub_i32 s0, s0, 1
    s_cmp_lt_i32 s0, 0
    s_cbranch_scc0 a_xrd
a_xrd_ok:
    ds_write_b128 v6, v[216:219] offset:0
    ds_write_b128 v6, v[220:223] offset:1024
    ds_write_b128 v6, v[224:227] offset:2048
    ds_write_b128 v6, v[228:231] offset:3072
    s_waitcnt lgkmcnt(0)
    s_mov_b64 exec, 1
    ds_add_u32 v15, v11 offset:20
    s_mov_b64 exec, -1
    v_mfma_f32_32x32x16_bf16 v[112:127], v[48:51], v[216:219], 0
    v_mfma_f32_32x32x16_bf16 v[128:143], v[80:83], v[216:219], 0
    v_mfma_f32_32x32x16_bf16 v[112:127], v[52:55], v[220:223], v[112:127]
    v_mfma_f32_32x32x16_bf16 v[128:143], v[84:87], v[220:223], v[128:143]
    v_mfma_f32_32x32x16_bf16 v[112:127], v[56:59], v[224:227], v[112:127]
    v_mfma_f32_32x32x16_bf16 v[128:143], v[88:91], v[224:227], v[128:143]
    v_mfma_f32_32x32x16_bf16 v[112:127], v[60:63], v[228:231], v[112:127]
    v_mfma_f32_32x32x16_bf16 v[128:143], v[92:95], v[228:231], v[128:143]
a_ex:
    ds_read_b32 v14, v15 offset:20
    s_waitcnt lgkmcnt(0)
    v_readfirstlane_b32 s66, v14
    s_cmp_ge_u32 s66, 6
    s_cbranch_scc1 a_ex_ok
    s_sleep 1
    s_sub_i32 s0, s0, 1
    s_cmp_lt_i32 s0, 0
    s_cbranch_scc0 a_ex
a_ex_ok:
    ds_read_b128 v[200:203], v7 offset:0
    ds_read_b128 v[204:207], v7 offset:1024
    ds_read_b128 v[208:211], v7 offset:2048
    ds_read_b128 v[212:215], v7 offset:3072
    s_waitcnt lgkmcnt(3)
    v_mfma_f32_32x32x16_bf16 v[112:127], v[64:67], v[200:203], v[112:127]
    v_mfma_f32_32x32x16_bf16 v[128:143], v[96:99], v[200:203], v[128:143]
    s_waitcnt lgkmcnt(2)
    v_mfma_f32_32x32x16_bf16 v[112:127], v[68:71], v[204:207], v[112:127]
    v_mfma_f32_32x32x16_bf16 v[128:143], v[100:103], v[204:207], v[128:143]
    s_waitcnt lgkmcnt(1)
    v_mfma_f32_32x32x16_bf16 v[112:127], v[72:75], v[208:211], v[112:127]
    v_mfma_f32_32x32x16_bf16 v[128:143], v[104:107], v[208:211], v[128:143]
    s_waitcnt lgkmcnt(0)
    v_mfma_f32_32x32x16_bf16 v[112:127], v[76:79], v[212:215], v[112:127]
    v_mfma_f32_32x32x16_bf16 v[128:143], v[108:111], v[212:215], v[128:143]
    s_lshl_b32 s64, s55, 12
    s_add_u32 s64, s64, 7536640
    s_nop 9
    v_cvt_pk_bf16_f32 v216, v112, v128
    v_cvt_pk_bf16_f32 v217, v113, v129
    v_cvt_pk_bf16_f32 v218, v114, v130
    v_cvt_pk_bf16_f32 v219, v115, v131
    buffer_store_dwordx4 v[216:219], v252, s[32:35], s64 offen offset:0 sc1
    v_cvt_pk_bf16_f32 v220, v116, v132
    v_cvt_pk_bf16_f32 v221, v117, v133
    v_cvt_pk_bf16_f32 v222, v118, v134
    v_cvt_pk_bf16_f32 v223, v119, v135
    buffer_store_dwordx4 v[220:223], v252, s[32:35], s64 offen offset:1024 sc1
    v_cvt_pk_bf16_f32 v224, v120, v136
    v_cvt_pk_bf16_f32 v225, v121, v137
    v_cvt_pk_bf16_f32 v226, v122, v138
    v_cvt_pk_bf16_f32 v227, v123, v139
    buffer_store_dwordx4 v[224:227], v252, s[32:35], s64 offen offset:2048 sc1
    v_cvt_pk_bf16_f32 v228, v124, v140
    v_cvt_pk_bf16_f32 v229, v125, v141
    v_cvt_pk_bf16_f32 v230, v126, v142
    v_cvt_pk_bf16_f32 v231, v127, v143
    buffer_store_dwordx4 v[228:231], v252, s[32:35], s64 offen offset:3072 sc1
    s_waitcnt vmcnt(0)
    s_mov_b64 exec, 1
    ds_add_rtn_u32 v14, v10, v11 offset:116
    s_mov_b64 exec, -1
    s_lshr_b32 s54, s2, 2
    s_lshl_b32 s54, s54, 7
    s_and_b32 s66, s2, 3
    s_lshl_b32 s66, s66, 2
    s_add_u32 s54, s54, s66
    s_add_u32 s54, s54, 212992
    s_waitcnt lgkmcnt(0)
    v_readfirstlane_b32 s66, v14
    s_cmp_eq_u32 s66, 3
    s_cselect_b32 s101, 1, 0
    s_cmp_eq_u32 s101, 1
    s_cbranch_scc0 a_ar3
    s_mov_b64 exec, 1
    v_mov_b32 v12, s68
    v_mov_b32 v13, 0
    buffer_store_dword v12, v13, s[32:35], s54 offen sc1
    s_mov_b64 exec, -1
    s_mov_b64 exec, 1
    ds_add_u32 v10, v11 offset:116
    s_mov_b64 exec, -1
a_ar3:
a_pub3:
    ds_read_b32 v14, v10 offset:116
    s_waitcnt lgkmcnt(0)
    v_readfirstlane_b32 s66, v14
    s_cmp_ge_u32 s66, 5
    s_cbranch_scc1 a_pub3_ok
    s_sleep 1
    s_sub_i32 s0, s0, 1
    s_cmp_lt_i32 s0, 0
    s_cbranch_scc0 a_pub3
a_pub3_ok:
    s_branch a_p3
a_defer:
    s_waitcnt vmcnt(0)
    s_mov_b64 exec, 1
    ds_add_rtn_u32 v14, v10, v11 offset:116
    s_mov_b64 exec, -1
    s_lshr_b32 s54, s2, 2
    s_lshl_b32 s54, s54, 7
    s_and_b32 s66, s2, 3
    s_lshl_b32 s66, s66, 2
    s_add_u32 s54, s54, s66
    s_add_u32 s54, s54, 212992
    s_waitcnt lgkmcnt(0)
    v_readfirstlane_b32 s66, v14
    s_cmp_eq_u32 s66, 3
    s_cselect_b32 s101, 1, 0
    s_cmp_eq_u32 s101, 1
    s_cbranch_scc0 a_ar3b
    s_mov_b64 exec, 1
    v_mov_b32 v12, s68
    v_mov_b32 v13, 0
    buffer_store_dword v12, v13, s[32:35], s54 offen sc1
    s_mov_b64 exec, -1
    s_mov_b64 exec, 1
    ds_add_u32 v10, v11 offset:116
    s_mov_b64 exec, -1
a_ar3b:
a_qr:
    ds_read_b32 v14, v10 offset:20
    s_waitcnt lgkmcnt(0)
    v_readfirstlane_b32 s66, v14
    s_cmp_ge_u32 s66, 4
    s_cbranch_scc1 a_qr_ok
    s_sleep 4
    s_sub_i32 s0, s0, 1
    s_cmp_lt_i32 s0, 0
    s_cbranch_scc0 a_qr
a_qr_ok:
    s_add_u32 s55, s63, 113664
    s_mov_b32 m0, s55
    s_nop 0
    buffer_load_dwordx4 v8, s[32:35], s55 offen offset:0 sc1 lds
    buffer_load_dwordx4 v8, s[32:35], s55 offen offset:1024 sc1 lds
    buffer_load_dwordx4 v8, s[32:35], s55 offen offset:2048 sc1 lds
    buffer_load_dwordx4 v8, s[32:35], s55 offen offset:3072 sc1 lds
    s_add_u32 s55, s63, 130048
    s_mov_b32 m0, s55
    s_nop 0
    buffer_load_dwordx4 v8, s[32:35], s55 offen offset:0 sc1 lds
    buffer_load_dwordx4 v8, s[32:35], s55 offen offset:1024 sc1 lds
    buffer_load_dwordx4 v8, s[32:35], s55 offen offset:2048 sc1 lds
    buffer_load_dwordx4 v8, s[32:35], s55 offen offset:3072 sc1 lds
    s_lshl_b32 s65, s3, 10
    s_add_u32 s55, s65, 146432
    s_mov_b32 m0, s55
    s_nop 0
    buffer_load_dwordx4 v8, s[32:35], s55 offen offset:0 sc1 lds
    buffer_load_dwordx4 v8, s[32:35], s55 offen offset:1024 sc1 lds
    s_waitcnt vmcnt(0)
    s_mov_b64 exec, 1
    ds_add_u32 v10, v11 offset:8
    s_mov_b64 exec, -1
a_p3:
    s_lshr_b32 s54, s62, 2
    s_lshl_b32 s54, s54, 7
    s_add_u32 s54, s54, 221184
    s_mov_b64 exec, 0x1
    buffer_load_dword v255, v254, s[32:35], s54 offen
    s_mov_b64 exec, -1
    s_lshl_b32 s54, s52, 10
    s_lshl_b32 s55, s53, 7
    s_add_u32 s54, s54, s55
    s_add_u32 s54, s54, 262144
    s_mov_b64 exec, 0x1
    buffer_load_dword v255, v254, s[32:35], s54 offen
    s_mov_b64 exec, -1
    s_mov_b32 s28, s18
    s_mov_b32 s29, s19
    s_mov_b32 s30, 663552
    s_mov_b32 s31, 0x20000
    s_mul_i32 s54, s59, 20736
    s_mul_i32 s55, s3, 5248
    s_add_u32 s54, s54, s55
    s_mov_b32 exec_hi, 0x1ff
    buffer_load_dword v255, v254, s[28:31], s54 offen
    s_mov_b64 exec, -1
    s_mov_b32 s65, 12288
    buffer_load_dwordx4 v[28:31], v8, s[36:39], s65 offen offset:0
    buffer_load_dwordx4 v[32:35], v8, s[36:39], s65 offen offset:1024
    buffer_load_dwordx4 v[36:39], v8, s[36:39], s65 offen offset:2048
    buffer_load_dwordx4 v[40:43], v8, s[36:39], s65 offen offset:3072
    s_add_u32 s65, s65, 4096
    buffer_load_dwordx4 v[44:47], v8, s[36:39], s65 offen offset:0
    buffer_load_dwordx4 v[48:51], v8, s[36:39], s65 offen offset:1024
    s_mov_b32 s65, 0
    buffer_load_dwordx4 v[52:55], v8, s[36:39], s65 offen offset:0
    buffer_load_dwordx4 v[56:59], v8, s[36:39], s65 offen offset:1024
    buffer_load_dwordx4 v[60:63], v8, s[36:39], s65 offen offset:2048
    buffer_load_dwordx4 v[64:67], v8, s[36:39], s65 offen offset:3072
    s_add_u32 s65, s65, 4096
    buffer_load_dwordx4 v[68:71], v8, s[36:39], s65 offen offset:0
    buffer_load_dwordx4 v[72:75], v8, s[36:39], s65 offen offset:1024
    s_mov_b32 s65, 18432
    buffer_load_dwordx4 v[144:147], v8, s[36:39], s65 offen offset:0
    buffer_load_dwordx4 v[148:151], v8, s[36:39], s65 offen offset:1024
    buffer_load_dwordx4 v[152:155], v8, s[36:39], s65 offen offset:2048
    s_mov_b32 s65, 21504
    buffer_load_dwordx4 v[160:163], v8, s[36:39], s65 offen offset:0
    buffer_load_dwordx4 v[164:167], v8, s[36:39], s65 offen offset:1024
    buffer_load_dwordx4 v[168:171], v8, s[36:39], s65 offen offset:2048
    s_cmp_gt_u32 s2, 32
    s_cselect_b32 s66, 1, 0
    s_cmp_eq_u32 s3, 3
    s_cselect_b32 s65, 1, 0
    s_cmp_eq_u32 s66, 1
    s_cselect_b32 s101, s65, s101
    s_cmp_eq_u32 s101, 1
    s_cbranch_scc0 a_f3_w
a_f3_own:
    ds_read_b32 v14, v10 offset:116
    s_waitcnt lgkmcnt(0)
    v_readfirstlane_b32 s66, v14
    s_cmp_ge_u32 s66, 5
    s_cbranch_scc1 a_f3_own_ok
    s_sleep 4
    s_sub_i32 s0, s0, 1
    s_cmp_lt_i32 s0, 0
    s_cbranch_scc0 a_f3_own
a_f3_own_ok:
    s_lshl_b32 s54, s58, 7
    s_add_u32 s54, s54, 311296
    s_cmp_ge_u32 s2, 248
    s_cbranch_scc0 a_f3_f
    s_mov_b32 s65, 212992
    s_mov_b32 s67, 32768
a_f3:
    buffer_load_dwordx4 v[80:83], v254, s[32:35], s65 offen sc1
    s_waitcnt vmcnt(0)
    v_xor_b32 v80, s68, v80
    v_xor_b32 v81, s68, v81
    v_xor_b32 v82, s68, v82
    v_xor_b32 v83, s68, v83
    v_or3_b32 v80, v80, v81, v82
    v_or_b32 v80, v80, v83
    v_cmp_eq_u32 vcc, 0, v80
    s_sub_u32 s67, s67, 1
    s_cbranch_scc1 a_f3_ok
    s_nop 1
    s_cmp_eq_u64 vcc, exec
    s_cbranch_scc1 a_f3_ok
    s_sleep 1
    s_branch a_f3
a_f3_ok:
    s_mov_b64 exec, 1
    v_mov_b32 v12, s68
    v_mov_b32 v13, 0
    buffer_store_dword v12, v13, s[32:35], s54 offen sc1
    s_mov_b64 exec, -1
    s_branch a_f3_g_ok
a_f3_f:
    s_mov_b32 s67, 32768
    v_mov_b32 v13, 0
a_f3_g:
    buffer_load_dword v12, v13, s[32:35], s54 offen sc1
    s_waitcnt vmcnt(0)
    v_readfirstlane_b32 s66, v12
    s_sub_u32 s67, s67, 1
    s_cbranch_scc1 a_f3_g_ok
    s_cmp_eq_u32 s66, s68
    s_cbranch_scc1 a_f3_g_ok
    s_sleep 2
    s_branch a_f3_g
a_f3_g_ok:
    s_mov_b64 exec, 1
    ds_add_u32 v10, v11 offset:32
    s_mov_b64 exec, -1
a_f3_w:
    s_mul_i32 s57, s53, 160
    s_min_u32 s57, s57, 992
a_go3:
    ds_read_b32 v14, v10 offset:32
    s_waitcnt lgkmcnt(0)
    v_readfirstlane_b32 s66, v14
    s_cmp_ge_u32 s66, 1
    s_cbranch_scc1 a_go3_ok
    s_sleep 4
    s_sub_i32 s0, s0, 1
    s_cmp_lt_i32 s0, 0
    s_cbranch_scc0 a_go3
a_go3_ok:
    s_lshl_b32 s55, s62, 4
    s_add_u32 s55, s55, 7536640
    s_mul_i32 s54, s3, 2304
    s_add_u32 s54, s54, 151552
    s_add_u32 m0, s54, 0
    s_nop 0
    buffer_load_dwordx4 v250, s[32:35], s55 offen sc1 lds
    s_add_u32 s55, s55, 262144
    s_add_u32 m0, s54, 1024
    s_nop 0
    buffer_load_dwordx4 v250, s[32:35], s55 offen sc1 lds
    s_add_u32 s55, s55, 262144
    s_add_u32 m0, s54, 2048
    s_mov_b64 exec, 0xffff
    buffer_load_dwordx4 v250, s[32:35], s55 offen sc1 lds
    s_mov_b64 exec, -1
    s_add_u32 s55, s55, 262144
    s_waitcnt vmcnt(0)
    s_mov_b64 exec, 1
    ds_add_u32 v10, v11 offset:36
    s_mov_b64 exec, -1
a_p3c:
    ds_read_b32 v14, v10 offset:36
    s_waitcnt lgkmcnt(0)
    v_readfirstlane_b32 s66, v14
    s_cmp_ge_u32 s66, 4
    s_cbranch_scc1 a_p3c_ok
    s_sleep 1
    s_sub_i32 s0, s0, 1
    s_cmp_lt_i32 s0, 0
    s_cbranch_scc0 a_p3c
a_p3c_ok:
    ds_read_b32 v16, v251 offset:0
    ds_read_b32 v17, v251 offset:384
    ds_read_b32 v18, v251 offset:768
    ds_read_b32 v19, v251 offset:1152
    ds_read_b32 v20, v251 offset:3072
    ds_read_b32 v21, v251 offset:3456
    ds_read_b32 v22, v251 offset:3840
    ds_read_b32 v23, v251 offset:4224
    ds_read_b32 v24, v251 offset:6144
    ds_read_b32 v25, v251 offset:6528
    ds_read_b32 v26, v251 offset:6912
    ds_read_b32 v27, v251 offset:7296
    s_waitcnt lgkmcnt(8)
    v_mfma_f32_32x32x16_bf16 v[112:127], v[16:19], v[28:31], 0
    v_mfma_f32_32x32x16_bf16 v[128:143], v[16:19], v[40:43], 0
    s_waitcnt lgkmcnt(4)
    v_mfma_f32_32x32x16_bf16 v[112:127], v[20:23], v[32:35], v[112:127]
    v_mfma_f32_32x32x16_bf16 v[128:143], v[20:23], v[44:47], v[128:143]
    s_waitcnt lgkmcnt(0)
    v_mfma_f32_32x32x16_bf16 v[112:127], v[24:27], v[36:39], v[112:127]
    v_mfma_f32_32x32x16_bf16 v[128:143], v[24:27], v[48:51], v[128:143]
    s_mov_b64 exec, 1
    ds_add_u32 v10, v11 offset:36
    s_mov_b64 exec, -1
    s_nop 7
    v_pk_mul_f32 v[232:233], v[112:113], v[144:145]
    v_pk_mul_f32 v[234:235], v[128:129], v[144:145]
    v_pk_fma_f32 v[232:233], v[128:129], v[160:161], v[232:233]
    v_pk_fma_f32 v[234:235], v[112:113], v[160:161], v[234:235] neg_lo:[1,0,0] neg_hi:[1,0,0]
    v_cvt_pk_bf16_f32 v222, v232, v233
    v_cvt_pk_bf16_f32 v216, v234, v235
    v_pk_mul_f32 v[236:237], v[114:115], v[146:147]
    v_pk_mul_f32 v[238:239], v[130:131], v[146:147]
    v_pk_fma_f32 v[236:237], v[130:131], v[162:163], v[236:237]
    v_pk_fma_f32 v[238:239], v[114:115], v[162:163], v[238:239] neg_lo:[1,0,0] neg_hi:[1,0,0]
    v_cvt_pk_bf16_f32 v223, v236, v237
    v_cvt_pk_bf16_f32 v217, v238, v239
    v_pk_mul_f32 v[232:233], v[116:117], v[148:149]
    v_pk_mul_f32 v[234:235], v[132:133], v[148:149]
    v_pk_fma_f32 v[232:233], v[132:133], v[164:165], v[232:233]
    v_pk_fma_f32 v[234:235], v[116:117], v[164:165], v[234:235] neg_lo:[1,0,0] neg_hi:[1,0,0]
    v_cvt_pk_bf16_f32 v224, v232, v233
    v_cvt_pk_bf16_f32 v218, v234, v235
    v_pk_mul_f32 v[236:237], v[118:119], v[150:151]
    v_pk_mul_f32 v[238:239], v[134:135], v[150:151]
    v_pk_fma_f32 v[236:237], v[134:135], v[166:167], v[236:237]
    v_pk_fma_f32 v[238:239], v[118:119], v[166:167], v[238:239] neg_lo:[1,0,0] neg_hi:[1,0,0]
    v_cvt_pk_bf16_f32 v225, v236, v237
    v_cvt_pk_bf16_f32 v219, v238, v239
    v_pk_mul_f32 v[232:233], v[120:121], v[152:153]
    v_pk_mul_f32 v[234:235], v[136:137], v[152:153]
    v_pk_fma_f32 v[232:233], v[136:137], v[168:169], v[232:233]
    v_pk_fma_f32 v[234:235], v[120:121], v[168:169], v[234:235] neg_lo:[1,0,0] neg_hi:[1,0,0]
    v_cvt_pk_bf16_f32 v226, v232, v233
    v_cvt_pk_bf16_f32 v220, v234, v235
    v_pk_mul_f32 v[236:237], v[122:123], v[154:155]
    v_pk_mul_f32 v[238:239], v[138:139], v[154:155]
    v_pk_fma_f32 v[236:237], v[138:139], v[170:171], v[236:237]
    v_pk_fma_f32 v[238:239], v[122:123], v[170:171], v[238:239] neg_lo:[1,0,0] neg_hi:[1,0,0]
    v_cvt_pk_bf16_f32 v227, v236, v237
    v_cvt_pk_bf16_f32 v221, v238, v239
    v_mfma_f32_32x32x16_bf16 v[128:143], v[216:219], v[52:55], 0
    v_mfma_f32_32x32x16_bf16 v[112:127], v[216:219], v[64:67], 0
    v_mfma_f32_32x32x16_bf16 v[128:143], v[220:223], v[56:59], v[128:143]
    v_mfma_f32_32x32x16_bf16 v[112:127], v[220:223], v[68:71], v[112:127]
    v_mfma_f32_32x32x16_bf16 v[128:143], v[224:227], v[60:63], v[128:143]
    v_mfma_f32_32x32x16_bf16 v[112:127], v[224:227], v[72:75], v[112:127]
    s_mul_i32 s54, s60, 1152
    s_add_u32 s54, s54, 2818048
a_p3r:
    ds_read_b32 v14, v10 offset:36
    s_waitcnt lgkmcnt(0)
    v_readfirstlane_b32 s66, v14
    s_cmp_ge_u32 s66, 8
    s_cbranch_scc1 a_p3r_ok
    s_sleep 1
    s_sub_i32 s0, s0, 1
    s_cmp_lt_i32 s0, 0
    s_cbranch_scc0 a_p3r
a_p3r_ok:
    s_mov_b32 exec_lo, 0x00ffffff
    s_mov_b32 exec_hi, 0x00ffffff
    s_nop 1
    v_cvt_pk_bf16_f32 v128, v128, v129
    v_cvt_pk_bf16_f32 v129, v130, v131
    ds_write_b64 v5, v[128:129] offset:1152
    v_cvt_pk_bf16_f32 v132, v132, v133
    v_cvt_pk_bf16_f32 v133, v134, v135
    ds_write_b64 v5, v[132:133] offset:1168
    v_cvt_pk_bf16_f32 v136, v136, v137
    v_cvt_pk_bf16_f32 v137, v138, v139
    ds_write_b64 v5, v[136:137] offset:1184
    v_cvt_pk_bf16_f32 v112, v112, v113
    v_cvt_pk_bf16_f32 v113, v114, v115
    ds_write_b64 v5, v[112:113] offset:0
    v_cvt_pk_bf16_f32 v116, v116, v117
    v_cvt_pk_bf16_f32 v117, v118, v119
    ds_write_b64 v5, v[116:117] offset:16
    v_cvt_pk_bf16_f32 v120, v120, v121
    v_cvt_pk_bf16_f32 v121, v122, v123
    ds_write_b64 v5, v[120:121] offset:32
    s_mov_b64 exec, -1
    s_waitcnt lgkmcnt(0)
    ds_read_b128 v[16:19], v9 offset:0
    ds_read_b128 v[20:23], v9 offset:1024
    ds_read_b128 v[24:27], v9 offset:2048
    s_waitcnt lgkmcnt(2)
    buffer_store_dwordx4 v[16:19], v8, s[32:35], s54 offen sc1
    s_waitcnt lgkmcnt(1)
    buffer_store_dwordx4 v[20:23], v248, s[32:35], s54 offen sc1
    s_waitcnt lgkmcnt(0)
    s_mov_b64 exec, 0xffff
    buffer_store_dwordx4 v[24:27], v249, s[32:35], s54 offen sc1
    s_mov_b64 exec, -1
a_x3:
    s_waitcnt vmcnt(0)
    s_mov_b64 exec, 1
    ds_add_rtn_u32 v14, v10, v11 offset:120
    s_mov_b64 exec, -1
    s_lshr_b32 s54, s62, 2
    s_lshl_b32 s54, s54, 7
    s_and_b32 s66, s62, 3
    s_lshl_b32 s66, s66, 2
    s_add_u32 s54, s54, s66
    s_add_u32 s54, s54, 221184
    s_waitcnt lgkmcnt(0)
    v_readfirstlane_b32 s66, v14
    s_cmp_eq_u32 s66, 3
    s_cselect_b32 s101, 1, 0
    s_cmp_eq_u32 s101, 1
    s_cbranch_scc0 a_ar4
    s_mov_b64 exec, 1
    v_mov_b32 v12, s68
    v_mov_b32 v13, 0
    buffer_store_dword v12, v13, s[32:35], s54 offen sc1
    s_mov_b64 exec, -1
    s_mov_b64 exec, 1
    ds_add_u32 v10, v11 offset:120
    s_mov_b64 exec, -1
a_ar4:
a_pub4:
    ds_read_b32 v14, v10 offset:120
    s_waitcnt lgkmcnt(0)
    v_readfirstlane_b32 s66, v14
    s_cmp_ge_u32 s66, 5
    s_cbranch_scc1 a_pub4_ok
    s_sleep 1
    s_sub_i32 s0, s0, 1
    s_cmp_lt_i32 s0, 0
    s_cbranch_scc0 a_pub4
a_pub4_ok:
a_prog:
    ds_read_b32 v14, v10 offset:16
    s_waitcnt lgkmcnt(0)
    v_readfirstlane_b32 s66, v14
    s_cmp_ge_u32 s66, 4
    s_cbranch_scc1 a_prog_ok
    s_sleep 6
    s_sub_i32 s0, s0, 1
    s_cmp_lt_i32 s0, 0
    s_cbranch_scc0 a_prog
a_prog_ok:
    s_xor_b32 s48, s3, 2
    s_mul_i32 s63, s48, 23168
    s_add_u32 s63, s63, 0
    s_mul_i32 s64, s48, 41472
    s_add_u32 s64, s64, s57
    s_add_u32 m0, s63, 0
    s_nop 0
    buffer_load_dwordx4 v240, s[28:31], s64 offen offset:0 lds
    buffer_load_dwordx4 v241, s[28:31], s64 offen offset:1024 lds
    buffer_load_dwordx4 v242, s[28:31], s64 offen offset:2048 lds
    buffer_load_dwordx4 v243, s[28:31], s64 offen offset:3072 lds
    s_add_u32 m0, s63, 4096
    s_nop 0
    buffer_load_dwordx4 v244, s[28:31], s64 offen offset:0 lds
    s_add_u32 s64, s64, 165888
    s_add_u32 m0, s63, 5120
    s_nop 0
    buffer_load_dwordx4 v240, s[28:31], s64 offen offset:0 lds
    buffer_load_dwordx4 v241, s[28:31], s64 offen offset:1024 lds
    buffer_load_dwordx4 v242, s[28:31], s64 offen offset:2048 lds
    buffer_load_dwordx4 v243, s[28:31], s64 offen offset:3072 lds
    s_add_u32 m0, s63, 9216
    s_nop 0
    buffer_load_dwordx4 v244, s[28:31], s64 offen offset:0 lds
    s_add_u32 s64, s64, 165888
    s_add_u32 m0, s63, 10240
    s_nop 0
    buffer_load_dwordx4 v240, s[28:31], s64 offen offset:0 lds
    buffer_load_dwordx4 v241, s[28:31], s64 offen offset:1024 lds
    buffer_load_dwordx4 v242, s[28:31], s64 offen offset:2048 lds
    buffer_load_dwordx4 v243, s[28:31], s64 offen offset:3072 lds
    s_add_u32 m0, s63, 14336
    s_nop 0
    buffer_load_dwordx4 v244, s[28:31], s64 offen offset:0 lds
    s_add_u32 s64, s64, 165888
    s_add_u32 m0, s63, 15360
    s_nop 0
    buffer_load_dwordx4 v240, s[28:31], s64 offen offset:0 lds
    buffer_load_dwordx4 v241, s[28:31], s64 offen offset:1024 lds
    buffer_load_dwordx4 v242, s[28:31], s64 offen offset:2048 lds
    buffer_load_dwordx4 v243, s[28:31], s64 offen offset:3072 lds
    s_add_u32 m0, s63, 19456
    s_nop 0
    buffer_load_dwordx4 v244, s[28:31], s64 offen offset:0 lds
    s_add_u32 s64, s64, 165888
    s_mul_i32 s64, s48, 165888
    s_add_u32 s64, s64, s57
    s_add_u32 m0, s63, 20480
    s_nop 0
    buffer_load_dwordx4 v245, s[28:31], s64 offen offset:0 lds
    buffer_load_dwordx4 v246, s[28:31], s64 offen offset:1024 lds
    s_mov_b64 exec, 0xffffffff
    buffer_load_dwordx4 v247, s[28:31], s64 offen offset:2048 lds
    s_mov_b64 exec, -1
    s_waitcnt vmcnt(0)
    s_mov_b64 exec, 1
    ds_add_u32 v10, v11 offset:84
    s_mov_b64 exec, -1
    s_cmp_eq_u32 s3, 0
    s_cbranch_scc0 a_nn
    s_lshl_b32 s65, s58, 10
    s_add_u32 s65, s65, 221184
    s_mov_b64 exec, 0xff
    s_mov_b32 s67, 32768
a_f4:
    buffer_load_dwordx4 v[16:19], v254, s[32:35], s65 offen sc1
    s_waitcnt vmcnt(0)
    v_xor_b32 v16, s68, v16
    v_xor_b32 v17, s68, v17
    v_xor_b32 v18, s68, v18
    v_xor_b32 v19, s68, v19
    v_or3_b32 v16, v16, v17, v18
    v_or_b32 v16, v16, v19
    v_cmp_eq_u32 vcc, 0, v16
    s_sub_u32 s67, s67, 1
    s_cbranch_scc1 a_f4_ok
    s_nop 1
    s_cmp_eq_u64 vcc, exec
    s_cbranch_scc1 a_f4_ok
    s_sleep 3
    s_branch a_f4
a_f4_ok:
    s_mov_b64 exec, 1
    ds_add_u32 v10, v11 offset:88
    s_mov_b64 exec, -1
    s_cmp_eq_u32 s2, 0
    s_cbranch_scc0 a_nn
    s_mov_b32 s65, 221184
    s_mov_b32 s67, 32768
a_f4a:
    buffer_load_dwordx4 v[16:19], v254, s[32:35], s65 offen sc1
    s_waitcnt vmcnt(0)
    v_xor_b32 v16, s68, v16
    v_xor_b32 v17, s68, v17
    v_xor_b32 v18, s68, v18
    v_xor_b32 v19, s68, v19
    v_or3_b32 v16, v16, v17, v18
    v_or_b32 v16, v16, v19
    v_cmp_eq_u32 vcc, 0, v16
    s_sub_u32 s67, s67, 1
    s_cbranch_scc1 a_f4a_ok
    s_nop 1
    s_cmp_eq_u64 vcc, exec
    s_cbranch_scc1 a_f4a_ok
    s_sleep 8
    s_branch a_f4a
a_f4a_ok:
    s_mov_b32 s54, 172032
    s_mov_b64 exec, 1
    v_mov_b32 v12, s68
    v_mov_b32 v13, 0
    buffer_store_dword v12, v13, s[32:35], s54 offen sc1
    s_mov_b64 exec, -1
a_nn:
    s_endpgm
k_end:
    s_endpgm
.section .rodata,"a"
.p2align 6
.amdhsa_kernel gated_mix__spectral_gfnet__grouped_kv_mqa__prompt_kernel
  .amdhsa_next_free_vgpr 256
  .amdhsa_next_free_sgpr 102
  .amdhsa_accum_offset 256
  .amdhsa_group_segment_fixed_size 0
  .amdhsa_kernarg_size 96
  .amdhsa_user_sgpr_count 2
  .amdhsa_user_sgpr_kernarg_segment_ptr 1
  .amdhsa_system_sgpr_workgroup_id_x 1
.end_amdhsa_kernel
.p2align 8
.type tbl_blob,@object
tbl_blob:
.long 0x3f803f80,0x3f803f80,0x3f803f80,0x3f803f80,0x3f773f80,0x3f353f5e,0xbf35bf00,0xbf77bf5e,0x3f5e3f80,0x248d3f00,0xa554bf00,0x3f5e3f00,0x3f353f80,0xbf35248d,0x3f353f80,0xbf3526ac
.long 0x3f003f80,0xbf80bf00,0xbf80bf00,0x3f00bf00,0x3e853f80,0xbf35bf5e,0x3f35bf00,0xbe853f5e,0x248d3f80,0xa554bf80,0x261f3f80,0xa731bf80,0xbe853f80,0x3f35bf5e,0xbf35bf00,0x3e853f5e
.long 0xbf003f80,0x3f80bf00,0x3f80bf00,0xbf00bf00,0xbf353f80,0x3f35a554,0xbf353f80,0x3f352677,0xbf5e3f80,0x26ac3f00,0x2677bf00,0xbf5e3f00,0xbf773f80,0xbf353f5e,0x3f35bf00,0x3f77bf5e
.long 0xbf803f80,0xbf803f80,0xbf803f80,0xbf803f80,0xbf773f80,0xbf353f5e,0x3f35bf00,0x3f77bf5e,0xbf5e3f80,0xa5f73f00,0xa60dbf00,0xbf5e3f00,0xbf353f80,0x3f3526ac,0xbf353f80,0x3f35a58e
.long 0xbf003f80,0x3f80bf00,0x3f80bf00,0xbf00bf00,0xbe853f80,0x3f35bf5e,0xbf35bf00,0x3e853f5e,0xa5543f80,0x261fbf80,0xa7773f80,0x2804bf80,0x3e853f80,0xbf35bf5e,0x3f35bf00,0xbe853f5e
.long 0x3f003f80,0xbf80bf00,0xbf80bf00,0x3f00bf00,0x3f353f80,0xbf35a5f7,0x3f353f80,0xbf352766,0x3f5e3f80,0x269f3f00,0x258dbf00,0x3f5e3f00,0x3f773f80,0x3f353f5e,0xbf35bf00,0xbf77bf5e
.long 0x0,0x0,0x0,0x0,0x0,0x0,0x0,0x0,0x0,0x0,0x0,0x0,0x0,0x0,0x0,0x0
.long 0x0,0x0,0x0,0x0,0x0,0x0,0x0,0x0,0x0,0x0,0x0,0x0,0x0,0x0,0x0,0x0
.long 0x3f803f80,0x3f803f80,0x3f803f80,0x3f803f80,0x3e853f00,0xbe85248d,0xbf77bf80,0xbf35bf5e,0xbf5ebf00,0xbf5ebf80,0x3f5e3f80,0x26ac3f00,0xbf35bf80,0x3f35a554,0xbf35bf80,0x3f35a5f7
.long 0x3f00bf00,0x3f003f80,0x3f003f80,0xbf80bf00,0x3f773f00,0xbf7726ac,0xbe85bf80,0x3f353f5e,0x26ac3f80,0xa5f7bf80,0xa68d3f80,0xa7e1bf80,0xbf773f00,0x3f77a5f7,0x3e85bf80,0xbf353f5e
.long 0xbf00bf00,0xbf003f80,0xbf003f80,0x3f80bf00,0x3f35bf80,0xbf35261f,0x3f35bf80,0xbf35a60d,0x3f5ebf00,0x3f5ebf80,0xbf5e3f80,0xa58e3f00,0xbe853f00,0x3e85269f,0x3f77bf80,0x3f35bf5e
.long 0xbf803f80,0xbf803f80,0xbf803f80,0xbf803f80,0xbe853f00,0x3e852739,0x3f77bf80,0x3f35bf5e,0x3f5ebf00,0x3f5ebf80,0xbf5e3f80,0xa8473f00,0x3f35bf80,0xbf352677,0x3f35bf80,0xbf352766
.long 0xbf00bf00,0xbf003f80,0xbf003f80,0x3f80bf00,0xbf773f00,0x3f77274b,0x3e85bf80,0xbf353f5e,0x26773f80,0xa60dbf80,0xa7963f80,0x268dbf80,0x3f773f00,0xbf77a754,0xbe85bf80,0x3f353f5e
.long 0x3f00bf00,0x3f003f80,0x3f003f80,0xbf80bf00,0xbf35bf80,0x3f35a60d,0xbf35bf80,0x3f35a7d4,0xbf5ebf00,0xbf5ebf80,0x3f5e3f80,0xa85d3f00,0x3e853f00,0xbe85a765,0xbf77bf80,0xbf35bf5e
.long 0x0,0x0,0x0,0x0,0x0,0x0,0x0,0x0,0x0,0x0,0x0,0x0,0x0,0x0,0x0,0x0
.long 0x0,0x0,0x0,0x0,0x0,0x0,0x0,0x0,0x0,0x0,0x0,0x0,0x0,0x0,0x0,0x0
.long 0x3f803f80,0x3f803f80,0x0,0x0,0xbe85bf00,0x3e85a554,0x3e850000,0x3f353f00,0xbf5ebf00,0xbf5ebf80,0x3f000000,0x3f803f5e,0x3f353f80,0xbf35261f,0x3f350000,0x3f353f80
.long 0x3f00bf00,0x3f003f80,0x3f5e0000,0x250d3f5e,0xbf77bf00,0x3f772677,0x3f770000,0xbf353f00,0xa79a3f80,0xa754bf80,0x3f800000,0xbf80250d,0x3f77bf00,0xbf77a60d,0x3f770000,0xbf35bf00
.long 0xbf00bf00,0xbf003f80,0x3f5e0000,0xa58dbf5e,0xbf353f80,0x3f35a777,0x3f350000,0x3f35bf80,0x3f5ebf00,0x3f5ebf80,0x3f000000,0x3f80bf5e,0x3e85bf00,0xbe85258d,0x3e850000,0x3f35bf00
.long 0xbf803f80,0xbf803f80,0x250d0000,0x25d4a58d,0x3e85bf00,0xbe85a796,0xbe850000,0xbf353f00,0x3f5ebf00,0x3f5ebf80,0xbf000000,0xbf803f5e,0xbf353f80,0x3f35268d,0xbf350000,0xbf353f80
.long 0xbf00bf00,0xbf003f80,0xbf5e0000,0xa60d3f5e,0x3f77bf00,0xbf77a7b1,0xbf770000,0x3f353f00,0xa7b13f80,0x281fbf80,0xbf800000,0x3f8025d4,0xbf77bf00,0x3f77281f,0xbf770000,0x3f35bf00
.long 0x3f00bf00,0x3f003f80,0xbf5e0000,0x272cbf5e,0x3f353f80,0xbf3526d4,0xbf350000,0xbf35bf80,0xbf5ebf00,0xbf5ebf80,0xbf000000,0xbf80bf5e,0xbe85bf00,0x3e852896,0xbe850000,0xbf35bf00
.long 0x0,0x0,0x0,0x0,0x0,0x0,0x0,0x0,0x0,0x0,0x0,0x0,0x0,0x0,0x0,0x0
.long 0x0,0x0,0x0,0x0,0x0,0x0,0x0,0x0,0x0,0x0,0x0,0x0,0x0,0x0,0x0,0x0
.long 0x3f803f80,0x3f803f80,0x0,0x0,0x3f353f00,0x3f773f5e,0x3f773f5e,0x3f773f80,0xa5f7bf00,0x3f5e3f00,0x3f003f5e,0xbf00250d,0xbf35bf80,0x3f35a731,0xbf35250d,0xbf35bf80
.long 0xbf80bf00,0x3f00bf00,0xbf5ebf5e,0x3f5ea58d,0xbf353f00,0x3e85bf5e,0x3e85bf5e,0x3e853f80,0xa60d3f80,0xa765bf80,0x3f80a58d,0xbf8025d4,0x3f353f00,0xbe85bf5e,0x3e853f5e,0x3e85bf80
.long 0x3f80bf00,0xbf00bf00,0xbf5e3f5e,0x3f5ea60d,0x3f35bf80,0xbf352804,0xbf3525d4,0xbf353f80,0x2766bf00,0xbf5e3f00,0x3f00bf5e,0xbf00272c,0xbf353f00,0xbf773f5e,0x3f77bf5e,0x3f77bf80
.long 0xbf803f80,0xbf803f80,0x272ca60d,0x2677a654,0xbf353f00,0xbf773f5e,0xbf773f5e,0xbf773f80,0xa7d4bf00,0xbf5e3f00,0xbf003f5e,0x3f002677,0x3f35bf80,0xbf35a85d,0x3f35272c,0x3f35bf80
.long 0x3f80bf00,0xbf00bf00,0x3f5ebf5e,0xbf5ea68d,0x3f353f00,0xbe85bf5e,0xbe85bf5e,0xbe853f80,0x26d43f80,0x2896bf80,0xbf80a654,0x3f80269f,0xbf353f00,0x3e85bf5e,0xbe853f5e,0xbe85bf80
.long 0xbf80bf00,0x3f00bf00,0x3f5e3f5e,0xbf5ea7ac,0xbf35bf80,0x3f35289a,0x3f352677,0x3f353f80,0x2754bf00,0x3f5e3f00,0xbf00bf5e,0x3f00a71f,0x3f353f00,0x3f773f5e,0xbf77bf5e,0xbf77bf80
.long 0x0,0x0,0x0,0x0,0x0,0x0,0x0,0x0,0x0,0x0,0x0,0x0,0x0,0x0,0x0,0x0
.long 0x0,0x0,0x0,0x0,0x0,0x0,0x0,0x0,0x0,0x0,0x0,0x0,0x0,0x0,0x0,0x0
.long 0x0,0x0,0x0,0x0,0x3f353f5e,0x3e853f00,0xbf77bf5e,0xbf77bf80,0xbf80bf5e,0xbf00bf5e,0x3f003f5e,0xbf0025d4,0x3f35a58d,0x3f353f80,0x3f35a60d,0x3f353f80
.long 0x25d43f5e,0xbf5ebf5e,0xbf5ebf5e,0x3f5ea654,0xbf35bf5e,0x3f773f00,0xbe853f5e,0xbe85bf80,0x3f80a60d,0xbf80272c,0x3f80a68d,0xbf80269f,0xbf353f5e,0x3f77bf00,0xbe85bf5e,0xbe853f80
.long 0xa654bf5e,0xbf5e3f5e,0xbf5e3f5e,0x3f5ea6d4,0x3f35a654,0x3f35bf80,0x3f35a6d4,0x3f35bf80,0xbf803f5e,0xbf003f5e,0x3f00bf5e,0xbf00a6f7,0x3f35bf5e,0x3e85bf00,0xbf773f5e,0xbf773f80
.long 0x269fa68d,0x27b1a7ac,0xa81aa70d,0x27d4a71f,0xbf353f5e,0xbe853f00,0x3f77bf5e,0x3f77bf80,0x3f80bf5e,0x3f00bf5e,0xbf003f5e,0x3f00a68d,0xbf35a7ac,0xbf353f80,0xbf35a82c,0xbf353f80
.long 0xa6d43f5e,0x3f5ebf5e,0x3f5ebf5e,0xbf5ea754,0x3f35bf5e,0xbf773f00,0x3e853f5e,0x3e85bf80,0xbf80a6d4,0x3f80a6f7,0xbf80a754,0x3f8027f7,0x3f353f5e,0xbf77bf00,0x3e85bf5e,0x3e853f80
.long 0xa6f7bf5e,0x3f5e3f5e,0x3f5e3f5e,0xbf5e2777,0xbf35a6f7,0xbf35bf80,0xbf35a777,0xbf35bf80,0x3f803f5e,0x3f003f5e,0xbf00bf5e,0x3f00260d,0xbf35bf5e,0xbe85bf00,0x3f773f5e,0x3f773f80
.long 0x0,0x0,0x0,0x0,0x0,0x0,0x0,0x0,0x0,0x0,0x0,0x0,0x0,0x0,0x0,0x0
.long 0x0,0x0,0x0,0x0,0x0,0x0,0x0,0x0,0x0,0x0,0x0,0x0,0x0,0x0,0x0,0x0
.long 0x0,0x0,0x0,0x0,0xbe85250d,0xbf35bf00,0xbf35bf5e,0xbe85bf00,0x3f00a58d,0x3f803f5e,0xbf80bf5e,0xbf00bf5e,0xbf3525d4,0xbf35bf80,0xbf35272c,0xbf35bf80
.long 0x3f5ea60d,0x272c3f5e,0x26773f5e,0xbf5ebf5e,0xbf77272c,0x3f35bf00,0x3f353f5e,0xbf77bf00,0x3f80a654,0xbf802677,0x3f80a7ac,0xbf8027b1,0xbf772677,0x3f353f00,0x3f35bf5e,0xbf773f00
.long 0x3f5ea68d,0xa7acbf5e,0xa6f7bf5e,0xbf5e3f5e,0xbf35269f,0xbf353f80,0xbf35a6f7,0xbf353f80,0x3f00a7ac,0x3f80bf5e,0xbf803f5e,0xbf003f5e,0xbe85a71f,0xbf353f00,0xbf353f5e,0xbe853f00
.long 0xa70da6d4,0x2861a6f7,0xa68da82c,0x27e5a831,0x3e8527b9,0x3f35bf00,0x3f35bf5e,0x3e85bf00,0xbf00a6f7,0xbf803f5e,0x3f80bf5e,0x3f00bf5e,0x3f35a6f7,0x3f35bf80,0x3f35a60e,0x3f35bf80
.long 0xbf5ea70d,0xa82c3f5e,0xa7773f5e,0x3f5ebf5e,0x3f7727cb,0xbf35bf00,0xbf353f5e,0x3f77bf00,0xbf80a71f,0x3f80a68d,0xbf802777,0x3f802884,0x3f7727d4,0xbf353f00,0xbf35bf5e,0x3f773f00
.long 0xbf5ea82c,0xa60ebf5e,0xa7e6bf5e,0x3f5e3f5e,0x3f35a68d,0x3f353f80,0x3f35a7e6,0x3f353f80,0xbf00279f,0xbf80bf5e,0x3f803f5e,0x3f003f5e,0x3e8527e5,0x3f353f00,0x3f353f5e,0x3e853f00
.long 0x0,0x0,0x0,0x0,0x0,0x0,0x0,0x0,0x0,0x0,0x0,0x0,0x0,0x0,0x0,0x0
.long 0x0,0x0,0x0,0x0,0x0,0x0,0x0,0x0,0x0,0x0,0x0,0x0,0x0,0x0,0x0,0x0
.long 0x80008000,0x80008000,0x80008000,0x80008000,0xbe858000,0xbf35bf00,0xbf35bf5e,0xbe85bf00,0xbf008000,0xbf80bf5e,0x3f803f5e,0x3f003f5e,0xbf358000,0xbf35bf80,0xbf35258d,0xbf35bf80
.long 0xbf5e8000,0xa50dbf5e,0xa5d4bf5e,0x3f5e3f5e,0xbf778000,0x3f35bf00,0x3f353f5e,0xbf77bf00,0xbf808000,0x3f80a50d,0xbf80260d,0x3f80a72c,0xbf778000,0x3f353f00,0x3f35bf5e,0xbf773f00
.long 0xbf5e8000,0x258d3f5e,0x26543f5e,0x3f5ebf5e,0xbf358000,0xbf353f80,0xbf352654,0xbf353f80,0xbf008000,0xbf803f5e,0x3f80bf5e,0x3f00bf5e,0xbe858000,0xbf353f00,0xbf353f5e,0xbe853f00
.long 0xa50d8000,0xa5d4258d,0xa69f268d,0xa7b127ac,0x3e858000,0x3f35bf00,0x3f35bf5e,0x3e85bf00,0x3f008000,0x3f80bf5e,0xbf803f5e,0xbf003f5e,0x3f358000,0x3f35bf80,0x3f3527ac,0x3f35bf80
.long 0x3f5e8000,0x260dbf5e,0x26d4bf5e,0xbf5e3f5e,0x3f778000,0xbf35bf00,0xbf353f5e,0x3f77bf00,0x3f808000,0xbf80a5d4,0x3f8026d4,0xbf8026f7,0x3f778000,0xbf353f00,0xbf35bf5e,0x3f773f00
.long 0x3f5e8000,0xa72c3f5e,0x26f73f5e,0xbf5ebf5e,0x3f358000,0x3f353f80,0x3f3526f7,0x3f353f80,0x3f008000,0x3f803f5e,0xbf80bf5e,0xbf00bf5e,0x3e858000,0x3f353f00,0x3f353f5e,0x3e853f00
.long 0x0,0x0,0x0,0x0,0x0,0x0,0x0,0x0,0x0,0x0,0x0,0x0,0x0,0x0,0x0,0x0
.long 0x0,0x0,0x0,0x0,0x0,0x0,0x0,0x0,0x0,0x0,0x0,0x0,0x0,0x0,0x0,0x0
.long 0x80008000,0x80008000,0x80008000,0x80008000,0xbf77bf5e,0xbf77bf80,0x3e85a50d,0x3f353f00,0xbf00bf5e,0x3f00a50d,0xbf00258d,0xbf80bf5e,0x3f35a50d,0x3f353f80,0x3f35a5d4,0x3f353f80
.long 0x3f5e3f5e,0xbf5e258d,0xbf5e260d,0xa72cbf5e,0xbe853f5e,0xbe85bf80,0x3f77a72c,0xbf353f00,0xbf80258d,0x3f80a5d4,0xbf802654,0x3f80a677,0xbe85bf5e,0xbe853f80,0x3f77a677,0xbf35bf00
.long 0x3f5ebf5e,0xbf5e260d,0xbf5e268d,0x27ac3f5e,0x3f35a5d4,0x3f35bf80,0x3f35a69f,0x3f35bf80,0xbf003f5e,0x3f00a72c,0xbf0027ac,0xbf803f5e,0xbf773f5e,0xbf773f80,0x3e85271f,0x3f35bf00
.long 0xa72c260d,0xa6772654,0x270d26d4,0xa86126f7,0x3f77bf5e,0x3f77bf80,0xbe85a7b9,0xbf353f00,0x3f00bf5e,0xbf00a677,0x3f0026f7,0x3f80bf5e,0xbf35a72c,0xbf353f80,0xbf3526f7,0xbf353f80
.long 0xbf5e3f5e,0x3f5e268d,0x3f5e270d,0x282cbf5e,0x3e853f5e,0x3e85bf80,0xbf77a7cb,0x3f353f00,0x3f802654,0xbf80a69f,0x3f80271f,0xbf80268d,0x3e85bf5e,0x3e853f80,0xbf77a7d4,0x3f35bf00
.long 0xbf5ebf5e,0x3f5e27ac,0x3f5e282c,0x260e3f5e,0xbf35a677,0xbf35bf80,0xbf35268d,0xbf35bf80,0x3f003f5e,0xbf00271f,0x3f00a79f,0x3f803f5e,0x3f773f5e,0x3f773f80,0xbe85a7e5,0xbf35bf00
.long 0x0,0x0,0x0,0x0,0x0,0x0,0x0,0x0,0x0,0x0,0x0,0x0,0x0,0x0,0x0,0x0
.long 0x0,0x0,0x0,0x0,0x0,0x0,0x0,0x0,0x0,0x0,0x0,0x0,0x0,0x0,0x0,0x0
.long 0x80008000,0x80008000,0x3f803f80,0x3f803f80,0x3f773f5e,0x3f773f80,0x3f773f80,0x3f353f5e,0xbf00bf5e,0x3f00a5d4,0x3f5e3f80,0x248d3f00,0xbf35260d,0xbf35bf80,0x3f353f80,0xbf35248d
.long 0x3f5e3f5e,0xbf5e2654,0x3f003f80,0xbf80bf00,0x3e85bf5e,0x3e853f80,0x3e853f80,0xbf35bf5e,0xbf80268d,0x3f80a69f,0x248d3f80,0xa554bf80,0x3e853f5e,0x3e85bf80,0xbe853f80,0x3f35bf5e
.long 0x3f5ebf5e,0xbf5e26d4,0xbf003f80,0x3f80bf00,0xbf3526d4,0xbf353f80,0xbf353f80,0x3f35a554,0xbf003f5e,0x3f0026f7,0xbf5e3f80,0x26ac3f00,0x3f77bf5e,0x3f77bf80,0xbf773f80,0xbf353f5e
.long 0x281a270d,0xa7d4271f,0xbf803f80,0xbf803f80,0xbf773f5e,0xbf773f80,0xbf773f80,0xbf353f5e,0x3f00bf5e,0xbf00268d,0xbf5e3f80,0xa5f73f00,0x3f35282c,0x3f35bf80,0xbf353f80,0x3f3526ac
.long 0xbf5e3f5e,0x3f5e2754,0xbf003f80,0x3f80bf00,0xbe85bf5e,0xbe853f80,0xbe853f80,0x3f35bf5e,0x3f802754,0xbf80a7f7,0xa5543f80,0x261fbf80,0xbe853f5e,0xbe85bf80,0x3e853f80,0xbf35bf5e
.long 0xbf5ebf5e,0x3f5ea777,0x3f003f80,0xbf80bf00,0x3f352777,0x3f353f80,0x3f353f80,0xbf35a5f7,0x3f003f5e,0xbf00a60d,0x3f5e3f80,0x269f3f00,0xbf77bf5e,0xbf77bf80,0x3f773f80,0x3f353f5e
.long 0x0,0x0,0x0,0x0,0x0,0x0,0x0,0x0,0x0,0x0,0x0,0x0,0x0,0x0,0x0,0x0
.long 0x0,0x0,0x0,0x0,0x0,0x0,0x0,0x0,0x0,0x0,0x0,0x0,0x0,0x0,0x0,0x0
.long 0x80008000,0x80008000,0x3f803f80,0x3f803f80,0x3f353f5e,0x3e853f00,0x3e853f00,0xbe85248d,0x3f803f5e,0x3f003f5e,0xbf5ebf00,0xbf5ebf80,0x3f35a72c,0x3f353f80,0xbf35bf80,0x3f35a554
.long 0xa677bf5e,0x3f5e3f5e,0x3f00bf00,0x3f003f80,0xbf35bf5e,0x3f773f00,0x3f773f00,0xbf7726ac,0xbf8027ac,0x3f80a7b1,0x26ac3f80,0xa5f7bf80,0xbf353f5e,0x3f77bf00,0xbf773f00,0x3f77a5f7
.long 0x26f73f5e,0x3f5ebf5e,0xbf00bf00,0xbf003f80,0x3f3526f7,0x3f35bf80,0x3f35bf80,0xbf35261f,0x3f80bf5e,0x3f00bf5e,0x3f5ebf00,0x3f5ebf80,0x3f35bf5e,0x3e85bf00,0xbe853f00,0x3e85269f
.long 0x268d282c,0xa7e52831,0xbf803f80,0xbf803f80,0xbf353f5e,0xbe853f00,0xbe853f00,0x3e852739,0xbf803f5e,0xbf003f5e,0x3f5ebf00,0x3f5ebf80,0xbf35260e,0xbf353f80,0x3f35bf80,0xbf352677
.long 0x2777bf5e,0xbf5e3f5e,0xbf00bf00,0xbf003f80,0x3f35bf5e,0xbf773f00,0xbf773f00,0x3f77274b,0x3f80a777,0xbf80a884,0x26773f80,0xa60dbf80,0x3f353f5e,0xbf77bf00,0x3f773f00,0xbf77a754
.long 0x27e63f5e,0xbf5ebf5e,0x3f00bf00,0x3f003f80,0xbf3527e6,0xbf35bf80,0xbf35bf80,0x3f35a60d,0xbf80bf5e,0xbf00bf5e,0xbf5ebf00,0xbf5ebf80,0xbf35bf5e,0xbe85bf00,0x3e853f00,0xbe85a765
.long 0x0,0x0,0x0,0x0,0x0,0x0,0x0,0x0,0x0,0x0,0x0,0x0,0x0,0x0,0x0,0x0
.long 0x0,0x0,0x0,0x0,0x0,0x0,0x0,0x0,0x0,0x0,0x0,0x0,0x0,0x0,0x0,0x0
.long 0x3f803f80,0x3f803f80,0x3f803f80,0x3f803f80,0xbf35bf00,0xbf77bf5e,0xbe85bf00,0x3e85a554,0xa554bf00,0x3f5e3f00,0xbf5ebf00,0xbf5ebf80,0x3f353f80,0xbf3526ac,0x3f353f80,0xbf35261f
.long 0xbf80bf00,0x3f00bf00,0x3f00bf00,0x3f003f80,0x3f35bf00,0xbe853f5e,0xbf77bf00,0x3f772677,0x261f3f80,0xa731bf80,0xa79a3f80,0xa754bf80,0xbf35bf00,0x3e853f5e,0x3f77bf00,0xbf77a60d
.long 0x3f80bf00,0xbf00bf00,0xbf00bf00,0xbf003f80,0xbf353f80,0x3f352677,0xbf353f80,0x3f35a777,0x2677bf00,0xbf5e3f00,0x3f5ebf00,0x3f5ebf80,0x3f35bf00,0x3f77bf5e,0x3e85bf00,0xbe85258d
.long 0xbf803f80,0xbf803f80,0xbf803f80,0xbf803f80,0x3f35bf00,0x3f77bf5e,0x3e85bf00,0xbe85a796,0xa60dbf00,0xbf5e3f00,0x3f5ebf00,0x3f5ebf80,0xbf353f80,0x3f35a58e,0xbf353f80,0x3f35268d
.long 0x3f80bf00,0xbf00bf00,0xbf00bf00,0xbf003f80,0xbf35bf00,0x3e853f5e,0x3f77bf00,0xbf77a7b1,0xa7773f80,0x2804bf80,0xa7b13f80,0x281fbf80,0x3f35bf00,0xbe853f5e,0xbf77bf00,0x3f77281f
.long 0xbf80bf00,0x3f00bf00,0x3f00bf00,0x3f003f80,0x3f353f80,0xbf352766,0x3f353f80,0xbf3526d4,0x258dbf00,0x3f5e3f00,0xbf5ebf00,0xbf5ebf80,0xbf35bf00,0xbf77bf5e,0xbe85bf00,0x3e852896
.long 0x0,0x0,0x0,0x0,0x0,0x0,0x0,0x0,0x0,0x0,0x0,0x0,0x0,0x0,0x0,0x0
.long 0x0,0x0,0x0,0x0,0x0,0x0,0x0,0x0,0x0,0x0,0x0,0x0,0x0,0x0,0x0,0x0
.long 0x3f803f80,0x3f803f80,0x3f803f80,0x3f803f80,0xbf77bf80,0xbf35bf5e,0x3f353f00,0x3f773f5e,0x3f5e3f80,0x26ac3f00,0xa5f7bf00,0x3f5e3f00,0xbf35bf80,0x3f35a5f7,0xbf35bf80,0x3f35a731
.long 0x3f003f80,0xbf80bf00,0xbf80bf00,0x3f00bf00,0xbe85bf80,0x3f353f5e,0xbf353f00,0x3e85bf5e,0xa68d3f80,0xa7e1bf80,0xa60d3f80,0xa765bf80,0x3e85bf80,0xbf353f5e,0x3f353f00,0xbe85bf5e
.long 0xbf003f80,0x3f80bf00,0x3f80bf00,0xbf00bf00,0x3f35bf80,0xbf35a60d,0x3f35bf80,0xbf352804,0xbf5e3f80,0xa58e3f00,0x2766bf00,0xbf5e3f00,0x3f77bf80,0x3f35bf5e,0xbf353f00,0xbf773f5e
.long 0xbf803f80,0xbf803f80,0xbf803f80,0xbf803f80,0x3f77bf80,0x3f35bf5e,0xbf353f00,0xbf773f5e,0xbf5e3f80,0xa8473f00,0xa7d4bf00,0xbf5e3f00,0x3f35bf80,0xbf352766,0x3f35bf80,0xbf35a85d
.long 0xbf003f80,0x3f80bf00,0x3f80bf00,0xbf00bf00,0x3e85bf80,0xbf353f5e,0x3f353f00,0xbe85bf5e,0xa7963f80,0x268dbf80,0x26d43f80,0x2896bf80,0xbe85bf80,0x3f353f5e,0xbf353f00,0x3e85bf5e
.long 0x3f003f80,0xbf80bf00,0xbf80bf00,0x3f00bf00,0xbf35bf80,0x3f35a7d4,0xbf35bf80,0x3f35289a,0x3f5e3f80,0xa85d3f00,0x2754bf00,0x3f5e3f00,0xbf77bf80,0xbf35bf5e,0x3f353f00,0x3f773f5e
.long 0x0,0x0,0x0,0x0,0x0,0x0,0x0,0x0,0x0,0x0,0x0,0x0,0x0,0x0,0x0,0x0
.long 0x0,0x0,0x0,0x0,0x0,0x0,0x0,0x0,0x0,0x0,0x0,0x0,0x0,0x0,0x0,0x0
.long 0x3f800000,0x3f800000,0x3f800000,0x3f800000,0x3f800000,0x3f7ffc1a,0x3f7ff067,0x3f7fdce9,0x3f800000,0x3f7ff067,0x3f7fc1a0,0x3f7f73af,0x3f800000,0x3f7fdce9,0x3f7f73af,0x3f7ec46d
.long 0x3f800000,0x3f7fc1a0,0x3f7f069e,0x3f7dcf55,0x3f800000,0x3f7f9e8c,0x3f7e7a7a,0x3f7c94a8,0x3f800000,0x3f7f73af,0x3f7dcf55,0x3f7b14be,0x3f800000,0x3f7f4109,0x3f7d0543,0x3f795000
.long 0x3f800000,0x3f7f069e,0x3f7c1c5c,0x3f7746ea,0x3f800000,0x3f7ec46d,0x3f7b14be,0x3f74fa0b,0x3f800000,0x3f7e7a7a,0x3f79ee89,0x3f726a03,0x3f800000,0x3f7e28c6,0x3f78a9e0,0x3f6f9788
.long 0x3f800000,0x3f7dcf55,0x3f7746ea,0x3f6c835e,0x3f800000,0x3f7d6e28,0x3f75c5d4,0x3f692e5f,0x3f800000,0x3f7d0543,0x3f7426cb,0x3f659974,0x3f800000,0x3f7c94a8,0x3f726a03,0x3f61c598
.long 0x3f800000,0x3f7c1c5c,0x3f708fb2,0x3f5db3d7,0x3f800000,0x3f7b9c62,0x3f6e9811,0x3f596550,0x3f800000,0x3f7b14be,0x3f6c835e,0x3f54db31,0x3f800000,0x3f7a8575,0x3f6a51da,0x3f5016b8
.long 0x3f800000,0x3f79ee89,0x3f6803ca,0x3f4b1934,0x3f800000,0x3f795000,0x3f659974,0x3f45e403,0x3f800000,0x3f78a9e0,0x3f631324,0x3f407893,0x3f800000,0x3f77fc2c,0x3f60712a,0x3f3ad85f
.long 0x0,0x0,0x0,0x0,0x0,0x0,0x0,0x0,0x0,0x0,0x0,0x0,0x0,0x0,0x0,0x0
.long 0x0,0x0,0x0,0x0,0x0,0x0,0x0,0x0,0x0,0x0,0x0,0x0,0x0,0x0,0x0,0x0
.long 0x3f800000,0x3f800000,0x3f800000,0x3f800000,0x3f7fc1a0,0x3f7f9e8c,0x3f7f73af,0x3f7f4109,0x3f7f069e,0x3f7e7a7a,0x3f7dcf55,0x3f7d0543,0x3f7dcf55,0x3f7c94a8,0x3f7b14be,0x3f795000
.long 0x3f7c1c5c,0x3f79ee89,0x3f7746ea,0x3f7426cb,0x3f79ee89,0x3f768a20,0x3f726a03,0x3f6d9156,0x3f7746ea,0x3f726a03,0x3f6c835e,0x3f659974,0x3f7426cb,0x3f6d9156,0x3f659974,0x3f5c4b07
.long 0x3f708fb2,0x3f6803ca,0x3f5db3d7,0x3f51b3f3,0x3f6c835e,0x3f61c598,0x3f54db31,0x3f45e403,0x3f6803ca,0x3f5adb81,0x3f4b1934,0x3f38ecd8,0x3f631324,0x3f534aca,0x3f407893,0x3f2ae1c9
.long 0x3f5db3d7,0x3f4b1934,0x3f3504f3,0x3f1bd7ca,0x3f57e880,0x3f424cfe,0x3f28cae3,0x3f0be54a,0x3f51b3f3,0x3f38ecd8,0x3f1bd7ca,0x3ef64429,0x3f4b1934,0x3f2effe8,0x3f0e39da,0x3ed34e56
.long 0x3f441b7d,0x3f248dbb,0x3f000000,0x3eaf1d44,0x3f3cbe35,0x3f199e45,0x3ee273aa,0x3e89e6f1,0x3f3504f3,0x3f0e39da,0x3ec3ef15,0x3e47c5c2,0x3f2cf37b,0x3f026926,0x3ea493b7,0x3df52731
.long 0x3f248dbb,0x3eec6a50,0x3e8483ee,0x3d32aa3e,0x3f1bd7ca,0x3ed34e56,0x3e47c5c2,0xbd060472,0x3f12d5e8,0x3eb9917b,0x3e05a8a8,0xbddef599,0x3f098c78,0x3e9f4757,0x3d85f213,0xbe3cce2b
.long 0x0,0x0,0x0,0x0,0x0,0x0,0x0,0x0,0x0,0x0,0x0,0x0,0x0,0x0,0x0,0x0
.long 0x0,0x0,0x0,0x0,0x0,0x0,0x0,0x0,0x0,0x0,0x0,0x0,0x0,0x0,0x0,0x0
.long 0x3f800000,0x3f800000,0x3f800000,0x3f800000,0x3f7f069e,0x3f7ec46d,0x3f7e7a7a,0x3f7e28c6,0x3f7c1c5c,0x3f7b14be,0x3f79ee89,0x3f78a9e0,0x3f7746ea,0x3f74fa0b,0x3f726a03,0x3f6f9788
.long 0x3f708fb2,0x3f6c835e,0x3f6803ca,0x3f631324,0x3f6803ca,0x3f61c598,0x3f5adb81,0x3f534aca,0x3f5db3d7,0x3f54db31,0x3f4b1934,0x3f407893,0x3f51b3f3,0x3f45e403,0x3f38ecd8,0x3f2ae1c9
.long 0x3f441b7d,0x3f3504f3,0x3f248dbb,0x3f12d5e8,0x3f3504f3,0x3f226799,0x3f0e39da,0x3ef15aea,0x3f248dbb,0x3f0e39da,0x3eec6a50,0x3eb9917b,0x3f12d5e8,0x3ef15aea,0x3eb9917b,0x3e7e39c4
.long 0x3f000000,0x3ec3ef15,0x3e8483ee,0x3e05a8a8,0x3ed8616c,0x3e94a031,0x3e1bc63c,0x3c32b7da,0x3eaf1d44,0x3e47c5c2,0x3d32aa3e,0xbddef599,0x3e8483ee,0x3dc8bd36,0xbd85f213,0xbe6886ae
.long 0x3e31d0d4,0x248d3132,0xbe31d0d4,0xbeaf1d44,0x3db27eb6,0xbdc8bd36,0xbe8f45c0,0xbee77284,0x248d3132,0xbe47c5c2,0xbec3ef15,0xbf0e39da,0xbdb27eb6,0xbe94a031,0xbef64429,0xbf26aed9
.long 0xbe31d0d4,0xbec3ef15,0xbf12d5e8,0xbf3cbe35,0xbe8483ee,0xbef15aea,0xbf28cae3,0xbf5016b8,0xbeaf1d44,0xbf0e39da,0xbf3cbe35,0xbf60712a,0xbed8616c,0xbf226799,0xbf4e7327,0xbf6d9156
.long 0x0,0x0,0x0,0x0,0x0,0x0,0x0,0x0,0x0,0x0,0x0,0x0,0x0,0x0,0x0,0x0
.long 0x0,0x0,0x0,0x0,0x0,0x0,0x0,0x0,0x0,0x0,0x0,0x0,0x0,0x0,0x0,0x0
.long 0x3f800000,0x3f800000,0x3f800000,0x3f800000,0x3f7dcf55,0x3f7d6e28,0x3f7d0543,0x3f7c94a8,0x3f7746ea,0x3f75c5d4,0x3f7426cb,0x3f726a03,0x3f6c835e,0x3f692e5f,0x3f659974,0x3f61c598
.long 0x3f5db3d7,0x3f57e880,0x3f51b3f3,0x3f4b1934,0x3f4b1934,0x3f424cfe,0x3f38ecd8,0x3f2effe8,0x3f3504f3,0x3f28cae3,0x3f1bd7ca,0x3f0e39da,0x3f1bd7ca,0x3f0be54a,0x3ef64429,0x3ed34e56
.long 0x3f000000,0x3ed8616c,0x3eaf1d44,0x3e8483ee,0x3ec3ef15,0x3e94a031,0x3e47c5c2,0x3dc8bd36,0x3e8483ee,0x3e1bc63c,0x3d32aa3e,0xbd85f213,0x3e05a8a8,0x3c32b7da,0xbddef599,0xbe6886ae
.long 0x248d3132,0xbe05a8a8,0xbe8483ee,0xbec3ef15,0xbe05a8a8,0xbe89e6f1,0xbece34d0,0xbf072f74,0xbe8483ee,0xbece34d0,0xbf098c78,0xbf28cae3,0xbec3ef15,0xbf072f74,0xbf28cae3,0xbf45e403
.long 0xbf000000,0xbf248dbb,0xbf441b7d,0xbf5db3d7,0xbf1bd7ca,0xbf3e9e4b,0xbf5adb81,0xbf6f9788,0xbf3504f3,0xbf54db31,0xbf6c835e,0xbf7b14be,0xbf4b1934,0xbf66d223,0xbf78a9e0,0xbf7fdce9
.long 0xbf5db3d7,0xbf7426cb,0xbf7f069e,0xbf7dcf55,0xbf6c835e,0xbf7c94a8,0xbf7f73af,0xbf74fa0b,0xbf7746ea,0xbf7ff067,0xbf79ee89,0xbf659974,0xbf7dcf55,0xbf7e28c6,0xbf6e9811,0xbf5016b8
.long 0x0,0x0,0x0,0x0,0x0,0x0,0x0,0x0,0x0,0x0,0x0,0x0,0x0,0x0,0x0,0x0
.long 0x0,0x0,0x0,0x0,0x0,0x0,0x0,0x0,0x0,0x0,0x0,0x0,0x0,0x0,0x0,0x0
.long 0x3f800000,0x3f800000,0x3f800000,0x3f800000,0x3f7c1c5c,0x3f7b9c62,0x3f7b14be,0x3f7a8575,0x3f708fb2,0x3f6e9811,0x3f6c835e,0x3f6a51da,0x3f5db3d7,0x3f596550,0x3f54db31,0x3f5016b8
.long 0x3f441b7d,0x3f3cbe35,0x3f3504f3,0x3f2cf37b,0x3f248dbb,0x3f199e45,0x3f0e39da,0x3f026926,0x3f000000,0x3ee273aa,0x3ec3ef15,0x3ea493b7,0x3eaf1d44,0x3e89e6f1,0x3e47c5c2,0x3df52731
.long 0x3e31d0d4,0x3db27eb6,0x248d3132,0xbdb27eb6,0x248d3132,0xbdc8bd36,0xbe47c5c2,0xbe94a031,0xbe31d0d4,0xbe8f45c0,0xbec3ef15,0xbef64429,0xbeaf1d44,0xbee77284,0xbf0e39da,0xbf26aed9
.long 0xbf000000,0xbf1bd7ca,0xbf3504f3,0xbf4b1934,0xbf248dbb,0xbf3e9e4b,0xbf54db31,0xbf66d223,0xbf441b7d,0xbf5adb81,0xbf6c835e,0xbf78a9e0,0xbf5db3d7,0xbf6f9788,0xbf7b14be,0xbf7fdce9
.long 0xbf708fb2,0xbf7c1c5c,0xbf800000,0xbf7c1c5c,0xbf7c1c5c,0xbf7ffc1a,0xbf7b14be,0xbf6d9156,0xbf800000,0xbf7b14be,0xbf6c835e,0xbf54db31,0xbf7c1c5c,0xbf6d9156,0xbf54db31,0xbf3308b4
.long 0xbf708fb2,0xbf57e880,0xbf3504f3,0xbf098c78,0xbf5db3d7,0xbf3ad85f,0xbf0e39da,0xbeb45a1e,0xbf441b7d,0xbf176012,0xbec3ef15,0xbe1bc63c,0xbf248dbb,0xbedd6dea,0xbe47c5c2,0x3d5f4a99
.long 0x0,0x0,0x0,0x0,0x0,0x0,0x0,0x0,0x0,0x0,0x0,0x0,0x0,0x0,0x0,0x0
.long 0x0,0x0,0x0,0x0,0x0,0x0,0x0,0x0,0x0,0x0,0x0,0x0,0x0,0x0,0x0,0x0
.long 0x3f800000,0x3f800000,0x3f800000,0x3f800000,0x3f79ee89,0x3f795000,0x3f78a9e0,0x3f77fc2c,0x3f6803ca,0x3f659974,0x3f631324,0x3f60712a,0x3f4b1934,0x3f45e403,0x3f407893,0x3f3ad85f
.long 0x3f248dbb,0x3f1bd7ca,0x3f12d5e8,0x3f098c78,0x3eec6a50,0x3ed34e56,0x3eb9917b,0x3e9f4757,0x3e8483ee,0x3e47c5c2,0x3e05a8a8,0x3d85f213,0x3d32aa3e,0xbd060472,0xbddef599,0xbe3cce2b
.long 0xbe31d0d4,0xbe8483ee,0xbeaf1d44,0xbed8616c,0xbec3ef15,0xbef15aea,0xbf0e39da,0xbf226799,0xbf12d5e8,0xbf28cae3,0xbf3cbe35,0xbf4e7327,0xbf3cbe35,0xbf5016b8,0xbf60712a,0xbf6d9156
.long 0xbf5db3d7,0xbf6c835e,0xbf7746ea,0xbf7dcf55,0xbf7426cb,0xbf7c94a8,0xbf7ff067,0xbf7e28c6,0xbf7f069e,0xbf7f73af,0xbf79ee89,0xbf6e9811,0xbf7dcf55,0xbf74fa0b,0xbf659974,0xbf5016b8
.long 0xbf708fb2,0xbf5db3d7,0xbf441b7d,0xbf248dbb,0xbf57e880,0xbf3ad85f,0xbf176012,0xbedd6dea,0xbf3504f3,0xbf0e39da,0xbec3ef15,0xbe47c5c2,0xbf098c78,0xbeb45a1e,0xbe1bc63c,0x3d5f4a99
.long 0xbeaf1d44,0xbe05a8a8,0x3db27eb6,0x3e99f61c,0xbe05a8a8,0x3dc8bd36,0x3ea493b7,0x3f072f74,0x3db27eb6,0x3ea493b7,0x3f098c78,0x3f38ecd8,0x3e99f61c,0x3f072f74,0x3f38ecd8,0x3f5f15e7
.long 0x0,0x0,0x0,0x0,0x0,0x0,0x0,0x0,0x0,0x0,0x0,0x0,0x0,0x0,0x0,0x0
.long 0x0,0x0,0x0,0x0,0x0,0x0,0x0,0x0,0x0,0x0,0x0,0x0,0x0,0x0,0x0,0x0
.long 0x0,0x0,0x0,0x0,0x0,0x3c32b7da,0x3cb2b521,0x3d060472,0x0,0x3cb2b521,0x3d32aa3e,0x3d85f213,0x0,0x3d060472,0x3d85f213,0x3dc8bd36
.long 0x0,0x3d32aa3e,0x3db27eb6,0x3e05a8a8,0x0,0x3d5f4a99,0x3ddef599,0x3e26ce12,0x0,0x3d85f213,0x3e05a8a8,0x3e47c5c2,0x0,0x3d9c3ac6,0x3e1bc63c,0x3e6886ae
.long 0x0,0x3db27eb6,0x3e31d0d4,0x3e8483ee,0x0,0x3dc8bd36,0x3e47c5c2,0x3e94a031,0x0,0x3ddef599,0x3e5da259,0x3ea493b7,0x0,0x3df52731,0x3e7363ee,0x3eb45a1e
.long 0x0,0x3e05a8a8,0x3e8483ee,0x3ec3ef15,0x0,0x3e10b9a6,0x3e8f45c0,0x3ed34e56,0x0,0x3e1bc63c,0x3e99f61c,0x3ee273aa,0x0,0x3e26ce12,0x3ea493b7,0x3ef15aea
.long 0x0,0x3e31d0d4,0x3eaf1d44,0x3f000000,0x0,0x3e3cce2b,0x3eb9917b,0x3f072f74,0x0,0x3e47c5c2,0x3ec3ef15,0x3f0e39da,0x0,0x3e52b743,0x3ece34d0,0x3f151d42
.long 0x0,0x3e5da259,0x3ed8616c,0x3f1bd7ca,0x0,0x3e6886ae,0x3ee273aa,0x3f226799,0x0,0x3e7363ee,0x3eec6a50,0x3f28cae3,0x0,0x3e7e39c4,0x3ef64429,0x3f2effe8
.long 0x0,0x0,0x0,0x0,0x0,0x0,0x0,0x0,0x0,0x0,0x0,0x0,0x0,0x0,0x0,0x0
.long 0x0,0x0,0x0,0x0,0x0,0x0,0x0,0x0,0x0,0x0,0x0,0x0,0x0,0x0,0x0,0x0
.long 0x0,0x0,0x0,0x0,0x3d32aa3e,0x3d5f4a99,0x3d85f213,0x3d9c3ac6,0x3db27eb6,0x3ddef599,0x3e05a8a8,0x3e1bc63c,0x3e05a8a8,0x3e26ce12,0x3e47c5c2,0x3e6886ae
.long 0x3e31d0d4,0x3e5da259,0x3e8483ee,0x3e99f61c,0x3e5da259,0x3e89e6f1,0x3ea493b7,0x3ebec330,0x3e8483ee,0x3ea493b7,0x3ec3ef15,0x3ee273aa,0x3e99f61c,0x3ebec330,0x3ee273aa,0x3f026926
.long 0x3eaf1d44,0x3ed8616c,0x3f000000,0x3f12d5e8,0x3ec3ef15,0x3ef15aea,0x3f0e39da,0x3f226799,0x3ed8616c,0x3f04ce53,0x3f1bd7ca,0x3f310700,0x3eec6a50,0x3f108a14,0x3f28cae3,0x3f3e9e4b
.long 0x3f000000,0x3f1bd7ca,0x3f3504f3,0x3f4b1934,0x3f098c78,0x3f26aed9,0x3f407893,0x3f56651d,0x3f12d5e8,0x3f310700,0x3f4b1934,0x3f60712a,0x3f1bd7ca,0x3f3ad85f,0x3f54db31,0x3f692e5f
.long 0x3f248dbb,0x3f441b7d,0x3f5db3d7,0x3f708fb2,0x3f2cf37b,0x3f4cc94c,0x3f659974,0x3f768a20,0x3f3504f3,0x3f54db31,0x3f6c835e,0x3f7b14be,0x3f3cbe35,0x3f5c4b07,0x3f726a03,0x3f7e28c6
.long 0x3f441b7d,0x3f631324,0x3f7746ea,0x3f7fc1a0,0x3f4b1934,0x3f692e5f,0x3f7b14be,0x3f7fdce9,0x3f51b3f3,0x3f6e9811,0x3f7dcf55,0x3f7e7a7a,0x3f57e880,0x3f734c1c,0x3f7f73af,0x3f7b9c62
.long 0x0,0x0,0x0,0x0,0x0,0x0,0x0,0x0,0x0,0x0,0x0,0x0,0x0,0x0,0x0,0x0
.long 0x0,0x0,0x0,0x0,0x0,0x0,0x0,0x0,0x0,0x0,0x0,0x0,0x0,0x0,0x0,0x0
.long 0x0,0x0,0x0,0x0,0x3db27eb6,0x3dc8bd36,0x3ddef599,0x3df52731,0x3e31d0d4,0x3e47c5c2,0x3e5da259,0x3e7363ee,0x3e8483ee,0x3e94a031,0x3ea493b7,0x3eb45a1e
.long 0x3eaf1d44,0x3ec3ef15,0x3ed8616c,0x3eec6a50,0x3ed8616c,0x3ef15aea,0x3f04ce53,0x3f108a14,0x3f000000,0x3f0e39da,0x3f1bd7ca,0x3f28cae3,0x3f12d5e8,0x3f226799,0x3f310700,0x3f3e9e4b
.long 0x3f248dbb,0x3f3504f3,0x3f441b7d,0x3f51b3f3,0x3f3504f3,0x3f45e403,0x3f54db31,0x3f61c598,0x3f441b7d,0x3f54db31,0x3f631324,0x3f6e9811,0x3f51b3f3,0x3f61c598,0x3f6e9811,0x3f77fc2c
.long 0x3f5db3d7,0x3f6c835e,0x3f7746ea,0x3f7dcf55,0x3f6803ca,0x3f74fa0b,0x3f7d0543,0x3f7ffc1a,0x3f708fb2,0x3f7b14be,0x3f7fc1a0,0x3f7e7a7a,0x3f7746ea,0x3f7ec46d,0x3f7f73af,0x3f795000
.long 0x3f7c1c5c,0x3f800000,0x3f7c1c5c,0x3f708fb2,0x3f7f069e,0x3f7ec46d,0x3f75c5d4,0x3f6459c6,0x3f800000,0x3f7b14be,0x3f6c835e,0x3f54db31,0x3f7f069e,0x3f74fa0b,0x3f60712a,0x3f424cfe
.long 0x3f7c1c5c,0x3f6c835e,0x3f51b3f3,0x3f2cf37b,0x3f7746ea,0x3f61c598,0x3f407893,0x3f151d42,0x3f708fb2,0x3f54db31,0x3f2cf37b,0x3ef64429,0x3f6803ca,0x3f45e403,0x3f176012,0x3ebec330
.long 0x0,0x0,0x0,0x0,0x0,0x0,0x0,0x0,0x0,0x0,0x0,0x0,0x0,0x0,0x0,0x0
.long 0x0,0x0,0x0,0x0,0x0,0x0,0x0,0x0,0x0,0x0,0x0,0x0,0x0,0x0,0x0,0x0
.long 0x0,0x0,0x0,0x0,0x3e05a8a8,0x3e10b9a6,0x3e1bc63c,0x3e26ce12,0x3e8483ee,0x3e8f45c0,0x3e99f61c,0x3ea493b7,0x3ec3ef15,0x3ed34e56,0x3ee273aa,0x3ef15aea
.long 0x3f000000,0x3f098c78,0x3f12d5e8,0x3f1bd7ca,0x3f1bd7ca,0x3f26aed9,0x3f310700,0x3f3ad85f,0x3f3504f3,0x3f407893,0x3f4b1934,0x3f54db31,0x3f4b1934,0x3f56651d,0x3f60712a,0x3f692e5f
.long 0x3f5db3d7,0x3f6803ca,0x3f708fb2,0x3f7746ea,0x3f6c835e,0x3f74fa0b,0x3f7b14be,0x3f7ec46d,0x3f7746ea,0x3f7d0543,0x3f7fc1a0,0x3f7f73af,0x3f7dcf55,0x3f7ffc1a,0x3f7e7a7a,0x3f795000
.long 0x3f800000,0x3f7dcf55,0x3f7746ea,0x3f6c835e,0x3f7dcf55,0x3f768a20,0x3f6a51da,0x3f596550,0x3f7746ea,0x3f6a51da,0x3f57e880,0x3f407893,0x3f6c835e,0x3f596550,0x3f407893,0x3f226799
.long 0x3f5db3d7,0x3f441b7d,0x3f248dbb,0x3f000000,0x3f4b1934,0x3f2ae1c9,0x3f04ce53,0x3eb45a1e,0x3f3504f3,0x3f0e39da,0x3ec3ef15,0x3e47c5c2,0x3f1bd7ca,0x3edd6dea,0x3e7363ee,0x3d060472
.long 0x3f000000,0x3e99f61c,0x3db27eb6,0xbe05a8a8,0x3ec3ef15,0x3e26ce12,0xbd85f213,0xbe94a031,0x3e8483ee,0x3cb2b521,0xbe5da259,0xbee273aa,0x3e05a8a8,0xbdf52731,0xbeb9917b,0xbf151d42
.long 0x0,0x0,0x0,0x0,0x0,0x0,0x0,0x0,0x0,0x0,0x0,0x0,0x0,0x0,0x0,0x0
.long 0x0,0x0,0x0,0x0,0x0,0x0,0x0,0x0,0x0,0x0,0x0,0x0,0x0,0x0,0x0,0x0
.long 0x0,0x0,0x0,0x0,0x3e31d0d4,0x3e3cce2b,0x3e47c5c2,0x3e52b743,0x3eaf1d44,0x3eb9917b,0x3ec3ef15,0x3ece34d0,0x3f000000,0x3f072f74,0x3f0e39da,0x3f151d42
.long 0x3f248dbb,0x3f2cf37b,0x3f3504f3,0x3f3cbe35,0x3f441b7d,0x3f4cc94c,0x3f54db31,0x3f5c4b07,0x3f5db3d7,0x3f659974,0x3f6c835e,0x3f726a03,0x3f708fb2,0x3f768a20,0x3f7b14be,0x3f7e28c6
.long 0x3f7c1c5c,0x3f7f069e,0x3f800000,0x3f7f069e,0x3f800000,0x3f7ec46d,0x3f7b14be,0x3f74fa0b,0x3f7c1c5c,0x3f75c5d4,0x3f6c835e,0x3f60712a,0x3f708fb2,0x3f6459c6,0x3f54db31,0x3f424cfe
.long 0x3f5db3d7,0x3f4b1934,0x3f3504f3,0x3f1bd7ca,0x3f441b7d,0x3f2ae1c9,0x3f0e39da,0x3edd6dea,0x3f248dbb,0x3f04ce53,0x3ec3ef15,0x3e7363ee,0x3f000000,0x3eb45a1e,0x3e47c5c2,0x3d060472
.long 0x3eaf1d44,0x3e31d0d4,0x250d3132,0xbe31d0d4,0x3e31d0d4,0xbc32b7da,0xbe47c5c2,0xbebec330,0x250d3132,0xbe47c5c2,0xbec3ef15,0xbf0e39da,0xbe31d0d4,0xbebec330,0xbf0e39da,0xbf36fbaf
.long 0xbeaf1d44,0xbf098c78,0xbf3504f3,0xbf57e880,0xbf000000,0xbf2effe8,0xbf54db31,0xbf6f9788,0xbf248dbb,0xbf4e7327,0xbf6c835e,0xbf7d0543,0xbf441b7d,0xbf66d223,0xbf7b14be,0xbf7f9e8c
.long 0x0,0x0,0x0,0x0,0x0,0x0,0x0,0x0,0x0,0x0,0x0,0x0,0x0,0x0,0x0,0x0
.long 0x0,0x0,0x0,0x0,0x0,0x0,0x0,0x0,0x0,0x0,0x0,0x0,0x0,0x0,0x0,0x0
.long 0x0,0x0,0x0,0x0,0x3e5da259,0x3e6886ae,0x3e7363ee,0x3e7e39c4,0x3ed8616c,0x3ee273aa,0x3eec6a50,0x3ef64429,0x3f1bd7ca,0x3f226799,0x3f28cae3,0x3f2effe8
.long 0x3f441b7d,0x3f4b1934,0x3f51b3f3,0x3f57e880,0x3f631324,0x3f692e5f,0x3f6e9811,0x3f734c1c,0x3f7746ea,0x3f7b14be,0x3f7dcf55,0x3f7f73af,0x3f7fc1a0,0x3f7fdce9,0x3f7e7a7a,0x3f7b9c62
.long 0x3f7c1c5c,0x3f7746ea,0x3f708fb2,0x3f6803ca,0x3f6c835e,0x3f61c598,0x3f54db31,0x3f45e403,0x3f51b3f3,0x3f407893,0x3f2cf37b,0x3f176012,0x3f2cf37b,0x3f151d42,0x3ef64429,0x3ebec330
.long 0x3f000000,0x3ec3ef15,0x3e8483ee,0x3e05a8a8,0x3e99f61c,0x3e26ce12,0x3cb2b521,0xbdf52731,0x3db27eb6,0xbd85f213,0xbe5da259,0xbeb9917b,0xbe05a8a8,0xbe94a031,0xbee273aa,0xbf151d42
.long 0xbeaf1d44,0xbf000000,0xbf248dbb,0xbf441b7d,0xbf098c78,0xbf2effe8,0xbf4e7327,0xbf66d223,0xbf3504f3,0xbf54db31,0xbf6c835e,0xbf7b14be,0xbf57e880,0xbf6f9788,0xbf7d0543,0xbf7f9e8c
.long 0xbf708fb2,0xbf7dcf55,0xbf7f069e,0xbf7426cb,0xbf7dcf55,0xbf7ec46d,0xbf726a03,0xbf596550,0xbf7f069e,0xbf726a03,0xbf57e880,0xbf310700,0xbf7426cb,0xbf596550,0xbf310700,0xbefb25e8
.long 0x0,0x0,0x0,0x0,0x0,0x0,0x0,0x0,0x0,0x0,0x0,0x0,0x0,0x0,0x0,0x0
.long 0x0,0x0,0x0,0x0,0x0,0x0,0x0,0x0,0x0,0x0,0x0,0x0,0x0,0x0,0x0,0x0
.long 0x80003f80,0x80003f80,0x80003f80,0x80003f80,0x80003f80,0xbe853f77,0xbf003f5e,0xbf353f35,0x80003f80,0xbf003f5e,0xbf5e3f00,0xbf80248d,0x80003f80,0xbf353f35,0xbf80248d,0xbf35bf35
.long 0x80003f80,0xbf5e3f00,0xbf5ebf00,0xa50dbf80,0x80003f80,0xbf773e85,0xbf00bf5e,0x3f35bf35,0x80003f80,0xbf80248d,0xa50dbf80,0x3f80a554,0x80003f80,0xbf77be85,0x3f00bf5e,0x3f353f35
.long 0x80003f80,0xbf5ebf00,0x3f5ebf00,0x258d3f80,0x80003f80,0xbf35bf35,0x3f80a554,0xbf353f35,0x80003f80,0xbf00bf5e,0x3f5e3f00,0xbf8026ac,0x80003f80,0xbe85bf77,0x3f003f5e,0xbf35bf35
.long 0x80003f80,0xa50dbf80,0x258d3f80,0xa5d4bf80,0x80003f80,0x3e85bf77,0xbf003f5e,0x3f35bf35,0x80003f80,0x3f00bf5e,0xbf5e3f00,0x3f80a5f7,0x80003f80,0x3f35bf35,0xbf8026ac,0x3f353f35
.long 0x80003f80,0x3f5ebf00,0xbf5ebf00,0x260d3f80,0x80003f80,0x3f77be85,0xbf00bf5e,0xbf353f35,0x80003f80,0x3f80a554,0xa5d4bf80,0xbf80261f,0x80003f80,0x3f773e85,0x3f00bf5e,0xbf35bf35
.long 0x80003f80,0x3f5e3f00,0x3f5ebf00,0xa72cbf80,0x80003f80,0x3f353f35,0x3f80a5f7,0x3f35bf35,0x80003f80,0x3f003f5e,0x3f5e3f00,0x3f80269f,0x80003f80,0x3e853f77,0x3f003f5e,0x3f353f35
.long 0x0,0x0,0x0,0x0,0x0,0x0,0x0,0x0,0x0,0x0,0x0,0x0,0x0,0x0,0x0,0x0
.long 0x0,0x0,0x0,0x0,0x0,0x0,0x0,0x0,0x0,0x0,0x0,0x0,0x0,0x0,0x0,0x0
.long 0x80003f80,0x80003f80,0x80003f80,0x80003f80,0xbf5e3f00,0xbf773e85,0xbf80248d,0xbf77be85,0xbf5ebf00,0xbf00bf5e,0xa50dbf80,0x3f00bf5e,0xa50dbf80,0x3f35bf35,0x3f80a554,0x3f353f35
.long 0x3f5ebf00,0x3f5e3f00,0x258d3f80,0xbf5e3f00,0x3f5e3f00,0xbe853f77,0xbf8026ac,0xbe85bf77,0x258d3f80,0xbf8026ac,0xa5d4bf80,0x3f80a5f7,0xbf5e3f00,0xbe85bf77,0x3f80a5f7,0xbe853f77
.long 0xbf5ebf00,0x3f5ebf00,0x260d3f80,0xbf5ebf00,0xa5d4bf80,0x3f353f35,0xbf80261f,0x3f35bf35,0x3f5ebf00,0xbf003f5e,0xa72cbf80,0x3f003f5e,0x3f5e3f00,0xbf77be85,0x3f80269f,0xbf773e85
.long 0x260d3f80,0xa72cbf80,0x26543f80,0xa677bf80,0xbf5e3f00,0x3f77be85,0xbf802739,0x3f773e85,0xbf5ebf00,0x3f003f5e,0xa677bf80,0xbf003f5e,0xa72cbf80,0xbf353f35,0x3f802677,0xbf35bf35
.long 0x3f5ebf00,0xbf5ebf00,0x268d3f80,0x3f5ebf00,0x3f5e3f00,0x3e85bf77,0xbf80274b,0x3e853f77,0x26543f80,0x3f802677,0xa69fbf80,0xbf80a60d,0xbf5e3f00,0x3e853f77,0x3f80a754,0x3e85bf77
.long 0xbf5ebf00,0xbf5e3f00,0x27ac3f80,0x3f5e3f00,0xa677bf80,0xbf35bf35,0xbf80a60d,0xbf353f35,0x3f5ebf00,0x3f00bf5e,0x271fbf80,0xbf00bf5e,0x3f5e3f00,0x3f773e85,0x3f80a765,0x3f77be85
.long 0x0,0x0,0x0,0x0,0x0,0x0,0x0,0x0,0x0,0x0,0x0,0x0,0x0,0x0,0x0,0x0
.long 0x0,0x0,0x0,0x0,0x0,0x0,0x0,0x0,0x0,0x0,0x0,0x0,0x0,0x0,0x0,0x0
.long 0x80003f80,0x80003f80,0x80003f80,0x80003f80,0xbf5ebf00,0xbf35bf35,0xbf00bf5e,0xbe85bf77,0x3f5ebf00,0x3f80a554,0x3f5e3f00,0x3f003f5e,0x258d3f80,0xbf353f35,0xbf8026ac,0xbf35bf35
.long 0xbf5ebf00,0xa5d4bf80,0x3f5ebf00,0x3f5e3f00,0x3f5ebf00,0x3f353f35,0xbf003f5e,0xbf77be85,0x260d3f80,0xbf80261f,0xa72cbf80,0x3f80a731,0xbf5ebf00,0x3f35bf35,0x3f003f5e,0xbf773e85
.long 0x3f5ebf00,0x26543f80,0xbf5ebf00,0x3f5ebf00,0x26543f80,0xbf35bf35,0x3f802677,0xbf353f35,0xbf5ebf00,0x3f802677,0xbf5e3f00,0x3f00bf5e,0x3f5ebf00,0xbf353f35,0x3f00bf5e,0xbe853f77
.long 0x268d3f80,0xa69fbf80,0x27ac3f80,0xa7b1bf80,0xbf5ebf00,0x3f353f35,0xbf00bf5e,0x3e853f77,0x3f5ebf00,0xbf80a60d,0x3f5e3f00,0xbf00bf5e,0x27ac3f80,0x3f35bf35,0xbf80a58e,0x3f353f35
.long 0xbf5ebf00,0x26d43f80,0x3f5ebf00,0xbf5ebf00,0x3f5ebf00,0xbf35bf35,0xbf003f5e,0x3f773e85,0x26d43f80,0x3f80a777,0x26f7bf80,0xbf802804,0xbf5ebf00,0xbf353f35,0x3f003f5e,0x3f77be85
.long 0x3f5ebf00,0x26f7bf80,0xbf5ebf00,0xbf5e3f00,0x26f73f80,0x3f353f35,0x3f802766,0x3f35bf35,0xbf5ebf00,0xbf80258d,0xbf5e3f00,0xbf003f5e,0x3f5ebf00,0x3f35bf35,0x3f00bf5e,0x3e85bf77
.long 0x0,0x0,0x0,0x0,0x0,0x0,0x0,0x0,0x0,0x0,0x0,0x0,0x0,0x0,0x0,0x0
.long 0x0,0x0,0x0,0x0,0x0,0x0,0x0,0x0,0x0,0x0,0x0,0x0,0x0,0x0,0x0,0x0
.long 0x80003f80,0x80003f80,0x80003f80,0x80003f80,0xa50dbf80,0x3e85bf77,0x3f00bf5e,0x3f35bf35,0x258d3f80,0xbf003f5e,0xbf5e3f00,0xbf8026ac,0xa5d4bf80,0x3f35bf35,0x3f80a5f7,0x3f353f35
.long 0x260d3f80,0xbf5e3f00,0xbf5ebf00,0xa72cbf80,0xa72cbf80,0x3f77be85,0x3f003f5e,0xbf353f35,0x26543f80,0xbf80a68d,0xa677bf80,0x3f80a7e1,0xa677bf80,0x3f773e85,0xbf003f5e,0xbf35bf35
.long 0x268d3f80,0xbf5ebf00,0x3f5ebf00,0x27ac3f80,0xa69fbf80,0x3f353f35,0xbf80a60d,0x3f35bf35,0x27ac3f80,0xbf00bf5e,0x3f5e3f00,0xbf80a58e,0x271fbf80,0x3e853f77,0xbf00bf5e,0x3f353f35
.long 0x26d43f80,0x270dbf80,0x26f73f80,0xa861bf80,0xa7b9bf80,0xbe853f77,0x3f00bf5e,0xbf353f35,0x26f73f80,0x3f00bf5e,0xbf5e3f00,0x3f80a847,0x26f7bf80,0xbf353f35,0x3f802766,0xbf35bf35
.long 0x270d3f80,0x3f5ebf00,0xbf5ebf00,0x282c3f80,0xa7cbbf80,0xbf773e85,0x3f003f5e,0x3f35bf35,0x271f3f80,0x3f80a796,0x268dbf80,0xbf80268d,0xa7d4bf80,0xbf77be85,0xbf003f5e,0x3f353f35
.long 0x282c3f80,0x3f5e3f00,0x3f5ebf00,0x260ebf80,0x268dbf80,0xbf35bf35,0xbf80a7d4,0xbf353f35,0xa79f3f80,0x3f003f5e,0x3f5e3f00,0x3f80a85d,0xa7e5bf80,0xbe85bf77,0xbf00bf5e,0xbf35bf35
.long 0x0,0x0,0x0,0x0,0x0,0x0,0x0,0x0,0x0,0x0,0x0,0x0,0x0,0x0,0x0,0x0
.long 0x0,0x0,0x0,0x0,0x0,0x0,0x0,0x0,0x0,0x0,0x0,0x0,0x0,0x0,0x0,0x0
.long 0x80003f80,0x80003f80,0x80003f80,0x80003f80,0x3f5ebf00,0x3f77be85,0x3f80a554,0x3f773e85,0xbf5ebf00,0xbf00bf5e,0xa5d4bf80,0x3f00bf5e,0x260d3f80,0xbf353f35,0xbf80261f,0xbf35bf35
.long 0x3f5ebf00,0x3f5e3f00,0x26543f80,0xbf5e3f00,0xbf5ebf00,0x3e85bf77,0x3f802677,0x3e853f77,0x268d3f80,0xbf80a79a,0xa69fbf80,0x3f80a754,0x3f5ebf00,0x3e853f77,0xbf80a60d,0x3e85bf77
.long 0xbf5ebf00,0x3f5ebf00,0x26d43f80,0xbf5ebf00,0x26d43f80,0xbf35bf35,0x3f80a777,0xbf353f35,0x3f5ebf00,0xbf003f5e,0x26f7bf80,0x3f003f5e,0xbf5ebf00,0x3f773e85,0xbf80258d,0x3f77be85
.long 0x270d3f80,0x281abf80,0x271f3f80,0xa7d4bf80,0x3f5ebf00,0xbf773e85,0x3f80a796,0xbf77be85,0xbf5ebf00,0x3f003f5e,0x268dbf80,0xbf003f5e,0x282c3f80,0x3f35bf35,0xbf80268d,0x3f353f35
.long 0x3f5ebf00,0xbf5ebf00,0x27543f80,0x3f5ebf00,0xbf5ebf00,0xbe853f77,0x3f80a7b1,0xbe85bf77,0x27543f80,0x3f80a7b1,0xa7f7bf80,0xbf80281f,0x3f5ebf00,0xbe85bf77,0xbf80281f,0xbe853f77
.long 0xbf5ebf00,0xbf5e3f00,0xa7773f80,0x3f5e3f00,0x27773f80,0x3f353f35,0x3f8026d4,0x3f35bf35,0x3f5ebf00,0x3f00bf5e,0xa60dbf80,0xbf00bf5e,0xbf5ebf00,0xbf77be85,0xbf802896,0xbf773e85
.long 0x0,0x0,0x0,0x0,0x0,0x0,0x0,0x0,0x0,0x0,0x0,0x0,0x0,0x0,0x0,0x0
.long 0x0,0x0,0x0,0x0,0x0,0x0,0x0,0x0,0x0,0x0,0x0,0x0,0x0,0x0,0x0,0x0
.long 0x80003f80,0x80003f80,0x80003f80,0x80003f80,0x3f5e3f00,0x3f353f35,0x3f003f5e,0x3e853f77,0x3f5ebf00,0x3f80a5f7,0x3f5e3f00,0x3f003f5e,0xa72cbf80,0x3f35bf35,0x3f80a731,0x3f353f35
.long 0xbf5ebf00,0xa677bf80,0x3f5ebf00,0x3f5e3f00,0xbf5e3f00,0xbf35bf35,0x3f00bf5e,0x3f773e85,0x27ac3f80,0xbf80a60d,0xa7b1bf80,0x3f80a765,0x3f5e3f00,0xbf353f35,0xbf00bf5e,0x3f77be85
.long 0x3f5ebf00,0x26f73f80,0xbf5ebf00,0x3f5ebf00,0x26f7bf80,0x3f353f35,0xbf802804,0x3f35bf35,0xbf5ebf00,0x3f802766,0xbf5e3f00,0x3f00bf5e,0xbf5e3f00,0x3f35bf35,0xbf003f5e,0x3e85bf77
.long 0x282c3f80,0x268dbf80,0x28313f80,0xa7e5bf80,0x3f5e3f00,0xbf35bf35,0x3f003f5e,0xbe85bf77,0x3f5ebf00,0xbf80a7d4,0x3f5e3f00,0xbf00bf5e,0x260ebf80,0xbf353f35,0x3f80a85d,0xbf35bf35
.long 0xbf5ebf00,0x27773f80,0x3f5ebf00,0xbf5ebf00,0xbf5e3f00,0x3f353f35,0x3f00bf5e,0xbf77be85,0xa7773f80,0x3f8026d4,0xa884bf80,0xbf802896,0x3f5e3f00,0x3f35bf35,0xbf00bf5e,0xbf773e85
.long 0x3f5ebf00,0x27e6bf80,0xbf5ebf00,0xbf5e3f00,0x27e6bf80,0xbf35bf35,0xbf80289a,0xbf353f35,0xbf5ebf00,0xbf802754,0xbf5e3f00,0xbf003f5e,0xbf5e3f00,0xbf353f35,0xbf003f5e,0xbe853f77
.long 0x0,0x0,0x0,0x0,0x0,0x0,0x0,0x0,0x0,0x0,0x0,0x0,0x0,0x0,0x0,0x0
.long 0x0,0x0,0x0,0x0,0x0,0x0,0x0,0x0,0x0,0x0,0x0,0x0,0x0,0x0,0x0,0x0
.long 0x3f800000,0x3f800000,0x3f800000,0x3f800000,0x3f800000,0x3f773e85,0x3f5e3f00,0x3f353f35,0x3f800000,0x3f5e3f00,0x3f003f5e,0x248d3f80,0x3f800000,0x3f353f35,0x248d3f80,0xbf353f35
.long 0x3f800000,0x3f003f5e,0xbf003f5e,0xbf80250d,0x3f800000,0x3e853f77,0xbf5e3f00,0xbf35bf35,0x3f800000,0x248d3f80,0xbf80250d,0xa554bf80,0x3f800000,0xbe853f77,0xbf5ebf00,0x3f35bf35
.long 0x3f800000,0xbf003f5e,0xbf00bf5e,0x3f80a58d,0x3f800000,0xbf353f35,0xa554bf80,0x3f353f35,0x3f800000,0xbf5e3f00,0x3f00bf5e,0x26ac3f80,0x3f800000,0xbf773e85,0x3f5ebf00,0xbf353f35
.long 0x3f800000,0xbf80250d,0x3f80a58d,0xbf8025d4,0x3f800000,0xbf77be85,0x3f5e3f00,0xbf35bf35,0x3f800000,0xbf5ebf00,0x3f003f5e,0xa5f7bf80,0x3f800000,0xbf35bf35,0x26ac3f80,0x3f35bf35
.long 0x3f800000,0xbf00bf5e,0xbf003f5e,0x3f80a60d,0x3f800000,0xbe85bf77,0xbf5e3f00,0x3f353f35,0x3f800000,0xa554bf80,0xbf8025d4,0x261f3f80,0x3f800000,0x3e85bf77,0xbf5ebf00,0xbf353f35
.long 0x3f800000,0x3f00bf5e,0xbf00bf5e,0xbf80272c,0x3f800000,0x3f35bf35,0xa5f7bf80,0xbf35bf35,0x3f800000,0x3f5ebf00,0x3f00bf5e,0x269fbf80,0x3f800000,0x3f77be85,0x3f5ebf00,0x3f35bf35
.long 0x0,0x0,0x0,0x0,0x0,0x0,0x0,0x0,0x0,0x0,0x0,0x0,0x0,0x0,0x0,0x0
.long 0x0,0x0,0x0,0x0,0x0,0x0,0x0,0x0,0x0,0x0,0x0,0x0,0x0,0x0,0x0,0x0
.long 0x3f800000,0x3f800000,0x3f800000,0x3f800000,0x3f003f5e,0x3e853f77,0x248d3f80,0xbe853f77,0xbf003f5e,0xbf5e3f00,0xbf80250d,0xbf5ebf00,0xbf80250d,0xbf35bf35,0xa554bf80,0x3f35bf35
.long 0xbf00bf5e,0x3f00bf5e,0x3f80a58d,0x3f003f5e,0x3f00bf5e,0x3f773e85,0x26ac3f80,0xbf773e85,0x3f80a58d,0x26ac3f80,0xbf8025d4,0xa5f7bf80,0x3f003f5e,0xbf773e85,0xa5f7bf80,0x3f773e85
.long 0xbf003f5e,0xbf00bf5e,0x3f80a60d,0xbf003f5e,0xbf8025d4,0x3f35bf35,0x261f3f80,0xbf35bf35,0xbf00bf5e,0x3f5e3f00,0xbf80272c,0x3f5ebf00,0x3f00bf5e,0xbe853f77,0x269fbf80,0x3e853f77
.long 0x3f80a60d,0xbf80272c,0x3f80a654,0xbf802677,0x3f003f5e,0xbe85bf77,0x27393f80,0x3e85bf77,0xbf003f5e,0x3f5ebf00,0xbf802677,0x3f5e3f00,0xbf80272c,0x3f353f35,0x2677bf80,0xbf353f35
.long 0xbf00bf5e,0xbf003f5e,0x3f80a68d,0xbf00bf5e,0x3f00bf5e,0xbf77be85,0x274b3f80,0x3f77be85,0x3f80a654,0x2677bf80,0xbf80269f,0xa60d3f80,0x3f003f5e,0x3f77be85,0xa754bf80,0xbf77be85
.long 0xbf003f5e,0x3f003f5e,0x3f80a7ac,0x3f00bf5e,0xbf802677,0xbf353f35,0xa60d3f80,0x3f353f35,0xbf00bf5e,0xbf5ebf00,0xbf80a71f,0xbf5e3f00,0x3f00bf5e,0x3e85bf77,0xa765bf80,0xbe85bf77
.long 0x0,0x0,0x0,0x0,0x0,0x0,0x0,0x0,0x0,0x0,0x0,0x0,0x0,0x0,0x0,0x0
.long 0x0,0x0,0x0,0x0,0x0,0x0,0x0,0x0,0x0,0x0,0x0,0x0,0x0,0x0,0x0,0x0
.long 0x3f800000,0x3f800000,0x3f800000,0x3f800000,0xbf003f5e,0xbf353f35,0xbf5e3f00,0xbf773e85,0xbf00bf5e,0xa554bf80,0x3f00bf5e,0x3f5ebf00,0x3f80a58d,0x3f353f35,0x26ac3f80,0xbf353f35
.long 0xbf003f5e,0xbf8025d4,0xbf00bf5e,0x3f00bf5e,0xbf00bf5e,0x3f35bf35,0x3f5e3f00,0xbe853f77,0x3f80a60d,0x261f3f80,0xbf80272c,0xa731bf80,0xbf003f5e,0xbf35bf35,0x3f5ebf00,0x3e853f77
.long 0xbf00bf5e,0x3f80a654,0xbf003f5e,0xbf00bf5e,0x3f80a654,0xbf353f35,0x2677bf80,0x3f353f35,0xbf003f5e,0x2677bf80,0x3f003f5e,0xbf5ebf00,0xbf00bf5e,0x3f353f35,0xbf5ebf00,0x3f773e85
.long 0x3f80a68d,0xbf80269f,0x3f80a7ac,0xbf8027b1,0xbf003f5e,0x3f35bf35,0xbf5e3f00,0x3f77be85,0xbf00bf5e,0xa60d3f80,0x3f00bf5e,0xbf5e3f00,0x3f80a7ac,0xbf35bf35,0xa58e3f80,0x3f35bf35
.long 0xbf003f5e,0x3f80a6d4,0xbf00bf5e,0xbf003f5e,0xbf00bf5e,0xbf353f35,0x3f5e3f00,0x3e85bf77,0x3f80a6d4,0xa777bf80,0xbf80a6f7,0x28043f80,0xbf003f5e,0x3f353f35,0x3f5ebf00,0xbe85bf77
.long 0xbf00bf5e,0xbf80a6f7,0xbf003f5e,0x3f003f5e,0x3f80a6f7,0x3f35bf35,0x2766bf80,0xbf35bf35,0xbf003f5e,0x258d3f80,0x3f003f5e,0x3f5e3f00,0xbf00bf5e,0xbf35bf35,0xbf5ebf00,0xbf77be85
.long 0x0,0x0,0x0,0x0,0x0,0x0,0x0,0x0,0x0,0x0,0x0,0x0,0x0,0x0,0x0,0x0
.long 0x0,0x0,0x0,0x0,0x0,0x0,0x0,0x0,0x0,0x0,0x0,0x0,0x0,0x0,0x0,0x0
.long 0x3f800000,0x3f800000,0x3f800000,0x3f800000,0xbf80250d,0xbf77be85,0xbf5ebf00,0xbf35bf35,0x3f80a58d,0x3f5e3f00,0x3f003f5e,0x26ac3f80,0xbf8025d4,0xbf35bf35,0xa5f7bf80,0x3f35bf35
.long 0x3f80a60d,0x3f003f5e,0xbf003f5e,0xbf80272c,0xbf80272c,0xbe85bf77,0x3f5ebf00,0x3f353f35,0x3f80a654,0xa68d3f80,0xbf802677,0xa7e1bf80,0xbf802677,0x3e85bf77,0x3f5e3f00,0xbf353f35
.long 0x3f80a68d,0xbf003f5e,0xbf00bf5e,0x3f80a7ac,0xbf80269f,0x3f35bf35,0xa60d3f80,0xbf35bf35,0x3f80a7ac,0xbf5e3f00,0x3f00bf5e,0xa58e3f80,0xbf80a71f,0x3f77be85,0xbf5e3f00,0x3f35bf35
.long 0x3f80a6d4,0xbf80a70d,0x3f80a6f7,0xbf802861,0xbf8027b9,0x3f773e85,0xbf5ebf00,0x3f353f35,0x3f80a6f7,0xbf5ebf00,0x3f003f5e,0xa847bf80,0xbf80a6f7,0x3f353f35,0x2766bf80,0xbf353f35
.long 0x3f80a70d,0xbf00bf5e,0xbf003f5e,0x3f80a82c,0xbf8027cb,0x3e853f77,0x3f5ebf00,0xbf35bf35,0x3f80a71f,0xa796bf80,0xbf80a68d,0x268d3f80,0xbf8027d4,0xbe853f77,0x3f5e3f00,0x3f35bf35
.long 0x3f80a82c,0x3f00bf5e,0xbf00bf5e,0xbf80a60e,0xbf80a68d,0xbf353f35,0xa7d43f80,0x3f353f35,0x3f80279f,0x3f5ebf00,0x3f00bf5e,0xa85dbf80,0xbf8027e5,0xbf773e85,0xbf5e3f00,0xbf353f35
.long 0x0,0x0,0x0,0x0,0x0,0x0,0x0,0x0,0x0,0x0,0x0,0x0,0x0,0x0,0x0,0x0
.long 0x0,0x0,0x0,0x0,0x0,0x0,0x0,0x0,0x0,0x0,0x0,0x0,0x0,0x0,0x0,0x0
.long 0x3f800000,0x3f800000,0x3f800000,0x3f800000,0xbf00bf5e,0xbe85bf77,0xa554bf80,0x3e85bf77,0xbf003f5e,0xbf5e3f00,0xbf8025d4,0xbf5ebf00,0x3f80a60d,0x3f353f35,0x261f3f80,0xbf353f35
.long 0xbf00bf5e,0x3f00bf5e,0x3f80a654,0x3f003f5e,0xbf003f5e,0xbf77be85,0x2677bf80,0x3f77be85,0x3f80a68d,0xa79a3f80,0xbf80269f,0xa754bf80,0xbf00bf5e,0x3f77be85,0xa60d3f80,0xbf77be85
.long 0xbf003f5e,0xbf00bf5e,0x3f80a6d4,0xbf003f5e,0x3f80a6d4,0xbf353f35,0xa777bf80,0x3f353f35,0xbf00bf5e,0x3f5e3f00,0xbf80a6f7,0x3f5ebf00,0xbf003f5e,0x3e85bf77,0x258d3f80,0xbe85bf77
.long 0x3f80a70d,0xbf80a81a,0x3f80a71f,0xbf8027d4,0xbf00bf5e,0x3e853f77,0xa796bf80,0xbe853f77,0xbf003f5e,0x3f5ebf00,0xbf80a68d,0x3f5e3f00,0x3f80a82c,0xbf35bf35,0x268d3f80,0x3f35bf35
.long 0xbf00bf5e,0xbf003f5e,0x3f80a754,0xbf00bf5e,0xbf003f5e,0x3f773e85,0xa7b1bf80,0xbf773e85,0x3f80a754,0xa7b1bf80,0xbf8027f7,0x281f3f80,0xbf00bf5e,0xbf773e85,0x281f3f80,0x3f773e85
.long 0xbf003f5e,0x3f003f5e,0x3f802777,0x3f00bf5e,0x3f80a777,0x3f35bf35,0x26d4bf80,0xbf35bf35,0xbf00bf5e,0xbf5ebf00,0xbf80260d,0xbf5e3f00,0xbf003f5e,0xbe853f77,0x28963f80,0x3e853f77
.long 0x0,0x0,0x0,0x0,0x0,0x0,0x0,0x0,0x0,0x0,0x0,0x0,0x0,0x0,0x0,0x0
.long 0x0,0x0,0x0,0x0,0x0,0x0,0x0,0x0,0x0,0x0,0x0,0x0,0x0,0x0,0x0,0x0
.long 0x3f800000,0x3f800000,0x3f800000,0x3f800000,0x3f00bf5e,0x3f35bf35,0x3f5ebf00,0x3f77be85,0xbf00bf5e,0xa5f7bf80,0x3f00bf5e,0x3f5ebf00,0xbf80272c,0xbf35bf35,0xa731bf80,0x3f35bf35
.long 0xbf003f5e,0xbf802677,0xbf00bf5e,0x3f00bf5e,0x3f003f5e,0xbf353f35,0xbf5ebf00,0x3e85bf77,0x3f80a7ac,0xa60d3f80,0xbf8027b1,0xa765bf80,0x3f00bf5e,0x3f353f35,0xbf5e3f00,0xbe85bf77
.long 0xbf00bf5e,0x3f80a6f7,0xbf003f5e,0xbf00bf5e,0xbf80a6f7,0x3f35bf35,0x28043f80,0xbf35bf35,0xbf003f5e,0x2766bf80,0x3f003f5e,0xbf5ebf00,0x3f003f5e,0xbf35bf35,0x3f5e3f00,0xbf77be85
.long 0x3f80a82c,0xbf80a68d,0x3f80a831,0xbf8027e5,0x3f00bf5e,0xbf353f35,0x3f5ebf00,0xbf773e85,0xbf00bf5e,0xa7d43f80,0x3f00bf5e,0xbf5e3f00,0xbf80a60e,0x3f353f35,0xa85dbf80,0xbf353f35
.long 0xbf003f5e,0x3f80a777,0xbf00bf5e,0xbf003f5e,0x3f003f5e,0x3f35bf35,0xbf5ebf00,0xbe853f77,0x3f802777,0x26d4bf80,0xbf802884,0x28963f80,0x3f00bf5e,0xbf35bf35,0xbf5e3f00,0x3e853f77
.long 0xbf00bf5e,0xbf80a7e6,0xbf003f5e,0x3f003f5e,0xbf80a7e6,0xbf353f35,0x289a3f80,0x3f353f35,0xbf003f5e,0x27543f80,0x3f003f5e,0x3f5e3f00,0x3f003f5e,0x3f353f35,0x3f5e3f00,0x3f773e85
.long 0x0,0x0,0x0,0x0,0x0,0x0,0x0,0x0,0x0,0x0,0x0,0x0,0x0,0x0,0x0,0x0
.long 0x0,0x0,0x0,0x0,0x0,0x0,0x0,0x0,0x0,0x0,0x0,0x0,0x0,0x0,0x0,0x0
.long 0x35638e39,0x35638e39,0x35638e39,0x35638e39,0x35638e39,0x35638ac2,0x3563805c,0x35636f08,0x35638e39,0x3563805c,0x356356c7,0x3563117f,0x35638e39,0x35636f08,0x3563117f,0x356275b6
.long 0x35638e39,0x356356c7,0x3562b08c,0x35619bd9,0x35638e39,0x35633799,0x356233fb,0x35608424,0x35638e39,0x3563117f,0x35619bd9,0x355f2ee2,0x35638e39,0x3562e47a,0x3560e83b,0x355d9c72
.long 0x35638e39,0x3562b08c,0x35601936,0x355bcd42,0x35638e39,0x356275b6,0x355f2ee2,0x3559c1d1,0x35638e39,0x356233fb,0x355e295d,0x35577aae,0x35638e39,0x3561eb5b,0x355d08c7,0x3554f879
.long 0x35638e39,0x35619bd9,0x355bcd42,0x35523be2,0x35638e39,0x35614579,0x355a76f5,0x354f45aa,0x35638e39,0x3560e83b,0x3559060a,0x354c16a0,0x35638e39,0x35608424,0x35577aae,0x3548afa3
.long 0x35638e39,0x35601936,0x3555d510,0x354511a3,0x35638e39,0x355fa774,0x35541565,0x35413d9d,0x35638e39,0x355f2ee2,0x35523be2,0x353d349e,0x35638e39,0x355eaf84,0x355048c2,0x3538f7c0
.long 0x35638e39,0x355e295d,0x354e3c41,0x3534882f,0x35638e39,0x355d9c72,0x354c16a0,0x352fe71f,0x35638e39,0x355d08c7,0x3549d820,0x352b15d8,0x35638e39,0x355c6e60,0x35478109,0x352615aa
.long 0x0,0x0,0x0,0x0,0x0,0x0,0x0,0x0,0x0,0x0,0x0,0x0,0x0,0x0,0x0,0x0
.long 0x0,0x0,0x0,0x0,0x0,0x0,0x0,0x0,0x0,0x0,0x0,0x0,0x0,0x0,0x0,0x0
.long 0x35638e39,0x35638e39,0x35638e39,0x35638e39,0x356356c7,0x35633799,0x3563117f,0x3562e47a,0x3562b08c,0x356233fb,0x35619bd9,0x3560e83b,0x35619bd9,0x35608424,0x355f2ee2,0x355d9c72
.long 0x35601936,0x355e295d,0x355bcd42,0x3559060a,0x355e295d,0x355b2572,0x35577aae,0x35532bdb,0x355bcd42,0x35577aae,0x35523be2,0x354c16a0,0x3559060a,0x35532bdb,0x354c16a0,0x3543d0ea
.long 0x3555d510,0x354e3c41,0x354511a3,0x353a6711,0x35523be2,0x3548afa3,0x353d349e,0x352fe71f,0x354e3c41,0x35428a3a,0x3534882f,0x352460c0,0x3549d820,0x353bd0b3,0x352b15d8,0x3517e525
.long 0x354511a3,0x3534882f,0x3520e7f5,0x350a86ec,0x353feb1d,0x352cb637,0x351609ad,0x34f8b412,0x353a6711,0x352460c0,0x350a86ec,0x34dae741,0x3534882f,0x351b8e23,0x34fcd8a0,0x34bbd3db
.long 0x352e5153,0x35124518,0x34e38e39,0x349ba83c,0x3527c585,0x35088caf,0x34c94a5e,0x347528c8,0x3520e7f5,0x34fcd8a0,0x34ae29da,0x34319357,0x3519bbfb,0x34e7d760,0x34924a69,0x33d9e9f2
.long 0x35124518,0x34d2259d,0x346b9535,0x331ed037,0x350a86ec,0x34bbd3db,0x34319357,0xb2ee40cb,0x35028540,0x34a4f318,0x33ed9d9d,0xb3c62fa4,0x34f487f1,0x348d94bf,0x336e2023,0xb427d3b5
.long 0x0,0x0,0x0,0x0,0x0,0x0,0x0,0x0,0x0,0x0,0x0,0x0,0x0,0x0,0x0,0x0
.long 0x0,0x0,0x0,0x0,0x0,0x0,0x0,0x0,0x0,0x0,0x0,0x0,0x0,0x0,0x0,0x0
.long 0x35638e39,0x35638e39,0x35638e39,0x35638e39,0x3562b08c,0x356275b6,0x356233fb,0x3561eb5b,0x35601936,0x355f2ee2,0x355e295d,0x355d08c7,0x355bcd42,0x3559c1d1,0x35577aae,0x3554f879
.long 0x3555d510,0x35523be2,0x354e3c41,0x3549d820,0x354e3c41,0x3548afa3,0x35428a3a,0x353bd0b3,0x354511a3,0x353d349e,0x3534882f,0x352b15d8,0x353a6711,0x352fe71f,0x352460c0,0x3517e525
.long 0x352e5153,0x3520e7f5,0x35124518,0x35028540,0x3520e7f5,0x35105c16,0x34fcd8a0,0x34d689b3,0x35124518,0x34fcd8a0,0x34d2259d,0x34a4f318,0x35028540,0x34d689b3,0x34a4f318,0x3461fa76
.long 0x34e38e39,0x34ae29da,0x346b9535,0x33ed9d9d,0x34c05699,0x34841c9e,0x340a7751,0x321edc50,0x349ba83c,0x34319357,0x331ed037,0xb3c62fa4,0x346b9535,0x33b26f4c,0xb36e2023,0xb44eb09b
.long 0x341e0ef5,0x1a7b021f,0xb41e0ef5,0xb49ba83c,0x339ea985,0xb3b26f4c,0xb47eb4e3,0xb4cdbb20,0x1a7b021f,0xb4319357,0xb4ae29da,0xb4fcd8a0,0xb39ea985,0xb4841c9e,0xb4dae741,0xb51429a4
.long 0xb41e0ef5,0xb4ae29da,0xb5028540,0xb527c585,0xb46b9535,0xb4d689b3,0xb51609ad,0xb538f7c0,0xb49ba83c,0xb4fcd8a0,0xb527c585,0xb5478109,0xb4c05699,0xb5105c16,0xb53782ce,0xb5532bdb
.long 0x0,0x0,0x0,0x0,0x0,0x0,0x0,0x0,0x0,0x0,0x0,0x0,0x0,0x0,0x0,0x0
.long 0x0,0x0,0x0,0x0,0x0,0x0,0x0,0x0,0x0,0x0,0x0,0x0,0x0,0x0,0x0,0x0
.long 0x35638e39,0x35638e39,0x35638e39,0x35638e39,0x35619bd9,0x35614579,0x3560e83b,0x35608424,0x355bcd42,0x355a76f5,0x3559060a,0x35577aae,0x35523be2,0x354f45aa,0x354c16a0,0x3548afa3
.long 0x354511a3,0x353feb1d,0x353a6711,0x3534882f,0x3534882f,0x352cb637,0x352460c0,0x351b8e23,0x3520e7f5,0x351609ad,0x350a86ec,0x34fcd8a0,0x350a86ec,0x34f8b412,0x34dae741,0x34bbd3db
.long 0x34e38e39,0x34c05699,0x349ba83c,0x346b9535,0x34ae29da,0x34841c9e,0x34319357,0x33b26f4c,0x346b9535,0x340a7751,0x331ed037,0xb36e2023,0x33ed9d9d,0x321edc50,0xb3c62fa4,0xb44eb09b
.long 0x1a7b021f,0xb3ed9d9d,0xb46b9535,0xb4ae29da,0xb3ed9d9d,0xb47528c8,0xb4b74b64,0xb4f0545d,0xb46b9535,0xb4b74b64,0xb4f487f1,0xb51609ad,0xb4ae29da,0xb4f0545d,0xb51609ad,0xb52fe71f
.long 0xb4e38e39,0xb5124518,0xb52e5153,0xb54511a3,0xb50a86ec,0xb5297043,0xb5428a3a,0xb554f879,0xb520e7f5,0xb53d349e,0xb5523be2,0xb55f2ee2,0xb534882f,0xb54d2c91,0xb55d08c7,0xb5636f08
.long 0xb54511a3,0xb559060a,0xb562b08c,0xb5619bd9,0xb5523be2,0xb5608424,0xb563117f,0xb559c1d1,0xb55bcd42,0xb563805c,0xb55e295d,0xb54c16a0,0xb5619bd9,0xb561eb5b,0xb5541565,0xb538f7c0
.long 0x0,0x0,0x0,0x0,0x0,0x0,0x0,0x0,0x0,0x0,0x0,0x0,0x0,0x0,0x0,0x0
.long 0x0,0x0,0x0,0x0,0x0,0x0,0x0,0x0,0x0,0x0,0x0,0x0,0x0,0x0,0x0,0x0
.long 0x35638e39,0x35638e39,0x35638e39,0x35638e39,0x35601936,0x355fa774,0x355f2ee2,0x355eaf84,0x3555d510,0x35541565,0x35523be2,0x355048c2,0x354511a3,0x35413d9d,0x353d349e,0x3538f7c0
.long 0x352e5153,0x3527c585,0x3520e7f5,0x3519bbfb,0x35124518,0x35088caf,0x34fcd8a0,0x34e7d760,0x34e38e39,0x34c94a5e,0x34ae29da,0x34924a69,0x349ba83c,0x347528c8,0x34319357,0x33d9e9f2
.long 0x341e0ef5,0x339ea985,0x1a7b021f,0xb39ea985,0x1a7b021f,0xb3b26f4c,0xb4319357,0xb4841c9e,0xb41e0ef5,0xb47eb4e3,0xb4ae29da,0xb4dae741,0xb49ba83c,0xb4cdbb20,0xb4fcd8a0,0xb51429a4
.long 0xb4e38e39,0xb50a86ec,0xb520e7f5,0xb534882f,0xb5124518,0xb5297043,0xb53d349e,0xb54d2c91,0xb52e5153,0xb5428a3a,0xb5523be2,0xb55d08c7,0xb54511a3,0xb554f879,0xb55f2ee2,0xb5636f08
.long 0xb555d510,0xb5601936,0xb5638e39,0xb5601936,0xb5601936,0xb5638ac2,0xb55f2ee2,0xb5532bdb,0xb5638e39,0xb55f2ee2,0xb5523be2,0xb53d349e,0xb5601936,0xb5532bdb,0xb53d349e,0xb51f242e
.long 0xb555d510,0xb53feb1d,0xb520e7f5,0xb4f487f1,0xb54511a3,0xb52615aa,0xb4fcd8a0,0xb4a0501b,0xb52e5153,0xb5068e49,0xb4ae29da,0xb40a7751,0xb5124518,0xb4c4d37b,0xb4319357,0x33467b33
.long 0x0,0x0,0x0,0x0,0x0,0x0,0x0,0x0,0x0,0x0,0x0,0x0,0x0,0x0,0x0,0x0
.long 0x0,0x0,0x0,0x0,0x0,0x0,0x0,0x0,0x0,0x0,0x0,0x0,0x0,0x0,0x0,0x0
.long 0x35638e39,0x35638e39,0x35638e39,0x35638e39,0x355e295d,0x355d9c72,0x355d08c7,0x355c6e60,0x354e3c41,0x354c16a0,0x3549d820,0x35478109,0x3534882f,0x352fe71f,0x352b15d8,0x352615aa
.long 0x35124518,0x350a86ec,0x35028540,0x34f487f1,0x34d2259d,0x34bbd3db,0x34a4f318,0x348d94bf,0x346b9535,0x34319357,0x33ed9d9d,0x336e2023,0x331ed037,0xb2ee40cb,0xb3c62fa4,0xb427d3b5
.long 0xb41e0ef5,0xb46b9535,0xb49ba83c,0xb4c05699,0xb4ae29da,0xb4d689b3,0xb4fcd8a0,0xb5105c16,0xb5028540,0xb51609ad,0xb527c585,0xb53782ce,0xb527c585,0xb538f7c0,0xb5478109,0xb5532bdb
.long 0xb54511a3,0xb5523be2,0xb55bcd42,0xb5619bd9,0xb559060a,0xb5608424,0xb563805c,0xb561eb5b,0xb562b08c,0xb563117f,0xb55e295d,0xb5541565,0xb5619bd9,0xb559c1d1,0xb54c16a0,0xb538f7c0
.long 0xb555d510,0xb54511a3,0xb52e5153,0xb5124518,0xb53feb1d,0xb52615aa,0xb5068e49,0xb4c4d37b,0xb520e7f5,0xb4fcd8a0,0xb4ae29da,0xb4319357,0xb4f487f1,0xb4a0501b,0xb40a7751,0x33467b33
.long 0xb49ba83c,0xb3ed9d9d,0x339ea985,0x3488dac4,0xb3ed9d9d,0x33b26f4c,0x34924a69,0x34f0545d,0x339ea985,0x34924a69,0x34f487f1,0x352460c0,0x3488dac4,0x34f0545d,0x352460c0,0x35464c5b
.long 0x0,0x0,0x0,0x0,0x0,0x0,0x0,0x0,0x0,0x0,0x0,0x0,0x0,0x0,0x0,0x0
.long 0x0,0x0,0x0,0x0,0x0,0x0,0x0,0x0,0x0,0x0,0x0,0x0,0x0,0x0,0x0,0x0
.long 0x80000000,0x80000000,0x80000000,0x80000000,0x80000000,0xb21edc50,0xb29ed9e5,0xb2ee40cb,0x80000000,0xb29ed9e5,0xb31ed037,0xb36e2023,0x80000000,0xb2ee40cb,0xb36e2023,0xb3b26f4c
.long 0x80000000,0xb31ed037,0xb39ea985,0xb3ed9d9d,0x80000000,0xb3467b33,0xb3c62fa4,0xb4144565,0x80000000,0xb36e2023,0xb3ed9d9d,0xb4319357,0x80000000,0xb38adee9,0xb40a7751,0xb44eb09b
.long 0x80000000,0xb39ea985,0xb41e0ef5,0xb46b9535,0x80000000,0xb3b26f4c,0xb4319357,0xb4841c9e,0x80000000,0xb3c62fa4,0xb4450216,0xb4924a69,0x80000000,0xb3d9e9f2,0xb45858d4,0xb4a0501b
.long 0x80000000,0xb3ed9d9d,0xb46b9535,0xb4ae29da,0x80000000,0xb400a506,0xb47eb4e3,0xb4bbd3db,0x80000000,0xb40a7751,0xb488dac4,0xb4c94a5e,0x80000000,0xb4144565,0xb4924a69,0xb4d689b3
.long 0x80000000,0xb41e0ef5,0xb49ba83c,0xb4e38e39,0x80000000,0xb427d3b5,0xb4a4f318,0xb4f0545d,0x80000000,0xb4319357,0xb4ae29da,0xb4fcd8a0,0x80000000,0xb43b4d91,0xb4b74b64,0xb5048bc9
.long 0x80000000,0xb4450216,0xb4c05699,0xb50a86ec,0x80000000,0xb44eb09b,0xb4c94a5e,0xb5105c16,0x80000000,0xb45858d4,0xb4d2259d,0xb51609ad,0x80000000,0xb461fa76,0xb4dae741,0xb51b8e23
.long 0x0,0x0,0x0,0x0,0x0,0x0,0x0,0x0,0x0,0x0,0x0,0x0,0x0,0x0,0x0,0x0
.long 0x0,0x0,0x0,0x0,0x0,0x0,0x0,0x0,0x0,0x0,0x0,0x0,0x0,0x0,0x0,0x0
.long 0x80000000,0x80000000,0x80000000,0x80000000,0xb31ed037,0xb3467b33,0xb36e2023,0xb38adee9,0xb39ea985,0xb3c62fa4,0xb3ed9d9d,0xb40a7751,0xb3ed9d9d,0xb4144565,0xb4319357,0xb44eb09b
.long 0xb41e0ef5,0xb4450216,0xb46b9535,0xb488dac4,0xb4450216,0xb47528c8,0xb4924a69,0xb4a9910e,0xb46b9535,0xb4924a69,0xb4ae29da,0xb4c94a5e,0xb488dac4,0xb4a9910e,0xb4c94a5e,0xb4e7d760
.long 0xb49ba83c,0xb4c05699,0xb4e38e39,0xb5028540,0xb4ae29da,0xb4d689b3,0xb4fcd8a0,0xb5105c16,0xb4c05699,0xb4ec1977,0xb50a86ec,0xb51d5b8e,0xb4d2259d,0xb5007abd,0xb51609ad,0xb5297043
.long 0xb4e38e39,0xb50a86ec,0xb520e7f5,0xb534882f,0xb4f487f1,0xb51429a4,0xb52b15d8,0xb53e92c4,0xb5028540,0xb51d5b8e,0xb534882f,0xb5478109,0xb50a86ec,0xb52615aa,0xb53d349e,0xb54f45aa
.long 0xb5124518,0xb52e5153,0xb54511a3,0xb555d510,0xb519bbfb,0xb5360844,0xb54c16a0,0xb55b2572,0xb520e7f5,0xb53d349e,0xb5523be2,0xb55f2ee2,0xb527c585,0xb543d0ea,0xb5577aae,0xb561eb5b
.long 0xb52e5153,0xb549d820,0xb55bcd42,0xb56356c7,0xb534882f,0xb54f45aa,0xb55f2ee2,0xb5636f08,0xb53a6711,0xb5541565,0xb5619bd9,0xb56233fb,0xb53feb1d,0xb55843a7,0xb563117f,0xb55fa774
.long 0x0,0x0,0x0,0x0,0x0,0x0,0x0,0x0,0x0,0x0,0x0,0x0,0x0,0x0,0x0,0x0
.long 0x0,0x0,0x0,0x0,0x0,0x0,0x0,0x0,0x0,0x0,0x0,0x0,0x0,0x0,0x0,0x0
.long 0x80000000,0x80000000,0x80000000,0x80000000,0xb39ea985,0xb3b26f4c,0xb3c62fa4,0xb3d9e9f2,0xb41e0ef5,0xb4319357,0xb4450216,0xb45858d4,0xb46b9535,0xb4841c9e,0xb4924a69,0xb4a0501b
.long 0xb49ba83c,0xb4ae29da,0xb4c05699,0xb4d2259d,0xb4c05699,0xb4d689b3,0xb4ec1977,0xb5007abd,0xb4e38e39,0xb4fcd8a0,0xb50a86ec,0xb51609ad,0xb5028540,0xb5105c16,0xb51d5b8e,0xb5297043
.long 0xb5124518,0xb520e7f5,0xb52e5153,0xb53a6711,0xb520e7f5,0xb52fe71f,0xb53d349e,0xb548afa3,0xb52e5153,0xb53d349e,0xb549d820,0xb5541565,0xb53a6711,0xb548afa3,0xb5541565,0xb55c6e60
.long 0xb54511a3,0xb5523be2,0xb55bcd42,0xb5619bd9,0xb54e3c41,0xb559c1d1,0xb560e83b,0xb5638ac2,0xb555d510,0xb55f2ee2,0xb56356c7,0xb56233fb,0xb55bcd42,0xb56275b6,0xb563117f,0xb55d9c72
.long 0xb5601936,0xb5638e39,0xb5601936,0xb555d510,0xb562b08c,0xb56275b6,0xb55a76f5,0xb54afa77,0xb5638e39,0xb55f2ee2,0xb5523be2,0xb53d349e,0xb562b08c,0xb559c1d1,0xb5478109,0xb52cb637
.long 0xb5601936,0xb5523be2,0xb53a6711,0xb519bbfb,0xb55bcd42,0xb548afa3,0xb52b15d8,0xb5048bc9,0xb555d510,0xb53d349e,0xb519bbfb,0xb4dae741,0xb54e3c41,0xb52fe71f,0xb5068e49,0xb4a9910e
.long 0x0,0x0,0x0,0x0,0x0,0x0,0x0,0x0,0x0,0x0,0x0,0x0,0x0,0x0,0x0,0x0
.long 0x0,0x0,0x0,0x0,0x0,0x0,0x0,0x0,0x0,0x0,0x0,0x0,0x0,0x0,0x0,0x0
.long 0x80000000,0x80000000,0x80000000,0x80000000,0xb3ed9d9d,0xb400a506,0xb40a7751,0xb4144565,0xb46b9535,0xb47eb4e3,0xb488dac4,0xb4924a69,0xb4ae29da,0xb4bbd3db,0xb4c94a5e,0xb4d689b3
.long 0xb4e38e39,0xb4f487f1,0xb5028540,0xb50a86ec,0xb50a86ec,0xb51429a4,0xb51d5b8e,0xb52615aa,0xb520e7f5,0xb52b15d8,0xb534882f,0xb53d349e,0xb534882f,0xb53e92c4,0xb5478109,0xb54f45aa
.long 0xb54511a3,0xb54e3c41,0xb555d510,0xb55bcd42,0xb5523be2,0xb559c1d1,0xb55f2ee2,0xb56275b6,0xb55bcd42,0xb560e83b,0xb56356c7,0xb563117f,0xb5619bd9,0xb5638ac2,0xb56233fb,0xb55d9c72
.long 0xb5638e39,0xb5619bd9,0xb55bcd42,0xb5523be2,0xb5619bd9,0xb55b2572,0xb55048c2,0xb5413d9d,0xb55bcd42,0xb55048c2,0xb53feb1d,0xb52b15d8,0xb5523be2,0xb5413d9d,0xb52b15d8,0xb5105c16
.long 0xb54511a3,0xb52e5153,0xb5124518,0xb4e38e39,0xb534882f,0xb517e525,0xb4ec1977,0xb4a0501b,0xb520e7f5,0xb4fcd8a0,0xb4ae29da,0xb4319357,0xb50a86ec,0xb4c4d37b,0xb45858d4,0xb2ee40cb
.long 0xb4e38e39,0xb488dac4,0xb39ea985,0x33ed9d9d,0xb4ae29da,0xb4144565,0x336e2023,0x34841c9e,0xb46b9535,0xb29ed9e5,0x34450216,0x34c94a5e,0xb3ed9d9d,0x33d9e9f2,0x34a4f318,0x35048bc9
.long 0x0,0x0,0x0,0x0,0x0,0x0,0x0,0x0,0x0,0x0,0x0,0x0,0x0,0x0,0x0,0x0
.long 0x0,0x0,0x0,0x0,0x0,0x0,0x0,0x0,0x0,0x0,0x0,0x0,0x0,0x0,0x0,0x0
.long 0x80000000,0x80000000,0x80000000,0x80000000,0xb41e0ef5,0xb427d3b5,0xb4319357,0xb43b4d91,0xb49ba83c,0xb4a4f318,0xb4ae29da,0xb4b74b64,0xb4e38e39,0xb4f0545d,0xb4fcd8a0,0xb5048bc9
.long 0xb5124518,0xb519bbfb,0xb520e7f5,0xb527c585,0xb52e5153,0xb5360844,0xb53d349e,0xb543d0ea,0xb54511a3,0xb54c16a0,0xb5523be2,0xb5577aae,0xb555d510,0xb55b2572,0xb55f2ee2,0xb561eb5b
.long 0xb5601936,0xb562b08c,0xb5638e39,0xb562b08c,0xb5638e39,0xb56275b6,0xb55f2ee2,0xb559c1d1,0xb5601936,0xb55a76f5,0xb5523be2,0xb5478109,0xb555d510,0xb54afa77,0xb53d349e,0xb52cb637
.long 0xb54511a3,0xb534882f,0xb520e7f5,0xb50a86ec,0xb52e5153,0xb517e525,0xb4fcd8a0,0xb4c4d37b,0xb5124518,0xb4ec1977,0xb4ae29da,0xb45858d4,0xb4e38e39,0xb4a0501b,0xb4319357,0xb2ee40cb
.long 0xb49ba83c,0xb41e0ef5,0x9afb021f,0x341e0ef5,0xb41e0ef5,0x321edc50,0x34319357,0x34a9910e,0x9afb021f,0x34319357,0x34ae29da,0x34fcd8a0,0x341e0ef5,0x34a9910e,0x34fcd8a0,0x3522a6d5
.long 0x349ba83c,0x34f487f1,0x3520e7f5,0x353feb1d,0x34e38e39,0x351b8e23,0x353d349e,0x3554f879,0x35124518,0x353782ce,0x35523be2,0x3560e83b,0x352e5153,0x354d2c91,0x355f2ee2,0x35633799
.long 0x0,0x0,0x0,0x0,0x0,0x0,0x0,0x0,0x0,0x0,0x0,0x0,0x0,0x0,0x0,0x0
.long 0x0,0x0,0x0,0x0,0x0,0x0,0x0,0x0,0x0,0x0,0x0,0x0,0x0,0x0,0x0,0x0
.long 0x80000000,0x80000000,0x80000000,0x80000000,0xb4450216,0xb44eb09b,0xb45858d4,0xb461fa76,0xb4c05699,0xb4c94a5e,0xb4d2259d,0xb4dae741,0xb50a86ec,0xb5105c16,0xb51609ad,0xb51b8e23
.long 0xb52e5153,0xb534882f,0xb53a6711,0xb53feb1d,0xb549d820,0xb54f45aa,0xb5541565,0xb55843a7,0xb55bcd42,0xb55f2ee2,0xb5619bd9,0xb563117f,0xb56356c7,0xb5636f08,0xb56233fb,0xb55fa774
.long 0xb5601936,0xb55bcd42,0xb555d510,0xb54e3c41,0xb5523be2,0xb548afa3,0xb53d349e,0xb52fe71f,0xb53a6711,0xb52b15d8,0xb519bbfb,0xb5068e49,0xb519bbfb,0xb5048bc9,0xb4dae741,0xb4a9910e
.long 0xb4e38e39,0xb4ae29da,0xb46b9535,0xb3ed9d9d,0xb488dac4,0xb4144565,0xb29ed9e5,0x33d9e9f2,0xb39ea985,0x336e2023,0x34450216,0x34a4f318,0x33ed9d9d,0x34841c9e,0x34c94a5e,0x35048bc9
.long 0x349ba83c,0x34e38e39,0x35124518,0x352e5153,0x34f487f1,0x351b8e23,0x353782ce,0x354d2c91,0x3520e7f5,0x353d349e,0x35523be2,0x355f2ee2,0x353feb1d,0x3554f879,0x3560e83b,0x35633799
.long 0x3555d510,0x35619bd9,0x3562b08c,0x3559060a,0x35619bd9,0x356275b6,0x35577aae,0x35413d9d,0x3562b08c,0x35577aae,0x353feb1d,0x351d5b8e,0x3559060a,0x35413d9d,0x351d5b8e,0x34df3e23
.long 0x0,0x0,0x0,0x0,0x0,0x0,0x0,0x0,0x0,0x0,0x0,0x0,0x0,0x0,0x0,0x0
.long 0x0,0x0,0x0,0x0,0x0,0x0,0x0,0x0,0x0,0x0,0x0,0x0,0x0,0x0,0x0,0x0
.long 0x3f003f00,0x3f003f00,0x3f003f00,0x3f003f00,0xbf003f00,0xbee63f0c,0xbec93f17,0xbeab3f20,0x3f003f00,0x3f173ec9,0x3f273e8b,0x3f323e0d,0xbf003f00,0xbeab3f20,0xbe0d3f32,0x3d8e3f34
.long 0x3f003f00,0x3f273e8b,0x3f352480,0x3f27be8b,0xbf003f00,0xbe523f2d,0x3e0d3f32,0x3ee63f0c,0x3f003f00,0x3f323e0d,0x3f27be8b,0x3ec9bf17,0xbf003f00,0xbd8e3f34,0x3ec93f17,0x3f2d3e52
.long 0x3f003f00,0x3f352480,0x3f00bf00,0x2480bf35,0xbf003f00,0x3d8e3f34,0x3f173ec9,0x3f2dbe52,0x3f003f00,0x3f32be0d,0x3e8bbf27,0xbec9bf17,0xbf003f00,0x3e523f2d,0x3f323e0d,0x3ee6bf0c
.long 0x3f003f00,0x3f27be8b,0x2480bf35,0xbf27be8b,0xbf003f00,0x3eab3f20,0x3f32be0d,0x3d8ebf34,0x3f003f00,0x3f17bec9,0xbe8bbf27,0xbf323e0d,0xbf003f00,0x3ee63f0c,0x3f17bec9,0xbeabbf20
.long 0x3f003f00,0x3f00bf00,0xbf00bf00,0xbf003f00,0xbf003f00,0x3f0c3ee6,0x3ec9bf17,0xbf20beab,0x3f003f00,0x3ec9bf17,0xbf27be8b,0xbe0d3f32,0xbf003f00,0x3f203eab,0x3e0dbf32,0xbf343d8e
.long 0x3f003f00,0x3e8bbf27,0xbf35a500,0x3e8b3f27,0xbf003f00,0x3f2d3e52,0xbe0dbf32,0xbf0c3ee6,0x3f003f00,0x3e0dbf32,0xbf273e8b,0x3f173ec9,0xbf003f00,0x3f343d8e,0xbec9bf17,0xbe523f2d
.long 0x3f003f00,0x2480bf35,0xbf003f00,0x3f352540,0xbf003f00,0x3f34bd8e,0xbf17bec9,0x3e523f2d,0x3f003f00,0xbe0dbf32,0xbe8b3f27,0x3f17bec9,0xbf003f00,0x3f2dbe52,0xbf32be0d,0x3f0c3ee6
.long 0x3f003f00,0xbe8bbf27,0xa5403f35,0x3e8bbf27,0xbf003f00,0x3f20beab,0xbf323e0d,0x3f343d8e,0x3f003f00,0xbec9bf17,0x3e8b3f27,0xbe0dbf32,0xbf003f00,0x3f0cbee6,0xbf173ec9,0x3f20beab
.long 0x3f003f00,0x3f003f00,0x3f003f00,0x3f003f00,0xbe8b3f27,0xbe523f2d,0xbe0d3f32,0xbd8e3f34,0x3f352480,0x3f32be0d,0x3f27be8b,0x3f17bec9,0x3e8b3f27,0x3ee63f0c,0x3f173ec9,0x3f2d3e52
.long 0x3f00bf00,0x3e8bbf27,0x2480bf35,0xbe8bbf27,0x3f273e8b,0x3f34bd8e,0x3f17bec9,0x3eabbf20,0x2480bf35,0xbec9bf17,0xbf27be8b,0xbf323e0d,0x3f27be8b,0x3eabbf20,0xbe0dbf32,0xbf0cbee6
.long 0xbf00bf00,0xbf35a500,0xbf003f00,0xa5403f35,0x3e8bbf27,0xbeabbf20,0xbf32be0d,0xbf0c3ee6,0xbf35a500,0xbec93f17,0x3e8b3f27,0x3f323e0d,0xbe8bbf27,0xbf34bd8e,0xbec93f17,0x3eab3f20
.long 0xbf003f00,0x3e8b3f27,0x3f352540,0x3e8bbf27,0xbf27be8b,0xbee63f0c,0x3ec93f17,0x3f2dbe52,0xa5403f35,0x3f323e0d,0x3e8bbf27,0xbf17bec9,0xbf273e8b,0x3e523f2d,0x3f32be0d,0xbd8ebf34
.long 0x3f003f00,0x3f00bf00,0xbf00bf00,0xbf003f00,0xbe8b3f27,0x3f2d3e52,0x3e0dbf32,0xbf34bd8e,0x3f352540,0xbe0dbf32,0xbf273e8b,0x3ec93f17,0x3e8b3f27,0x3f0cbee6,0xbf17bec9,0xbe523f2d
.long 0x3f00bf00,0xbf27be8b,0xa6883f35,0x3f27be8b,0x3f273e8b,0xbd8ebf34,0xbf173ec9,0x3f203eab,0x2670bf35,0xbf173ec9,0x3f273e8b,0xbe0dbf32,0x3f27be8b,0xbf20beab,0x3e0d3f32,0x3ee6bf0c
.long 0xbf00bf00,0xa6883f35,0x3f00bf00,0xbf352540,0x3e8bbf27,0xbf203eab,0x3f323e0d,0xbee6bf0c,0xbf3525e0,0x3f173ec9,0xbe8bbf27,0xbe0d3f32,0xbe8bbf27,0xbd8e3f34,0x3ec9bf17,0xbf203eab
.long 0xbf003f00,0x3f27be8b,0xbf352540,0x3f273e8b,0xbf27be8b,0x3f0c3ee6,0xbec9bf17,0x3e523f2d,0xa6883f35,0x3e0dbf32,0xbe8b3f27,0x3ec9bf17,0xbf273e8b,0x3f2dbe52,0xbf323e0d,0x3f34bd8e
.long 0x3f003f00,0x3f003f00,0x3f003f00,0x3f003f00,0xa4803f35,0x3d8e3f34,0x3e0d3f32,0x3e523f2d,0x3f00bf00,0x3ec9bf17,0x3e8bbf27,0x3e0dbf32,0x3f352480,0x3f2dbe52,0x3f17bec9,0x3ee6bf0c
.long 0xbf00bf00,0xbf27be8b,0xbf35a500,0xbf273e8b,0x2500bf35,0xbeabbf20,0xbf17bec9,0xbf34bd8e,0xbf003f00,0xbe0d3f32,0x3e8b3f27,0x3f173ec9,0xbf35a540,0xbf0c3ee6,0xbe0d3f32,0x3eab3f20
.long 0x3f003f00,0x3f352540,0x3f00bf00,0x2670bf35,0xa5403f35,0x3f0c3ee6,0x3f32be0d,0x3eabbf20,0x3f00bf00,0xbe0dbf32,0xbf27be8b,0xbf173ec9,0x3f352670,0x3eabbf20,0xbec9bf17,0xbf343d8e
.long 0xbf00bf00,0xbf273e8b,0xa6883f35,0x3f273e8b,0xa5e0bf35,0xbf2dbe52,0xbec93f17,0x3ee63f0c,0xbf003f00,0x3ec93f17,0x3f27be8b,0xbe0dbf32,0xbf35a688,0xbd8e3f34,0x3f323e0d,0x3e52bf2d
.long 0x3f003f00,0x3f00bf00,0xbf00bf00,0xbf003f00,0x25a03f35,0x3f34bd8e,0xbe0dbf32,0xbf2d3e52,0x3f00bf00,0xbf17bec9,0xbe8b3f27,0x3f323e0d,0x3f352698,0xbe52bf2d,0xbf173ec9,0x3f0c3ee6
.long 0xbf00bf00,0xbe8b3f27,0x3f35a480,0xbe8bbf27,0xa540bf35,0xbf203eab,0x3f173ec9,0x3d8ebf34,0xbf003f00,0x3f323e0d,0xbe8bbf27,0xbec93f17,0xbf35a6a8,0x3ee63f0c,0x3e0dbf32,0xbf203eab
.long 0x3f003f00,0x26a8bf35,0xbf003f00,0x3f35273c,0x24803f35,0x3ee6bf0c,0xbf323e0d,0x3f203eab,0x3f00bf00,0xbf323e0d,0x3f273e8b,0xbec9bf17,0x3f3526a8,0xbf20beab,0x3ec93f17,0xbd8ebf34
.long 0xbf00bf00,0x3e8b3f27,0x26c8bf35,0xbe8b3f27,0x8000bf35,0xbe523f2d,0x3ec9bf17,0xbf0c3ee6,0xbf003f00,0x3f17bec9,0xbf273e8b,0x3f32be0d,0xbf35a6b8,0x3f343d8e,0xbf32be0d,0x3f2d3e52
.long 0x3f003f00,0x3f003f00,0x3f003f00,0x3f003f00,0x3e8b3f27,0x3eab3f20,0x3ec93f17,0x3ee63f0c,0x2480bf35,0xbe0dbf32,0xbe8bbf27,0xbec9bf17,0x3e8bbf27,0x3d8ebf34,0xbe0dbf32,0xbeabbf20
.long 0xbf003f00,0xbe8b3f27,0xa5403f35,0x3e8b3f27,0xbf273e8b,0xbee63f0c,0xbe0d3f32,0x3e523f2d,0x3f352540,0x3f17bec9,0x3e8bbf27,0xbe0dbf32,0x3f273e8b,0x3f2dbe52,0x3ec9bf17,0xbd8ebf34
.long 0xbf00bf00,0xbf3525e0,0xbf003f00,0xa6883f35,0xbe8bbf27,0xbf2dbe52,0xbf173ec9,0xbd8e3f34,0xa6883f35,0x3f173ec9,0x3f27be8b,0x3e0dbf32,0xbe8b3f27,0x3ee63f0c,0x3f32be0d,0x3e52bf2d
.long 0x3f00bf00,0xbe8bbf27,0xbf352540,0xbe8b3f27,0x3f27be8b,0xbd8ebf34,0xbf32be0d,0xbeab3f20,0xbf352540,0xbe0d3f32,0x3f273e8b,0x3ec9bf17,0xbf27be8b,0xbeab3f20,0x3f173ec9,0x3ee6bf0c
.long 0x3f003f00,0x3f00bf00,0xbf00bf00,0xbf003f00,0x3e8b3f27,0x3f20beab,0xbec9bf17,0xbf0c3ee6,0x26a8bf35,0xbf323e0d,0x3e8b3f27,0x3f17bec9,0x3e8bbf27,0xbf34bd8e,0x3e0d3f32,0x3f20beab
.long 0xbf003f00,0x3f273e8b,0x26c8bf35,0xbf273e8b,0xbf273e8b,0x3f0c3ee6,0x3e0dbf32,0xbf2d3e52,0x3f352480,0xbec9bf17,0xbe8b3f27,0x3f32be0d,0x3f273e8b,0xbe52bf2d,0xbec93f17,0x3f34bd8e
.long 0xbf00bf00,0x26983f35,0x3f00bf00,0xbf35a7c2,0xbe8bbf27,0xbe523f2d,0x3f17bec9,0xbf34bd8e,0xa6d83f35,0x3ec9bf17,0xbf273e8b,0x3f323e0d,0xbe8b3f27,0x3f0cbee6,0xbf323e0d,0x3f2d3e52
.long 0x3f00bf00,0xbf273e8b,0x3f352754,0xbf27be8b,0x3f27be8b,0xbf343d8e,0x3f323e0d,0xbf20beab,0xbf35a5e0,0x3f323e0d,0xbf27be8b,0x3f173ec9,0xbf27be8b,0x3f203eab,0xbf17bec9,0x3f0c3ee6
.long 0x3f003f00,0x3f003f00,0x3f003f00,0x3f003f00,0x3f003f00,0x3f0c3ee6,0x3f173ec9,0x3f203eab,0xbf00bf00,0xbf17bec9,0xbf27be8b,0xbf32be0d,0xbf00bf00,0xbf20beab,0xbf32be0d,0xbf343d8e
.long 0x3f003f00,0x3f273e8b,0x3f352540,0x3f27be8b,0x3f003f00,0x3f2d3e52,0x3f32be0d,0x3f0cbee6,0xbf00bf00,0xbf32be0d,0xbf273e8b,0xbec93f17,0xbf00bf00,0xbf34bd8e,0xbf173ec9,0xbe523f2d
.long 0x3f003f00,0x3f35a5a0,0x3f00bf00,0x2698bf35,0x3f003f00,0x3f34bd8e,0x3ec9bf17,0xbe52bf2d,0xbf00bf00,0xbf323e0d,0xbe8b3f27,0x3ec93f17,0xbf00bf00,0xbf2d3e52,0xbe0d3f32,0x3f0c3ee6
.long 0x3f003f00,0x3f27be8b,0x26a8bf35,0xbf27be8b,0x3f003f00,0x3f20beab,0xbe0dbf32,0xbf34bd8e,0xbf00bf00,0xbf173ec9,0x3e8b3f27,0x3f32be0d,0xbf00bf00,0xbf0c3ee6,0x3ec93f17,0x3f20beab
.long 0x3f003f00,0x3f00bf00,0xbf00bf00,0xbf003f00,0x3f003f00,0x3ee6bf0c,0xbf17bec9,0xbeab3f20,0xbf00bf00,0xbec93f17,0x3f273e8b,0x3e0dbf32,0xbf00bf00,0xbeab3f20,0x3f323e0d,0xbd8ebf34
.long 0x3f003f00,0x3e8bbf27,0xbf35a5e0,0x3e8b3f27,0x3f003f00,0x3e52bf2d,0xbf323e0d,0x3ee63f0c,0xbf00bf00,0xbe0d3f32,0x3f27be8b,0xbf17bec9,0xbf00bf00,0xbd8e3f34,0x3f17bec9,0xbf2dbe52
.long 0x3f003f00,0xa76cbf35,0xbf003f00,0x3f352764,0x3f003f00,0xbd8ebf34,0xbec93f17,0x3f2dbe52,0xbf00bf00,0x3e0d3f32,0x3e8bbf27,0xbf173ec9,0xbf00bf00,0x3e523f2d,0x3e0dbf32,0xbee63f0c
.long 0x3f003f00,0xbe8bbf27,0x26103f35,0x3e8bbf27,0x3f003f00,0xbeabbf20,0x3e0d3f32,0x3d8ebf34,0xbf00bf00,0x3ec93f17,0xbe8bbf27,0x3e0d3f32,0xbf00bf00,0x3ee63f0c,0xbec9bf17,0x3eab3f20
.long 0x3f003f00,0x3f003f00,0x3f003f00,0x3f003f00,0x3f273e8b,0x3f2d3e52,0x3f323e0d,0x3f343d8e,0xbf35a500,0xbf323e0d,0xbf273e8b,0xbf173ec9,0xbf273e8b,0xbf0c3ee6,0xbec93f17,0xbe523f2d
.long 0x3f00bf00,0x3e8bbf27,0x2670bf35,0xbe8bbf27,0x3e8bbf27,0xbd8ebf34,0xbec9bf17,0xbf20beab,0xa6883f35,0x3ec93f17,0x3f273e8b,0x3f32be0d,0x3e8b3f27,0x3f203eab,0x3f32be0d,0x3ee6bf0c
.long 0xbf00bf00,0xbf352540,0xbf003f00,0xa6a83f35,0xbf27be8b,0xbf203eab,0xbe0d3f32,0x3ee63f0c,0x3f35a480,0x3ec9bf17,0xbe8bbf27,0xbf32be0d,0x3f27be8b,0x3d8ebf34,0xbf17bec9,0xbf203eab
.long 0xbf003f00,0x3e8b3f27,0x3f35273c,0x3e8bbf27,0xbe8b3f27,0x3f0c3ee6,0x3f17bec9,0xbe52bf2d,0x26c8bf35,0xbf32be0d,0xbe8b3f27,0x3f173ec9,0xbe8bbf27,0xbf2d3e52,0x3e0d3f32,0x3f34bd8e
.long 0x3f003f00,0x3f00bf00,0xbf00bf00,0xbf003f00,0x3f273e8b,0x3e52bf2d,0xbf32be0d,0xbd8e3f34,0xbf35a5e0,0x3e0d3f32,0x3f27be8b,0xbec9bf17,0xbf273e8b,0x3ee63f0c,0x3ec9bf17,0xbf2dbe52
.long 0x3f00bf00,0xbf27be8b,0xa79c3f35,0x3f27be8b,0x3e8bbf27,0xbf343d8e,0x3ec93f17,0x3eabbf20,0x26503f35,0x3f17bec9,0xbf27be8b,0x3e0d3f32,0x3e8b3f27,0x3eabbf20,0xbf323e0d,0x3f0c3ee6
.long 0xbf00bf00,0x26103f35,0x3f00bf00,0xbf35a670,0xbf27be8b,0x3eab3f20,0x3e0dbf32,0xbf0c3ee6,0x3f35276c,0xbf17bec9,0x3e8b3f27,0x3e0dbf32,0x3f27be8b,0xbf34bd8e,0x3f173ec9,0xbeabbf20
.long 0xbf003f00,0x3f27be8b,0xbf35a7da,0x3f273e8b,0xbe8b3f27,0x3ee6bf0c,0xbf173ec9,0x3f2dbe52,0x2724bf35,0xbe0d3f32,0x3e8bbf27,0xbec93f17,0xbe8bbf27,0x3e523f2d,0xbe0dbf32,0x3d8e3f34
.long 0x3f003f00,0x3f003f00,0x3f003f00,0x3f003f00,0x3f352480,0x3f34bd8e,0x3f32be0d,0x3f2dbe52,0xbf003f00,0xbec93f17,0xbe8b3f27,0xbe0d3f32,0xa5403f35,0x3e523f2d,0x3ec93f17,0x3f0c3ee6
.long 0xbf00bf00,0xbf27be8b,0xbf3525e0,0xbf273e8b,0xbf35a688,0xbf203eab,0xbec93f17,0xbd8e3f34,0x3f00bf00,0x3e0dbf32,0xbe8bbf27,0xbf17bec9,0xa540bf35,0xbee6bf0c,0xbf32be0d,0xbf203eab
.long 0x3f003f00,0x3f35a480,0x3f00bf00,0x26a8bf35,0x3f3526a8,0x3ee6bf0c,0xbe0dbf32,0xbf20beab,0xbf003f00,0x3e0d3f32,0x3f273e8b,0x3f17bec9,0xa4803f35,0x3f203eab,0x3f17bec9,0xbd8ebf34
.long 0xbf00bf00,0xbf273e8b,0x26983f35,0x3f273e8b,0xbf35a6d8,0xbe523f2d,0x3f173ec9,0x3f0cbee6,0x3f00bf00,0xbec9bf17,0xbf273e8b,0x3e0d3f32,0x25e0bf35,0xbf34bd8e,0xbe0d3f32,0x3f2d3e52
.long 0x3f003f00,0x3f00bf00,0xbf00bf00,0xbf003f00,0x3f3526f8,0xbd8ebf34,0xbf323e0d,0x3e523f2d,0xbf003f00,0x3f173ec9,0x3e8bbf27,0xbf32be0d,0xa7643f35,0x3f2dbe52,0xbec9bf17,0xbee63f0c
.long 0xbf00bf00,0xbe8b3f27,0x3f35a6f8,0xbe8bbf27,0xbf352610,0x3eab3f20,0x3ec9bf17,0xbf34bd8e,0x3f00bf00,0xbf32be0d,0x3e8b3f27,0x3ec9bf17,0x2670bf35,0xbf0c3ee6,0x3f323e0d,0xbeabbf20
.long 0x3f003f00,0x2724bf35,0xbf003f00,0x3f352782,0x3f352724,0xbf0cbee6,0x3e0d3f32,0x3eabbf20,0xbf003f00,0x3f32be0d,0xbf27be8b,0x3ec93f17,0xa7823f35,0x3eabbf20,0xbf173ec9,0x3f34bd8e
.long 0xbf00bf00,0x3e8b3f27,0xa807bf35,0xbe8b3f27,0xbf35a7b6,0x3f2d3e52,0xbf17bec9,0x3ee63f0c,0x3f00bf00,0xbf173ec9,0x3f27be8b,0xbf323e0d,0x27e6bf35,0xbd8e3f34,0x3e0dbf32,0xbe523f2d
.long 0x3f003f00,0x3f003f00,0x3f003f00,0x3f003f00,0x3f27be8b,0x3f20beab,0x3f17bec9,0x3f0cbee6,0xa5403f35,0x3e0d3f32,0x3e8b3f27,0x3ec93f17,0x3f273e8b,0x3f343d8e,0x3f32be0d,0x3f20beab
.long 0xbf003f00,0xbe8b3f27,0xa6883f35,0x3e8b3f27,0x3e8b3f27,0x3f0c3ee6,0x3f323e0d,0x3f2dbe52,0xbf352540,0xbf173ec9,0xbe8b3f27,0x3e0d3f32,0xbe8b3f27,0x3e523f2d,0x3f173ec9,0x3f34bd8e
.long 0xbf00bf00,0xbf350000,0xbf003f00,0xa6b83f35,0xbf273e8b,0xbe523f2d,0x3ec93f17,0x3f343d8e,0x26c8bf35,0xbf17bec9,0xbf273e8b,0xbe0d3f32,0xbf27be8b,0xbf0c3ee6,0x3e0d3f32,0x3f2d3e52
.long 0x3f00bf00,0xbe8bbf27,0xbf35a7c2,0xbe8b3f27,0xbe8bbf27,0xbf343d8e,0xbe0d3f32,0x3f203eab,0x3f352754,0x3e0dbf32,0xbf27be8b,0xbec93f17,0x3e8bbf27,0xbf20beab,0xbec93f17,0x3f0c3ee6
.long 0x3f003f00,0x3f00bf00,0xbf00bf00,0xbf003f00,0x3f27be8b,0xbeabbf20,0xbf173ec9,0x3ee63f0c,0x26103f35,0x3f32be0d,0xbe8bbf27,0xbf173ec9,0x3f273e8b,0x3d8ebf34,0xbf323e0d,0x3eab3f20
.long 0xbf003f00,0x3f273e8b,0x2724bf35,0xbf273e8b,0x3e8b3f27,0x3ee6bf0c,0xbf32be0d,0x3e523f2d,0xbf35a698,0x3ec93f17,0x3e8bbf27,0xbf323e0d,0xbe8b3f27,0x3f2dbe52,0xbf17bec9,0x3d8e3f34
.long 0xbf00bf00,0xa7b63f35,0x3f00bf00,0xbf35a7e6,0xbf273e8b,0x3f2d3e52,0xbec9bf17,0xbd8e3f34,0x273cbf35,0xbec93f17,0x3f27be8b,0xbf32be0d,0xbf27be8b,0x3ee63f0c,0xbe0dbf32,0xbe523f2d
.long 0x3f00bf00,0xbf273e8b,0x3f352825,0xbf27be8b,0xbe8bbf27,0x3d8e3f34,0x3e0dbf32,0xbeab3f20,0x3f35a670,0xbf32be0d,0x3f273e8b,0xbf17bec9,0x3e8bbf27,0xbeab3f20,0x3ec9bf17,0xbee63f0c
.long 0x3f003f00,0x3f003f00,0x3f003f00,0x3f003f00,0xbf003f00,0xbf0c3ee6,0xbf173ec9,0xbf203eab,0x3f003f00,0x3ec93f17,0x3e8b3f27,0x3e0d3f32,0xbf003f00,0xbf203eab,0xbf323e0d,0xbf34bd8e
.long 0x3f003f00,0x3e8b3f27,0x24803f35,0xbe8b3f27,0xbf003f00,0xbf2d3e52,0xbf32be0d,0xbf0cbee6,0x3f003f00,0x3e0d3f32,0xbe8b3f27,0xbf173ec9,0xbf003f00,0xbf343d8e,0xbf17bec9,0xbe52bf2d
.long 0x3f003f00,0x24803f35,0xbf003f00,0xbf352480,0xbf003f00,0xbf34bd8e,0xbec9bf17,0x3e52bf2d,0x3f003f00,0xbe0d3f32,0xbf273e8b,0xbf17bec9,0xbf003f00,0xbf2dbe52,0xbe0dbf32,0x3f0cbee6
.long 0x3f003f00,0xbe8b3f27,0xbf352480,0xbe8bbf27,0xbf003f00,0xbf20beab,0x3e0dbf32,0x3f34bd8e,0x3f003f00,0xbec93f17,0xbf27be8b,0x3e0dbf32,0xbf003f00,0xbf0cbee6,0x3ec9bf17,0x3f203eab
.long 0x3f003f00,0xbf003f00,0xbf00bf00,0x3f00bf00,0xbf003f00,0xbee6bf0c,0x3f17bec9,0x3eab3f20,0x3f003f00,0xbf173ec9,0xbe8bbf27,0x3f32be0d,0xbf003f00,0xbeabbf20,0x3f32be0d,0xbd8e3f34
.long 0x3f003f00,0xbf273e8b,0xa500bf35,0x3f273e8b,0xbf003f00,0xbe52bf2d,0x3f323e0d,0xbee63f0c,0x3f003f00,0xbf323e0d,0x3e8bbf27,0x3ec93f17,0xbf003f00,0xbd8ebf34,0x3f173ec9,0xbf2d3e52
.long 0x3f003f00,0xbf352480,0x3f00bf00,0x25403f35,0xbf003f00,0x3d8ebf34,0x3ec93f17,0xbf2dbe52,0x3f003f00,0xbf32be0d,0x3f27be8b,0xbec93f17,0xbf003f00,0x3e52bf2d,0x3e0d3f32,0xbee6bf0c
.long 0x3f003f00,0xbf27be8b,0x3f35a540,0xbf273e8b,0xbf003f00,0x3eabbf20,0xbe0d3f32,0xbd8ebf34,0x3f003f00,0xbf17bec9,0x3f273e8b,0xbf32be0d,0xbf003f00,0x3ee6bf0c,0xbec93f17,0x3eabbf20
.long 0x3f003f00,0x3f003f00,0x3f003f00,0x3f003f00,0xbf273e8b,0xbf2d3e52,0xbf323e0d,0xbf343d8e,0x24803f35,0xbe0d3f32,0xbe8b3f27,0xbec93f17,0xbf27be8b,0xbf0cbee6,0xbec9bf17,0xbe52bf2d
.long 0xbf003f00,0xbf273e8b,0xbf352480,0xbf27be8b,0xbe8bbf27,0x3d8ebf34,0x3ec9bf17,0x3f20beab,0xbf352480,0xbf17bec9,0xbe8bbf27,0x3e0dbf32,0x3e8bbf27,0x3f20beab,0x3f323e0d,0x3ee63f0c
.long 0xbf00bf00,0xa500bf35,0x3f00bf00,0x3f35a540,0x3f27be8b,0x3f203eab,0x3e0d3f32,0xbee63f0c,0xa500bf35,0x3f17bec9,0x3f273e8b,0x3e0d3f32,0x3f273e8b,0x3d8e3f34,0xbf173ec9,0xbf20beab
.long 0x3f00bf00,0x3f273e8b,0x25403f35,0xbf273e8b,0x3e8b3f27,0xbf0c3ee6,0xbf17bec9,0x3e52bf2d,0x3f35a540,0x3e0d3f32,0xbf273e8b,0xbec9bf17,0xbe8b3f27,0xbf2dbe52,0x3e0dbf32,0x3f343d8e
.long 0x3f003f00,0xbf003f00,0xbf00bf00,0x3f00bf00,0xbf273e8b,0xbe52bf2d,0x3f32be0d,0x3d8e3f34,0x25403f35,0xbf32be0d,0x3e8bbf27,0x3f173ec9,0xbf27be8b,0x3ee6bf0c,0x3ec93f17,0xbf2d3e52
.long 0xbf003f00,0xbe8bbf27,0x3f35a688,0xbe8b3f27,0xbe8bbf27,0x3f343d8e,0xbec93f17,0xbeabbf20,0xbf352670,0x3ec9bf17,0x3e8b3f27,0xbf32be0d,0x3e8bbf27,0x3eab3f20,0xbf32be0d,0x3f0cbee6
.long 0xbf00bf00,0x3f35a688,0xbf003f00,0x2540bf35,0x3f27be8b,0xbeab3f20,0xbe0dbf32,0x3f0c3ee6,0x25e0bf35,0x3ec93f17,0xbf27be8b,0x3f32be0d,0x3f273e8b,0xbf343d8e,0x3f17bec9,0xbeab3f20
.long 0x3f00bf00,0xbe8b3f27,0x2540bf35,0x3e8b3f27,0x3e8b3f27,0xbee6bf0c,0x3f173ec9,0xbf2dbe52,0x3f35a688,0xbf323e0d,0x3f27be8b,0xbf173ec9,0xbe8b3f27,0x3e52bf2d,0xbe0d3f32,0x3d8ebf34
.long 0x3f003f00,0x3f003f00,0x3f003f00,0x3f003f00,0xbf352480,0xbf34bd8e,0xbf32be0d,0xbf2dbe52,0xbf003f00,0xbf173ec9,0xbf273e8b,0xbf323e0d,0xa480bf35,0x3e52bf2d,0x3ec9bf17,0x3f0cbee6
.long 0xbf00bf00,0xbe8bbf27,0xa500bf35,0x3e8bbf27,0x3f35a500,0x3f203eab,0x3ec93f17,0x3d8e3f34,0x3f00bf00,0x3f32be0d,0x3f273e8b,0x3ec93f17,0x25403f35,0xbee63f0c,0xbf323e0d,0xbf20beab
.long 0x3f003f00,0x25403f35,0xbf003f00,0xbf352670,0xbf352540,0xbee6bf0c,0x3e0dbf32,0x3f20beab,0xbf003f00,0xbf32be0d,0xbe8bbf27,0x3ec9bf17,0xa670bf35,0x3f20beab,0x3f173ec9,0xbd8e3f34
.long 0xbf00bf00,0x3e8bbf27,0x3f35a688,0x3e8b3f27,0x3f3525e0,0x3e523f2d,0xbf173ec9,0xbf0cbee6,0x3f00bf00,0x3f173ec9,0xbe8b3f27,0xbf32be0d,0x26883f35,0xbf343d8e,0xbe0dbf32,0x3f2dbe52
.long 0x3f003f00,0xbf003f00,0xbf00bf00,0x3f00bf00,0xbf35a5a0,0x3d8ebf34,0x3f323e0d,0xbe523f2d,0xbf003f00,0xbec9bf17,0x3f27be8b,0x3e0d3f32,0xa698bf35,0x3f2d3e52,0xbec93f17,0xbee6bf0c
.long 0xbf00bf00,0x3f27be8b,0xa4803f35,0xbf27be8b,0x3f352540,0xbeab3f20,0xbec9bf17,0x3f34bd8e,0x3f00bf00,0x3e0d3f32,0xbf27be8b,0x3f17bec9,0x26a83f35,0xbf0cbee6,0x3f32be0d,0xbeab3f20
.long 0x3f003f00,0xbf3526a8,0x3f00bf00,0x273c3f35,0xbf35a480,0x3f0cbee6,0xbe0d3f32,0xbeabbf20,0xbf003f00,0x3e0dbf32,0x3e8b3f27,0xbf17bec9,0xa6a8bf35,0x3eab3f20,0xbf17bec9,0x3f343d8e
.long 0xbf00bf00,0x3f273e8b,0xbf3526c8,0x3f27be8b,0x3f350000,0xbf2d3e52,0x3f17bec9,0xbee63f0c,0x3f00bf00,0xbec93f17,0x3e8bbf27,0xbe0d3f32,0x26b83f35,0xbd8ebf34,0x3e0d3f32,0xbe52bf2d
.long 0x3f003f00,0x3f003f00,0x3f003f00,0x3f003f00,0xbf27be8b,0xbf20beab,0xbf17bec9,0xbf0cbee6,0xbf352480,0xbf32be0d,0xbf27be8b,0xbf17bec9,0x3f27be8b,0x3f34bd8e,0x3f323e0d,0x3f203eab
.long 0x3f00bf00,0x3f27be8b,0x3f35a540,0x3f273e8b,0xbe8b3f27,0xbf0c3ee6,0xbf323e0d,0xbf2dbe52,0x25403f35,0xbec93f17,0xbf273e8b,0xbf32be0d,0xbe8bbf27,0x3e52bf2d,0x3f17bec9,0x3f343d8e
.long 0xbf00bf00,0x25e0bf35,0x3f00bf00,0x3f35a688,0x3f273e8b,0x3e523f2d,0xbec93f17,0xbf343d8e,0x3f35a688,0x3ec93f17,0xbe8b3f27,0xbf323e0d,0xbf273e8b,0xbf0cbee6,0x3e0dbf32,0x3f2dbe52
.long 0xbf003f00,0xbf27be8b,0x2540bf35,0x3f27be8b,0x3e8bbf27,0x3f343d8e,0x3e0d3f32,0xbf203eab,0x2540bf35,0x3f32be0d,0x3e8b3f27,0xbf173ec9,0x3e8b3f27,0xbf203eab,0xbec9bf17,0x3f0cbee6
.long 0x3f003f00,0xbf003f00,0xbf00bf00,0x3f00bf00,0xbf27be8b,0x3eabbf20,0x3f173ec9,0xbee63f0c,0xbf3526a8,0x3e0dbf32,0x3f273e8b,0xbec93f17,0x3f27be8b,0x3d8e3f34,0xbf32be0d,0x3eabbf20
.long 0x3f00bf00,0x3e8b3f27,0xbf3526c8,0x3e8bbf27,0xbe8b3f27,0xbee6bf0c,0x3f32be0d,0xbe523f2d,0x24803f35,0xbf17bec9,0x3f27be8b,0xbe0d3f32,0xbe8bbf27,0x3f2d3e52,0xbf173ec9,0x3d8ebf34
.long 0xbf00bf00,0x3f352698,0xbf003f00,0xa7c2bf35,0x3f273e8b,0xbf2d3e52,0x3ec9bf17,0x3d8e3f34,0x3f35a6d8,0xbf173ec9,0x3e8bbf27,0x3e0d3f32,0xbf273e8b,0x3ee6bf0c,0xbe0d3f32,0xbe52bf2d
.long 0xbf003f00,0x3e8bbf27,0x27543f35,0xbe8bbf27,0x3e8bbf27,0xbd8e3f34,0xbe0dbf32,0x3eab3f20,0xa5e0bf35,0x3e0d3f32,0xbe8bbf27,0x3ec93f17,0x3e8b3f27,0xbeabbf20,0x3ec93f17,0xbee6bf0c
.long 0x3f003f00,0x3f003f00,0x3f003f00,0x3f003f00,0xbf00bf00,0xbee6bf0c,0xbec9bf17,0xbeabbf20,0xbf00bf00,0xbec9bf17,0xbe8bbf27,0xbe0dbf32,0x3f003f00,0x3eab3f20,0x3e0d3f32,0xbd8e3f34
.long 0x3f003f00,0x3e8b3f27,0x25403f35,0xbe8b3f27,0xbf00bf00,0xbe52bf2d,0x3e0dbf32,0x3ee6bf0c,0xbf00bf00,0xbe0dbf32,0x3e8bbf27,0x3f17bec9,0x3f003f00,0x3d8e3f34,0xbec93f17,0xbf2d3e52
.long 0x3f003f00,0xa5a03f35,0xbf003f00,0xbf352698,0xbf00bf00,0x3d8ebf34,0x3f17bec9,0x3f2d3e52,0xbf00bf00,0x3e0dbf32,0x3f27be8b,0x3f173ec9,0x3f003f00,0xbe523f2d,0xbf323e0d,0xbee6bf0c
.long 0x3f003f00,0xbe8b3f27,0xbf3526a8,0xbe8bbf27,0xbf00bf00,0x3eabbf20,0x3f323e0d,0x3d8e3f34,0xbf00bf00,0x3ec9bf17,0x3f273e8b,0xbe0d3f32,0x3f003f00,0xbee63f0c,0xbf17bec9,0x3eabbf20
.long 0x3f003f00,0xbf003f00,0xbf00bf00,0x3f00bf00,0xbf00bf00,0x3f0cbee6,0x3ec93f17,0xbf203eab,0xbf00bf00,0x3f17bec9,0x3e8b3f27,0xbf323e0d,0x3f003f00,0xbf203eab,0xbe0dbf32,0x3f343d8e
.long 0x3f003f00,0xbf273e8b,0xa5e0bf35,0x3f273e8b,0xbf00bf00,0x3f2dbe52,0xbe0d3f32,0xbf0cbee6,0xbf00bf00,0x3f32be0d,0xbe8b3f27,0xbec9bf17,0x3f003f00,0xbf343d8e,0x3ec9bf17,0x3e523f2d
.long 0x3f003f00,0xbf35a76c,0x3f00bf00,0x27643f35,0xbf00bf00,0x3f343d8e,0xbf173ec9,0x3e52bf2d,0xbf00bf00,0x3f323e0d,0xbf273e8b,0x3ec9bf17,0x3f003f00,0xbf2dbe52,0x3f32be0d,0xbf0c3ee6
.long 0x3f003f00,0xbf27be8b,0x3f352610,0xbf273e8b,0xbf00bf00,0x3f203eab,0xbf32be0d,0x3f34bd8e,0xbf00bf00,0x3f173ec9,0xbf27be8b,0x3f323e0d,0x3f003f00,0xbf0cbee6,0x3f173ec9,0xbf20beab
.long 0x3f003f00,0x3f003f00,0x3f003f00,0x3f003f00,0xbe8bbf27,0xbe52bf2d,0xbe0dbf32,0xbd8ebf34,0xa500bf35,0x3e0dbf32,0x3e8bbf27,0x3ec9bf17,0xbe8b3f27,0xbee63f0c,0xbf173ec9,0xbf2d3e52
.long 0xbf003f00,0xbf273e8b,0xbf352670,0xbf27be8b,0x3f27be8b,0x3f343d8e,0x3f173ec9,0x3eab3f20,0x3f35a688,0x3f173ec9,0x3e8b3f27,0xbe0d3f32,0xbf27be8b,0xbeabbf20,0x3e0dbf32,0x3f0cbee6
.long 0xbf00bf00,0x2540bf35,0x3f00bf00,0x3f35a6a8,0x3e8b3f27,0xbeab3f20,0xbf323e0d,0xbf0cbee6,0xa4803f35,0xbf173ec9,0xbf27be8b,0xbe0dbf32,0x3e8bbf27,0x3f34bd8e,0x3ec93f17,0xbeab3f20
.long 0x3f00bf00,0x3f273e8b,0x273c3f35,0xbf273e8b,0xbf273e8b,0xbee6bf0c,0x3ec9bf17,0x3f2d3e52,0xbf3526c8,0xbe0dbf32,0x3f27be8b,0x3ec93f17,0x3f273e8b,0xbe523f2d,0xbf32be0d,0x3d8ebf34
.long 0x3f003f00,0xbf003f00,0xbf00bf00,0x3f00bf00,0xbe8bbf27,0x3f2dbe52,0x3e0d3f32,0xbf343d8e,0xa5e0bf35,0x3f323e0d,0xbe8b3f27,0xbf17bec9,0xbe8b3f27,0xbf0cbee6,0x3f17bec9,0x3e523f2d
.long 0xbf003f00,0xbe8bbf27,0x3f35a79c,0xbe8b3f27,0x3f27be8b,0xbd8e3f34,0xbf17bec9,0x3f20beab,0x3f352650,0xbec93f17,0xbe8bbf27,0x3f323e0d,0xbf27be8b,0x3f20beab,0xbe0d3f32,0xbee6bf0c
.long 0xbf00bf00,0x3f352610,0xbf003f00,0xa670bf35,0x3e8b3f27,0xbf20beab,0x3f32be0d,0xbee63f0c,0x276c3f35,0xbec9bf17,0x3f273e8b,0xbf323e0d,0x3e8bbf27,0x3d8e3f34,0xbec9bf17,0x3f203eab
.long 0x3f00bf00,0xbe8b3f27,0xa7dabf35,0x3e8b3f27,0xbf273e8b,0x3f0cbee6,0xbec93f17,0x3e52bf2d,0xbf352724,0x3f32be0d,0xbf273e8b,0x3f17bec9,0x3f273e8b,0xbf2dbe52,0x3f323e0d,0xbf34bd8e
.long 0x3f003f00,0x3f003f00,0x3f003f00,0x3f003f00,0xa480bf35,0x3d8ebf34,0x3e0dbf32,0x3e52bf2d,0x3f00bf00,0x3f17bec9,0x3f27be8b,0x3f32be0d,0xbf352540,0xbf2dbe52,0xbf17bec9,0xbee6bf0c
.long 0xbf00bf00,0xbe8bbf27,0x25e0bf35,0x3e8bbf27,0x26883f35,0xbeab3f20,0xbf173ec9,0xbf343d8e,0xbf003f00,0xbf323e0d,0xbf27be8b,0xbec9bf17,0x3f352540,0x3f0c3ee6,0x3e0d3f32,0xbeab3f20
.long 0x3f003f00,0xa4803f35,0xbf003f00,0xbf3526a8,0xa6a8bf35,0x3f0cbee6,0x3f323e0d,0x3eab3f20,0x3f00bf00,0x3f323e0d,0x3e8b3f27,0xbec93f17,0xbf352480,0xbeabbf20,0x3ec9bf17,0x3f343d8e
.long 0xbf00bf00,0x3e8bbf27,0x3f352698,0x3e8b3f27,0x26d83f35,0xbf2d3e52,0xbec9bf17,0x3ee6bf0c,0xbf003f00,0xbf17bec9,0x3e8bbf27,0x3f323e0d,0x3f35a5e0,0x3d8e3f34,0xbf323e0d,0xbe52bf2d
.long 0x3f003f00,0xbf003f00,0xbf00bf00,0x3f00bf00,0xa6f8bf35,0x3f343d8e,0xbe0d3f32,0xbf2dbe52,0x3f00bf00,0x3ec93f17,0xbf273e8b,0xbe0dbf32,0xbf352764,0x3e52bf2d,0x3f173ec9,0xbf0c3ee6
.long 0xbf00bf00,0x3f27be8b,0xa6f83f35,0xbf27be8b,0xa6103f35,0xbf20beab,0x3f17bec9,0x3d8e3f34,0xbf003f00,0xbe0dbf32,0x3f273e8b,0xbf173ec9,0x3f35a670,0xbee63f0c,0xbe0dbf32,0x3f203eab
.long 0x3f003f00,0xbf352724,0x3f00bf00,0x27823f35,0xa724bf35,0x3ee63f0c,0xbf32be0d,0x3f20beab,0x3f00bf00,0xbe0d3f32,0xbe8bbf27,0x3f173ec9,0xbf352782,0x3f20beab,0xbec93f17,0x3d8ebf34
.long 0xbf00bf00,0x3f273e8b,0xbf35a807,0x3f27be8b,0x27b63f35,0xbe52bf2d,0x3ec93f17,0xbf0cbee6,0xbf003f00,0x3ec9bf17,0xbe8b3f27,0x3e0dbf32,0x3f35a7e6,0xbf343d8e,0x3f32be0d,0xbf2d3e52
.long 0x3f003f00,0x3f003f00,0x3f003f00,0x3f003f00,0x3e8bbf27,0x3eabbf20,0x3ec9bf17,0x3ee6bf0c,0x3f35a540,0x3f323e0d,0x3f273e8b,0x3f173ec9,0xbe8bbf27,0xbd8ebf34,0x3e0dbf32,0x3eabbf20
.long 0x3f00bf00,0x3f27be8b,0x3f35a688,0x3f273e8b,0xbf27be8b,0xbee6bf0c,0xbe0dbf32,0x3e52bf2d,0x2540bf35,0x3ec9bf17,0x3f27be8b,0x3f323e0d,0xbf273e8b,0xbf2dbe52,0xbec9bf17,0x3d8ebf34
.long 0xbf00bf00,0xbf35,0x3f00bf00,0x3f35a6b8,0xbe8b3f27,0xbf2d3e52,0xbf17bec9,0xbd8ebf34,0xbf3526c8,0xbec9bf17,0x3e8bbf27,0x3f32be0d,0x3e8b3f27,0xbee63f0c,0xbf32be0d,0xbe52bf2d
.long 0xbf003f00,0xbf27be8b,0xa7c2bf35,0x3f27be8b,0x3f273e8b,0xbd8e3f34,0xbf323e0d,0xbeabbf20,0x27543f35,0xbf323e0d,0xbe8bbf27,0x3f17bec9,0x3f27be8b,0x3eab3f20,0xbf173ec9,0xbee6bf0c
.long 0x3f003f00,0xbf003f00,0xbf00bf00,0x3f00bf00,0x3e8bbf27,0x3f203eab,0xbec93f17,0xbf0cbee6,0x3f352610,0xbe0d3f32,0xbf27be8b,0x3ec9bf17,0xbe8bbf27,0x3f34bd8e,0xbe0d3f32,0xbf20beab
.long 0x3f00bf00,0x3e8b3f27,0xbf352724,0x3e8bbf27,0xbf27be8b,0x3f0cbee6,0x3e0d3f32,0xbf2dbe52,0xa698bf35,0x3f173ec9,0xbf273e8b,0x3e0dbf32,0xbf273e8b,0x3e52bf2d,0x3ec93f17,0xbf34bd8e
.long 0xbf00bf00,0x3f35a7b6,0xbf003f00,0xa7e6bf35,0xbe8b3f27,0xbe52bf2d,0x3f173ec9,0xbf343d8e,0xbf35273c,0x3f17bec9,0xbe8b3f27,0xbe0dbf32,0x3e8b3f27,0xbf0cbee6,0x3f323e0d,0xbf2d3e52
.long 0xbf003f00,0x3e8bbf27,0x28253f35,0xbe8bbf27,0x3f273e8b,0xbf34bd8e,0x3f32be0d,0xbf203eab,0xa6703f35,0xbe0dbf32,0x3e8b3f27,0xbec9bf17,0x3f27be8b,0xbf203eab,0x3f17bec9,0xbf0c3ee6
.long 0x3f00bf00,0x3f00bf00,0x3f00bf00,0x3f00bf00,0x3f003f00,0x3f0c3ee6,0x3f173ec9,0x3f203eab,0x3f00bf00,0x3ec9bf17,0x3e8bbf27,0x3e0dbf32,0x3f003f00,0x3f203eab,0x3f323e0d,0x3f34bd8e
.long 0x3f00bf00,0x3e8bbf27,0x2480bf35,0xbe8bbf27,0x3f003f00,0x3f2d3e52,0x3f32be0d,0x3f0cbee6,0x3f00bf00,0x3e0dbf32,0xbe8bbf27,0xbf17bec9,0x3f003f00,0x3f343d8e,0x3f17bec9,0x3e52bf2d
.long 0x3f00bf00,0x2480bf35,0xbf00bf00,0xbf35a480,0x3f003f00,0x3f34bd8e,0x3ec9bf17,0xbe52bf2d,0x3f00bf00,0xbe0dbf32,0xbf27be8b,0xbf173ec9,0x3f003f00,0x3f2dbe52,0x3e0dbf32,0xbf0cbee6
.long 0x3f00bf00,0xbe8bbf27,0xbf35a480,0xbe8b3f27,0x3f003f00,0x3f20beab,0xbe0dbf32,0xbf34bd8e,0x3f00bf00,0xbec9bf17,0xbf273e8b,0x3e0d3f32,0x3f003f00,0x3f0cbee6,0xbec9bf17,0xbf203eab
.long 0x3f00bf00,0xbf00bf00,0xbf003f00,0x3f003f00,0x3f003f00,0x3ee6bf0c,0xbf17bec9,0xbeab3f20,0x3f00bf00,0xbf17bec9,0xbe8b3f27,0x3f323e0d,0x3f003f00,0x3eabbf20,0xbf32be0d,0x3d8e3f34
.long 0x3f00bf00,0xbf27be8b,0xa5003f35,0x3f27be8b,0x3f003f00,0x3e52bf2d,0xbf323e0d,0x3ee63f0c,0x3f00bf00,0xbf32be0d,0x3e8b3f27,0x3ec9bf17,0x3f003f00,0x3d8ebf34,0xbf173ec9,0x3f2d3e52
.long 0x3f00bf00,0xbf35a480,0x3f003f00,0x2540bf35,0x3f003f00,0xbd8ebf34,0xbec93f17,0x3f2dbe52,0x3f00bf00,0xbf323e0d,0x3f273e8b,0xbec9bf17,0x3f003f00,0xbe52bf2d,0xbe0d3f32,0x3ee6bf0c
.long 0x3f00bf00,0xbf273e8b,0x3f352540,0xbf27be8b,0x3f003f00,0xbeabbf20,0x3e0d3f32,0x3d8ebf34,0x3f00bf00,0xbf173ec9,0x3f27be8b,0xbf323e0d,0x3f003f00,0xbee6bf0c,0x3ec93f17,0xbeabbf20
.long 0x3f00bf00,0x3f00bf00,0x3f00bf00,0x3f00bf00,0x3f273e8b,0x3f2d3e52,0x3f323e0d,0x3f343d8e,0x2480bf35,0xbe0dbf32,0xbe8bbf27,0xbec9bf17,0x3f27be8b,0x3f0cbee6,0x3ec9bf17,0x3e52bf2d
.long 0xbf00bf00,0xbf27be8b,0xbf35a480,0xbf273e8b,0x3e8bbf27,0xbd8ebf34,0xbec9bf17,0xbf20beab,0xbf35a480,0xbf173ec9,0xbe8b3f27,0x3e0d3f32,0xbe8bbf27,0xbf20beab,0xbf323e0d,0xbee63f0c
.long 0xbf003f00,0xa5003f35,0x3f003f00,0x3f352540,0xbf27be8b,0xbf203eab,0xbe0d3f32,0x3ee63f0c,0xa5003f35,0x3f173ec9,0x3f27be8b,0x3e0dbf32,0xbf273e8b,0xbd8e3f34,0x3f173ec9,0x3f20beab
.long 0x3f003f00,0x3f27be8b,0x2540bf35,0xbf27be8b,0xbe8b3f27,0x3f0c3ee6,0x3f17bec9,0xbe52bf2d,0x3f352540,0x3e0dbf32,0xbf27be8b,0xbec93f17,0x3e8b3f27,0x3f2dbe52,0xbe0dbf32,0xbf343d8e
.long 0x3f00bf00,0xbf00bf00,0xbf003f00,0x3f003f00,0x3f273e8b,0x3e52bf2d,0xbf32be0d,0xbd8e3f34,0x2540bf35,0xbf323e0d,0x3e8b3f27,0x3f17bec9,0x3f27be8b,0xbee6bf0c,0xbec93f17,0x3f2d3e52
.long 0xbf00bf00,0xbe8b3f27,0x3f352688,0xbe8bbf27,0x3e8bbf27,0xbf343d8e,0x3ec93f17,0x3eabbf20,0xbf35a670,0x3ec93f17,0x3e8bbf27,0xbf323e0d,0xbe8bbf27,0xbeab3f20,0x3f32be0d,0xbf0cbee6
.long 0xbf003f00,0x3f352688,0xbf00bf00,0x25403f35,0xbf27be8b,0x3eab3f20,0x3e0dbf32,0xbf0c3ee6,0x25e03f35,0x3ec9bf17,0xbf273e8b,0x3f323e0d,0xbf273e8b,0x3f343d8e,0xbf17bec9,0x3eab3f20
.long 0x3f003f00,0xbe8bbf27,0x25403f35,0x3e8bbf27,0xbe8b3f27,0x3ee6bf0c,0xbf173ec9,0x3f2dbe52,0x3f352688,0xbf32be0d,0x3f273e8b,0xbf17bec9,0x3e8b3f27,0xbe52bf2d,0x3e0d3f32,0xbd8ebf34
.long 0x3f00bf00,0x3f00bf00,0x3f00bf00,0x3f00bf00,0x3f352480,0x3f34bd8e,0x3f32be0d,0x3f2dbe52,0xbf00bf00,0xbf17bec9,0xbf27be8b,0xbf32be0d,0x2480bf35,0xbe52bf2d,0xbec9bf17,0xbf0cbee6
.long 0xbf003f00,0xbe8b3f27,0xa5003f35,0x3e8b3f27,0xbf35a500,0xbf203eab,0xbec93f17,0xbd8e3f34,0x3f003f00,0x3f323e0d,0x3f27be8b,0x3ec9bf17,0xa5403f35,0x3ee63f0c,0x3f323e0d,0x3f20beab
.long 0x3f00bf00,0x2540bf35,0xbf00bf00,0xbf35a670,0x3f352540,0x3ee6bf0c,0xbe0dbf32,0xbf20beab,0xbf00bf00,0xbf323e0d,0xbe8b3f27,0x3ec93f17,0x2670bf35,0xbf20beab,0xbf173ec9,0x3d8e3f34
.long 0xbf003f00,0x3e8b3f27,0x3f352688,0x3e8bbf27,0xbf3525e0,0xbe523f2d,0x3f173ec9,0x3f0cbee6,0x3f003f00,0x3f17bec9,0xbe8bbf27,0xbf323e0d,0xa6883f35,0x3f343d8e,0x3e0dbf32,0xbf2dbe52
.long 0x3f00bf00,0xbf00bf00,0xbf003f00,0x3f003f00,0x3f35a5a0,0xbd8ebf34,0xbf323e0d,0x3e523f2d,0xbf00bf00,0xbec93f17,0x3f273e8b,0x3e0dbf32,0x2698bf35,0xbf2d3e52,0x3ec93f17,0x3ee6bf0c
.long 0xbf003f00,0x3f273e8b,0xa480bf35,0xbf273e8b,0xbf352540,0x3eab3f20,0x3ec9bf17,0xbf34bd8e,0x3f003f00,0x3e0dbf32,0xbf273e8b,0x3f173ec9,0xa6a83f35,0x3f0cbee6,0xbf32be0d,0x3eab3f20
.long 0x3f00bf00,0xbf35a6a8,0x3f003f00,0x273cbf35,0x3f35a480,0xbf0cbee6,0x3e0d3f32,0x3eabbf20,0xbf00bf00,0x3e0d3f32,0x3e8bbf27,0xbf173ec9,0x26a8bf35,0xbeab3f20,0x3f17bec9,0xbf343d8e
.long 0xbf003f00,0x3f27be8b,0xbf35a6c8,0x3f273e8b,0xbf350000,0x3f2d3e52,0xbf17bec9,0x3ee63f0c,0x3f003f00,0xbec9bf17,0x3e8b3f27,0xbe0dbf32,0xa6b83f35,0x3d8ebf34,0xbe0d3f32,0x3e52bf2d
.long 0x3f00bf00,0x3f00bf00,0x3f00bf00,0x3f00bf00,0x3f27be8b,0x3f20beab,0x3f17bec9,0x3f0cbee6,0xbf35a480,0xbf323e0d,0xbf273e8b,0xbf173ec9,0xbf27be8b,0xbf34bd8e,0xbf323e0d,0xbf203eab
.long 0x3f003f00,0x3f273e8b,0x3f352540,0x3f27be8b,0x3e8b3f27,0x3f0c3ee6,0x3f323e0d,0x3f2dbe52,0x2540bf35,0xbec9bf17,0xbf27be8b,0xbf323e0d,0x3e8bbf27,0xbe52bf2d,0xbf17bec9,0xbf343d8e
.long 0xbf003f00,0x25e03f35,0x3f003f00,0x3f352688,0xbf273e8b,0xbe523f2d,0x3ec93f17,0x3f343d8e,0x3f352688,0x3ec9bf17,0xbe8bbf27,0xbf32be0d,0x3f273e8b,0x3f0cbee6,0xbe0dbf32,0xbf2dbe52
.long 0xbf00bf00,0xbf273e8b,0x25403f35,0x3f273e8b,0xbe8bbf27,0xbf343d8e,0xbe0d3f32,0x3f203eab,0x25403f35,0x3f323e0d,0x3e8bbf27,0xbf17bec9,0xbe8b3f27,0x3f203eab,0x3ec9bf17,0xbf0cbee6
.long 0x3f00bf00,0xbf00bf00,0xbf003f00,0x3f003f00,0x3f27be8b,0xbeabbf20,0xbf173ec9,0x3ee63f0c,0xbf35a6a8,0x3e0d3f32,0x3f27be8b,0xbec9bf17,0xbf27be8b,0xbd8e3f34,0x3f32be0d,0xbeabbf20
.long 0x3f003f00,0x3e8bbf27,0xbf35a6c8,0x3e8b3f27,0x3e8b3f27,0x3ee6bf0c,0xbf32be0d,0x3e523f2d,0x2480bf35,0xbf173ec9,0x3f273e8b,0xbe0dbf32,0x3e8bbf27,0xbf2d3e52,0x3f173ec9,0xbd8ebf34
.long 0xbf003f00,0x3f35a698,0xbf00bf00,0xa7c23f35,0xbf273e8b,0x3f2d3e52,0xbec9bf17,0xbd8e3f34,0x3f3526d8,0xbf17bec9,0x3e8b3f27,0x3e0dbf32,0x3f273e8b,0xbee6bf0c,0x3e0d3f32,0x3e52bf2d
.long 0xbf00bf00,0x3e8b3f27,0x2754bf35,0xbe8b3f27,0xbe8bbf27,0x3d8e3f34,0x3e0dbf32,0xbeab3f20,0xa5e03f35,0x3e0dbf32,0xbe8b3f27,0x3ec9bf17,0xbe8b3f27,0x3eabbf20,0xbec93f17,0x3ee6bf0c
.long 0x3f00bf00,0x3f00bf00,0x3f00bf00,0x3f00bf00,0x3f00bf00,0x3ee6bf0c,0x3ec9bf17,0x3eabbf20,0xbf003f00,0xbec93f17,0xbe8b3f27,0xbe0d3f32,0xbf003f00,0xbeab3f20,0xbe0d3f32,0x3d8e3f34
.long 0x3f00bf00,0x3e8bbf27,0x2540bf35,0xbe8bbf27,0x3f00bf00,0x3e52bf2d,0xbe0dbf32,0xbee6bf0c,0xbf003f00,0xbe0d3f32,0x3e8b3f27,0x3f173ec9,0xbf003f00,0xbd8e3f34,0x3ec93f17,0x3f2d3e52
.long 0x3f00bf00,0xa5a0bf35,0xbf00bf00,0xbf35a698,0x3f00bf00,0xbd8ebf34,0xbf17bec9,0xbf2d3e52,0xbf003f00,0x3e0d3f32,0x3f273e8b,0x3f17bec9,0xbf003f00,0x3e523f2d,0x3f323e0d,0x3ee6bf0c
.long 0x3f00bf00,0xbe8bbf27,0xbf35a6a8,0xbe8b3f27,0x3f00bf00,0xbeabbf20,0xbf323e0d,0xbd8e3f34,0xbf003f00,0x3ec93f17,0x3f27be8b,0xbe0dbf32,0xbf003f00,0x3ee63f0c,0x3f17bec9,0xbeabbf20
.long 0x3f00bf00,0xbf00bf00,0xbf003f00,0x3f003f00,0x3f00bf00,0xbf0cbee6,0xbec93f17,0x3f203eab,0xbf003f00,0x3f173ec9,0x3e8bbf27,0xbf32be0d,0xbf003f00,0x3f203eab,0x3e0dbf32,0xbf343d8e
.long 0x3f00bf00,0xbf27be8b,0xa5e03f35,0x3f27be8b,0x3f00bf00,0xbf2dbe52,0x3e0d3f32,0x3f0cbee6,0xbf003f00,0x3f323e0d,0xbe8bbf27,0xbec93f17,0xbf003f00,0x3f343d8e,0xbec9bf17,0xbe523f2d
.long 0x3f00bf00,0xbf35276c,0x3f003f00,0x2764bf35,0x3f00bf00,0xbf343d8e,0x3f173ec9,0xbe52bf2d,0xbf003f00,0x3f32be0d,0xbf27be8b,0x3ec93f17,0xbf003f00,0x3f2dbe52,0xbf32be0d,0x3f0c3ee6
.long 0x3f00bf00,0xbf273e8b,0x3f35a610,0xbf27be8b,0x3f00bf00,0xbf203eab,0x3f32be0d,0xbf34bd8e,0xbf003f00,0x3f17bec9,0xbf273e8b,0x3f32be0d,0xbf003f00,0x3f0cbee6,0xbf173ec9,0x3f20beab
.long 0x3f00bf00,0x3f00bf00,0x3f00bf00,0x3f00bf00,0x3e8bbf27,0x3e52bf2d,0x3e0dbf32,0x3d8ebf34,0xa5003f35,0x3e0d3f32,0x3e8b3f27,0x3ec93f17,0x3e8b3f27,0x3ee63f0c,0x3f173ec9,0x3f2d3e52
.long 0xbf00bf00,0xbf27be8b,0xbf35a670,0xbf273e8b,0xbf27be8b,0xbf343d8e,0xbf173ec9,0xbeab3f20,0x3f352688,0x3f17bec9,0x3e8bbf27,0xbe0dbf32,0x3f27be8b,0x3eabbf20,0xbe0dbf32,0xbf0cbee6
.long 0xbf003f00,0x25403f35,0x3f003f00,0x3f3526a8,0xbe8b3f27,0x3eab3f20,0x3f323e0d,0x3f0cbee6,0xa480bf35,0xbf17bec9,0xbf273e8b,0xbe0d3f32,0xbe8bbf27,0xbf34bd8e,0xbec93f17,0x3eab3f20
.long 0x3f003f00,0x3f27be8b,0x273cbf35,0xbf27be8b,0x3f273e8b,0x3ee6bf0c,0xbec9bf17,0xbf2d3e52,0xbf35a6c8,0xbe0d3f32,0x3f273e8b,0x3ec9bf17,0xbf273e8b,0x3e523f2d,0x3f32be0d,0xbd8ebf34
.long 0x3f00bf00,0xbf00bf00,0xbf003f00,0x3f003f00,0x3e8bbf27,0xbf2dbe52,0xbe0d3f32,0x3f343d8e,0xa5e03f35,0x3f32be0d,0xbe8bbf27,0xbf173ec9,0x3e8b3f27,0x3f0cbee6,0xbf17bec9,0xbe523f2d
.long 0xbf00bf00,0xbe8b3f27,0x3f35279c,0xbe8bbf27,0xbf27be8b,0x3d8e3f34,0x3f17bec9,0xbf20beab,0x3f35a650,0xbec9bf17,0xbe8b3f27,0x3f32be0d,0x3f27be8b,0xbf20beab,0x3e0d3f32,0x3ee6bf0c
.long 0xbf003f00,0x3f35a610,0xbf00bf00,0xa6703f35,0xbe8b3f27,0x3f20beab,0xbf32be0d,0x3ee63f0c,0x276cbf35,0xbec93f17,0x3f27be8b,0xbf32be0d,0xbe8bbf27,0xbd8e3f34,0x3ec9bf17,0xbf203eab
.long 0x3f003f00,0xbe8bbf27,0xa7da3f35,0x3e8bbf27,0x3f273e8b,0xbf0cbee6,0x3ec93f17,0xbe52bf2d,0xbf35a724,0x3f323e0d,0xbf27be8b,0x3f173ec9,0xbf273e8b,0x3f2dbe52,0xbf323e0d,0x3f34bd8e
.long 0x3f00bf00,0x3f00bf00,0x3f00bf00,0x3f00bf00,0x2480bf35,0xbd8ebf34,0xbe0dbf32,0xbe52bf2d,0x3f003f00,0x3f173ec9,0x3f273e8b,0x3f323e0d,0x3f352540,0x3f2dbe52,0x3f17bec9,0x3ee6bf0c
.long 0xbf003f00,0xbe8b3f27,0x25e03f35,0x3e8b3f27,0xa6883f35,0x3eab3f20,0x3f173ec9,0x3f343d8e,0xbf00bf00,0xbf32be0d,0xbf273e8b,0xbec93f17,0xbf352540,0xbf0c3ee6,0xbe0d3f32,0x3eab3f20
.long 0x3f00bf00,0xa480bf35,0xbf00bf00,0xbf35a6a8,0x26a8bf35,0xbf0cbee6,0xbf323e0d,0xbeab3f20,0x3f003f00,0x3f32be0d,0x3e8bbf27,0xbec9bf17,0x3f352480,0x3eabbf20,0xbec9bf17,0xbf343d8e
.long 0xbf003f00,0x3e8b3f27,0x3f35a698,0x3e8bbf27,0xa6d83f35,0x3f2d3e52,0x3ec9bf17,0xbee6bf0c,0xbf00bf00,0xbf173ec9,0x3e8b3f27,0x3f32be0d,0xbf35a5e0,0xbd8e3f34,0x3f323e0d,0x3e52bf2d
.long 0x3f00bf00,0xbf00bf00,0xbf003f00,0x3f003f00,0x26f8bf35,0xbf343d8e,0x3e0d3f32,0x3f2dbe52,0x3f003f00,0x3ec9bf17,0xbf27be8b,0xbe0d3f32,0x3f352764,0xbe52bf2d,0xbf173ec9,0x3f0c3ee6
.long 0xbf003f00,0x3f273e8b,0xa6f8bf35,0xbf273e8b,0x26103f35,0x3f20beab,0xbf17bec9,0xbd8e3f34,0xbf00bf00,0xbe0d3f32,0x3f27be8b,0xbf17bec9,0xbf35a670,0x3ee63f0c,0x3e0dbf32,0xbf203eab
.long 0x3f00bf00,0xbf35a724,0x3f003f00,0x2782bf35,0x2724bf35,0xbee63f0c,0x3f32be0d,0xbf20beab,0x3f003f00,0xbe0dbf32,0xbe8b3f27,0x3f17bec9,0x3f352782,0xbf20beab,0x3ec93f17,0xbd8ebf34
.long 0xbf003f00,0x3f27be8b,0xbf352807,0x3f273e8b,0xa7b63f35,0x3e52bf2d,0xbec93f17,0x3f0cbee6,0xbf00bf00,0x3ec93f17,0xbe8bbf27,0x3e0d3f32,0xbf35a7e6,0x3f343d8e,0xbf32be0d,0x3f2d3e52
.long 0x3f00bf00,0x3f00bf00,0x3f00bf00,0x3f00bf00,0xbe8bbf27,0xbeabbf20,0xbec9bf17,0xbee6bf0c,0x3f352540,0x3f32be0d,0x3f27be8b,0x3f17bec9,0x3e8bbf27,0x3d8ebf34,0xbe0dbf32,0xbeabbf20
.long 0x3f003f00,0x3f273e8b,0x3f352688,0x3f27be8b,0x3f27be8b,0x3ee6bf0c,0x3e0dbf32,0xbe52bf2d,0x25403f35,0x3ec93f17,0x3f273e8b,0x3f32be0d,0x3f273e8b,0x3f2dbe52,0x3ec9bf17,0xbd8ebf34
.long 0xbf003f00,0x3f35,0x3f003f00,0x3f3526b8,0x3e8b3f27,0x3f2d3e52,0x3f17bec9,0x3d8ebf34,0xbf35a6c8,0xbec93f17,0x3e8b3f27,0x3f323e0d,0xbe8b3f27,0x3ee63f0c,0x3f32be0d,0x3e52bf2d
.long 0xbf00bf00,0xbf273e8b,0xa7c23f35,0x3f273e8b,0xbf273e8b,0x3d8e3f34,0x3f323e0d,0x3eabbf20,0x2754bf35,0xbf32be0d,0xbe8b3f27,0x3f173ec9,0xbf27be8b,0xbeab3f20,0x3f173ec9,0x3ee6bf0c
.long 0x3f00bf00,0xbf00bf00,0xbf003f00,0x3f003f00,0xbe8bbf27,0xbf203eab,0x3ec93f17,0x3f0cbee6,0x3f35a610,0xbe0dbf32,0xbf273e8b,0x3ec93f17,0x3e8bbf27,0xbf34bd8e,0x3e0d3f32,0x3f20beab
.long 0x3f003f00,0x3e8bbf27,0xbf35a724,0x3e8b3f27,0x3f27be8b,0xbf0cbee6,0xbe0d3f32,0x3f2dbe52,0xa6983f35,0x3f17bec9,0xbf27be8b,0x3e0d3f32,0x3f273e8b,0xbe52bf2d,0xbec93f17,0x3f34bd8e
.long 0xbf003f00,0x3f3527b6,0xbf00bf00,0xa7e63f35,0x3e8b3f27,0x3e52bf2d,0xbf173ec9,0x3f343d8e,0xbf35a73c,0x3f173ec9,0xbe8bbf27,0xbe0d3f32,0xbe8b3f27,0x3f0cbee6,0xbf323e0d,0x3f2d3e52
.long 0xbf00bf00,0x3e8b3f27,0x2825bf35,0xbe8b3f27,0xbf273e8b,0x3f34bd8e,0xbf32be0d,0x3f203eab,0xa670bf35,0xbe0d3f32,0x3e8bbf27,0xbec93f17,0xbf27be8b,0x3f203eab,0xbf17bec9,0x3f0c3ee6
.long 0xbf003f00,0xbf003f00,0xbf003f00,0xbf003f00,0xbf00bf00,0xbee6bf0c,0xbec9bf17,0xbeabbf20,0xbf003f00,0xbf173ec9,0xbf273e8b,0xbf323e0d,0xbf00bf00,0xbeabbf20,0xbe0dbf32,0x3d8ebf34
.long 0xbf003f00,0xbf273e8b,0xbf352480,0xbf27be8b,0xbf00bf00,0xbe52bf2d,0x3e0dbf32,0x3ee6bf0c,0xbf003f00,0xbf323e0d,0xbf27be8b,0xbec9bf17,0xbf00bf00,0xbd8ebf34,0x3ec9bf17,0x3f2dbe52
.long 0xbf003f00,0xbf352480,0xbf00bf00,0xa480bf35,0xbf00bf00,0x3d8ebf34,0x3f17bec9,0x3f2d3e52,0xbf003f00,0xbf32be0d,0xbe8bbf27,0x3ec9bf17,0xbf00bf00,0x3e52bf2d,0x3f32be0d,0x3ee63f0c
.long 0xbf003f00,0xbf27be8b,0xa480bf35,0x3f27be8b,0xbf00bf00,0x3eabbf20,0x3f323e0d,0x3d8e3f34,0xbf003f00,0xbf17bec9,0x3e8bbf27,0x3f323e0d,0xbf00bf00,0x3ee6bf0c,0x3f173ec9,0xbeab3f20
.long 0xbf003f00,0xbf00bf00,0x3f00bf00,0x3f003f00,0xbf00bf00,0x3f0cbee6,0x3ec93f17,0xbf203eab,0xbf003f00,0xbec9bf17,0x3f27be8b,0x3e0d3f32,0xbf00bf00,0x3f20beab,0x3e0d3f32,0xbf34bd8e
.long 0xbf003f00,0xbe8bbf27,0x3f35a500,0xbe8b3f27,0xbf00bf00,0x3f2dbe52,0xbe0d3f32,0xbf0cbee6,0xbf003f00,0xbe0dbf32,0x3f273e8b,0xbf173ec9,0xbf00bf00,0x3f34bd8e,0xbec93f17,0xbe52bf2d
.long 0xbf003f00,0xa480bf35,0x3f003f00,0xbf352540,0xbf00bf00,0x3f343d8e,0xbf173ec9,0x3e52bf2d,0xbf003f00,0x3e0dbf32,0x3e8b3f27,0xbf17bec9,0xbf00bf00,0x3f2d3e52,0xbf323e0d,0x3f0cbee6
.long 0xbf003f00,0x3e8bbf27,0x25403f35,0xbe8bbf27,0xbf00bf00,0x3f203eab,0xbf32be0d,0x3f34bd8e,0xbf003f00,0x3ec9bf17,0xbe8b3f27,0x3e0dbf32,0xbf00bf00,0x3f0c3ee6,0xbf17bec9,0x3f203eab
.long 0xbf003f00,0xbf003f00,0xbf003f00,0xbf003f00,0xbe8bbf27,0xbe52bf2d,0xbe0dbf32,0xbd8ebf34,0xbf352480,0xbf32be0d,0xbf27be8b,0xbf17bec9,0x3e8bbf27,0x3ee6bf0c,0x3f17bec9,0x3f2dbe52
.long 0xbf00bf00,0xbe8bbf27,0xa480bf35,0x3e8bbf27,0x3f27be8b,0x3f343d8e,0x3f173ec9,0x3eab3f20,0xa480bf35,0x3ec9bf17,0x3f27be8b,0x3f323e0d,0x3f273e8b,0x3eab3f20,0xbe0d3f32,0xbf0c3ee6
.long 0x3f00bf00,0x3f35a500,0x3f003f00,0x25403f35,0x3e8b3f27,0xbeab3f20,0xbf323e0d,0xbf0cbee6,0x3f35a500,0x3ec93f17,0xbe8b3f27,0xbf323e0d,0xbe8b3f27,0xbf343d8e,0xbec9bf17,0x3eabbf20
.long 0x3f003f00,0xbe8b3f27,0xbf352540,0xbe8bbf27,0xbf273e8b,0xbee6bf0c,0x3ec9bf17,0x3f2d3e52,0x25403f35,0xbf323e0d,0xbe8bbf27,0x3f17bec9,0xbf27be8b,0x3e52bf2d,0x3f323e0d,0xbd8e3f34
.long 0xbf003f00,0xbf00bf00,0x3f00bf00,0x3f003f00,0xbe8bbf27,0x3f2dbe52,0x3e0d3f32,0xbf343d8e,0xbf352540,0x3e0dbf32,0x3f273e8b,0xbec93f17,0x3e8bbf27,0x3f0c3ee6,0xbf173ec9,0xbe52bf2d
.long 0xbf00bf00,0x3f27be8b,0x26883f35,0xbf27be8b,0x3f27be8b,0xbd8e3f34,0xbf17bec9,0x3f20beab,0xa670bf35,0x3f173ec9,0xbf273e8b,0x3e0dbf32,0x3f273e8b,0xbf203eab,0x3e0dbf32,0x3ee63f0c
.long 0x3f00bf00,0x26883f35,0xbf00bf00,0x3f352540,0x3e8b3f27,0xbf20beab,0x3f32be0d,0xbee63f0c,0x3f3525e0,0xbf173ec9,0x3e8bbf27,0x3e0d3f32,0xbe8b3f27,0xbd8ebf34,0x3ec93f17,0xbf20beab
.long 0x3f003f00,0xbf27be8b,0x3f352540,0xbf273e8b,0xbf273e8b,0x3f0cbee6,0xbec93f17,0x3e52bf2d,0x26883f35,0xbe0dbf32,0x3e8b3f27,0xbec9bf17,0xbf27be8b,0x3f2d3e52,0xbf32be0d,0x3f343d8e
.long 0xbf003f00,0xbf003f00,0xbf003f00,0xbf003f00,0xa480bf35,0x3d8ebf34,0x3e0dbf32,0x3e52bf2d,0xbf00bf00,0xbec9bf17,0xbe8bbf27,0xbe0dbf32,0x3f35a480,0x3f2d3e52,0x3f173ec9,0x3ee63f0c
.long 0x3f00bf00,0x3f27be8b,0x3f35a500,0x3f273e8b,0x25003f35,0xbeab3f20,0xbf173ec9,0xbf343d8e,0x3f003f00,0x3e0d3f32,0xbe8b3f27,0xbf173ec9,0xbf352540,0xbf0cbee6,0xbe0dbf32,0x3eabbf20
.long 0xbf003f00,0xbf352540,0xbf00bf00,0xa670bf35,0xa540bf35,0x3f0cbee6,0x3f323e0d,0x3eab3f20,0xbf00bf00,0x3e0dbf32,0x3f27be8b,0x3f173ec9,0x3f35a670,0x3eab3f20,0xbec93f17,0xbf34bd8e
.long 0x3f00bf00,0x3f273e8b,0x26883f35,0xbf273e8b,0xa5e03f35,0xbf2d3e52,0xbec9bf17,0x3ee6bf0c,0x3f003f00,0xbec93f17,0xbf27be8b,0x3e0dbf32,0xbf352688,0xbd8ebf34,0x3f32be0d,0x3e523f2d
.long 0xbf003f00,0xbf00bf00,0x3f00bf00,0x3f003f00,0x25a0bf35,0x3f343d8e,0xbe0d3f32,0xbf2dbe52,0xbf00bf00,0x3f17bec9,0x3e8b3f27,0xbf323e0d,0x3f35a698,0xbe523f2d,0xbf17bec9,0x3f0cbee6
.long 0x3f00bf00,0x3e8b3f27,0xbf35a480,0x3e8bbf27,0xa5403f35,0xbf20beab,0x3f17bec9,0x3d8e3f34,0x3f003f00,0xbf323e0d,0x3e8bbf27,0x3ec93f17,0xbf3526a8,0x3ee6bf0c,0x3e0d3f32,0xbf20beab
.long 0xbf003f00,0xa6a8bf35,0x3f003f00,0xbf35273c,0x2480bf35,0x3ee63f0c,0xbf32be0d,0x3f20beab,0xbf00bf00,0x3f323e0d,0xbf273e8b,0x3ec9bf17,0x3f35a6a8,0xbf203eab,0x3ec9bf17,0xbd8e3f34
.long 0x3f00bf00,0xbe8b3f27,0xa6c8bf35,0x3e8b3f27,0x80003f35,0xbe52bf2d,0x3ec93f17,0xbf0cbee6,0x3f003f00,0xbf17bec9,0x3f273e8b,0xbf32be0d,0xbf3526b8,0x3f34bd8e,0xbf323e0d,0x3f2dbe52
.long 0xbf003f00,0xbf003f00,0xbf003f00,0xbf003f00,0x3e8bbf27,0x3eabbf20,0x3ec9bf17,0x3ee6bf0c,0xa480bf35,0x3e0dbf32,0x3e8bbf27,0x3ec9bf17,0x3e8b3f27,0x3d8e3f34,0xbe0d3f32,0xbeab3f20
.long 0x3f003f00,0x3e8b3f27,0x25403f35,0xbe8b3f27,0xbf27be8b,0xbee6bf0c,0xbe0dbf32,0x3e52bf2d,0xbf352540,0xbf17bec9,0xbe8bbf27,0x3e0dbf32,0x3f27be8b,0x3f2d3e52,0x3ec93f17,0xbd8e3f34
.long 0x3f00bf00,0x3f3525e0,0x3f003f00,0x26883f35,0xbe8b3f27,0xbf2d3e52,0xbf17bec9,0xbd8ebf34,0x26883f35,0xbf173ec9,0xbf27be8b,0xbe0dbf32,0xbe8bbf27,0x3ee6bf0c,0x3f323e0d,0x3e523f2d
.long 0xbf00bf00,0x3e8bbf27,0x3f352540,0x3e8b3f27,0x3f273e8b,0xbd8e3f34,0xbf323e0d,0xbeabbf20,0x3f352540,0x3e0d3f32,0xbf273e8b,0xbec9bf17,0xbf273e8b,0xbeabbf20,0x3f17bec9,0x3ee63f0c
.long 0xbf003f00,0xbf00bf00,0x3f00bf00,0x3f003f00,0x3e8bbf27,0x3f203eab,0xbec93f17,0xbf0cbee6,0xa6a8bf35,0x3f323e0d,0xbe8b3f27,0xbf17bec9,0x3e8b3f27,0xbf343d8e,0x3e0dbf32,0x3f203eab
.long 0x3f003f00,0xbf273e8b,0xa6c8bf35,0x3f273e8b,0xbf27be8b,0x3f0cbee6,0x3e0d3f32,0xbf2dbe52,0xbf352480,0x3ec9bf17,0x3e8b3f27,0xbf32be0d,0x3f27be8b,0xbe523f2d,0xbec9bf17,0x3f343d8e
.long 0x3f00bf00,0xa6983f35,0xbf00bf00,0x3f35a7c2,0xbe8b3f27,0xbe52bf2d,0x3f173ec9,0xbf343d8e,0x26d83f35,0xbec9bf17,0x3f273e8b,0xbf323e0d,0xbe8bbf27,0x3f0c3ee6,0xbf32be0d,0x3f2dbe52
.long 0xbf00bf00,0x3f273e8b,0xbf352754,0x3f27be8b,0x3f273e8b,0xbf34bd8e,0x3f32be0d,0xbf203eab,0x3f35a5e0,0xbf323e0d,0x3f27be8b,0xbf173ec9,0xbf273e8b,0x3f20beab,0xbf173ec9,0x3f0cbee6
.long 0xbf003f00,0xbf003f00,0xbf003f00,0xbf003f00,0x3f00bf00,0x3f0cbee6,0x3f17bec9,0x3f20beab,0x3f00bf00,0x3f17bec9,0x3f27be8b,0x3f32be0d,0xbf003f00,0xbf203eab,0xbf323e0d,0xbf34bd8e
.long 0xbf003f00,0xbf273e8b,0xbf352540,0xbf27be8b,0x3f00bf00,0x3f2dbe52,0x3f323e0d,0x3f0c3ee6,0x3f00bf00,0x3f32be0d,0x3f273e8b,0x3ec93f17,0xbf003f00,0xbf343d8e,0xbf17bec9,0xbe52bf2d
.long 0xbf003f00,0xbf35a5a0,0xbf00bf00,0xa698bf35,0x3f00bf00,0x3f343d8e,0x3ec93f17,0xbe523f2d,0x3f00bf00,0x3f323e0d,0x3e8b3f27,0xbec93f17,0xbf003f00,0xbf2dbe52,0xbe0dbf32,0x3f0cbee6
.long 0xbf003f00,0xbf27be8b,0xa6a8bf35,0x3f27be8b,0x3f00bf00,0x3f203eab,0xbe0d3f32,0xbf343d8e,0x3f00bf00,0x3f173ec9,0xbe8b3f27,0xbf32be0d,0xbf003f00,0xbf0cbee6,0x3ec9bf17,0x3f203eab
.long 0xbf003f00,0xbf00bf00,0x3f00bf00,0x3f003f00,0x3f00bf00,0x3ee63f0c,0xbf173ec9,0xbeabbf20,0x3f00bf00,0x3ec93f17,0xbf273e8b,0xbe0dbf32,0xbf003f00,0xbeabbf20,0x3f32be0d,0xbd8e3f34
.long 0xbf003f00,0xbe8bbf27,0x3f35a5e0,0xbe8b3f27,0x3f00bf00,0x3e523f2d,0xbf32be0d,0x3ee6bf0c,0x3f00bf00,0x3e0d3f32,0xbf27be8b,0x3f17bec9,0xbf003f00,0xbd8ebf34,0x3f173ec9,0xbf2d3e52
.long 0xbf003f00,0x276cbf35,0x3f003f00,0xbf352764,0x3f00bf00,0xbd8e3f34,0xbec9bf17,0x3f2d3e52,0x3f00bf00,0xbe0d3f32,0xbe8bbf27,0x3f173ec9,0xbf003f00,0x3e52bf2d,0x3e0d3f32,0xbee6bf0c
.long 0xbf003f00,0x3e8bbf27,0xa6103f35,0xbe8bbf27,0x3f00bf00,0xbeab3f20,0x3e0dbf32,0x3d8e3f34,0x3f00bf00,0xbec93f17,0x3e8bbf27,0xbe0d3f32,0xbf003f00,0x3ee6bf0c,0xbec93f17,0x3eabbf20
.long 0xbf003f00,0xbf003f00,0xbf003f00,0xbf003f00,0x3f27be8b,0x3f2dbe52,0x3f32be0d,0x3f34bd8e,0x3f35a500,0x3f323e0d,0x3f273e8b,0x3f173ec9,0xbf27be8b,0xbf0cbee6,0xbec9bf17,0xbe52bf2d
.long 0xbf00bf00,0xbe8bbf27,0xa670bf35,0x3e8bbf27,0x3e8b3f27,0xbd8e3f34,0xbec93f17,0xbf203eab,0x26883f35,0xbec93f17,0xbf273e8b,0xbf32be0d,0x3e8bbf27,0x3f20beab,0x3f323e0d,0x3ee63f0c
.long 0x3f00bf00,0x3f352540,0x3f003f00,0x26a83f35,0xbf273e8b,0xbf20beab,0xbe0dbf32,0x3ee6bf0c,0xbf35a480,0xbec9bf17,0x3e8bbf27,0x3f32be0d,0x3f273e8b,0x3d8e3f34,0xbf173ec9,0xbf20beab
.long 0x3f003f00,0xbe8b3f27,0xbf35273c,0xbe8bbf27,0xbe8bbf27,0x3f0cbee6,0x3f173ec9,0xbe523f2d,0xa6c8bf35,0x3f32be0d,0x3e8b3f27,0xbf173ec9,0xbe8b3f27,0xbf2dbe52,0x3e0dbf32,0x3f343d8e
.long 0xbf003f00,0xbf00bf00,0x3f00bf00,0x3f003f00,0x3f27be8b,0x3e523f2d,0xbf323e0d,0xbd8ebf34,0x3f35a5e0,0xbe0d3f32,0xbf27be8b,0x3ec9bf17,0xbf27be8b,0x3ee6bf0c,0x3ec93f17,0xbf2d3e52
.long 0xbf00bf00,0x3f27be8b,0x279c3f35,0xbf27be8b,0x3e8b3f27,0xbf34bd8e,0x3ec9bf17,0x3eab3f20,0xa6503f35,0xbf17bec9,0x3f27be8b,0xbe0d3f32,0x3e8bbf27,0x3eab3f20,0xbf32be0d,0x3f0cbee6
.long 0x3f00bf00,0xa6103f35,0xbf00bf00,0x3f35a670,0xbf273e8b,0x3eabbf20,0x3e0d3f32,0xbf0cbee6,0xbf35276c,0x3f17bec9,0xbe8b3f27,0xbe0dbf32,0x3f273e8b,0xbf343d8e,0x3f17bec9,0xbeab3f20
.long 0x3f003f00,0xbf27be8b,0x3f35a7da,0xbf273e8b,0xbe8bbf27,0x3ee63f0c,0xbf17bec9,0x3f2d3e52,0xa724bf35,0x3e0d3f32,0xbe8bbf27,0x3ec93f17,0xbe8b3f27,0x3e52bf2d,0xbe0d3f32,0x3d8ebf34
.long 0xbf003f00,0xbf003f00,0xbf003f00,0xbf003f00,0x3f35a480,0x3f343d8e,0x3f323e0d,0x3f2d3e52,0x3f003f00,0x3ec93f17,0x3e8b3f27,0x3e0d3f32,0xa540bf35,0x3e52bf2d,0x3ec9bf17,0x3f0cbee6
.long 0x3f00bf00,0x3f27be8b,0x3f3525e0,0x3f273e8b,0xbf352688,0xbf20beab,0xbec9bf17,0xbd8ebf34,0xbf00bf00,0xbe0dbf32,0x3e8bbf27,0x3f17bec9,0xa5403f35,0xbee63f0c,0xbf323e0d,0xbf20beab
.long 0xbf003f00,0xbf35a480,0xbf00bf00,0xa6a8bf35,0x3f35a6a8,0x3ee63f0c,0xbe0d3f32,0xbf203eab,0x3f003f00,0xbe0d3f32,0xbf273e8b,0xbf17bec9,0xa480bf35,0x3f20beab,0x3f173ec9,0xbd8e3f34
.long 0x3f00bf00,0x3f273e8b,0xa6983f35,0xbf273e8b,0xbf3526d8,0xbe52bf2d,0x3f17bec9,0x3f0c3ee6,0xbf00bf00,0x3ec9bf17,0x3f273e8b,0xbe0d3f32,0x25e03f35,0xbf343d8e,0xbe0dbf32,0x3f2dbe52
.long 0xbf003f00,0xbf00bf00,0x3f00bf00,0x3f003f00,0x3f35a6f8,0xbd8e3f34,0xbf32be0d,0x3e52bf2d,0x3f003f00,0xbf173ec9,0xbe8bbf27,0x3f32be0d,0xa764bf35,0x3f2d3e52,0xbec93f17,0xbee6bf0c
.long 0x3f00bf00,0x3e8b3f27,0xbf35a6f8,0x3e8bbf27,0xbf35a610,0x3eabbf20,0x3ec93f17,0xbf343d8e,0xbf00bf00,0x3f32be0d,0xbe8b3f27,0xbec9bf17,0x26703f35,0xbf0cbee6,0x3f32be0d,0xbeab3f20
.long 0xbf003f00,0xa724bf35,0x3f003f00,0xbf352782,0x3f35a724,0xbf0c3ee6,0x3e0dbf32,0x3eab3f20,0x3f003f00,0xbf32be0d,0x3f27be8b,0xbec93f17,0xa782bf35,0x3eab3f20,0xbf17bec9,0x3f343d8e
.long 0x3f00bf00,0xbe8b3f27,0x2807bf35,0x3e8b3f27,0xbf3527b6,0x3f2dbe52,0xbf173ec9,0x3ee6bf0c,0xbf00bf00,0x3f173ec9,0xbf27be8b,0x3f323e0d,0x27e63f35,0xbd8ebf34,0x3e0d3f32,0xbe52bf2d
.long 0xbf003f00,0xbf003f00,0xbf003f00,0xbf003f00,0x3f273e8b,0x3f203eab,0x3f173ec9,0x3f0c3ee6,0x25403f35,0xbe0d3f32,0xbe8b3f27,0xbec93f17,0x3f27be8b,0x3f34bd8e,0x3f323e0d,0x3f203eab
.long 0x3f003f00,0x3e8b3f27,0x26883f35,0xbe8b3f27,0x3e8bbf27,0x3f0cbee6,0x3f32be0d,0x3f2d3e52,0x3f352540,0x3f173ec9,0x3e8b3f27,0xbe0d3f32,0xbe8bbf27,0x3e52bf2d,0x3f17bec9,0x3f343d8e
.long 0x3f00bf00,0x3f350000,0x3f003f00,0x26b83f35,0xbf27be8b,0xbe52bf2d,0x3ec9bf17,0x3f34bd8e,0xa6c8bf35,0x3f17bec9,0x3f273e8b,0x3e0d3f32,0xbf273e8b,0xbf0cbee6,0x3e0dbf32,0x3f2dbe52
.long 0xbf00bf00,0x3e8bbf27,0x3f35a7c2,0x3e8b3f27,0xbe8b3f27,0xbf34bd8e,0xbe0dbf32,0x3f20beab,0xbf352754,0xbe0dbf32,0x3f27be8b,0x3ec93f17,0x3e8b3f27,0xbf203eab,0xbec9bf17,0x3f0cbee6
.long 0xbf003f00,0xbf00bf00,0x3f00bf00,0x3f003f00,0x3f273e8b,0xbeab3f20,0xbf17bec9,0x3ee6bf0c,0xa6103f35,0xbf32be0d,0x3e8bbf27,0x3f173ec9,0x3f27be8b,0x3d8e3f34,0xbf32be0d,0x3eabbf20
.long 0x3f003f00,0xbf273e8b,0xa724bf35,0x3f273e8b,0x3e8bbf27,0x3ee63f0c,0xbf323e0d,0x3e52bf2d,0x3f35a698,0xbec93f17,0xbe8bbf27,0x3f323e0d,0xbe8bbf27,0x3f2d3e52,0xbf173ec9,0x3d8ebf34
.long 0x3f00bf00,0x27b63f35,0xbf00bf00,0x3f35a7e6,0xbf27be8b,0x3f2dbe52,0xbec93f17,0xbd8ebf34,0xa73cbf35,0x3ec93f17,0xbf27be8b,0x3f32be0d,0xbf273e8b,0x3ee6bf0c,0xbe0d3f32,0xbe52bf2d
.long 0xbf00bf00,0x3f273e8b,0xbf352825,0x3f27be8b,0xbe8b3f27,0x3d8ebf34,0x3e0d3f32,0xbeabbf20,0xbf35a670,0x3f32be0d,0xbf273e8b,0x3f17bec9,0x3e8b3f27,0xbeabbf20,0x3ec93f17,0xbee6bf0c
.long 0x3f003f00,0xbf00bf00,0x3f003f00,0xbf00bf00,0xbf003f00,0x3ee6bf0c,0xbec93f17,0x3eabbf20,0x3f003f00,0xbf17bec9,0x3f273e8b,0xbf32be0d,0xbf003f00,0x3eabbf20,0xbe0d3f32,0xbd8ebf34
.long 0x3f003f00,0xbf27be8b,0x3f352540,0xbf273e8b,0xbf003f00,0x3e52bf2d,0x3e0d3f32,0xbee6bf0c,0x3f003f00,0xbf32be0d,0x3f27be8b,0xbec93f17,0xbf003f00,0x3d8ebf34,0x3ec93f17,0xbf2dbe52
.long 0x3f003f00,0xbf35a500,0x3f00bf00,0xa6883f35,0xbf003f00,0xbd8ebf34,0x3f173ec9,0xbf2d3e52,0x3f003f00,0xbf323e0d,0x3e8bbf27,0x3ec93f17,0xbf003f00,0xbe52bf2d,0x3f323e0d,0xbee63f0c
.long 0x3f003f00,0xbf273e8b,0x2670bf35,0x3f273e8b,0xbf003f00,0xbeabbf20,0x3f32be0d,0xbd8e3f34,0x3f003f00,0xbf173ec9,0xbe8bbf27,0x3f32be0d,0xbf003f00,0xbee6bf0c,0x3f17bec9,0x3eab3f20
.long 0x3f003f00,0xbf003f00,0xbf00bf00,0x3f00bf00,0xbf003f00,0xbf0cbee6,0x3ec9bf17,0x3f203eab,0x3f003f00,0xbec93f17,0xbf27be8b,0x3e0dbf32,0xbf003f00,0xbf20beab,0x3e0dbf32,0x3f34bd8e
.long 0x3f003f00,0xbe8b3f27,0xbf3525e0,0xbe8bbf27,0xbf003f00,0xbf2dbe52,0xbe0dbf32,0x3f0cbee6,0x3f003f00,0xbe0d3f32,0xbf273e8b,0xbf17bec9,0xbf003f00,0xbf34bd8e,0xbec9bf17,0x3e52bf2d
.long 0x3f003f00,0xa5403f35,0xbf003f00,0xbf352540,0xbf003f00,0xbf343d8e,0xbf17bec9,0xbe52bf2d,0x3f003f00,0x3e0d3f32,0xbe8b3f27,0xbf173ec9,0xbf003f00,0xbf2d3e52,0xbf32be0d,0xbf0cbee6
.long 0x3f003f00,0x3e8b3f27,0xa6883f35,0xbe8b3f27,0xbf003f00,0xbf203eab,0xbf323e0d,0xbf34bd8e,0x3f003f00,0x3ec93f17,0x3e8b3f27,0x3e0d3f32,0xbf003f00,0xbf0c3ee6,0xbf173ec9,0xbf203eab
.long 0x3f003f00,0xbf00bf00,0x3f003f00,0xbf00bf00,0xbe8b3f27,0x3e52bf2d,0xbe0d3f32,0x3d8ebf34,0x3f35a5a0,0xbf323e0d,0x3f27be8b,0xbf173ec9,0x3e8b3f27,0xbee6bf0c,0x3f173ec9,0xbf2dbe52
.long 0x3f00bf00,0xbe8b3f27,0x26a8bf35,0x3e8b3f27,0x3f273e8b,0xbf343d8e,0x3f17bec9,0xbeab3f20,0x2698bf35,0x3ec93f17,0xbf27be8b,0x3f32be0d,0x3f27be8b,0xbeab3f20,0xbe0dbf32,0x3f0c3ee6
.long 0xbf00bf00,0x3f35a480,0xbf003f00,0x26c8bf35,0x3e8bbf27,0x3eab3f20,0xbf32be0d,0x3f0cbee6,0xbf352540,0x3ec9bf17,0x3e8b3f27,0xbf32be0d,0xbe8bbf27,0x3f343d8e,0xbec93f17,0xbeabbf20
.long 0xbf003f00,0xbe8bbf27,0x3f352480,0xbe8b3f27,0xbf27be8b,0x3ee6bf0c,0x3ec93f17,0xbf2d3e52,0xa6a83f35,0xbf32be0d,0x3e8bbf27,0x3f173ec9,0xbf273e8b,0xbe52bf2d,0x3f32be0d,0x3d8e3f34
.long 0x3f003f00,0xbf003f00,0xbf00bf00,0x3f00bf00,0xbe8b3f27,0xbf2dbe52,0x3e0dbf32,0x3f343d8e,0x3f35a480,0x3e0d3f32,0xbf273e8b,0xbec9bf17,0x3e8b3f27,0xbf0c3ee6,0xbf17bec9,0x3e52bf2d
.long 0x3f00bf00,0x3f273e8b,0xa6d83f35,0xbf273e8b,0x3f273e8b,0x3d8e3f34,0xbf173ec9,0xbf20beab,0x26a8bf35,0x3f17bec9,0x3f273e8b,0x3e0d3f32,0x3f27be8b,0x3f203eab,0x3e0d3f32,0xbee63f0c
.long 0xbf00bf00,0x26c8bf35,0x3f00bf00,0x3f352754,0x3e8bbf27,0x3f20beab,0x3f323e0d,0x3ee63f0c,0xbf350000,0xbf17bec9,0xbe8bbf27,0x3e0dbf32,0xbe8bbf27,0x3d8ebf34,0x3ec9bf17,0x3f20beab
.long 0xbf003f00,0xbf273e8b,0xbf35a5e0,0xbf27be8b,0xbf27be8b,0xbf0cbee6,0xbec9bf17,0xbe52bf2d,0xa6b83f35,0xbe0d3f32,0xbe8b3f27,0xbec93f17,0xbf273e8b,0xbf2d3e52,0xbf323e0d,0xbf343d8e
.long 0x3f003f00,0xbf00bf00,0x3f003f00,0xbf00bf00,0xa4803f35,0xbd8ebf34,0x3e0d3f32,0xbe52bf2d,0x3f00bf00,0xbec93f17,0x3e8bbf27,0xbe0d3f32,0x3f3526c8,0xbf2d3e52,0x3f17bec9,0xbee63f0c
.long 0xbf00bf00,0x3f273e8b,0xbf35a5e0,0x3f27be8b,0x2540bf35,0x3eab3f20,0xbf17bec9,0x3f343d8e,0xbf003f00,0x3e0dbf32,0x3e8b3f27,0xbf17bec9,0xbf35a6d8,0x3f0cbee6,0xbe0d3f32,0xbeabbf20
.long 0x3f003f00,0xbf35a5e0,0x3f00bf00,0xa79c3f35,0xa7483f35,0xbf0cbee6,0x3f32be0d,0xbeab3f20,0x3f00bf00,0x3e0d3f32,0xbf27be8b,0x3f17bec9,0x3f3526e0,0xbeab3f20,0xbec9bf17,0x3f34bd8e
.long 0xbf00bf00,0x3f27be8b,0x26503f35,0xbf27be8b,0x25e0bf35,0x3f2d3e52,0xbec93f17,0xbee6bf0c,0xbf003f00,0xbec9bf17,0x3f27be8b,0x3e0d3f32,0xbf352670,0x3d8ebf34,0x3f323e0d,0xbe523f2d
.long 0x3f003f00,0xbf003f00,0xbf00bf00,0x3f00bf00,0xa7543f35,0xbf343d8e,0xbe0dbf32,0x3f2dbe52,0x3f00bf00,0x3f173ec9,0xbe8b3f27,0xbf32be0d,0x3f3526f8,0x3e523f2d,0xbf173ec9,0xbf0cbee6
.long 0xbf00bf00,0x3e8bbf27,0x3f35276c,0x3e8b3f27,0x2610bf35,0x3f20beab,0x3f173ec9,0xbd8e3f34,0xbf003f00,0xbf32be0d,0xbe8bbf27,0x3ec9bf17,0xbf352650,0xbee6bf0c,0x3e0dbf32,0x3f20beab
.long 0x3f003f00,0x26103f35,0xbf003f00,0xbf35a7da,0xa7643f35,0xbee63f0c,0xbf323e0d,0xbf20beab,0x3f00bf00,0x3f32be0d,0x3f273e8b,0x3ec93f17,0x3f35270c,0x3f203eab,0x3ec93f17,0x3d8e3f34
.long 0xbf00bf00,0xbe8bbf27,0x2724bf35,0x3e8bbf27,0x2650bf35,0x3e52bf2d,0x3ec9bf17,0x3f0cbee6,0xbf003f00,0xbf173ec9,0xbf273e8b,0xbf323e0d,0xbf352610,0xbf34bd8e,0xbf32be0d,0xbf2dbe52
.long 0x3f003f00,0xbf00bf00,0x3f003f00,0xbf00bf00,0x3e8b3f27,0xbeabbf20,0x3ec93f17,0xbee6bf0c,0x26f8bf35,0x3e0d3f32,0xbe8bbf27,0x3ec93f17,0x3e8bbf27,0xbd8e3f34,0xbe0dbf32,0x3eab3f20
.long 0xbf003f00,0x3e8bbf27,0x26103f35,0xbe8bbf27,0xbf273e8b,0x3ee6bf0c,0xbe0d3f32,0xbe52bf2d,0x3f352764,0xbf173ec9,0x3e8bbf27,0x3e0d3f32,0x3f273e8b,0xbf2d3e52,0x3ec9bf17,0x3d8e3f34
.long 0xbf00bf00,0x3f35a6f8,0xbf003f00,0x2724bf35,0xbe8bbf27,0x3f2d3e52,0xbf173ec9,0x3d8ebf34,0x26103f35,0xbf17bec9,0x3f27be8b,0xbe0d3f32,0xbe8b3f27,0xbee6bf0c,0x3f32be0d,0xbe523f2d
.long 0x3f00bf00,0x3e8b3f27,0xbf35a698,0x3e8bbf27,0x3f27be8b,0x3d8e3f34,0xbf32be0d,0x3eabbf20,0xbf35a670,0x3e0dbf32,0x3f273e8b,0xbec93f17,0xbf27be8b,0x3eabbf20,0x3f173ec9,0xbee63f0c
.long 0x3f003f00,0xbf003f00,0xbf00bf00,0x3f00bf00,0x3e8b3f27,0xbf203eab,0xbec9bf17,0x3f0cbee6,0x2724bf35,0x3f32be0d,0x3e8b3f27,0xbf173ec9,0x3e8bbf27,0x3f343d8e,0x3e0d3f32,0xbf203eab
.long 0xbf003f00,0xbf27be8b,0x273cbf35,0x3f27be8b,0xbf273e8b,0xbf0cbee6,0x3e0dbf32,0x3f2dbe52,0x3f352782,0x3ec93f17,0xbe8b3f27,0xbf323e0d,0x3f273e8b,0x3e523f2d,0xbec93f17,0xbf343d8e
.long 0xbf00bf00,0xa807bf35,0x3f00bf00,0x3f352825,0xbe8bbf27,0x3e52bf2d,0x3f17bec9,0x3f343d8e,0xa7b63f35,0xbec93f17,0xbf273e8b,0xbf32be0d,0xbe8b3f27,0xbf0c3ee6,0xbf323e0d,0xbf2dbe52
.long 0x3f00bf00,0x3f27be8b,0x3f35a670,0x3f273e8b,0x3f27be8b,0x3f34bd8e,0x3f323e0d,0x3f203eab,0xbf35a7e6,0xbf32be0d,0xbf27be8b,0xbf17bec9,0xbf27be8b,0xbf20beab,0xbf17bec9,0xbf0cbee6
.long 0x3f003f00,0xbf00bf00,0x3f003f00,0xbf00bf00,0x3f003f00,0xbf0cbee6,0x3f173ec9,0xbf20beab,0xbf00bf00,0x3f173ec9,0xbf27be8b,0x3f323e0d,0xbf00bf00,0x3f203eab,0xbf32be0d,0x3f34bd8e
.long 0x3f003f00,0xbf27be8b,0x3f352782,0xbf273e8b,0x3f003f00,0xbf2dbe52,0x3f32be0d,0xbf0c3ee6,0xbf00bf00,0x3f323e0d,0xbf273e8b,0x3ec9bf17,0xbf00bf00,0x3f343d8e,0xbf173ec9,0x3e52bf2d
.long 0x3f003f00,0xbf35a6a8,0x3f00bf00,0xa5403f35,0x3f003f00,0xbf343d8e,0x3ec9bf17,0x3e523f2d,0xbf00bf00,0x3f32be0d,0xbe8b3f27,0xbec9bf17,0xbf00bf00,0x3f2dbe52,0xbe0d3f32,0xbf0cbee6
.long 0x3f003f00,0xbf273e8b,0xa724bf35,0x3f273e8b,0x3f003f00,0xbf203eab,0xbe0dbf32,0x3f343d8e,0xbf00bf00,0x3f17bec9,0x3e8b3f27,0xbf323e0d,0xbf00bf00,0x3f0cbee6,0x3ec93f17,0xbf203eab
.long 0x3f003f00,0xbf003f00,0xbf00bf00,0x3f00bf00,0x3f003f00,0xbee63f0c,0xbf17bec9,0x3eabbf20,0xbf00bf00,0x3ec9bf17,0x3f273e8b,0xbe0d3f32,0xbf00bf00,0x3eabbf20,0x3f323e0d,0x3d8e3f34
.long 0x3f003f00,0xbe8b3f27,0xbf35a70c,0xbe8bbf27,0x3f003f00,0xbe523f2d,0xbf323e0d,0xbee6bf0c,0xbf00bf00,0x3e0dbf32,0x3f27be8b,0x3f173ec9,0xbf00bf00,0x3d8ebf34,0x3f17bec9,0x3f2d3e52
.long 0x3f003f00,0x279c3f35,0xbf003f00,0xbf35a85d,0x3f003f00,0x3d8e3f34,0xbec93f17,0xbf2d3e52,0xbf00bf00,0xbe0dbf32,0x3e8bbf27,0x3f17bec9,0xbf00bf00,0xbe52bf2d,0x3e0dbf32,0x3ee6bf0c
.long 0x3f003f00,0x3e8b3f27,0xa7da3f35,0xbe8b3f27,0x3f003f00,0x3eab3f20,0x3e0d3f32,0xbd8e3f34,0xbf00bf00,0xbec9bf17,0xbe8bbf27,0xbe0dbf32,0xbf00bf00,0xbee6bf0c,0xbec9bf17,0xbeabbf20
.long 0x3f003f00,0xbf00bf00,0x3f003f00,0xbf00bf00,0x3f273e8b,0xbf2dbe52,0x3f323e0d,0xbf34bd8e,0xbf35a6a8,0x3f32be0d,0xbf273e8b,0x3f17bec9,0xbf273e8b,0x3f0cbee6,0xbec93f17,0x3e52bf2d
.long 0x3f00bf00,0xbe8b3f27,0x280dbf35,0x3e8b3f27,0x3e8bbf27,0x3d8e3f34,0xbec9bf17,0x3f203eab,0xa5403f35,0xbec9bf17,0x3f273e8b,0xbf323e0d,0x3e8b3f27,0xbf20beab,0x3f32be0d,0xbee63f0c
.long 0xbf00bf00,0x3f35a670,0xbf003f00,0x2813bf35,0xbf27be8b,0x3f20beab,0xbe0d3f32,0xbee6bf0c,0x3f35a670,0xbec93f17,0xbe8bbf27,0x3f323e0d,0x3f27be8b,0xbd8e3f34,0xbf17bec9,0x3f20beab
.long 0xbf003f00,0xbe8bbf27,0x3f35282b,0xbe8b3f27,0xbe8b3f27,0xbf0cbee6,0x3f17bec9,0x3e523f2d,0xa70cbf35,0x3f323e0d,0xbe8b3f27,0xbf17bec9,0xbe8bbf27,0x3f2dbe52,0x3e0d3f32,0xbf343d8e
.long 0x3f003f00,0xbf003f00,0xbf00bf00,0x3f00bf00,0x3f273e8b,0xbe523f2d,0xbf32be0d,0x3d8ebf34,0xbf35a800,0xbe0dbf32,0x3f27be8b,0x3ec93f17,0xbf273e8b,0xbee6bf0c,0x3ec9bf17,0x3f2d3e52
.long 0x3f00bf00,0x3f273e8b,0xa84b3f35,0xbf273e8b,0x3e8bbf27,0x3f34bd8e,0x3ec93f17,0xbeab3f20,0xa7da3f35,0xbf173ec9,0xbf27be8b,0xbe0dbf32,0x3e8b3f27,0xbeab3f20,0xbf323e0d,0xbf0cbee6
.long 0xbf00bf00,0xa6a8bf35,0x3f00bf00,0x3f3527c2,0xbf27be8b,0xbeabbf20,0x3e0dbf32,0x3f0cbee6,0x3f3527b6,0x3f173ec9,0x3e8b3f27,0xbe0d3f32,0x3f27be8b,0x3f343d8e,0x3f173ec9,0x3eab3f20
.long 0xbf003f00,0xbf273e8b,0xbf35a86a,0xbf27be8b,0xbe8b3f27,0xbee63f0c,0xbf173ec9,0xbf2d3e52,0x278ebf35,0x3e0dbf32,0x3e8bbf27,0x3ec9bf17,0xbe8bbf27,0xbe52bf2d,0xbe0dbf32,0xbd8ebf34
.long 0x3f003f00,0xbf00bf00,0x3f003f00,0xbf00bf00,0x3f35a724,0xbf343d8e,0x3f32be0d,0xbf2d3e52,0xbf003f00,0x3ec9bf17,0xbe8b3f27,0x3e0dbf32,0x26703f35,0xbe52bf2d,0x3ec93f17,0xbf0cbee6
.long 0xbf00bf00,0x3f273e8b,0xbf35a70c,0x3f27be8b,0xbf35a610,0x3f20beab,0xbec93f17,0x3d8ebf34,0x3f00bf00,0xbe0d3f32,0xbe8bbf27,0x3f173ec9,0x270cbf35,0x3ee63f0c,0xbf32be0d,0x3f20beab
.long 0x3f003f00,0xbf352754,0x3f00bf00,0xa7da3f35,0x3f35276c,0xbee63f0c,0xbe0dbf32,0x3f203eab,0xbf003f00,0xbe0dbf32,0x3f273e8b,0xbf173ec9,0xa7aa3f35,0xbf20beab,0x3f17bec9,0x3d8e3f34
.long 0xbf00bf00,0x3f27be8b,0x281f3f35,0xbf27be8b,0xbf35a7da,0x3e52bf2d,0x3f173ec9,0xbf0c3ee6,0x3f00bf00,0x3ec93f17,0xbf273e8b,0xbe0dbf32,0x2807bf35,0x3f343d8e,0xbe0d3f32,0xbf2dbe52
.long 0x3f003f00,0xbf003f00,0xbf00bf00,0x3f00bf00,0x3f35a6a8,0x3d8e3f34,0xbf323e0d,0xbe52bf2d,0xbf003f00,0xbf17bec9,0x3e8bbf27,0x3f323e0d,0xa5403f35,0xbf2d3e52,0xbec9bf17,0x3ee6bf0c
.long 0xbf00bf00,0x3e8bbf27,0x3f352610,0x3e8b3f27,0xbf35a6e0,0xbeabbf20,0x3ec9bf17,0x3f343d8e,0x3f00bf00,0x3f323e0d,0x3e8b3f27,0xbec93f17,0x286abf35,0x3f0cbee6,0x3f323e0d,0x3eab3f20
.long 0x3f003f00,0x28133f35,0xbf003f00,0xbf35a8a7,0x3f35279c,0x3f0c3ee6,0x3e0d3f32,0xbeab3f20,0xbf003f00,0xbf323e0d,0xbf27be8b,0xbec9bf17,0x279c3f35,0xbeab3f20,0xbf173ec9,0xbf343d8e
.long 0xbf00bf00,0xbe8bbf27,0xa839bf35,0x3e8bbf27,0xbf35a800,0xbf2dbe52,0xbf17bec9,0xbee6bf0c,0x3f00bf00,0x3f17bec9,0x3f27be8b,0x3f32be0d,0xa6e0bf35,0x3d8ebf34,0x3e0dbf32,0x3e52bf2d
.long 0x3f003f00,0xbf00bf00,0x3f003f00,0xbf00bf00,0x3f27be8b,0xbf203eab,0x3f17bec9,0xbf0c3ee6,0xa7ce3f35,0xbe0dbf32,0x3e8b3f27,0xbec9bf17,0x3f273e8b,0xbf34bd8e,0x3f32be0d,0xbf203eab
.long 0xbf003f00,0x3e8bbf27,0xa7da3f35,0xbe8bbf27,0x3e8b3f27,0xbf0cbee6,0x3f323e0d,0xbf2d3e52,0xbf35a724,0x3f17bec9,0xbe8b3f27,0xbe0dbf32,0xbe8b3f27,0xbe52bf2d,0x3f173ec9,0xbf343d8e
.long 0xbf00bf00,0x3f35a7b6,0xbf003f00,0x278ebf35,0xbf273e8b,0x3e52bf2d,0x3ec93f17,0xbf34bd8e,0xa6a8bf35,0x3f173ec9,0xbf273e8b,0x3e0dbf32,0xbf27be8b,0x3f0cbee6,0x3e0d3f32,0xbf2dbe52
.long 0x3f00bf00,0x3e8b3f27,0xbf35a86a,0x3e8bbf27,0xbe8bbf27,0x3f34bd8e,0xbe0d3f32,0xbf20beab,0x3f3527c2,0xbe0d3f32,0xbf27be8b,0x3ec9bf17,0x3e8bbf27,0x3f203eab,0xbec93f17,0xbf0cbee6
.long 0x3f003f00,0xbf003f00,0xbf00bf00,0x3f00bf00,0x3f27be8b,0x3eab3f20,0xbf173ec9,0xbee6bf0c,0xa8573f35,0xbf323e0d,0xbe8bbf27,0x3f17bec9,0x3f273e8b,0xbd8e3f34,0xbf323e0d,0xbeabbf20
.long 0xbf003f00,0xbf27be8b,0x2832bf35,0x3f27be8b,0x3e8b3f27,0xbee63f0c,0xbf32be0d,0xbe52bf2d,0xbf3526e0,0xbec9bf17,0x3e8bbf27,0x3f32be0d,0xbe8b3f27,0xbf2d3e52,0xbf17bec9,0xbd8ebf34
.long 0xbf00bf00,0x27b6bf35,0x3f00bf00,0x3f352851,0xbf273e8b,0xbf2dbe52,0xbec9bf17,0x3d8ebf34,0x27b6bf35,0x3ec9bf17,0x3f27be8b,0x3f323e0d,0xbf27be8b,0xbee6bf0c,0xbe0dbf32,0x3e52bf2d
.long 0x3f00bf00,0x3f27be8b,0x3f3527f2,0x3f273e8b,0xbe8bbf27,0xbd8ebf34,0x3e0dbf32,0x3eabbf20,0x3f352851,0x3f323e0d,0x3f273e8b,0x3f173ec9,0x3e8bbf27,0x3eabbf20,0x3ec9bf17,0x3ee6bf0c
.long 0x3f003f00,0xbf00bf00,0x3f003f00,0xbf00bf00,0xbf003f00,0x3f0cbee6,0xbf173ec9,0x3f20beab,0x3f003f00,0xbec9bf17,0x3e8b3f27,0xbe0dbf32,0xbf003f00,0x3f20beab,0xbf323e0d,0x3f343d8e
.long 0x3f003f00,0xbe8bbf27,0x25403f35,0x3e8bbf27,0xbf003f00,0x3f2dbe52,0xbf32be0d,0x3f0c3ee6,0x3f003f00,0xbe0dbf32,0xbe8b3f27,0x3f17bec9,0xbf003f00,0x3f34bd8e,0xbf17bec9,0x3e523f2d
.long 0x3f003f00,0xa500bf35,0xbf003f00,0x3f35a688,0xbf003f00,0x3f343d8e,0xbec9bf17,0xbe523f2d,0x3f003f00,0x3e0dbf32,0xbf273e8b,0x3f173ec9,0xbf003f00,0x3f2d3e52,0xbe0dbf32,0xbf0c3ee6
.long 0x3f003f00,0x3e8bbf27,0xbf352670,0x3e8b3f27,0xbf003f00,0x3f203eab,0x3e0dbf32,0xbf343d8e,0x3f003f00,0x3ec9bf17,0xbf27be8b,0xbe0d3f32,0xbf003f00,0x3f0c3ee6,0x3ec9bf17,0xbf20beab
.long 0x3f003f00,0x3f00bf00,0xbf00bf00,0xbf003f00,0xbf003f00,0x3ee63f0c,0x3f17bec9,0xbeabbf20,0x3f003f00,0x3f17bec9,0xbe8bbf27,0xbf323e0d,0xbf003f00,0x3eab3f20,0x3f32be0d,0x3d8ebf34
.long 0x3f003f00,0x3f27be8b,0x25e0bf35,0xbf27be8b,0xbf003f00,0x3e523f2d,0x3f323e0d,0x3ee6bf0c,0x3f003f00,0x3f32be0d,0x3e8bbf27,0xbec9bf17,0xbf003f00,0x3d8e3f34,0x3f173ec9,0x3f2dbe52
.long 0x3f003f00,0x3f35a540,0x3f00bf00,0x2540bf35,0xbf003f00,0xbd8e3f34,0x3ec93f17,0x3f2d3e52,0x3f003f00,0x3f323e0d,0x3f27be8b,0x3ec9bf17,0xbf003f00,0xbe523f2d,0x3e0d3f32,0x3ee63f0c
.long 0x3f003f00,0x3f273e8b,0x3f35a688,0x3f27be8b,0xbf003f00,0xbeab3f20,0xbe0d3f32,0x3d8e3f34,0x3f003f00,0x3f173ec9,0x3f273e8b,0x3f323e0d,0xbf003f00,0xbee63f0c,0xbec93f17,0xbeab3f20
.long 0x3f003f00,0xbf00bf00,0x3f003f00,0xbf00bf00,0xbf273e8b,0x3f2dbe52,0xbf323e0d,0x3f34bd8e,0xa5a03f35,0x3e0dbf32,0xbe8b3f27,0x3ec9bf17,0xbf27be8b,0x3f0c3ee6,0xbec9bf17,0x3e523f2d
.long 0xbf003f00,0x3f27be8b,0xbf3526a8,0x3f273e8b,0xbe8bbf27,0xbd8e3f34,0x3ec9bf17,0xbf203eab,0xbf352698,0x3f173ec9,0xbe8bbf27,0xbe0d3f32,0x3e8bbf27,0xbf203eab,0x3f323e0d,0xbee6bf0c
.long 0xbf00bf00,0xa4803f35,0x3f00bf00,0xbf3526c8,0x3f27be8b,0xbf20beab,0x3e0d3f32,0x3ee6bf0c,0x2540bf35,0xbf173ec9,0x3f273e8b,0xbe0dbf32,0x3f273e8b,0xbd8ebf34,0xbf173ec9,0x3f203eab
.long 0x3f00bf00,0xbf27be8b,0x24803f35,0x3f27be8b,0x3e8b3f27,0x3f0cbee6,0xbf17bec9,0xbe523f2d,0x3f35a6a8,0xbe0dbf32,0xbf273e8b,0x3ec93f17,0xbe8b3f27,0x3f2d3e52,0x3e0dbf32,0xbf34bd8e
.long 0x3f003f00,0x3f00bf00,0xbf00bf00,0xbf003f00,0xbf273e8b,0x3e523f2d,0x3f32be0d,0xbd8ebf34,0xa4803f35,0x3f323e0d,0x3e8bbf27,0xbf17bec9,0xbf27be8b,0xbee63f0c,0x3ec93f17,0x3f2dbe52
.long 0xbf003f00,0x3e8b3f27,0x3f35a6d8,0x3e8bbf27,0xbe8bbf27,0xbf34bd8e,0xbec93f17,0x3eab3f20,0xbf3526a8,0xbec93f17,0x3e8b3f27,0x3f323e0d,0x3e8bbf27,0xbeabbf20,0xbf32be0d,0xbf0c3ee6
.long 0xbf00bf00,0xbf3526c8,0xbf003f00,0x27543f35,0x3f27be8b,0x3eabbf20,0xbe0dbf32,0xbf0cbee6,0xbf35,0xbec9bf17,0xbf27be8b,0xbf323e0d,0x3f273e8b,0x3f34bd8e,0x3f17bec9,0x3eabbf20
.long 0x3f00bf00,0x3e8bbf27,0xa5e0bf35,0xbe8bbf27,0x3e8b3f27,0x3ee63f0c,0x3f173ec9,0x3f2d3e52,0x3f35a6b8,0x3f32be0d,0x3f27be8b,0x3f17bec9,0xbe8b3f27,0xbe523f2d,0xbe0d3f32,0xbd8e3f34
.long 0x3f003f00,0xbf00bf00,0x3f003f00,0xbf00bf00,0xbf352480,0x3f343d8e,0xbf32be0d,0x3f2d3e52,0xbf003f00,0x3f17bec9,0xbf273e8b,0x3f32be0d,0xa6c8bf35,0xbe523f2d,0x3ec9bf17,0xbf0c3ee6
.long 0xbf00bf00,0x3e8b3f27,0xa5e0bf35,0xbe8b3f27,0x3f35a540,0xbf20beab,0x3ec93f17,0xbd8ebf34,0x3f00bf00,0xbf323e0d,0x3f273e8b,0xbec9bf17,0x26d83f35,0x3ee6bf0c,0xbf323e0d,0x3f203eab
.long 0x3f003f00,0xa5e0bf35,0xbf003f00,0x3f35a79c,0xbf352748,0x3ee63f0c,0x3e0dbf32,0xbf203eab,0xbf003f00,0x3f323e0d,0xbe8bbf27,0xbec93f17,0xa6e0bf35,0xbf203eab,0x3f173ec9,0x3d8ebf34
.long 0xbf00bf00,0xbe8b3f27,0x3f352650,0xbe8bbf27,0x3f35a5e0,0xbe52bf2d,0xbf173ec9,0x3f0c3ee6,0x3f00bf00,0xbf17bec9,0xbe8b3f27,0x3f323e0d,0xa6703f35,0x3f34bd8e,0xbe0dbf32,0xbf2d3e52
.long 0x3f003f00,0x3f00bf00,0xbf00bf00,0xbf003f00,0xbf352754,0xbd8e3f34,0x3f323e0d,0x3e52bf2d,0xbf003f00,0x3ec93f17,0x3f27be8b,0xbe0dbf32,0xa6f8bf35,0xbf2dbe52,0xbec93f17,0x3ee63f0c
.long 0xbf00bf00,0xbf273e8b,0x276c3f35,0x3f273e8b,0x3f35a610,0x3eabbf20,0xbec9bf17,0xbf343d8e,0x3f00bf00,0xbe0dbf32,0xbf27be8b,0xbf173ec9,0xa6503f35,0x3f0c3ee6,0x3f32be0d,0x3eabbf20
.long 0x3f003f00,0x3f352610,0x3f00bf00,0xa7dabf35,0xbf352764,0xbf0c3ee6,0xbe0d3f32,0x3eab3f20,0xbf003f00,0xbe0d3f32,0x3e8b3f27,0x3f173ec9,0xa70cbf35,0xbeabbf20,0xbf17bec9,0xbf34bd8e
.long 0xbf00bf00,0xbf27be8b,0xbf352724,0xbf273e8b,0x3f35a650,0x3f2dbe52,0x3f17bec9,0x3ee6bf0c,0x3f00bf00,0x3ec9bf17,0x3e8bbf27,0x3e0dbf32,0xa6103f35,0x3d8e3f34,0x3e0d3f32,0x3e523f2d
.long 0x3f003f00,0xbf00bf00,0x3f003f00,0xbf00bf00,0xbf27be8b,0x3f203eab,0xbf17bec9,0x3f0c3ee6,0xbf3526f8,0x3f323e0d,0xbf27be8b,0x3f173ec9,0x3f27be8b,0xbf343d8e,0x3f323e0d,0xbf20beab
.long 0x3f00bf00,0xbf273e8b,0x3f352610,0xbf27be8b,0xbe8b3f27,0x3f0cbee6,0xbf323e0d,0x3f2d3e52,0x27643f35,0x3ec9bf17,0xbf273e8b,0x3f323e0d,0xbe8bbf27,0xbe523f2d,0x3f17bec9,0xbf34bd8e
.long 0xbf00bf00,0xa6f83f35,0x3f00bf00,0xbf352724,0x3f273e8b,0xbe52bf2d,0xbec93f17,0x3f34bd8e,0x3f352610,0xbec9bf17,0xbe8b3f27,0x3f32be0d,0xbf273e8b,0x3f0c3ee6,0x3e0dbf32,0xbf2d3e52
.long 0xbf003f00,0x3f273e8b,0xa698bf35,0xbf273e8b,0x3e8bbf27,0xbf34bd8e,0x3e0d3f32,0x3f20beab,0xa670bf35,0xbf323e0d,0x3e8b3f27,0x3f17bec9,0x3e8b3f27,0x3f20beab,0xbec9bf17,0xbf0c3ee6
.long 0x3f003f00,0x3f00bf00,0xbf00bf00,0xbf003f00,0xbf27be8b,0xbeab3f20,0x3f173ec9,0x3ee6bf0c,0xbf352724,0xbe0d3f32,0x3f273e8b,0x3ec9bf17,0x3f27be8b,0xbd8ebf34,0xbf32be0d,0xbeab3f20
.long 0x3f00bf00,0xbe8bbf27,0xbf35273c,0xbe8b3f27,0xbe8b3f27,0x3ee63f0c,0x3f32be0d,0x3e52bf2d,0x27823f35,0x3f173ec9,0x3f27be8b,0x3e0dbf32,0xbe8bbf27,0xbf2dbe52,0xbf173ec9,0xbd8e3f34
.long 0xbf00bf00,0xbf35a807,0xbf003f00,0x28253f35,0x3f273e8b,0x3f2dbe52,0x3ec9bf17,0xbd8ebf34,0x3f35a7b6,0x3f17bec9,0x3e8bbf27,0xbe0dbf32,0xbf273e8b,0xbee63f0c,0xbe0d3f32,0x3e523f2d
.long 0xbf003f00,0xbe8b3f27,0xa6703f35,0x3e8b3f27,0x3e8bbf27,0x3d8ebf34,0xbe0dbf32,0xbeabbf20,0xa7e6bf35,0xbe0dbf32,0xbe8bbf27,0xbec9bf17,0x3e8b3f27,0x3eab3f20,0x3ec93f17,0x3ee63f0c
.long 0x3f003f00,0xbf00bf00,0x3f003f00,0xbf00bf00,0xbf00bf00,0x3ee63f0c,0xbec9bf17,0x3eab3f20,0xbf00bf00,0x3ec93f17,0xbe8bbf27,0x3e0d3f32,0x3f003f00,0xbeabbf20,0x3e0d3f32,0x3d8ebf34
.long 0x3f003f00,0xbe8bbf27,0x27823f35,0x3e8bbf27,0xbf00bf00,0x3e523f2d,0x3e0dbf32,0xbee63f0c,0xbf00bf00,0x3e0d3f32,0x3e8bbf27,0xbf173ec9,0x3f003f00,0xbd8ebf34,0xbec93f17,0x3f2dbe52
.long 0x3f003f00,0xa6a8bf35,0xbf003f00,0x3f35a540,0xbf00bf00,0xbd8e3f34,0x3f17bec9,0xbf2dbe52,0xbf00bf00,0xbe0d3f32,0x3f27be8b,0xbf17bec9,0x3f003f00,0x3e52bf2d,0xbf323e0d,0x3ee63f0c
.long 0x3f003f00,0x3e8bbf27,0xbf35a724,0x3e8b3f27,0xbf00bf00,0xbeab3f20,0x3f323e0d,0xbd8ebf34,0xbf00bf00,0xbec93f17,0x3f273e8b,0x3e0dbf32,0x3f003f00,0x3ee6bf0c,0xbf17bec9,0xbeab3f20
.long 0x3f003f00,0x3f00bf00,0xbf00bf00,0xbf003f00,0xbf00bf00,0xbf0c3ee6,0x3ec93f17,0x3f20beab,0xbf00bf00,0xbf173ec9,0x3e8b3f27,0x3f32be0d,0x3f003f00,0x3f20beab,0xbe0dbf32,0xbf34bd8e
.long 0x3f003f00,0x3f27be8b,0xa70cbf35,0xbf27be8b,0xbf00bf00,0xbf2d3e52,0xbe0d3f32,0x3f0c3ee6,0xbf00bf00,0xbf323e0d,0xbe8b3f27,0x3ec93f17,0x3f003f00,0x3f34bd8e,0x3ec9bf17,0xbe52bf2d
.long 0x3f003f00,0x3f35279c,0x3f00bf00,0xa85dbf35,0xbf00bf00,0xbf34bd8e,0xbf173ec9,0xbe523f2d,0xbf00bf00,0xbf32be0d,0xbf273e8b,0xbec93f17,0x3f003f00,0x3f2d3e52,0x3f32be0d,0x3f0cbee6
.long 0x3f003f00,0x3f273e8b,0x3f35a7da,0x3f27be8b,0xbf00bf00,0xbf20beab,0xbf32be0d,0xbf343d8e,0xbf00bf00,0xbf17bec9,0xbf27be8b,0xbf32be0d,0x3f003f00,0x3f0c3ee6,0x3f173ec9,0x3f203eab
.long 0x3f003f00,0xbf00bf00,0x3f003f00,0xbf00bf00,0xbe8bbf27,0x3e523f2d,0xbe0dbf32,0x3d8e3f34,0xa6a8bf35,0xbe0d3f32,0x3e8bbf27,0xbec93f17,0xbe8b3f27,0x3ee6bf0c,0xbf173ec9,0x3f2dbe52
.long 0xbf003f00,0x3f27be8b,0xbf35280d,0x3f273e8b,0x3f27be8b,0xbf34bd8e,0x3f173ec9,0xbeabbf20,0x3f35a540,0xbf17bec9,0x3e8b3f27,0x3e0dbf32,0xbf27be8b,0x3eab3f20,0x3e0dbf32,0xbf0c3ee6
.long 0xbf00bf00,0xa6703f35,0x3f00bf00,0xbf352813,0x3e8b3f27,0x3eabbf20,0xbf323e0d,0x3f0c3ee6,0xa6703f35,0x3f17bec9,0xbf27be8b,0x3e0d3f32,0x3e8bbf27,0xbf343d8e,0x3ec93f17,0x3eabbf20
.long 0x3f00bf00,0xbf27be8b,0x282b3f35,0x3f27be8b,0xbf273e8b,0x3ee63f0c,0x3ec9bf17,0xbf2dbe52,0xbf35a70c,0x3e0d3f32,0x3f27be8b,0xbec9bf17,0x3f273e8b,0x3e52bf2d,0xbf32be0d,0xbd8e3f34
.long 0x3f003f00,0x3f00bf00,0xbf00bf00,0xbf003f00,0xbe8bbf27,0xbf2d3e52,0x3e0d3f32,0x3f34bd8e,0xa800bf35,0xbf32be0d,0xbe8b3f27,0x3f173ec9,0xbe8b3f27,0x3f0c3ee6,0x3f17bec9,0xbe52bf2d
.long 0xbf003f00,0x3e8b3f27,0x3f35a84b,0x3e8bbf27,0x3f27be8b,0x3d8ebf34,0xbf17bec9,0xbf203eab,0x3f35a7da,0x3ec9bf17,0xbe8bbf27,0xbf32be0d,0xbf27be8b,0xbf203eab,0xbe0d3f32,0x3ee63f0c
.long 0xbf00bf00,0xbf35a6a8,0xbf003f00,0x27c23f35,0x3e8b3f27,0x3f203eab,0x3f32be0d,0x3ee6bf0c,0x27b63f35,0x3ec93f17,0x3f273e8b,0x3f32be0d,0x3e8bbf27,0xbd8ebf34,0xbec9bf17,0xbf20beab
.long 0x3f00bf00,0x3e8bbf27,0xa86abf35,0xbe8bbf27,0xbf273e8b,0xbf0c3ee6,0xbec93f17,0xbe523f2d,0xbf35278e,0xbf323e0d,0xbf273e8b,0xbf173ec9,0x3f273e8b,0x3f2d3e52,0x3f323e0d,0x3f343d8e
.long 0x3f003f00,0xbf00bf00,0x3f003f00,0xbf00bf00,0x2724bf35,0xbd8e3f34,0x3e0dbf32,0xbe523f2d,0x3f00bf00,0xbf173ec9,0x3f27be8b,0xbf323e0d,0xbf35a670,0x3f2d3e52,0xbf17bec9,0x3ee63f0c
.long 0xbf00bf00,0x3e8b3f27,0xa70cbf35,0xbe8b3f27,0x26103f35,0x3eabbf20,0xbf173ec9,0x3f34bd8e,0xbf003f00,0x3f32be0d,0xbf27be8b,0x3ec93f17,0x3f35a70c,0xbf0cbee6,0x3e0d3f32,0x3eabbf20
.long 0x3f003f00,0x2754bf35,0xbf003f00,0x3f35a7da,0xa76cbf35,0xbf0c3ee6,0x3f323e0d,0xbeabbf20,0x3f00bf00,0xbf32be0d,0x3e8b3f27,0x3ec9bf17,0xbf3527aa,0x3eab3f20,0x3ec9bf17,0xbf34bd8e
.long 0xbf00bf00,0xbe8b3f27,0x3f35281f,0xbe8bbf27,0x27da3f35,0x3f2dbe52,0xbec9bf17,0xbee63f0c,0xbf003f00,0x3f173ec9,0x3e8bbf27,0xbf32be0d,0x3f35a807,0xbd8ebf34,0xbf323e0d,0x3e523f2d
.long 0x3f003f00,0x3f00bf00,0xbf00bf00,0xbf003f00,0x26a8bf35,0xbf34bd8e,0xbe0d3f32,0x3f2d3e52,0x3f00bf00,0xbec9bf17,0xbf273e8b,0x3e0d3f32,0xbf352540,0xbe523f2d,0x3f173ec9,0x3f0cbee6
.long 0xbf00bf00,0xbf273e8b,0x26103f35,0x3f273e8b,0x26e03f35,0x3f203eab,0x3f17bec9,0xbd8ebf34,0xbf003f00,0x3e0d3f32,0x3f273e8b,0x3f17bec9,0x3f35a86a,0x3ee6bf0c,0xbe0dbf32,0xbf20beab
.long 0x3f003f00,0x3f352813,0x3f00bf00,0xa8a7bf35,0xa79cbf35,0xbee6bf0c,0xbf32be0d,0xbf203eab,0x3f00bf00,0x3e0dbf32,0xbe8bbf27,0xbf17bec9,0xbf35a79c,0xbf203eab,0xbec93f17,0xbd8e3f34
.long 0xbf00bf00,0xbf27be8b,0xbf35a839,0xbf273e8b,0x28003f35,0x3e523f2d,0x3ec93f17,0x3f0c3ee6,0xbf003f00,0xbec93f17,0xbe8b3f27,0xbe0d3f32,0x3f3526e0,0x3f34bd8e,0x3f32be0d,0x3f2dbe52
.long 0x3f003f00,0xbf00bf00,0x3f003f00,0xbf00bf00,0x3e8bbf27,0xbeab3f20,0x3ec9bf17,0xbee63f0c,0x3f35a7ce,0xbf32be0d,0x3f273e8b,0xbf17bec9,0xbe8bbf27,0x3d8e3f34,0x3e0dbf32,0xbeab3f20
.long 0x3f00bf00,0xbf273e8b,0x3f35a7da,0xbf27be8b,0xbf27be8b,0x3ee63f0c,0xbe0dbf32,0xbe523f2d,0xa724bf35,0xbec93f17,0x3f27be8b,0xbf32be0d,0xbf273e8b,0x3f2d3e52,0xbec9bf17,0xbd8e3f34
.long 0xbf00bf00,0xa7b63f35,0x3f00bf00,0xbf35278e,0xbe8b3f27,0x3f2dbe52,0xbf17bec9,0x3d8e3f34,0xbf35a6a8,0x3ec93f17,0x3e8bbf27,0xbf323e0d,0x3e8b3f27,0x3ee6bf0c,0xbf32be0d,0x3e523f2d
.long 0xbf003f00,0x3f273e8b,0xa86abf35,0xbf273e8b,0x3f273e8b,0x3d8ebf34,0xbf323e0d,0x3eab3f20,0x27c23f35,0x3f32be0d,0xbe8bbf27,0xbf173ec9,0x3f27be8b,0xbeabbf20,0xbf173ec9,0x3ee63f0c
.long 0x3f003f00,0x3f00bf00,0xbf00bf00,0xbf003f00,0x3e8bbf27,0xbf20beab,0xbec93f17,0x3f0c3ee6,0x3f35a857,0x3e0dbf32,0xbf27be8b,0xbec93f17,0xbe8bbf27,0xbf343d8e,0xbe0d3f32,0x3f203eab
.long 0x3f00bf00,0xbe8bbf27,0xbf352832,0xbe8b3f27,0xbf27be8b,0xbf0c3ee6,0x3e0d3f32,0x3f2d3e52,0x26e0bf35,0xbf17bec9,0xbf273e8b,0xbe0d3f32,0xbf273e8b,0xbe523f2d,0x3ec93f17,0x3f343d8e
.long 0xbf00bf00,0xbf3527b6,0xbf003f00,0x28513f35,0xbe8b3f27,0x3e523f2d,0x3f173ec9,0x3f34bd8e,0xbf3527b6,0xbf173ec9,0xbe8b3f27,0x3e0d3f32,0x3e8b3f27,0x3f0c3ee6,0x3f323e0d,0x3f2dbe52
.long 0xbf003f00,0xbe8b3f27,0x27f23f35,0x3e8b3f27,0x3f273e8b,0x3f343d8e,0x3f32be0d,0x3f20beab,0x28513f35,0x3e0d3f32,0x3e8b3f27,0x3ec93f17,0x3f27be8b,0x3f20beab,0x3f17bec9,0x3f0cbee6
.long 0x3f00bf00,0xbf003f00,0x3f00bf00,0xbf003f00,0x3f003f00,0xbf0cbee6,0x3f173ec9,0xbf20beab,0x3f00bf00,0xbec93f17,0x3e8bbf27,0xbe0d3f32,0x3f003f00,0xbf20beab,0x3f323e0d,0xbf343d8e
.long 0x3f00bf00,0xbe8b3f27,0x2540bf35,0x3e8b3f27,0x3f003f00,0xbf2dbe52,0x3f32be0d,0xbf0c3ee6,0x3f00bf00,0xbe0d3f32,0xbe8bbf27,0x3f173ec9,0x3f003f00,0xbf34bd8e,0x3f17bec9,0xbe523f2d
.long 0x3f00bf00,0xa5003f35,0xbf00bf00,0x3f352688,0x3f003f00,0xbf343d8e,0x3ec9bf17,0x3e523f2d,0x3f00bf00,0x3e0d3f32,0xbf27be8b,0x3f17bec9,0x3f003f00,0xbf2d3e52,0x3e0dbf32,0x3f0c3ee6
.long 0x3f00bf00,0x3e8b3f27,0xbf35a670,0x3e8bbf27,0x3f003f00,0xbf203eab,0xbe0dbf32,0x3f343d8e,0x3f00bf00,0x3ec93f17,0xbf273e8b,0xbe0dbf32,0x3f003f00,0xbf0c3ee6,0xbec9bf17,0x3f20beab
.long 0x3f00bf00,0x3f003f00,0xbf003f00,0xbf00bf00,0x3f003f00,0xbee63f0c,0xbf17bec9,0x3eabbf20,0x3f00bf00,0x3f173ec9,0xbe8b3f27,0xbf32be0d,0x3f003f00,0xbeab3f20,0xbf32be0d,0xbd8ebf34
.long 0x3f00bf00,0x3f273e8b,0x25e03f35,0xbf273e8b,0x3f003f00,0xbe523f2d,0xbf323e0d,0xbee6bf0c,0x3f00bf00,0x3f323e0d,0x3e8b3f27,0xbec93f17,0x3f003f00,0xbd8e3f34,0xbf173ec9,0xbf2dbe52
.long 0x3f00bf00,0x3f352540,0x3f003f00,0x25403f35,0x3f003f00,0x3d8e3f34,0xbec93f17,0xbf2d3e52,0x3f00bf00,0x3f32be0d,0x3f273e8b,0x3ec93f17,0x3f003f00,0x3e523f2d,0xbe0d3f32,0xbee63f0c
.long 0x3f00bf00,0x3f27be8b,0x3f352688,0x3f273e8b,0x3f003f00,0x3eab3f20,0x3e0d3f32,0xbd8e3f34,0x3f00bf00,0x3f17bec9,0x3f27be8b,0x3f32be0d,0x3f003f00,0x3ee63f0c,0x3ec93f17,0x3eab3f20
.long 0x3f00bf00,0xbf003f00,0x3f00bf00,0xbf003f00,0x3f273e8b,0xbf2dbe52,0x3f323e0d,0xbf34bd8e,0xa5a0bf35,0x3e0d3f32,0xbe8bbf27,0x3ec93f17,0x3f27be8b,0xbf0c3ee6,0x3ec9bf17,0xbe523f2d
.long 0xbf00bf00,0x3f273e8b,0xbf35a6a8,0x3f27be8b,0x3e8bbf27,0x3d8e3f34,0xbec9bf17,0x3f203eab,0xbf35a698,0x3f17bec9,0xbe8b3f27,0xbe0dbf32,0xbe8bbf27,0x3f203eab,0xbf323e0d,0x3ee6bf0c
.long 0xbf003f00,0xa480bf35,0x3f003f00,0xbf35a6c8,0xbf27be8b,0x3f20beab,0xbe0d3f32,0xbee6bf0c,0x25403f35,0xbf17bec9,0x3f27be8b,0xbe0d3f32,0xbf273e8b,0x3d8ebf34,0x3f173ec9,0xbf203eab
.long 0x3f003f00,0xbf273e8b,0x2480bf35,0x3f273e8b,0xbe8b3f27,0xbf0cbee6,0x3f17bec9,0x3e523f2d,0x3f3526a8,0xbe0d3f32,0xbf27be8b,0x3ec9bf17,0x3e8b3f27,0xbf2d3e52,0xbe0dbf32,0x3f34bd8e
.long 0x3f00bf00,0x3f003f00,0xbf003f00,0xbf00bf00,0x3f273e8b,0xbe523f2d,0xbf32be0d,0x3d8ebf34,0xa480bf35,0x3f32be0d,0x3e8b3f27,0xbf173ec9,0x3f27be8b,0x3ee63f0c,0xbec93f17,0xbf2dbe52
.long 0xbf00bf00,0x3e8bbf27,0x3f3526d8,0x3e8b3f27,0x3e8bbf27,0x3f34bd8e,0x3ec93f17,0xbeab3f20,0xbf35a6a8,0xbec9bf17,0x3e8bbf27,0x3f32be0d,0xbe8bbf27,0x3eabbf20,0x3f32be0d,0x3f0c3ee6
.long 0xbf003f00,0xbf35a6c8,0xbf00bf00,0x2754bf35,0xbf27be8b,0xbeabbf20,0x3e0dbf32,0x3f0cbee6,0x3f35,0xbec93f17,0xbf273e8b,0xbf32be0d,0xbf273e8b,0xbf34bd8e,0xbf17bec9,0xbeabbf20
.long 0x3f003f00,0x3e8b3f27,0xa5e03f35,0xbe8b3f27,0xbe8b3f27,0xbee63f0c,0xbf173ec9,0xbf2d3e52,0x3f3526b8,0x3f323e0d,0x3f273e8b,0x3f173ec9,0x3e8b3f27,0x3e523f2d,0x3e0d3f32,0x3d8e3f34
.long 0x3f00bf00,0xbf003f00,0x3f00bf00,0xbf003f00,0x3f352480,0xbf343d8e,0x3f32be0d,0xbf2d3e52,0xbf00bf00,0x3f173ec9,0xbf27be8b,0x3f323e0d,0x26c8bf35,0x3e523f2d,0xbec9bf17,0x3f0c3ee6
.long 0xbf003f00,0x3e8bbf27,0xa5e03f35,0xbe8bbf27,0xbf35a540,0x3f20beab,0xbec93f17,0x3d8ebf34,0x3f003f00,0xbf32be0d,0x3f27be8b,0xbec93f17,0xa6d83f35,0xbee6bf0c,0x3f323e0d,0xbf203eab
.long 0x3f00bf00,0xa5e03f35,0xbf00bf00,0x3f35279c,0x3f352748,0xbee63f0c,0xbe0dbf32,0x3f203eab,0xbf00bf00,0x3f32be0d,0xbe8b3f27,0xbec9bf17,0x26e0bf35,0x3f203eab,0xbf173ec9,0xbd8ebf34
.long 0xbf003f00,0xbe8bbf27,0x3f35a650,0xbe8b3f27,0xbf35a5e0,0x3e52bf2d,0x3f173ec9,0xbf0c3ee6,0x3f003f00,0xbf173ec9,0xbe8bbf27,0x3f32be0d,0x26703f35,0xbf34bd8e,0x3e0dbf32,0x3f2d3e52
.long 0x3f00bf00,0x3f003f00,0xbf003f00,0xbf00bf00,0x3f352754,0x3d8e3f34,0xbf323e0d,0xbe52bf2d,0xbf00bf00,0x3ec9bf17,0x3f273e8b,0xbe0d3f32,0x26f8bf35,0x3f2dbe52,0x3ec93f17,0xbee63f0c
.long 0xbf003f00,0xbf27be8b,0x276cbf35,0x3f27be8b,0xbf35a610,0xbeabbf20,0x3ec9bf17,0x3f343d8e,0x3f003f00,0xbe0d3f32,0xbf273e8b,0xbf17bec9,0x26503f35,0xbf0c3ee6,0xbf32be0d,0xbeabbf20
.long 0x3f00bf00,0x3f35a610,0x3f003f00,0xa7da3f35,0x3f352764,0x3f0c3ee6,0x3e0d3f32,0xbeab3f20,0xbf00bf00,0xbe0dbf32,0x3e8bbf27,0x3f17bec9,0x270cbf35,0x3eabbf20,0x3f17bec9,0x3f34bd8e
.long 0xbf003f00,0xbf273e8b,0xbf35a724,0xbf27be8b,0xbf35a650,0xbf2dbe52,0xbf17bec9,0xbee6bf0c,0x3f003f00,0x3ec93f17,0x3e8b3f27,0x3e0d3f32,0x26103f35,0xbd8e3f34,0xbe0d3f32,0xbe523f2d
.long 0x3f00bf00,0xbf003f00,0x3f00bf00,0xbf003f00,0x3f27be8b,0xbf203eab,0x3f17bec9,0xbf0c3ee6,0xbf35a6f8,0x3f32be0d,0xbf273e8b,0x3f17bec9,0xbf27be8b,0x3f343d8e,0xbf323e0d,0x3f20beab
.long 0x3f003f00,0xbf27be8b,0x3f35a610,0xbf273e8b,0x3e8b3f27,0xbf0cbee6,0x3f323e0d,0xbf2d3e52,0x2764bf35,0x3ec93f17,0xbf27be8b,0x3f32be0d,0x3e8bbf27,0x3e523f2d,0xbf17bec9,0x3f34bd8e
.long 0xbf003f00,0xa6f8bf35,0x3f003f00,0xbf35a724,0xbf273e8b,0x3e52bf2d,0x3ec93f17,0xbf34bd8e,0x3f35a610,0xbec93f17,0xbe8bbf27,0x3f323e0d,0x3f273e8b,0xbf0c3ee6,0xbe0dbf32,0x3f2d3e52
.long 0xbf00bf00,0x3f27be8b,0xa6983f35,0xbf27be8b,0xbe8bbf27,0x3f34bd8e,0xbe0d3f32,0xbf20beab,0xa6703f35,0xbf32be0d,0x3e8bbf27,0x3f173ec9,0xbe8b3f27,0xbf20beab,0x3ec9bf17,0x3f0c3ee6
.long 0x3f00bf00,0x3f003f00,0xbf003f00,0xbf00bf00,0x3f27be8b,0x3eab3f20,0xbf173ec9,0xbee6bf0c,0xbf35a724,0xbe0dbf32,0x3f27be8b,0x3ec93f17,0xbf27be8b,0x3d8ebf34,0x3f32be0d,0x3eab3f20
.long 0x3f003f00,0xbe8b3f27,0xbf35a73c,0xbe8bbf27,0x3e8b3f27,0xbee63f0c,0xbf32be0d,0xbe52bf2d,0x2782bf35,0x3f17bec9,0x3f273e8b,0x3e0d3f32,0x3e8bbf27,0x3f2dbe52,0x3f173ec9,0x3d8e3f34
.long 0xbf003f00,0xbf352807,0xbf00bf00,0x2825bf35,0xbf273e8b,0xbf2dbe52,0xbec9bf17,0x3d8ebf34,0x3f3527b6,0x3f173ec9,0x3e8b3f27,0xbe0d3f32,0x3f273e8b,0x3ee63f0c,0x3e0d3f32,0xbe523f2d
.long 0xbf00bf00,0xbe8bbf27,0xa670bf35,0x3e8bbf27,0xbe8bbf27,0xbd8ebf34,0x3e0dbf32,0x3eabbf20,0xa7e63f35,0xbe0d3f32,0xbe8b3f27,0xbec93f17,0xbe8b3f27,0xbeab3f20,0xbec93f17,0xbee63f0c
.long 0x3f00bf00,0xbf003f00,0x3f00bf00,0xbf003f00,0x3f00bf00,0xbee63f0c,0x3ec9bf17,0xbeab3f20,0xbf003f00,0x3ec9bf17,0xbe8b3f27,0x3e0dbf32,0xbf003f00,0x3eabbf20,0xbe0d3f32,0xbd8ebf34
.long 0x3f00bf00,0xbe8b3f27,0x2782bf35,0x3e8b3f27,0x3f00bf00,0xbe523f2d,0xbe0dbf32,0x3ee63f0c,0xbf003f00,0x3e0dbf32,0x3e8b3f27,0xbf17bec9,0xbf003f00,0x3d8ebf34,0x3ec93f17,0xbf2dbe52
.long 0x3f00bf00,0xa6a83f35,0xbf00bf00,0x3f352540,0x3f00bf00,0x3d8e3f34,0xbf17bec9,0x3f2dbe52,0xbf003f00,0xbe0dbf32,0x3f273e8b,0xbf173ec9,0xbf003f00,0xbe52bf2d,0x3f323e0d,0xbee63f0c
.long 0x3f00bf00,0x3e8b3f27,0xbf352724,0x3e8bbf27,0x3f00bf00,0x3eab3f20,0xbf323e0d,0x3d8ebf34,0xbf003f00,0xbec9bf17,0x3f27be8b,0x3e0d3f32,0xbf003f00,0xbee6bf0c,0x3f17bec9,0x3eab3f20
.long 0x3f00bf00,0x3f003f00,0xbf003f00,0xbf00bf00,0x3f00bf00,0x3f0c3ee6,0xbec93f17,0xbf20beab,0xbf003f00,0xbf17bec9,0x3e8bbf27,0x3f323e0d,0xbf003f00,0xbf20beab,0x3e0dbf32,0x3f34bd8e
.long 0x3f00bf00,0x3f273e8b,0xa70c3f35,0xbf273e8b,0x3f00bf00,0x3f2d3e52,0x3e0d3f32,0xbf0c3ee6,0xbf003f00,0xbf32be0d,0xbe8bbf27,0x3ec9bf17,0xbf003f00,0xbf34bd8e,0xbec9bf17,0x3e52bf2d
.long 0x3f00bf00,0x3f35a79c,0x3f003f00,0xa85d3f35,0x3f00bf00,0x3f34bd8e,0x3f173ec9,0x3e523f2d,0xbf003f00,0xbf323e0d,0xbf27be8b,0xbec9bf17,0xbf003f00,0xbf2d3e52,0xbf32be0d,0xbf0cbee6
.long 0x3f00bf00,0x3f27be8b,0x3f3527da,0x3f273e8b,0x3f00bf00,0x3f20beab,0x3f32be0d,0x3f343d8e,0xbf003f00,0xbf173ec9,0xbf273e8b,0xbf323e0d,0xbf003f00,0xbf0c3ee6,0xbf173ec9,0xbf203eab
.long 0x3f00bf00,0xbf003f00,0x3f00bf00,0xbf003f00,0x3e8bbf27,0xbe523f2d,0x3e0dbf32,0xbd8e3f34,0xa6a83f35,0xbe0dbf32,0x3e8b3f27,0xbec9bf17,0x3e8b3f27,0xbee6bf0c,0x3f173ec9,0xbf2dbe52
.long 0xbf00bf00,0x3f273e8b,0xbf35a80d,0x3f27be8b,0xbf27be8b,0x3f34bd8e,0xbf173ec9,0x3eabbf20,0x3f352540,0xbf173ec9,0x3e8bbf27,0x3e0d3f32,0x3f27be8b,0xbeab3f20,0xbe0dbf32,0x3f0c3ee6
.long 0xbf003f00,0xa670bf35,0x3f003f00,0xbf35a813,0xbe8b3f27,0xbeabbf20,0x3f323e0d,0xbf0c3ee6,0xa670bf35,0x3f173ec9,0xbf273e8b,0x3e0dbf32,0xbe8bbf27,0x3f343d8e,0xbec93f17,0xbeabbf20
.long 0x3f003f00,0xbf273e8b,0x282bbf35,0x3f273e8b,0x3f273e8b,0xbee63f0c,0xbec9bf17,0x3f2dbe52,0xbf35270c,0x3e0dbf32,0x3f273e8b,0xbec93f17,0xbf273e8b,0xbe52bf2d,0x3f32be0d,0x3d8e3f34
.long 0x3f00bf00,0x3f003f00,0xbf003f00,0xbf00bf00,0x3e8bbf27,0x3f2d3e52,0xbe0d3f32,0xbf34bd8e,0xa8003f35,0xbf323e0d,0xbe8bbf27,0x3f17bec9,0x3e8b3f27,0xbf0c3ee6,0xbf17bec9,0x3e52bf2d
.long 0xbf00bf00,0x3e8bbf27,0x3f35284b,0x3e8b3f27,0xbf27be8b,0xbd8ebf34,0x3f17bec9,0x3f203eab,0x3f3527da,0x3ec93f17,0xbe8b3f27,0xbf323e0d,0x3f27be8b,0x3f203eab,0x3e0d3f32,0xbee63f0c
.long 0xbf003f00,0xbf3526a8,0xbf00bf00,0x27c2bf35,0xbe8b3f27,0xbf203eab,0xbf32be0d,0xbee6bf0c,0x27b6bf35,0x3ec9bf17,0x3f27be8b,0x3f323e0d,0xbe8bbf27,0x3d8ebf34,0x3ec9bf17,0x3f20beab
.long 0x3f003f00,0x3e8b3f27,0xa86a3f35,0xbe8b3f27,0x3f273e8b,0x3f0c3ee6,0x3ec93f17,0x3e523f2d,0xbf35a78e,0xbf32be0d,0xbf27be8b,0xbf17bec9,0xbf273e8b,0xbf2d3e52,0xbf323e0d,0xbf343d8e
.long 0x3f00bf00,0xbf003f00,0x3f00bf00,0xbf003f00,0xa724bf35,0x3d8e3f34,0xbe0dbf32,0x3e523f2d,0x3f003f00,0xbf17bec9,0x3f273e8b,0xbf32be0d,0x3f35a670,0xbf2d3e52,0x3f17bec9,0xbee63f0c
.long 0xbf003f00,0x3e8bbf27,0xa70c3f35,0xbe8bbf27,0xa6103f35,0xbeabbf20,0x3f173ec9,0xbf34bd8e,0xbf00bf00,0x3f323e0d,0xbf273e8b,0x3ec9bf17,0xbf35a70c,0x3f0cbee6,0xbe0d3f32,0xbeabbf20
.long 0x3f00bf00,0x27543f35,0xbf00bf00,0x3f3527da,0x276cbf35,0x3f0c3ee6,0xbf323e0d,0x3eabbf20,0x3f003f00,0xbf323e0d,0x3e8bbf27,0x3ec93f17,0x3f3527aa,0xbeab3f20,0xbec9bf17,0x3f34bd8e
.long 0xbf003f00,0xbe8bbf27,0x3f35a81f,0xbe8b3f27,0xa7da3f35,0xbf2dbe52,0x3ec9bf17,0x3ee63f0c,0xbf00bf00,0x3f17bec9,0x3e8b3f27,0xbf323e0d,0xbf35a807,0x3d8ebf34,0x3f323e0d,0xbe523f2d
.long 0x3f00bf00,0x3f003f00,0xbf003f00,0xbf00bf00,0xa6a8bf35,0x3f34bd8e,0x3e0d3f32,0xbf2d3e52,0x3f003f00,0xbec93f17,0xbf27be8b,0x3e0dbf32,0x3f352540,0x3e523f2d,0xbf173ec9,0xbf0cbee6
.long 0xbf003f00,0xbf27be8b,0x2610bf35,0x3f27be8b,0xa6e03f35,0xbf203eab,0xbf17bec9,0x3d8ebf34,0xbf00bf00,0x3e0dbf32,0x3f27be8b,0x3f173ec9,0xbf35a86a,0xbee6bf0c,0x3e0dbf32,0x3f20beab
.long 0x3f00bf00,0x3f35a813,0x3f003f00,0xa8a73f35,0x279cbf35,0x3ee6bf0c,0x3f32be0d,0x3f203eab,0x3f003f00,0x3e0d3f32,0xbe8b3f27,0xbf173ec9,0x3f35a79c,0x3f203eab,0x3ec93f17,0x3d8e3f34
.long 0xbf003f00,0xbf273e8b,0xbf352839,0xbf27be8b,0xa8003f35,0xbe523f2d,0xbec93f17,0xbf0c3ee6,0xbf00bf00,0xbec9bf17,0xbe8bbf27,0xbe0dbf32,0xbf3526e0,0xbf34bd8e,0xbf32be0d,0xbf2dbe52
.long 0x3f00bf00,0xbf003f00,0x3f00bf00,0xbf003f00,0xbe8bbf27,0x3eab3f20,0xbec9bf17,0x3ee63f0c,0x3f3527ce,0xbf323e0d,0x3f27be8b,0xbf173ec9,0x3e8bbf27,0xbd8e3f34,0xbe0dbf32,0x3eab3f20
.long 0x3f003f00,0xbf27be8b,0x3f3527da,0xbf273e8b,0x3f27be8b,0xbee63f0c,0x3e0dbf32,0x3e523f2d,0xa7243f35,0xbec9bf17,0x3f273e8b,0xbf323e0d,0x3f273e8b,0xbf2d3e52,0x3ec9bf17,0x3d8e3f34
.long 0xbf003f00,0xa7b6bf35,0x3f003f00,0xbf35a78e,0x3e8b3f27,0xbf2dbe52,0x3f17bec9,0xbd8e3f34,0xbf3526a8,0x3ec9bf17,0x3e8b3f27,0xbf32be0d,0xbe8b3f27,0xbee6bf0c,0x3f32be0d,0xbe523f2d
.long 0xbf00bf00,0x3f27be8b,0xa86a3f35,0xbf27be8b,0xbf273e8b,0xbd8ebf34,0x3f323e0d,0xbeab3f20,0x27c2bf35,0x3f323e0d,0xbe8b3f27,0xbf17bec9,0xbf27be8b,0x3eabbf20,0x3f173ec9,0xbee63f0c
.long 0x3f00bf00,0x3f003f00,0xbf003f00,0xbf00bf00,0xbe8bbf27,0x3f20beab,0x3ec93f17,0xbf0c3ee6,0x3f352857,0x3e0d3f32,0xbf273e8b,0xbec9bf17,0x3e8bbf27,0x3f343d8e,0x3e0d3f32,0xbf203eab
.long 0x3f003f00,0xbe8b3f27,0xbf35a832,0xbe8bbf27,0x3f27be8b,0x3f0c3ee6,0xbe0d3f32,0xbf2d3e52,0x26e03f35,0xbf173ec9,0xbf27be8b,0xbe0dbf32,0x3f273e8b,0x3e523f2d,0xbec93f17,0xbf343d8e
.long 0xbf003f00,0xbf35a7b6,0xbf00bf00,0x2851bf35,0x3e8b3f27,0xbe523f2d,0xbf173ec9,0xbf34bd8e,0xbf35a7b6,0xbf17bec9,0xbe8bbf27,0x3e0dbf32,0xbe8b3f27,0xbf0c3ee6,0xbf323e0d,0xbf2dbe52
.long 0xbf00bf00,0xbe8bbf27,0x27f2bf35,0x3e8bbf27,0xbf273e8b,0xbf343d8e,0xbf32be0d,0xbf20beab,0x2851bf35,0x3e0dbf32,0x3e8bbf27,0x3ec9bf17,0xbf27be8b,0xbf20beab,0xbf17bec9,0xbf0cbee6
.long 0xbf003f00,0x3f00bf00,0xbf003f00,0x3f00bf00,0xbf00bf00,0x3ee63f0c,0xbec9bf17,0x3eab3f20,0xbf003f00,0x3f17bec9,0xbf273e8b,0x3f32be0d,0xbf00bf00,0x3eab3f20,0xbe0dbf32,0xbd8e3f34
.long 0xbf003f00,0x3f27be8b,0xbf352540,0x3f273e8b,0xbf00bf00,0x3e523f2d,0x3e0dbf32,0xbee63f0c,0xbf003f00,0x3f32be0d,0xbf27be8b,0x3ec93f17,0xbf00bf00,0x3d8e3f34,0x3ec9bf17,0xbf2d3e52
.long 0xbf003f00,0x3f35a500,0xbf00bf00,0x26883f35,0xbf00bf00,0xbd8e3f34,0x3f17bec9,0xbf2dbe52,0xbf003f00,0x3f323e0d,0xbe8bbf27,0xbec93f17,0xbf00bf00,0xbe523f2d,0x3f32be0d,0xbee6bf0c
.long 0xbf003f00,0x3f273e8b,0xa670bf35,0xbf273e8b,0xbf00bf00,0xbeab3f20,0x3f323e0d,0xbd8ebf34,0xbf003f00,0x3f173ec9,0x3e8bbf27,0xbf32be0d,0xbf00bf00,0xbee63f0c,0x3f173ec9,0x3eabbf20
.long 0xbf003f00,0x3f003f00,0x3f00bf00,0xbf00bf00,0xbf00bf00,0xbf0c3ee6,0x3ec93f17,0x3f20beab,0xbf003f00,0x3ec93f17,0x3f27be8b,0xbe0dbf32,0xbf00bf00,0xbf203eab,0x3e0d3f32,0x3f343d8e
.long 0xbf003f00,0x3e8b3f27,0x3f3525e0,0x3e8bbf27,0xbf00bf00,0xbf2d3e52,0xbe0d3f32,0x3f0c3ee6,0xbf003f00,0x3e0d3f32,0x3f273e8b,0x3f17bec9,0xbf00bf00,0xbf343d8e,0xbec93f17,0x3e523f2d
.long 0xbf003f00,0x25403f35,0x3f003f00,0x3f352540,0xbf00bf00,0xbf34bd8e,0xbf173ec9,0xbe523f2d,0xbf003f00,0xbe0d3f32,0x3e8b3f27,0x3f173ec9,0xbf00bf00,0xbf2dbe52,0xbf323e0d,0xbf0c3ee6
.long 0xbf003f00,0xbe8b3f27,0x26883f35,0x3e8b3f27,0xbf00bf00,0xbf20beab,0xbf32be0d,0xbf343d8e,0xbf003f00,0xbec93f17,0xbe8b3f27,0xbe0d3f32,0xbf00bf00,0xbf0cbee6,0xbf17bec9,0xbf20beab
.long 0xbf003f00,0x3f00bf00,0xbf003f00,0x3f00bf00,0xbe8bbf27,0x3e523f2d,0xbe0dbf32,0x3d8e3f34,0xbf35a5a0,0x3f323e0d,0xbf27be8b,0x3f173ec9,0x3e8bbf27,0xbee63f0c,0x3f17bec9,0xbf2d3e52
.long 0xbf00bf00,0x3e8b3f27,0xa6a8bf35,0xbe8b3f27,0x3f27be8b,0xbf34bd8e,0x3f173ec9,0xbeabbf20,0xa698bf35,0xbec93f17,0x3f27be8b,0xbf32be0d,0x3f273e8b,0xbeabbf20,0xbe0d3f32,0x3f0cbee6
.long 0x3f00bf00,0xbf35a480,0x3f003f00,0xa6c8bf35,0x3e8b3f27,0x3eabbf20,0xbf323e0d,0x3f0c3ee6,0x3f352540,0xbec9bf17,0xbe8b3f27,0x3f32be0d,0xbe8b3f27,0x3f34bd8e,0xbec9bf17,0xbeab3f20
.long 0x3f003f00,0x3e8bbf27,0xbf352480,0x3e8b3f27,0xbf273e8b,0x3ee63f0c,0x3ec9bf17,0xbf2dbe52,0x26a83f35,0x3f32be0d,0xbe8bbf27,0xbf173ec9,0xbf27be8b,0xbe523f2d,0x3f323e0d,0x3d8ebf34
.long 0xbf003f00,0x3f003f00,0x3f00bf00,0xbf00bf00,0xbe8bbf27,0xbf2d3e52,0x3e0d3f32,0x3f34bd8e,0xbf35a480,0xbe0d3f32,0x3f273e8b,0x3ec9bf17,0x3e8bbf27,0xbf0cbee6,0xbf173ec9,0x3e523f2d
.long 0xbf00bf00,0xbf273e8b,0x26d83f35,0x3f273e8b,0x3f27be8b,0x3d8ebf34,0xbf17bec9,0xbf203eab,0xa6a8bf35,0xbf17bec9,0xbf273e8b,0xbe0d3f32,0x3f273e8b,0x3f20beab,0x3e0dbf32,0xbee6bf0c
.long 0x3f00bf00,0xa6c8bf35,0xbf00bf00,0xbf352754,0x3e8b3f27,0x3f203eab,0x3f32be0d,0x3ee6bf0c,0x3f350000,0x3f17bec9,0x3e8bbf27,0xbe0dbf32,0xbe8b3f27,0x3d8e3f34,0x3ec93f17,0x3f203eab
.long 0x3f003f00,0x3f273e8b,0x3f35a5e0,0x3f27be8b,0xbf273e8b,0xbf0c3ee6,0xbec93f17,0xbe523f2d,0x26b83f35,0x3e0d3f32,0x3e8b3f27,0x3ec93f17,0xbf27be8b,0xbf2dbe52,0xbf32be0d,0xbf34bd8e
.long 0xbf003f00,0x3f00bf00,0xbf003f00,0x3f00bf00,0xa480bf35,0xbd8e3f34,0x3e0dbf32,0xbe523f2d,0xbf00bf00,0x3ec93f17,0xbe8bbf27,0x3e0d3f32,0x3f35a6c8,0xbf2dbe52,0x3f173ec9,0xbee6bf0c
.long 0x3f00bf00,0xbf273e8b,0x3f35a5e0,0xbf27be8b,0x25403f35,0x3eabbf20,0xbf173ec9,0x3f34bd8e,0x3f003f00,0xbe0dbf32,0xbe8b3f27,0x3f17bec9,0xbf3526d8,0x3f0c3ee6,0xbe0dbf32,0xbeab3f20
.long 0xbf003f00,0x3f35a5e0,0xbf00bf00,0x279c3f35,0xa748bf35,0xbf0c3ee6,0x3f323e0d,0xbeabbf20,0xbf00bf00,0xbe0d3f32,0x3f27be8b,0xbf17bec9,0x3f35a6e0,0xbeabbf20,0xbec93f17,0x3f343d8e
.long 0x3f00bf00,0xbf27be8b,0xa6503f35,0x3f27be8b,0x25e03f35,0x3f2dbe52,0xbec9bf17,0xbee63f0c,0x3f003f00,0x3ec9bf17,0xbf27be8b,0xbe0d3f32,0xbf35a670,0x3d8e3f34,0x3f32be0d,0xbe52bf2d
.long 0xbf003f00,0x3f003f00,0x3f00bf00,0xbf00bf00,0xa754bf35,0xbf34bd8e,0xbe0d3f32,0x3f2d3e52,0xbf00bf00,0xbf173ec9,0x3e8b3f27,0x3f32be0d,0x3f35a6f8,0x3e52bf2d,0xbf17bec9,0xbf0c3ee6
.long 0x3f00bf00,0xbe8bbf27,0xbf35276c,0xbe8b3f27,0x26103f35,0x3f203eab,0x3f17bec9,0xbd8ebf34,0x3f003f00,0x3f32be0d,0x3e8bbf27,0xbec9bf17,0xbf35a650,0xbee63f0c,0x3e0d3f32,0x3f203eab
.long 0xbf003f00,0xa6103f35,0x3f003f00,0x3f35a7da,0xa764bf35,0xbee6bf0c,0xbf32be0d,0xbf203eab,0xbf00bf00,0xbf32be0d,0xbf273e8b,0xbec93f17,0x3f35a70c,0x3f20beab,0x3ec9bf17,0x3d8ebf34
.long 0x3f00bf00,0x3e8bbf27,0xa724bf35,0xbe8bbf27,0x26503f35,0x3e523f2d,0x3ec93f17,0x3f0c3ee6,0x3f003f00,0x3f173ec9,0x3f273e8b,0x3f323e0d,0xbf35a610,0xbf343d8e,0xbf323e0d,0xbf2d3e52
.long 0xbf003f00,0x3f00bf00,0xbf003f00,0x3f00bf00,0x3e8bbf27,0xbeab3f20,0x3ec9bf17,0xbee63f0c,0xa6f8bf35,0xbe0d3f32,0x3e8bbf27,0xbec93f17,0x3e8b3f27,0xbd8ebf34,0xbe0d3f32,0x3eabbf20
.long 0x3f003f00,0xbe8bbf27,0xa6103f35,0x3e8bbf27,0xbf27be8b,0x3ee63f0c,0xbe0dbf32,0xbe523f2d,0xbf352764,0x3f173ec9,0xbe8bbf27,0xbe0d3f32,0x3f27be8b,0xbf2dbe52,0x3ec93f17,0x3d8ebf34
.long 0x3f00bf00,0xbf35a6f8,0x3f003f00,0xa724bf35,0xbe8b3f27,0x3f2dbe52,0xbf17bec9,0x3d8e3f34,0xa6103f35,0x3f17bec9,0xbf27be8b,0x3e0d3f32,0xbe8bbf27,0xbee63f0c,0x3f323e0d,0xbe52bf2d
.long 0xbf00bf00,0xbe8b3f27,0x3f35a698,0xbe8bbf27,0x3f273e8b,0x3d8ebf34,0xbf323e0d,0x3eab3f20,0x3f35a670,0xbe0dbf32,0xbf273e8b,0x3ec93f17,0xbf273e8b,0x3eab3f20,0x3f17bec9,0xbee6bf0c
.long 0xbf003f00,0x3f003f00,0x3f00bf00,0xbf00bf00,0x3e8bbf27,0xbf20beab,0xbec93f17,0x3f0c3ee6,0xa724bf35,0xbf32be0d,0xbe8b3f27,0x3f173ec9,0x3e8b3f27,0x3f34bd8e,0x3e0dbf32,0xbf20beab
.long 0x3f003f00,0x3f27be8b,0xa73cbf35,0xbf27be8b,0xbf27be8b,0xbf0c3ee6,0x3e0d3f32,0x3f2d3e52,0xbf352782,0xbec93f17,0x3e8b3f27,0x3f323e0d,0x3f27be8b,0x3e52bf2d,0xbec9bf17,0xbf34bd8e
.long 0x3f00bf00,0x2807bf35,0xbf00bf00,0xbf352825,0xbe8b3f27,0x3e523f2d,0x3f173ec9,0x3f34bd8e,0x27b63f35,0x3ec93f17,0x3f273e8b,0x3f32be0d,0xbe8bbf27,0xbf0cbee6,0xbf32be0d,0xbf2d3e52
.long 0xbf00bf00,0xbf27be8b,0xbf35a670,0xbf273e8b,0x3f273e8b,0x3f343d8e,0x3f32be0d,0x3f20beab,0x3f35a7e6,0x3f32be0d,0x3f27be8b,0x3f17bec9,0xbf273e8b,0xbf203eab,0xbf173ec9,0xbf0c3ee6
.long 0xbf003f00,0x3f00bf00,0xbf003f00,0x3f00bf00,0x3f00bf00,0xbf0c3ee6,0x3f17bec9,0xbf203eab,0x3f00bf00,0xbf173ec9,0x3f27be8b,0xbf323e0d,0xbf003f00,0x3f20beab,0xbf323e0d,0x3f343d8e
.long 0xbf003f00,0x3f27be8b,0xbf352782,0x3f273e8b,0x3f00bf00,0xbf2d3e52,0x3f323e0d,0xbf0cbee6,0x3f00bf00,0xbf323e0d,0x3f273e8b,0xbec9bf17,0xbf003f00,0x3f34bd8e,0xbf17bec9,0x3e523f2d
.long 0xbf003f00,0x3f35a6a8,0xbf00bf00,0x25403f35,0x3f00bf00,0xbf34bd8e,0x3ec93f17,0x3e52bf2d,0x3f00bf00,0xbf32be0d,0x3e8b3f27,0x3ec9bf17,0xbf003f00,0x3f2d3e52,0xbe0dbf32,0xbf0c3ee6
.long 0xbf003f00,0x3f273e8b,0x2724bf35,0xbf273e8b,0x3f00bf00,0xbf20beab,0xbe0d3f32,0x3f34bd8e,0x3f00bf00,0xbf17bec9,0xbe8b3f27,0x3f323e0d,0xbf003f00,0x3f0c3ee6,0x3ec9bf17,0xbf20beab
.long 0xbf003f00,0x3f003f00,0x3f00bf00,0xbf00bf00,0x3f00bf00,0xbee6bf0c,0xbf173ec9,0x3eab3f20,0x3f00bf00,0xbec9bf17,0xbf273e8b,0x3e0d3f32,0xbf003f00,0x3eab3f20,0x3f32be0d,0x3d8ebf34
.long 0xbf003f00,0x3e8b3f27,0x3f35a70c,0x3e8bbf27,0x3f00bf00,0xbe52bf2d,0xbf32be0d,0xbee63f0c,0x3f00bf00,0xbe0dbf32,0xbf27be8b,0xbf173ec9,0xbf003f00,0x3d8e3f34,0x3f173ec9,0x3f2dbe52
.long 0xbf003f00,0xa79c3f35,0x3f003f00,0x3f35a85d,0x3f00bf00,0x3d8ebf34,0xbec9bf17,0xbf2dbe52,0x3f00bf00,0x3e0dbf32,0xbe8bbf27,0xbf17bec9,0xbf003f00,0xbe523f2d,0x3e0d3f32,0x3ee63f0c
.long 0xbf003f00,0xbe8b3f27,0x27da3f35,0x3e8b3f27,0x3f00bf00,0x3eabbf20,0x3e0dbf32,0xbd8ebf34,0x3f00bf00,0x3ec9bf17,0x3e8bbf27,0x3e0dbf32,0xbf003f00,0xbee63f0c,0xbec93f17,0xbeab3f20
.long 0xbf003f00,0x3f00bf00,0xbf003f00,0x3f00bf00,0x3f27be8b,0xbf2d3e52,0x3f32be0d,0xbf343d8e,0x3f35a6a8,0xbf32be0d,0x3f273e8b,0xbf17bec9,0xbf27be8b,0x3f0c3ee6,0xbec9bf17,0x3e523f2d
.long 0xbf00bf00,0x3e8b3f27,0xa80dbf35,0xbe8b3f27,0x3e8b3f27,0x3d8ebf34,0xbec93f17,0x3f20beab,0x25403f35,0x3ec9bf17,0xbf273e8b,0x3f323e0d,0x3e8bbf27,0xbf203eab,0x3f323e0d,0xbee6bf0c
.long 0x3f00bf00,0xbf35a670,0x3f003f00,0xa813bf35,0xbf273e8b,0x3f203eab,0xbe0dbf32,0xbee63f0c,0xbf35a670,0x3ec93f17,0x3e8bbf27,0xbf323e0d,0x3f273e8b,0xbd8ebf34,0xbf173ec9,0x3f203eab
.long 0x3f003f00,0x3e8bbf27,0xbf35282b,0x3e8b3f27,0xbe8bbf27,0xbf0c3ee6,0x3f173ec9,0x3e52bf2d,0x270cbf35,0xbf323e0d,0x3e8b3f27,0x3f17bec9,0xbe8b3f27,0x3f2d3e52,0x3e0dbf32,0xbf34bd8e
.long 0xbf003f00,0x3f003f00,0x3f00bf00,0xbf00bf00,0x3f27be8b,0xbe52bf2d,0xbf323e0d,0x3d8e3f34,0x3f35a800,0x3e0dbf32,0xbf27be8b,0xbec93f17,0xbf27be8b,0xbee63f0c,0x3ec93f17,0x3f2dbe52
.long 0xbf00bf00,0xbf273e8b,0x284b3f35,0x3f273e8b,0x3e8b3f27,0x3f343d8e,0x3ec9bf17,0xbeabbf20,0x27da3f35,0x3f173ec9,0x3f27be8b,0x3e0dbf32,0x3e8bbf27,0xbeabbf20,0xbf32be0d,0xbf0c3ee6
.long 0x3f00bf00,0x26a8bf35,0xbf00bf00,0xbf3527c2,0xbf273e8b,0xbeab3f20,0x3e0d3f32,0x3f0c3ee6,0xbf3527b6,0xbf173ec9,0xbe8b3f27,0x3e0d3f32,0x3f273e8b,0x3f34bd8e,0x3f17bec9,0x3eabbf20
.long 0x3f003f00,0x3f273e8b,0x3f35a86a,0x3f27be8b,0xbe8bbf27,0xbee6bf0c,0xbf17bec9,0xbf2dbe52,0xa78ebf35,0xbe0dbf32,0xbe8bbf27,0xbec9bf17,0xbe8b3f27,0xbe523f2d,0xbe0d3f32,0xbd8e3f34
.long 0xbf003f00,0x3f00bf00,0xbf003f00,0x3f00bf00,0x3f352724,0xbf34bd8e,0x3f323e0d,0xbf2dbe52,0x3f003f00,0xbec9bf17,0x3e8b3f27,0xbe0dbf32,0x2670bf35,0xbe523f2d,0x3ec9bf17,0xbf0c3ee6
.long 0x3f00bf00,0xbf273e8b,0x3f35a70c,0xbf27be8b,0xbf352610,0x3f203eab,0xbec9bf17,0x3d8e3f34,0xbf00bf00,0x3e0d3f32,0x3e8bbf27,0xbf173ec9,0x270c3f35,0x3ee6bf0c,0xbf323e0d,0x3f203eab
.long 0xbf003f00,0x3f352754,0xbf00bf00,0x27da3f35,0x3f35a76c,0xbee6bf0c,0xbe0d3f32,0x3f20beab,0x3f003f00,0x3e0dbf32,0xbf273e8b,0x3f173ec9,0xa7aabf35,0xbf203eab,0x3f173ec9,0x3d8ebf34
.long 0x3f00bf00,0xbf27be8b,0xa81f3f35,0x3f27be8b,0xbf3527da,0x3e523f2d,0x3f17bec9,0xbf0cbee6,0xbf00bf00,0xbec93f17,0x3f273e8b,0x3e0dbf32,0x28073f35,0x3f34bd8e,0xbe0dbf32,0xbf2d3e52
.long 0xbf003f00,0x3f003f00,0x3f00bf00,0xbf00bf00,0x3f3526a8,0x3d8ebf34,0xbf32be0d,0xbe523f2d,0x3f003f00,0x3f17bec9,0xbe8bbf27,0xbf323e0d,0xa540bf35,0xbf2dbe52,0xbec93f17,0x3ee63f0c
.long 0x3f00bf00,0xbe8bbf27,0xbf352610,0xbe8b3f27,0xbf3526e0,0xbeab3f20,0x3ec93f17,0x3f34bd8e,0xbf00bf00,0xbf323e0d,0xbe8b3f27,0x3ec93f17,0x286a3f35,0x3f0c3ee6,0x3f32be0d,0x3eabbf20
.long 0xbf003f00,0xa8133f35,0x3f003f00,0x3f35a8a7,0x3f35a79c,0x3f0cbee6,0x3e0dbf32,0xbeabbf20,0x3f003f00,0x3f323e0d,0x3f27be8b,0x3ec9bf17,0x279cbf35,0xbeabbf20,0xbf17bec9,0xbf34bd8e
.long 0x3f00bf00,0x3e8bbf27,0x2839bf35,0xbe8bbf27,0xbf352800,0xbf2d3e52,0xbf173ec9,0xbee63f0c,0xbf00bf00,0xbf17bec9,0xbf27be8b,0xbf32be0d,0xa6e03f35,0x3d8e3f34,0x3e0d3f32,0x3e523f2d
.long 0xbf003f00,0x3f00bf00,0xbf003f00,0x3f00bf00,0x3f273e8b,0xbf20beab,0x3f173ec9,0xbf0cbee6,0x27ce3f35,0x3e0dbf32,0xbe8b3f27,0x3ec9bf17,0x3f27be8b,0xbf343d8e,0x3f323e0d,0xbf20beab
.long 0x3f003f00,0xbe8bbf27,0x27da3f35,0x3e8bbf27,0x3e8bbf27,0xbf0c3ee6,0x3f32be0d,0xbf2dbe52,0x3f35a724,0xbf17bec9,0x3e8b3f27,0x3e0dbf32,0xbe8bbf27,0xbe523f2d,0x3f17bec9,0xbf34bd8e
.long 0x3f00bf00,0xbf35a7b6,0x3f003f00,0xa78ebf35,0xbf27be8b,0x3e523f2d,0x3ec9bf17,0xbf343d8e,0x26a8bf35,0xbf173ec9,0x3f273e8b,0xbe0dbf32,0xbf273e8b,0x3f0c3ee6,0x3e0dbf32,0xbf2d3e52
.long 0xbf00bf00,0xbe8b3f27,0x3f35a86a,0xbe8bbf27,0xbe8b3f27,0x3f343d8e,0xbe0dbf32,0xbf203eab,0xbf3527c2,0x3e0d3f32,0x3f27be8b,0xbec9bf17,0x3e8b3f27,0x3f20beab,0xbec9bf17,0xbf0c3ee6
.long 0xbf003f00,0x3f003f00,0x3f00bf00,0xbf00bf00,0x3f273e8b,0x3eabbf20,0xbf17bec9,0xbee63f0c,0x28573f35,0x3f323e0d,0x3e8bbf27,0xbf17bec9,0x3f27be8b,0xbd8ebf34,0xbf32be0d,0xbeab3f20
.long 0x3f003f00,0x3f27be8b,0xa832bf35,0xbf27be8b,0x3e8bbf27,0xbee6bf0c,0xbf323e0d,0xbe523f2d,0x3f3526e0,0x3ec9bf17,0xbe8bbf27,0xbf32be0d,0xbe8bbf27,0xbf2dbe52,0xbf173ec9,0xbd8e3f34
.long 0x3f00bf00,0xa7b6bf35,0xbf00bf00,0xbf352851,0xbf27be8b,0xbf2d3e52,0xbec93f17,0x3d8e3f34,0xa7b6bf35,0xbec9bf17,0xbf27be8b,0xbf323e0d,0xbf273e8b,0xbee63f0c,0xbe0d3f32,0x3e523f2d
.long 0xbf00bf00,0xbf27be8b,0xbf3527f2,0xbf273e8b,0xbe8b3f27,0xbd8e3f34,0x3e0d3f32,0x3eab3f20,0xbf352851,0xbf323e0d,0xbf273e8b,0xbf173ec9,0x3e8b3f27,0x3eab3f20,0x3ec93f17,0x3ee63f0c
.long 0x3f803f80,0x3f803f80,0x3f803f80,0x3f803f80,0x3f7b3f80,0x3f553f6d,0xbe48248d,0xbf0ebec4,0x3f6d3f80,0x3ec43f35,0xbf6dbf80,0xbec4bf35,0x3f553f80,0xbe483ec4,0x3f0ea554,0x3f7b3f6d
.long 0x3f353f80,0xbf35248d,0x3f353f80,0xbf3525b0,0x3f0e3f80,0xbf7bbec4,0xbf5525b0,0xbe48bf6d,0x3ec43f80,0xbf6dbf35,0xbec4bf80,0x3f6d3f35,0x3e483f80,0xbf0ebf6d,0x3f7ba5f7,0xbf553ec4
.long 0x248d3f80,0xa554bf80,0x261f3f80,0xa731bf80,0xbe483f80,0x3f0ebf6d,0xbf7b261f,0x3f553ec4,0xbec43f80,0x3f6dbf35,0x3ec4bf80,0xbf6d3f35,0xbf0e3f80,0x3f7bbec4,0x3f55a731,0x3e48bf6d
.long 0xbf353f80,0x3f35a554,0xbf353f80,0x3f35a742,0xbf553f80,0x3e483ec4,0xbf0ea68d,0xbf7b3f6d,0xbf6d3f80,0xbec43f35,0x3f6dbf80,0x3ec4bf35,0xbf7b3f80,0xbf553f6d,0x3e48a742,0x3f0ebec4
.long 0xbf803f80,0xbf803f80,0xbf803f80,0xbf803f80,0xbf7b3f80,0xbf553f6d,0x3e48a654,0x3f0ebec4,0xbf6d3f80,0xbec43f35,0x3f6dbf80,0x3ec4bf35,0xbf553f80,0x3e483ec4,0xbf0ea754,0xbf7b3f6d
.long 0xbf353f80,0x3f3525b0,0xbf353f80,0x3f35a58e,0xbf0e3f80,0x3f7bbec4,0x3f55a60d,0x3e48bf6d,0xbec43f80,0x3f6dbf35,0x3ec4bf80,0xbf6d3f35,0xbe483f80,0x3f0ebf6d,0xbf7ba765,0x3f553ec4
.long 0xa5543f80,0x261fbf80,0xa7773f80,0x2804bf80,0x3e483f80,0xbf0ebf6d,0x3f7ba58e,0xbf553ec4,0x3ec43f80,0xbf6dbf35,0xbec4bf80,0x3f6d3f35,0x3f0e3f80,0xbf7bbec4,0xbf55a777,0xbe48bf6d
.long 0x3f353f80,0xbf35a5f7,0x3f353f80,0xbf35a78d,0x3f553f80,0xbe483ec4,0x3f0ea137,0x3f7b3f6d,0x3f6d3f80,0x3ec43f35,0xbf6dbf80,0xbec4bf35,0x3f7b3f80,0x3f553f6d,0xbe48a784,0xbf0ebec4
.long 0x3f803f80,0x3f803f80,0x3f803f80,0x3f803f80,0x3f0e3f35,0x3e483ec4,0xbf55bf35,0xbf7bbf6d,0xbec4248d,0xbf6dbf35,0x3ec4a554,0x3f6d3f35,0xbf7bbf35,0xbf0ebf6d,0x3e483f35,0xbf55bec4
.long 0xbf35bf80,0x3f35a554,0xbf35bf80,0x3f35a5f7,0x3e48bf35,0x3f553f6d,0x3f7b3f35,0xbf0e3ec4,0x3f6da554,0xbec43f35,0xbf6d261f,0x3ec4bf35,0x3f553f35,0xbf7bbec4,0x3f0ebf35,0xbe483f6d
.long 0x25b03f80,0xa5f7bf80,0xa68d3f80,0xa742bf80,0xbf553f35,0x3f7bbec4,0xbf0ebf35,0x3e483f6d,0xbf6d25b0,0x3ec43f35,0x3f6da742,0xbec4bf35,0xbe48bf35,0xbf553f6d,0xbf7b3f35,0x3f0e3ec4
.long 0x3f35bf80,0xbf35261f,0x3f35bf80,0xbf35a60d,0x3f7bbf35,0x3f0ebf6d,0xbe483f35,0x3f55bec4,0x3ec4a5f7,0x3f6dbf35,0xbec4a60d,0xbf6d3f35,0xbf0e3f35,0xbe483ec4,0x3f55bf35,0x3f7bbf6d
.long 0xbf803f80,0xbf803f80,0xbf803f80,0xbf803f80,0xbf0e3f35,0xbe483ec4,0x3f55bf35,0x3f7bbf6d,0x3ec4261f,0x3f6dbf35,0xbec4a777,0xbf6d3f35,0x3f7bbf35,0x3f0ebf6d,0xbe483f35,0x3f55bec4
.long 0x3f35bf80,0xbf35a742,0x3f35bf80,0xbf35a78d,0xbe48bf35,0xbf553f6d,0xbf7b3f35,0x3f0e3ec4,0xbf6da731,0x3ec43f35,0x3f6d258d,0xbec4bf35,0xbf553f35,0x3f7bbec4,0xbf0ebf35,0x3e483f6d
.long 0xa7423f80,0xa60dbf80,0x27543f80,0x2889bf80,0x3f553f35,0xbf7bbec4,0x3f0ebf35,0xbe483f6d,0x3f6da68d,0xbec43f35,0xbf6da796,0x3ec4bf35,0x3e48bf35,0x3f553f6d,0x3f7b3f35,0xbf0e3ec4
.long 0xbf35bf80,0x3f35a60d,0xbf35bf80,0x3f352816,0xbf7bbf35,0xbf0ebf6d,0x3e483f35,0xbf55bec4,0xbec4a742,0xbf6dbf35,0x3ec4268d,0x3f6d3f35,0x3f0e3f35,0x3e483ec4,0xbf55bf35,0xbf7bbf6d
.long 0x3f803f80,0x3f803f80,0x3f803f80,0x3f803f80,0xbf7bbf80,0xbf55bf6d,0x3e48a554,0x3f0e3ec4,0x3f6d3f80,0x3ec43f35,0xbf6dbf80,0xbec4bf35,0xbf55bf80,0x3e48bec4,0xbf0e261f,0xbf7bbf6d
.long 0x3f353f80,0xbf35261f,0x3f353f80,0xbf35a68d,0xbf0ebf80,0x3f7b3ec4,0x3f55a742,0x3e483f6d,0x3ec43f80,0xbf6dbf35,0xbec4bf80,0x3f6d3f35,0xbe48bf80,0x3f0e3f6d,0xbf7ba60d,0x3f55bec4
.long 0xa6543f80,0xa754bf80,0xa58e3f80,0xa777bf80,0x3e48bf80,0xbf0e3f6d,0x3f7ba777,0xbf55bec4,0xbec43f80,0x3f6dbf35,0x3ec4bf80,0xbf6d3f35,0x3f0ebf80,0xbf7b3ec4,0xbf55258d,0xbe483f6d
.long 0xbf353f80,0x3f35a777,0xbf353f80,0x3f352754,0x3f55bf80,0xbe48bec4,0x3f0ea796,0x3f7bbf6d,0xbf6d3f80,0xbec43f35,0x3f6dbf80,0x3ec4bf35,0x3f7bbf80,0x3f55bf6d,0xbe48268d,0xbf0e3ec4
.long 0xbf803f80,0xbf803f80,0xbf803f80,0xbf803f80,0x3f7bbf80,0x3f55bf6d,0xbe48a7b1,0xbf0e3ec4,0xbf6d3f80,0xbec43f35,0x3f6dbf80,0x3ec4bf35,0x3f55bf80,0xbe48bec4,0x3f0e281f,0x3f7bbf6d
.long 0xbf353f80,0x3f35268d,0xbf353f80,0x3f35a7b1,0x3f0ebf80,0xbf7b3ec4,0xbf5526d4,0xbe483f6d,0xbec43f80,0x3f6dbf35,0x3ec4bf80,0xbf6d3f35,0x3e48bf80,0xbf0e3f6d,0x3f7b2730,0xbf55bec4
.long 0x28283f80,0x281fbf80,0xa7e53f80,0x2839bf80,0xbe48bf80,0x3f0e3f6d,0xbf7ba7e5,0x3f55bec4,0x3ec43f80,0xbf6dbf35,0xbec4bf80,0x3f6d3f35,0xbf0ebf80,0x3f7b3ec4,0x3f552839,0x3e483f6d
.long 0x3f353f80,0xbf3526d4,0x3f353f80,0xbf3528be,0xbf55bf80,0x3e48bec4,0xbf0ea880,0xbf7bbf6d,0x3f6d3f80,0x3ec43f35,0xbf6dbf80,0xbec4bf35,0xbf7bbf80,0xbf55bf6d,0x3e4828a3,0x3f0e3ec4
.long 0x3f803f80,0x3f803f80,0x3f803f80,0x3f803f80,0xbf0ebf35,0xbe48bec4,0x3f553f35,0x3f7b3f6d,0xbec425b0,0xbf6dbf35,0x3ec4a5f7,0x3f6d3f35,0x3f7b3f35,0x3f0e3f6d,0xbe48bf35,0x3f553ec4
.long 0xbf35bf80,0x3f35a731,0xbf35bf80,0x3f35a742,0xbe483f35,0xbf55bf6d,0xbf7bbf35,0x3f0ebec4,0x3f6da742,0xbec43f35,0xbf6da60d,0x3ec4bf35,0xbf55bf35,0x3f7b3ec4,0xbf0e3f35,0x3e48bf6d
.long 0xa60d3f80,0xa765bf80,0xa1373f80,0xa784bf80,0x3f55bf35,0xbf7b3ec4,0x3f0e3f35,0xbe48bf6d,0xbf6da58e,0x3ec43f35,0x3f6da78d,0xbec4bf35,0x3e483f35,0x3f55bf6d,0x3f7bbf35,0xbf0ebec4
.long 0x3f35bf80,0xbf352804,0x3f35bf80,0xbf352889,0xbf7b3f35,0xbf0e3f6d,0x3e48bf35,0xbf553ec4,0x3ec4a78d,0x3f6dbf35,0xbec42816,0xbf6d3f35,0x3f0ebf35,0x3e48bec4,0xbf553f35,0xbf7b3f6d
.long 0xbf803f80,0xbf803f80,0xbf803f80,0xbf803f80,0x3f0ebf35,0x3e48bec4,0xbf553f35,0xbf7b3f6d,0x3ec4268d,0x3f6dbf35,0xbec426d4,0xbf6d3f35,0xbf7b3f35,0xbf0e3f6d,0x3e48bf35,0xbf553ec4
.long 0x3f35bf80,0xbf35a85d,0x3f35bf80,0xbf35a7e5,0x3e483f35,0x3f55bf6d,0x3f7bbf35,0xbf0ebec4,0xbf6d270d,0x3ec43f35,0x3f6d2754,0xbec4bf35,0x3f55bf35,0xbf7b3ec4,0x3f0e3f35,0xbe48bf6d
.long 0x26d43f80,0x2730bf80,0xa8803f80,0x28a3bf80,0xbf55bf35,0x3f7b3ec4,0xbf0e3f35,0x3e48bf6d,0x3f6d2828,0xbec43f35,0xbf6da804,0x3ec4bf35,0xbe483f35,0xbf55bf6d,0xbf7bbf35,0x3f0ebec4
.long 0xbf35bf80,0x3f35289a,0xbf35bf80,0x3f3528ea,0x3f7b3f35,0x3f0e3f6d,0xbe48bf35,0x3f553ec4,0xbec4a7e5,0xbf6dbf35,0x3ec4a731,0x3f6d3f35,0xbf0ebf35,0xbe48bec4,0x3f553f35,0x3f7b3f6d
.long 0x0,0x0,0x0,0x0,0x3e480000,0x3f0e3ec4,0x3f7b3f80,0x3f553f6d,0x3ec40000,0x3f6d3f35,0xbec4250d,0xbf6dbf35,0x3f0e0000,0x3f7b3f6d,0xbf55bf80,0x3e48bec4
.long 0x3f350000,0x3f353f80,0x3f35a58d,0x3f353f80,0x3f550000,0x3e483f6d,0x3f0e3f80,0xbf7bbec4,0x3f6d0000,0xbec43f35,0xbf6d25d4,0x3ec4bf35,0x3f7b0000,0xbf553ec4,0xbe48bf80,0x3f0e3f6d
.long 0x3f800000,0xbf80250d,0x3f80a60d,0xbf802630,0x3f7b0000,0xbf55bec4,0xbe483f80,0x3f0ebf6d,0x3f6d0000,0xbec4bf35,0xbf6d2630,0x3ec43f35,0x3f550000,0x3e48bf6d,0x3f0ebf80,0xbf7b3ec4
.long 0x3f350000,0x3f35bf80,0x3f35a654,0x3f35bf80,0x3f0e0000,0x3f7bbf6d,0xbf553f80,0x3e483ec4,0x3ec40000,0x3f6dbf35,0xbec42677,0xbf6d3f35,0x3e480000,0x3f0ebec4,0x3f7bbf80,0x3f55bf6d
.long 0x250d0000,0x25d4a58d,0x269fa68d,0x27b1a6b0,0xbe480000,0xbf0e3ec4,0xbf7b3f80,0xbf553f6d,0xbec40000,0xbf6d3f35,0x3ec4269f,0x3f6dbf35,0xbf0e0000,0xbf7b3f6d,0x3f55bf80,0xbe48bec4
.long 0xbf350000,0xbf353f80,0xbf35a6b0,0xbf353f80,0xbf550000,0xbe483f6d,0xbf0e3f80,0x3f7bbec4,0xbf6d0000,0x3ec43f35,0x3f6d27b1,0xbec4bf35,0xbf7b0000,0x3f553ec4,0x3e48bf80,0xbf0e3f6d
.long 0xbf800000,0x3f8025d4,0xbf80a6d4,0x3f8027c2,0xbf7b0000,0x3f55bec4,0x3e483f80,0xbf0ebf6d,0xbf6d0000,0x3ec4bf35,0x3f6da70d,0xbec43f35,0xbf550000,0xbe48bf6d,0xbf0ebf80,0x3f7b3ec4
.long 0xbf350000,0xbf35bf80,0xbf35a6f7,0xbf35bf80,0xbf0e0000,0xbf7bbf6d,0x3f553f80,0xbe483ec4,0xbec40000,0xbf6dbf35,0x3ec427c2,0x3f6d3f35,0xbe480000,0xbf0ebec4,0xbf7bbf80,0xbf55bf6d
.long 0x0,0x0,0x0,0x0,0x3f553f35,0x3f7b3f6d,0x3f0e3f35,0x3e483ec4,0x3f6d3f80,0x3ec43f35,0xbf6dbf80,0xbec4bf35,0x3e483f35,0xbf55bec4,0x3f7b3f35,0x3f0e3f6d
.long 0xbf35250d,0xbf35bf80,0xbf3525d4,0xbf35bf80,0xbf7bbf35,0x3f0ebec4,0x3e48bf35,0x3f553f6d,0xbec4bf80,0x3f6d3f35,0x3ec43f80,0xbf6dbf35,0x3f0ebf35,0xbe483f6d,0xbf55bf35,0x3f7b3ec4
.long 0x3f80a58d,0xbf8025d4,0x3f80a654,0xbf802677,0x3f0e3f35,0xbe48bf6d,0xbf553f35,0x3f7bbec4,0xbec43f80,0x3f6dbf35,0x3ec4bf80,0xbf6d3f35,0xbf7b3f35,0x3f0e3ec4,0x3e483f35,0x3f55bf6d
.long 0xbf3525d4,0xbf353f80,0xbf35269f,0xbf353f80,0x3e48bf35,0xbf553ec4,0x3f7bbf35,0x3f0ebf6d,0x3f6dbf80,0x3ec4bf35,0xbf6d3f80,0xbec43f35,0x3f55bf35,0x3f7bbf6d,0x3f0ebf35,0x3e48bec4
.long 0x2630a60d,0x2677a654,0xa70da6d4,0x27c2a6f7,0xbf553f35,0xbf7b3f6d,0xbf0e3f35,0xbe483ec4,0xbf6d3f80,0xbec43f35,0x3f6dbf80,0x3ec4bf35,0xbe483f35,0x3f55bec4,0xbf7b3f35,0xbf0e3f6d
.long 0x3f352630,0x3f35bf80,0x3f3527c2,0x3f35bf80,0x3f7bbf35,0xbf0ebec4,0xbe48bf35,0xbf553f6d,0x3ec4bf80,0xbf6d3f35,0xbec43f80,0x3f6dbf35,0xbf0ebf35,0x3e483f6d,0x3f55bf35,0xbf7b3ec4
.long 0xbf80a654,0x3f80269f,0xbf80a71f,0x3f80a68d,0xbf0e3f35,0x3e48bf6d,0x3f553f35,0xbf7bbec4,0x3ec43f80,0xbf6dbf35,0xbec4bf80,0x3f6d3f35,0x3f7b3f35,0xbf0e3ec4,0xbe483f35,0xbf55bf6d
.long 0x3f352677,0x3f353f80,0x3f35a68d,0x3f353f80,0xbe48bf35,0x3f553ec4,0xbf7bbf35,0xbf0ebf6d,0xbf6dbf80,0xbec4bf35,0x3f6d3f80,0x3ec43f35,0xbf55bf35,0xbf7bbf6d,0xbf0ebf35,0xbe48bec4
.long 0x0,0x0,0x0,0x0,0xbe48250d,0xbf0ebec4,0xbf7bbf80,0xbf55bf6d,0x3ec4a58d,0x3f6d3f35,0xbec425d4,0xbf6dbf35,0xbf0e25d4,0xbf7bbf6d,0x3f553f80,0xbe483ec4
.long 0x3f35a60d,0x3f353f80,0x3f35a654,0x3f353f80,0xbf552630,0xbe48bf6d,0xbf0ebf80,0x3f7b3ec4,0x3f6da654,0xbec43f35,0xbf6d269f,0x3ec4bf35,0xbf7b2677,0x3f55bec4,0x3e483f80,0xbf0ebf6d
.long 0x3f80a68d,0xbf80269f,0x3f80a6d4,0xbf80a70d,0xbf7b269f,0x3f553ec4,0x3e48bf80,0xbf0e3f6d,0x3f6da6b0,0xbec4bf35,0xbf6d27c2,0x3ec43f35,0xbf5527b1,0xbe483f6d,0xbf0e3f80,0x3f7bbec4
.long 0x3f35a6d4,0x3f35bf80,0x3f35a71f,0x3f35bf80,0xbf0ea70d,0xbf7b3f6d,0x3f55bf80,0xbe48bec4,0x3ec4a6f7,0x3f6dbf35,0xbec4a68d,0xbf6d3f35,0xbe4827c2,0xbf0e3ec4,0xbf7b3f80,0xbf553f6d
.long 0xa6d4a70d,0x27d4a71f,0xa60ea754,0x27f7278d,0x3e48a6d4,0x3f0ebec4,0x3f7bbf80,0x3f55bf6d,0xbec4a71f,0xbf6d3f35,0x3ec427f7,0x3f6dbf35,0x3f0e27d4,0x3f7bbf6d,0xbf553f80,0x3e483ec4
.long 0xbf35a730,0xbf353f80,0xbf35a842,0xbf353f80,0x3f55a68d,0x3e48bf6d,0x3f0ebf80,0xbf7b3ec4,0xbf6da831,0x3ec43f35,0x3f6d260d,0xbec4bf35,0x3f7b27e5,0xbf55bec4,0xbe483f80,0x3f0ebf6d
.long 0xbf80a754,0x3f8027f7,0xbf80a79f,0x3f80a7d4,0x3f7ba60e,0xbf553ec4,0xbe48bf80,0x3f0e3f6d,0xbf6d278d,0x3ec4bf35,0x3f6d2816,0xbec43f35,0x3f5527f7,0x3e483f6d,0x3f0e3f80,0xbf7bbec4
.long 0xbf35a777,0xbf35bf80,0xbf35270d,0xbf35bf80,0x3f0ea1b7,0x3f7b3f6d,0xbf55bf80,0x3e48bec4,0xbec4a842,0xbf6dbf35,0x3ec4270d,0x3f6d3f35,0x3e482804,0x3f0e3ec4,0x3f7b3f80,0x3f553f6d
.long 0x0,0x0,0x0,0x0,0xbf55bf35,0xbf7bbf6d,0xbf0ebf35,0xbe48bec4,0x3f6d3f80,0x3ec43f35,0xbf6dbf80,0xbec4bf35,0xbe48bf35,0x3f553ec4,0xbf7bbf35,0xbf0ebf6d
.long 0xbf352630,0xbf35bf80,0xbf352677,0xbf35bf80,0x3f7b3f35,0xbf0e3ec4,0xbe483f35,0xbf55bf6d,0xbec4bf80,0x3f6d3f35,0x3ec43f80,0xbf6dbf35,0xbf0e3f35,0x3e48bf6d,0x3f553f35,0xbf7bbec4
.long 0x3f80a6b0,0xbf8027b1,0x3f80a6f7,0xbf8027c2,0xbf0ebf35,0x3e483f6d,0x3f55bf35,0xbf7b3ec4,0xbec43f80,0x3f6dbf35,0x3ec4bf80,0xbf6d3f35,0x3f7bbf35,0xbf0ebec4,0xbe48bf35,0xbf553f6d
.long 0xbf3527c2,0xbf353f80,0xbf35a68d,0xbf353f80,0xbe483f35,0x3f55bec4,0xbf7b3f35,0xbf0e3f6d,0x3f6dbf80,0x3ec4bf35,0xbf6d3f80,0xbec43f35,0xbf553f35,0xbf7b3f6d,0xbf0e3f35,0xbe483ec4
.long 0xa68da730,0x27e5a831,0xa1b7a777,0x2804a842,0x3f55bf35,0x3f7bbf6d,0x3f0ebf35,0x3e48bec4,0xbf6d3f80,0xbec43f35,0x3f6dbf80,0x3ec4bf35,0x3e48bf35,0xbf553ec4,0x3f7bbf35,0x3f0ebf6d
.long 0x3f35a60e,0x3f35bf80,0x3f35280d,0x3f35bf80,0xbf7b3f35,0x3f0e3ec4,0x3e483f35,0x3f55bf6d,0x3ec4bf80,0xbf6d3f35,0xbec43f80,0x3f6dbf35,0x3f0e3f35,0xbe48bf6d,0xbf553f35,0x3f7bbec4
.long 0xbf80a842,0x3f802884,0xbf80270d,0x3f802909,0x3f0ebf35,0xbe483f6d,0xbf55bf35,0x3f7b3ec4,0x3ec43f80,0xbf6dbf35,0xbec4bf80,0x3f6d3f35,0xbf7bbf35,0x3f0ebec4,0x3e48bf35,0x3f553f6d
.long 0x3f35280d,0x3f353f80,0x3f352896,0x3f353f80,0x3e483f35,0xbf55bec4,0x3f7b3f35,0x3f0e3f6d,0xbf6dbf80,0xbec4bf35,0x3f6d3f80,0x3ec43f35,0x3f553f35,0x3f7b3f6d,0x3f0e3f35,0x3e483ec4
.long 0x80008000,0x80008000,0x80008000,0x80008000,0xbe488000,0xbf0ebec4,0xbf7bbf80,0xbf55bf6d,0xbec48000,0xbf6dbf35,0x3ec4a50d,0x3f6d3f35,0xbf0e8000,0xbf7bbf6d,0x3f553f80,0xbe483ec4
.long 0xbf358000,0xbf35bf80,0xbf35258d,0xbf35bf80,0xbf558000,0xbe48bf6d,0xbf0ebf80,0x3f7b3ec4,0xbf6d8000,0x3ec4bf35,0x3f6da5d4,0xbec43f35,0xbf7b8000,0x3f55bec4,0x3e483f80,0xbf0ebf6d
.long 0xbf808000,0x3f80a50d,0xbf80260d,0x3f80a630,0xbf7b8000,0x3f553ec4,0x3e48bf80,0xbf0e3f6d,0xbf6d8000,0x3ec43f35,0x3f6da630,0xbec4bf35,0xbf558000,0xbe483f6d,0xbf0e3f80,0x3f7bbec4
.long 0xbf358000,0xbf353f80,0xbf352654,0xbf353f80,0xbf0e8000,0xbf7b3f6d,0x3f55bf80,0xbe48bec4,0xbec48000,0xbf6d3f35,0x3ec4a677,0x3f6dbf35,0xbe488000,0xbf0e3ec4,0xbf7b3f80,0xbf553f6d
.long 0xa50d8000,0xa5d4258d,0xa69f268d,0xa7b126b0,0x3e488000,0x3f0ebec4,0x3f7bbf80,0x3f55bf6d,0x3ec48000,0x3f6dbf35,0xbec4a69f,0xbf6d3f35,0x3f0e8000,0x3f7bbf6d,0xbf553f80,0x3e483ec4
.long 0x3f358000,0x3f35bf80,0x3f3526b0,0x3f35bf80,0x3f558000,0x3e48bf6d,0x3f0ebf80,0xbf7b3ec4,0x3f6d8000,0xbec4bf35,0xbf6da7b1,0x3ec43f35,0x3f7b8000,0xbf55bec4,0xbe483f80,0x3f0ebf6d
.long 0x3f808000,0xbf80a5d4,0x3f8026d4,0xbf80a7c2,0x3f7b8000,0xbf553ec4,0xbe48bf80,0x3f0e3f6d,0x3f6d8000,0xbec43f35,0xbf6d270d,0x3ec4bf35,0x3f558000,0x3e483f6d,0x3f0e3f80,0xbf7bbec4
.long 0x3f358000,0x3f353f80,0x3f3526f7,0x3f353f80,0x3f0e8000,0x3f7b3f6d,0xbf55bf80,0x3e48bec4,0x3ec48000,0x3f6d3f35,0xbec4a7c2,0xbf6dbf35,0x3e488000,0x3f0e3ec4,0x3f7b3f80,0x3f553f6d
.long 0x80008000,0x80008000,0x80008000,0x80008000,0xbf55bf35,0xbf7bbf6d,0xbf0ebf35,0xbe48bec4,0xbf6dbf80,0xbec4bf35,0x3f6d3f80,0x3ec43f35,0xbe48bf35,0x3f553ec4,0xbf7bbf35,0xbf0ebf6d
.long 0x3f35a50d,0x3f353f80,0x3f35a5d4,0x3f353f80,0x3f7b3f35,0xbf0e3ec4,0xbe483f35,0xbf55bf6d,0x3ec43f80,0xbf6dbf35,0xbec4bf80,0x3f6d3f35,0xbf0e3f35,0x3e48bf6d,0x3f553f35,0xbf7bbec4
.long 0xbf80258d,0x3f80a5d4,0xbf802654,0x3f80a677,0xbf0ebf35,0x3e483f6d,0x3f55bf35,0xbf7b3ec4,0x3ec4bf80,0xbf6d3f35,0xbec43f80,0x3f6dbf35,0x3f7bbf35,0xbf0ebec4,0xbe48bf35,0xbf553f6d
.long 0x3f35a5d4,0x3f35bf80,0x3f35a69f,0x3f35bf80,0xbe483f35,0x3f55bec4,0xbf7b3f35,0xbf0e3f6d,0xbf6d3f80,0xbec43f35,0x3f6dbf80,0x3ec4bf35,0xbf553f35,0xbf7b3f6d,0xbf0e3f35,0xbe483ec4
.long 0xa630260d,0xa6772654,0x270d26d4,0xa7c226f7,0x3f55bf35,0x3f7bbf6d,0x3f0ebf35,0x3e48bec4,0x3f6dbf80,0x3ec4bf35,0xbf6d3f80,0xbec43f35,0x3e48bf35,0xbf553ec4,0x3f7bbf35,0x3f0ebf6d
.long 0xbf35a630,0xbf353f80,0xbf35a7c2,0xbf353f80,0xbf7b3f35,0x3f0e3ec4,0x3e483f35,0x3f55bf6d,0xbec43f80,0x3f6dbf35,0x3ec4bf80,0xbf6d3f35,0x3f0e3f35,0xbe48bf6d,0xbf553f35,0x3f7bbec4
.long 0x3f802654,0xbf80a69f,0x3f80271f,0xbf80268d,0x3f0ebf35,0xbe483f6d,0xbf55bf35,0x3f7b3ec4,0xbec4bf80,0x3f6d3f35,0x3ec43f80,0xbf6dbf35,0xbf7bbf35,0x3f0ebec4,0x3e48bf35,0x3f553f6d
.long 0xbf35a677,0xbf35bf80,0xbf35268d,0xbf35bf80,0x3e483f35,0xbf55bec4,0x3f7b3f35,0x3f0e3f6d,0x3f6d3f80,0x3ec43f35,0xbf6dbf80,0xbec4bf35,0x3f553f35,0x3f7b3f6d,0x3f0e3f35,0x3e483ec4
.long 0x80008000,0x80008000,0x80008000,0x80008000,0x3e48a50d,0x3f0e3ec4,0x3f7b3f80,0x3f553f6d,0xbec4258d,0xbf6dbf35,0x3ec4a5d4,0x3f6d3f35,0x3f0ea5d4,0x3f7b3f6d,0xbf55bf80,0x3e48bec4
.long 0xbf35260d,0xbf35bf80,0xbf352654,0xbf35bf80,0x3f55a630,0x3e483f6d,0x3f0e3f80,0xbf7bbec4,0xbf6d2654,0x3ec4bf35,0x3f6da69f,0xbec43f35,0x3f7ba677,0xbf553ec4,0xbe48bf80,0x3f0e3f6d
.long 0xbf80268d,0x3f80a69f,0xbf8026d4,0x3f80270d,0x3f7ba69f,0xbf55bec4,0xbe483f80,0x3f0ebf6d,0xbf6d26b0,0x3ec43f35,0x3f6da7c2,0xbec4bf35,0x3f55a7b1,0x3e48bf6d,0x3f0ebf80,0xbf7b3ec4
.long 0xbf3526d4,0xbf353f80,0xbf35271f,0xbf353f80,0x3f0e270d,0x3f7bbf6d,0xbf553f80,0x3e483ec4,0xbec426f7,0xbf6d3f35,0x3ec4268d,0x3f6dbf35,0x3e48a7c2,0x3f0ebec4,0x3f7bbf80,0x3f55bf6d
.long 0x26d4270d,0xa7d4271f,0x260e2754,0xa7f7a78d,0xbe4826d4,0xbf0e3ec4,0xbf7b3f80,0xbf553f6d,0x3ec4271f,0x3f6dbf35,0xbec4a7f7,0xbf6d3f35,0xbf0ea7d4,0xbf7b3f6d,0x3f55bf80,0xbe48bec4
.long 0x3f352730,0x3f35bf80,0x3f352842,0x3f35bf80,0xbf55268d,0xbe483f6d,0xbf0e3f80,0x3f7bbec4,0x3f6d2831,0xbec4bf35,0xbf6da60d,0x3ec43f35,0xbf7ba7e5,0x3f553ec4,0x3e48bf80,0xbf0e3f6d
.long 0x3f802754,0xbf80a7f7,0x3f80279f,0xbf8027d4,0xbf7b260e,0x3f55bec4,0x3e483f80,0xbf0ebf6d,0x3f6da78d,0xbec43f35,0xbf6da816,0x3ec4bf35,0xbf55a7f7,0xbe48bf6d,0xbf0ebf80,0x3f7b3ec4
.long 0x3f352777,0x3f353f80,0x3f35a70d,0x3f353f80,0xbf0e21b7,0xbf7bbf6d,0x3f553f80,0xbe483ec4,0x3ec42842,0x3f6d3f35,0xbec4a70d,0xbf6dbf35,0xbe48a804,0xbf0ebec4,0xbf7bbf80,0xbf55bf6d
.long 0x80008000,0x80008000,0x80008000,0x80008000,0x3f553f35,0x3f7b3f6d,0x3f0e3f35,0x3e483ec4,0xbf6dbf80,0xbec4bf35,0x3f6d3f80,0x3ec43f35,0x3e483f35,0xbf55bec4,0x3f7b3f35,0x3f0e3f6d
.long 0x3f35a630,0x3f353f80,0x3f35a677,0x3f353f80,0xbf7bbf35,0x3f0ebec4,0x3e48bf35,0x3f553f6d,0x3ec43f80,0xbf6dbf35,0xbec4bf80,0x3f6d3f35,0x3f0ebf35,0xbe483f6d,0xbf55bf35,0x3f7b3ec4
.long 0xbf8026b0,0x3f80a7b1,0xbf8026f7,0x3f80a7c2,0x3f0e3f35,0xbe48bf6d,0xbf553f35,0x3f7bbec4,0x3ec4bf80,0xbf6d3f35,0xbec43f80,0x3f6dbf35,0xbf7b3f35,0x3f0e3ec4,0x3e483f35,0x3f55bf6d
.long 0x3f35a7c2,0x3f35bf80,0x3f35268d,0x3f35bf80,0x3e48bf35,0xbf553ec4,0x3f7bbf35,0x3f0ebf6d,0xbf6d3f80,0xbec43f35,0x3f6dbf80,0x3ec4bf35,0x3f55bf35,0x3f7bbf6d,0x3f0ebf35,0x3e48bec4
.long 0x268d2730,0xa7e52831,0x21b72777,0xa8042842,0xbf553f35,0xbf7b3f6d,0xbf0e3f35,0xbe483ec4,0x3f6dbf80,0x3ec4bf35,0xbf6d3f80,0xbec43f35,0xbe483f35,0x3f55bec4,0xbf7b3f35,0xbf0e3f6d
.long 0xbf35260e,0xbf353f80,0xbf35a80d,0xbf353f80,0x3f7bbf35,0xbf0ebec4,0xbe48bf35,0xbf553f6d,0xbec43f80,0x3f6dbf35,0x3ec4bf80,0xbf6d3f35,0xbf0ebf35,0x3e483f6d,0x3f55bf35,0xbf7b3ec4
.long 0x3f802842,0xbf80a884,0x3f80a70d,0xbf80a909,0xbf0e3f35,0x3e48bf6d,0x3f553f35,0xbf7bbec4,0xbec4bf80,0x3f6d3f35,0x3ec43f80,0xbf6dbf35,0x3f7b3f35,0xbf0e3ec4,0xbe483f35,0xbf55bf6d
.long 0xbf35a80d,0xbf35bf80,0xbf35a896,0xbf35bf80,0xbe48bf35,0x3f553ec4,0xbf7bbf35,0xbf0ebf6d,0x3f6d3f80,0x3ec43f35,0xbf6dbf80,0xbec4bf35,0xbf55bf35,0xbf7bbf6d,0xbf0ebf35,0xbe48bec4
.long 0x3f800000,0x3f800000,0x3f800000,0x3f800000,0x3f800000,0x3f7fffb1,0x3f7ffec4,0x3f7ffd39,0x3f800000,0x3f7ffec4,0x3f7ffb11,0x3f7ff4e6,0x3f800000,0x3f7ffd39,0x3f7ff4e6,0x3f7fe705
.long 0x3f800000,0x3f7ffb11,0x3f7fec43,0x3f7fd397,0x3f800000,0x3f7ff84a,0x3f7fe129,0x3f7fba9e,0x3f800000,0x3f7ff4e6,0x3f7fd397,0x3f7f9c18,0x3f800000,0x3f7ff0e3,0x3f7fc38f,0x3f7f7808
.long 0x3f800000,0x3f7fec43,0x3f7fb10f,0x3f7f4e6d,0x3f800000,0x3f7fe705,0x3f7f9c18,0x3f7f1f49,0x3f800000,0x3f7fe129,0x3f7f84ab,0x3f7eea9d,0x3f800000,0x3f7fdaaf,0x3f7f6ac7,0x3f7eb069
.long 0x3f800000,0x3f7fd397,0x3f7f4e6d,0x3f7e70b0,0x3f800000,0x3f7fcbe2,0x3f7f2f9d,0x3f7e2b72,0x3f800000,0x3f7fc38f,0x3f7f0e58,0x3f7de0b1,0x3f800000,0x3f7fba9e,0x3f7eea9d,0x3f7d906e
.long 0x3f800000,0x3f7fb10f,0x3f7ec46d,0x3f7d3aac,0x3f800000,0x3f7fa6e3,0x3f7e9bc9,0x3f7cdf6c,0x3f800000,0x3f7f9c18,0x3f7e70b0,0x3f7c7eb0,0x3f800000,0x3f7f90b1,0x3f7e4323,0x3f7c187a
.long 0x3f800000,0x3f7f84ab,0x3f7e1324,0x3f7baccd,0x3f800000,0x3f7f7808,0x3f7de0b1,0x3f7b3bab,0x3f800000,0x3f7f6ac7,0x3f7dabcc,0x3f7ac516,0x3f800000,0x3f7f5ce9,0x3f7d7474,0x3f7a4910
.long 0x3f800000,0x3f7f4e6d,0x3f7d3aac,0x3f79c79d,0x3f800000,0x3f7f3f54,0x3f7cfe73,0x3f7940c0,0x3f800000,0x3f7f2f9d,0x3f7cbfc9,0x3f78b47b,0x3f800000,0x3f7f1f49,0x3f7c7eb0,0x3f7822d1
.long 0x3f800000,0x3f7f0e58,0x3f7c3b28,0x3f778bc5,0x3f800000,0x3f7efcc9,0x3f7bf531,0x3f76ef5b,0x3f800000,0x3f7eea9d,0x3f7baccd,0x3f764d97,0x3f800000,0x3f7ed7d4,0x3f7b61fc,0x3f75a67b
.long 0x3f800000,0x3f800000,0x3f800000,0x3f800000,0x3f7ffb11,0x3f7ff84a,0x3f7ff4e6,0x3f7ff0e3,0x3f7fec43,0x3f7fe129,0x3f7fd397,0x3f7fc38f,0x3f7fd397,0x3f7fba9e,0x3f7f9c18,0x3f7f7808
.long 0x3f7fb10f,0x3f7f84ab,0x3f7f4e6d,0x3f7f0e58,0x3f7f84ab,0x3f7f3f54,0x3f7eea9d,0x3f7e868b,0x3f7f4e6d,0x3f7eea9d,0x3f7e70b0,0x3f7de0b1,0x3f7f0e58,0x3f7e868b,0x3f7de0b1,0x3f7d1cdd
.long 0x3f7ec46d,0x3f7e1324,0x3f7d3aac,0x3f7c3b28,0x3f7e70b0,0x3f7d906e,0x3f7c7eb0,0x3f7b3bab,0x3f7e1324,0x3f7cfe73,0x3f7baccd,0x3f7a1e84,0x3f7dabcc,0x3f7c5d3a,0x3f7ac516,0x3f78e3d6
.long 0x3f7d3aac,0x3f7baccd,0x3f79c79d,0x3f778bc5,0x3f7cbfc9,0x3f7aed37,0x3f78b47b,0x3f76167a,0x3f7c3b28,0x3f7a1e84,0x3f778bc5,0x3f748422,0x3f7baccd,0x3f7940c0,0x3f764d97,0x3f72d4eb
.long 0x3f7b14be,0x3f7853f8,0x3f74fa0b,0x3f710908,0x3f7a7302,0x3f77583a,0x3f73913f,0x3f6f20b0,0x3f79c79d,0x3f764d97,0x3f721352,0x3f6d1c1d,0x3f791298,0x3f75341d,0x3f708066,0x3f6afb8c
.long 0x3f7853f8,0x3f740bdd,0x3f6ed89e,0x3f68bf3c,0x3f778bc5,0x3f72d4eb,0x3f6d1c1d,0x3f666771,0x3f76ba07,0x3f718f57,0x3f6b4b0c,0x3f63f473,0x3f75dec6,0x3f703b37,0x3f696591,0x3f61668a
.long 0x3f74fa0b,0x3f6ed89e,0x3f676bd8,0x3f5ebe05,0x3f740bdd,0x3f6d67a1,0x3f655e0b,0x3f5bfb34,0x3f731447,0x3f6be858,0x3f633c5a,0x3f591e6a,0x3f721352,0x3f6a5ad9,0x3f6106f2,0x3f5627fe
.long 0x3f710908,0x3f68bf3c,0x3f5ebe05,0x3f531849,0x3f6ff573,0x3f671599,0x3f5c61c7,0x3f4fefa8,0x3f6ed89e,0x3f655e0b,0x3f59f26a,0x3f4cae79,0x3f6db293,0x3f6398ac,0x3f577026,0x3f495521
.long 0x3f800000,0x3f800000,0x3f800000,0x3f800000,0x3f7fec43,0x3f7fe705,0x3f7fe129,0x3f7fdaaf,0x3f7fb10f,0x3f7f9c18,0x3f7f84ab,0x3f7f6ac7,0x3f7f4e6d,0x3f7f1f49,0x3f7eea9d,0x3f7eb069
.long 0x3f7ec46d,0x3f7e70b0,0x3f7e1324,0x3f7dabcc,0x3f7e1324,0x3f7d906e,0x3f7cfe73,0x3f7c5d3a,0x3f7d3aac,0x3f7c7eb0,0x3f7baccd,0x3f7ac516,0x3f7c3b28,0x3f7b3bab,0x3f7a1e84,0x3f78e3d6
.long 0x3f7b14be,0x3f79c79d,0x3f7853f8,0x3f76ba07,0x3f79c79d,0x3f7822d1,0x3f764d97,0x3f74484b,0x3f7853f8,0x3f764d97,0x3f740bdd,0x3f718f57,0x3f76ba07,0x3f74484b,0x3f718f57,0x3f6e8ff8
.long 0x3f74fa0b,0x3f721352,0x3f6ed89e,0x3f6b4b0c,0x3f731447,0x3f6faf1b,0x3f6be858,0x3f67c187,0x3f710908,0x3f6d1c1d,0x3f68bf3c,0x3f63f473,0x3f6ed89e,0x3f6a5ad9,0x3f655e0b,0x3f5fe4e9
.long 0x3f6c835e,0x3f676bd8,0x3f61c598,0x3f5b941a,0x3f6a09a7,0x3f644fac,0x3f5df6be,0x3f570348,0x3f676bd8,0x3f6106f2,0x3f59f26a,0x3f5233c6,0x3f64aa59,0x3f5d924d,0x3f55b993,0x3f4d26fd
.long 0x3f61c598,0x3f59f26a,0x3f514d3d,0x3f47de65,0x3f5ebe05,0x3f5627fe,0x3f4cae79,0x3f425b89,0x3f5b941a,0x3f5233c6,0x3f47de65,0x3f3ca003,0x3f584853,0x3f4e1689,0x3f42de29,0x3f36ad7f
.long 0x3f54db31,0x3f49d112,0x3f3daef9,0x3f3085bb,0x3f514d3d,0x3f456439,0x3f385216,0x3f2a2a80,0x3f4d9f02,0x3f40d0da,0x3f32c8c9,0x3f239da9,0x3f49d112,0x3f3c17d9,0x3f2d1469,0x3f1ce11f
.long 0x3f45e403,0x3f373a23,0x3f273656,0x3f15f6d9,0x3f41d870,0x3f3238aa,0x3f212ff9,0x3f0ee0db,0x3f3daef9,0x3f2d1469,0x3f1b02c6,0x3f07a136,0x3f396842,0x3f27ce61,0x3f14b039,0x3f003a06
.long 0x3f800000,0x3f800000,0x3f800000,0x3f800000,0x3f7fd397,0x3f7fcbe2,0x3f7fc38f,0x3f7fba9e,0x3f7f4e6d,0x3f7f2f9d,0x3f7f0e58,0x3f7eea9d,0x3f7e70b0,0x3f7e2b72,0x3f7de0b1,0x3f7d906e
.long 0x3f7d3aac,0x3f7cbfc9,0x3f7c3b28,0x3f7baccd,0x3f7baccd,0x3f7aed37,0x3f7a1e84,0x3f7940c0,0x3f79c79d,0x3f78b47b,0x3f778bc5,0x3f764d97,0x3f778bc5,0x3f76167a,0x3f748422,0x3f72d4eb
.long 0x3f74fa0b,0x3f731447,0x3f710908,0x3f6ed89e,0x3f721352,0x3f6faf1b,0x3f6d1c1d,0x3f6a5ad9,0x3f6ed89e,0x3f6be858,0x3f68bf3c,0x3f655e0b,0x3f6b4b0c,0x3f67c187,0x3f63f473,0x3f5fe4e9
.long 0x3f676bd8,0x3f633c5a,0x3f5ebe05,0x3f59f26a,0x3f633c5a,0x3f5e5aa6,0x3f591e6a,0x3f5389c7,0x3f5ebe05,0x3f591e6a,0x3f531849,0x3f4cae79,0x3f59f26a,0x3f5389c7,0x3f4cae79,0x3f456439
.long 0x3f54db31,0x3f4d9f02,0x3f45e403,0x3f3daef9,0x3f4f7a1f,0x3f476085,0x3f3ebc1b,0x3f3592e7,0x3f49d112,0x3f40d0da,0x3f373a23,0x3f2d1469,0x3f43e200,0x3f39f2ac,0x3f2f61a5,0x3f24381a
.long 0x3f3daef9,0x3f32c8c9,0x3f273656,0x3f1b02c6,0x3f373a23,0x3f2b561b,0x3f1ebc12,0x3f11796b,0x3f3085bb,0x3f239da9,0x3f15f6d9,0x3f07a136,0x3f299415,0x3f1ba299,0x3f0cead0,0x3efafef7
.long 0x3f226799,0x3f13682a,0x3f039c3d,0x3ee63375,0x3f1b02c6,0x3f0af1b7,0x3ef41f07,0x3ed0eb2a,0x3f13682a,0x3f0242b1,0x3ee0924f,0x3ebb31a0,0x3f0b9a6b,0x3ef2bd43,0x3ecc9b8b,0x3ea5129f
.long 0x3f039c3d,0x3ee0924f,0x3eb8442a,0x3e8e9a22,0x3ef6e0cb,0x3ece0bea,0x3ea395c5,0x3e6fa8b2,0x3ee63375,0x3ebb31a0,0x3e8e9a22,0x3e419b37,0x3ed53641,0x3ea80b1f,0x3e72b651,0x3e1324ca
.long 0x3f800000,0x3f800000,0x3f800000,0x3f800000,0x3f7fb10f,0x3f7fa6e3,0x3f7f9c18,0x3f7f90b1,0x3f7ec46d,0x3f7e9bc9,0x3f7e70b0,0x3f7e4323,0x3f7d3aac,0x3f7cdf6c,0x3f7c7eb0,0x3f7c187a
.long 0x3f7b14be,0x3f7a7302,0x3f79c79d,0x3f791298,0x3f7853f8,0x3f77583a,0x3f764d97,0x3f75341d,0x3f74fa0b,0x3f73913f,0x3f721352,0x3f708066,0x3f710908,0x3f6f20b0,0x3f6d1c1d,0x3f6afb8c
.long 0x3f6c835e,0x3f6a09a7,0x3f676bd8,0x3f64aa59,0x3f676bd8,0x3f644fac,0x3f6106f2,0x3f5d924d,0x3f61c598,0x3f5df6be,0x3f59f26a,0x3f55b993,0x3f5b941a,0x3f570348,0x3f5233c6,0x3f4d26fd
.long 0x3f54db31,0x3f4f7a1f,0x3f49d112,0x3f43e200,0x3f4d9f02,0x3f476085,0x3f40d0da,0x3f39f2ac,0x3f45e403,0x3f3ebc1b,0x3f373a23,0x3f2f61a5,0x3f3daef9,0x3f3592e7,0x3f2d1469,0x3f24381a
.long 0x3f3504f3,0x3f2beb4a,0x3f226799,0x3f187fc0,0x3f2beb4a,0x3f21cbfb,0x3f173c07,0x3f0c42c9,0x3f226799,0x3f173c07,0x3f0b9a6b,0x3eff17b2,0x3f187fc0,0x3f0c42c9,0x3eff17b2,0x3ee4cbfe
.long 0x3f0e39da,0x3f00e7e4,0x3ee63375,0x3ec9b953,0x3f039c3d,0x3eea6681,0x3ecc9b8b,0x3eadf73c,0x3ef15aea,0x3ed25a09,0x3eb263ef,0x3e919ddd,0x3edae880,0x3eb9bb1e,0x3e97a117,0x3e698bba
.long 0x3ec3ef15,0x3ea09ae5,0x3e78cfcc,0x3e2f10a2,0x3eac7cd4,0x3e870ada,0x3e419b37,0x3de7fa9a,0x3e94a031,0x3e5a3997,0x3e09cf86,0x3d621469,0x3e78cfcc,0x3e25c58c,0x3da3308c,0xbb490fc6
.long 0x3e47c5c2,0x3de1bc2e,0x3cc90ab0,0xbd7b2b74,0x3e164083,0x3d6ea038,0xbcfb49ba,0xbdf475c0,0x3dc8bd36,0x3bc90f88,0xbdafb680,0xbe354098,0x3d48fb30,0xbd3c6dd5,0xbe1008b7,0xbe6fa8b2
.long 0x3f800000,0x3f800000,0x3f800000,0x3f800000,0x3f7f84ab,0x3f7f7808,0x3f7f6ac7,0x3f7f5ce9,0x3f7e1324,0x3f7de0b1,0x3f7dabcc,0x3f7d7474,0x3f7baccd,0x3f7b3bab,0x3f7ac516,0x3f7a4910
.long 0x3f7853f8,0x3f778bc5,0x3f76ba07,0x3f75dec6,0x3f740bdd,0x3f72d4eb,0x3f718f57,0x3f703b37,0x3f6ed89e,0x3f6d1c1d,0x3f6b4b0c,0x3f696591,0x3f68bf3c,0x3f666771,0x3f63f473,0x3f61668a
.long 0x3f61c598,0x3f5ebe05,0x3f5b941a,0x3f584853,0x3f59f26a,0x3f5627fe,0x3f5233c6,0x3f4e1689,0x3f514d3d,0x3f4cae79,0x3f47de65,0x3f42de29,0x3f47de65,0x3f425b89,0x3f3ca003,0x3f36ad7f
.long 0x3f3daef9,0x3f373a23,0x3f3085bb,0x3f299415,0x3f32c8c9,0x3f2b561b,0x3f239da9,0x3f1ba299,0x3f273656,0x3f1ebc12,0x3f15f6d9,0x3f0cead0,0x3f1b02c6,0x3f11796b,0x3f07a136,0x3efafef7
.long 0x3f0e39da,0x3f039c3d,0x3ef15aea,0x3edae880,0x3f00e7e4,0x3eea6681,0x3ed25a09,0x3eb9bb1e,0x3ee63375,0x3ecc9b8b,0x3eb263ef,0x3e97a117,0x3ec9b953,0x3eadf73c,0x3e919ddd,0x3e698bba
.long 0x3eac7cd4,0x3e8e9a22,0x3e605c13,0x3e22abb6,0x3e8e9a22,0x3e5d4b1a,0x3e1c76de,0x3db5f8da,0x3e605c13,0x3e1c76de,0x3dafb680,0x3c96c9b6,0x3e22abb6,0x3db5f8da,0x3c96c9b6,0xbd55880e
.long 0x3dc8bd36,0x3cc90ab0,0xbd48fb30,0xbdfab273,0x3d16c32c,0xbd2351cb,0xbdee3876,0xbe44b0b9,0xbcc90ab0,0xbdd53db9,0xbe3b6ecf,0xbe8586ce,0xbdafb680,0xbe2bf804,0xbe7ee6e1,0xbea80b1f
.long 0xbe164083,0xbe6c9a7f,0xbea09ae5,0xbec9b953,0xbe541501,0xbe9620d2,0xbec1071e,0xbeea6681,0xbe888e93,0xbeb554ec,0xbee0924f,0xbf04f484,0xbea68f12,0xbed3c867,0xbeff17b2,0xbf140c5f
.long 0x3f800000,0x3f800000,0x3f800000,0x3f800000,0x3f7f4e6d,0x3f7f3f54,0x3f7f2f9d,0x3f7f1f49,0x3f7d3aac,0x3f7cfe73,0x3f7cbfc9,0x3f7c7eb0,0x3f79c79d,0x3f7940c0,0x3f78b47b,0x3f7822d1
.long 0x3f74fa0b,0x3f740bdd,0x3f731447,0x3f721352,0x3f6ed89e,0x3f6d67a1,0x3f6be858,0x3f6a5ad9,0x3f676bd8,0x3f655e0b,0x3f633c5a,0x3f6106f2,0x3f5ebe05,0x3f5bfb34,0x3f591e6a,0x3f5627fe
.long 0x3f54db31,0x3f514d3d,0x3f4d9f02,0x3f49d112,0x3f49d112,0x3f456439,0x3f40d0da,0x3f3c17d9,0x3f3daef9,0x3f385216,0x3f32c8c9,0x3f2d1469,0x3f3085bb,0x3f2a2a80,0x3f239da9,0x3f1ce11f
.long 0x3f226799,0x3f1b02c6,0x3f13682a,0x3f0b9a6b,0x3f13682a,0x3f0af1b7,0x3f0242b1,0x3ef2bd43,0x3f039c3d,0x3ef41f07,0x3ee0924f,0x3ecc9b8b,0x3ee63375,0x3ed0eb2a,0x3ebb31a0,0x3ea5129f
.long 0x3ec3ef15,0x3eac7cd4,0x3e94a031,0x3e78cfcc,0x3ea09ae5,0x3e870ada,0x3e5a3997,0x3e25c58c,0x3e78cfcc,0x3e419b37,0x3e09cf86,0x3da3308c,0x3e2f10a2,0x3de7fa9a,0x3d621469,0xbb490fc6
.long 0x3dc8bd36,0x3d16c32c,0xbcc90ab0,0xbdafb680,0x3cc90ab0,0xbd2351cb,0xbdd53db9,0xbe2bf804,0xbd48fb30,0xbdee3876,0xbe3b6ecf,0xbe7ee6e1,0xbdfab273,0xbe44b0b9,0xbe8586ce,0xbea80b1f
.long 0xbe47c5c2,0xbe888e93,0xbeac7cd4,0xbecf7bca,0xbe888e93,0xbeadf73c,0xbed25a09,0xbef58035,0xbeac7cd4,0xbed25a09,0xbef6e0cb,0xbf0cead0,0xbecf7bca,0xbef58035,0xbf0cead0,0xbf1e1e22
.long 0xbef15aea,0xbf0b9a6b,0xbf1d7fd1,0xbf2e3bde,0xbf08f59b,0xbf1ba299,0xbf2d1469,0xbf3d27b8,0xbf187fc0,0xbf2ac082,0xbf3b8f3b,0xbf4ac77f,0xbf273656,0xbf38dd65,0xbf48d8b3,0xbf570348
.long 0x3f800000,0x3f800000,0x3f800000,0x3f800000,0x3f7f0e58,0x3f7efcc9,0x3f7eea9d,0x3f7ed7d4,0x3f7c3b28,0x3f7bf531,0x3f7baccd,0x3f7b61fc,0x3f778bc5,0x3f76ef5b,0x3f764d97,0x3f75a67b
.long 0x3f710908,0x3f6ff573,0x3f6ed89e,0x3f6db293,0x3f68bf3c,0x3f671599,0x3f655e0b,0x3f6398ac,0x3f5ebe05,0x3f5c61c7,0x3f59f26a,0x3f577026,0x3f531849,0x3f4fefa8,0x3f4cae79,0x3f495521
.long 0x3f45e403,0x3f41d870,0x3f3daef9,0x3f396842,0x3f373a23,0x3f3238aa,0x3f2d1469,0x3f27ce61,0x3f273656,0x3f212ff9,0x3f1b02c6,0x3f14b039,0x3f15f6d9,0x3f0ee0db,0x3f07a136,0x3f003a06
.long 0x3f039c3d,0x3ef6e0cb,0x3ee63375,0x3ed53641,0x3ee0924f,0x3ece0bea,0x3ebb31a0,0x3ea80b1f,0x3eb8442a,0x3ea395c5,0x3e8e9a22,0x3e72b651,0x3e8e9a22,0x3e6fa8b2,0x3e419b37,0x3e1324ca
.long 0x3e47c5c2,0x3e164083,0x3dc8bd36,0x3d48fb30,0x3de1bc2e,0x3d6ea038,0x3bc90f88,0xbd3c6dd5,0x3cc90ab0,0xbcfb49ba,0xbdafb680,0xbe1008b7,0xbd7b2b74,0xbdf475c0,0xbe354098,0xbe6fa8b2
.long 0xbe164083,0xbe541501,0xbe888e93,0xbea68f12,0xbe6c9a7f,0xbe9620d2,0xbeb554ec,0xbed3c867,0xbea09ae5,0xbec1071e,0xbee0924f,0xbeff17b2,0xbec9b953,0xbeea6681,0xbf04f484,0xbf140c5f
.long 0xbef15aea,0xbf08f59b,0xbf187fc0,0xbf273656,0xbf0b9a6b,0xbf1ba299,0xbf2ac082,0xbf38dd65,0xbf1d7fd1,0xbf2d1469,0xbf3b8f3b,0xbf48d8b3,0xbf2e3bde,0xbf3d27b8,0xbf4ac77f,0xbf570348
.long 0xbf3daef9,0xbf4bbbf8,0xbf584853,0xbf633c5a,0xbf4bbbf8,0xbf58b3a1,0xbf63f473,0xbf6d67a1,0xbf584853,0xbf63f473,0xbf6db293,0xbf756d97,0xbf633c5a,0xbf6d67a1,0xbf756d97,0xbf7b3bab
.long 0x0,0x0,0x0,0x0,0x0,0x3b490fc6,0x3bc90f88,0x3c16cb58,0x0,0x3bc90f88,0x3c490e90,0x3c96c9b6,0x0,0x3c16cb58,0x3c96c9b6,0x3ce22a7a
.long 0x0,0x3c490e90,0x3cc90ab0,0x3d16c32c,0x0,0x3c7b514b,0x3cfb49ba,0x3d3c6dd5,0x0,0x3c96c9b6,0x3d16c32c,0x3d621469,0x0,0x3cafea69,0x3d2fe007,0x3d83db0a
.long 0x0,0x3cc90ab0,0x3d48fb30,0x3d96a905,0x0,0x3ce22a7a,0x3d621469,0x3da973ba,0x0,0x3cfb49ba,0x3d7b2b74,0x3dbc3ac3,0x0,0x3d0a342f,0x3d8a200a,0x3dcefdb7
.long 0x0,0x3d16c32c,0x3d96a905,0x3de1bc2e,0x0,0x3d2351cb,0x3da3308c,0x3df475c0,0x0,0x3d2fe007,0x3dafb680,0x3e039502,0x0,0x3d3c6dd5,0x3dbc3ac3,0x3e0cec4a
.long 0x0,0x3d48fb30,0x3dc8bd36,0x3e164083,0x0,0x3d55880e,0x3dd53db9,0x3e1f917b,0x0,0x3d621469,0x3de1bc2e,0x3e28defc,0x0,0x3d6ea038,0x3dee3876,0x3e3228d4
.long 0x0,0x3d7b2b74,0x3dfab273,0x3e3b6ecf,0x0,0x3d83db0a,0x3e039502,0x3e44b0b9,0x0,0x3d8a200a,0x3e09cf86,0x3e4dee60,0x0,0x3d9064b4,0x3e1008b7,0x3e57278f
.long 0x0,0x3d96a905,0x3e164083,0x3e605c13,0x0,0x3d9cecf9,0x3e1c76de,0x3e698bba,0x0,0x3da3308c,0x3e22abb6,0x3e72b651,0x0,0x3da973ba,0x3e28defc,0x3e7bdba4
.long 0x0,0x3dafb680,0x3e2f10a2,0x3e827dc0,0x0,0x3db5f8da,0x3e354098,0x3e870ada,0x0,0x3dbc3ac3,0x3e3b6ecf,0x3e8b9507,0x0,0x3dc27c39,0x3e419b37,0x3e901c2c
.long 0x0,0x0,0x0,0x0,0x3c490e90,0x3c7b514b,0x3c96c9b6,0x3cafea69,0x3cc90ab0,0x3cfb49ba,0x3d16c32c,0x3d2fe007,0x3d16c32c,0x3d3c6dd5,0x3d621469,0x3d83db0a
.long 0x3d48fb30,0x3d7b2b74,0x3d96a905,0x3dafb680,0x3d7b2b74,0x3d9cecf9,0x3dbc3ac3,0x3ddb7d37,0x3d96a905,0x3dbc3ac3,0x3de1bc2e,0x3e039502,0x3dafb680,0x3ddb7d37,0x3e039502,0x3e195be0
.long 0x3dc8bd36,0x3dfab273,0x3e164083,0x3e2f10a2,0x3de1bc2e,0x3e0cec4a,0x3e28defc,0x3e44b0b9,0x3dfab273,0x3e1c76de,0x3e3b6ecf,0x3e5a3997,0x3e09cf86,0x3e2bf804,0x3e4dee60,0x3e6fa8b2
.long 0x3e164083,0x3e3b6ecf,0x3e605c13,0x3e827dc0,0x3e22abb6,0x3e4ada4f,0x3e72b651,0x3e8d17c0,0x3e2f10a2,0x3e5a3997,0x3e827dc0,0x3e97a117,0x3e3b6ecf,0x3e698bba,0x3e8b9507,0x3ea21887
.long 0x3e47c5c2,0x3e78cfcc,0x3e94a031,0x3eac7cd4,0x3e541501,0x3e840270,0x3e9d9e78,0x3eb6ccc3,0x3e605c13,0x3e8b9507,0x3ea68f12,0x3ec1071e,0x3e6c9a7f,0x3e931f35,0x3eaf713a,0x3ecb2aae
.long 0x3e78cfcc,0x3e9aa086,0x3eb8442a,0x3ed53641,0x3e827dc0,0x3ea21887,0x3ec1071e,0x3edf28a9,0x3e888e93,0x3ea986c4,0x3ec9b953,0x3ee900b7,0x3e8e9a22,0x3eb0eacb,0x3ed25a09,0x3ef2bd43
.long 0x3e94a031,0x3eb8442a,0x3edae880,0x3efc5d27,0x3e9aa086,0x3ebf926f,0x3ee363fa,0x3f02ef9f,0x3ea09ae5,0x3ec6d529,0x3eebcbbb,0x3f07a136,0x3ea68f12,0x3ece0bea,0x3ef41f07,0x3f0c42c9
.long 0x3eac7cd4,0x3ed53641,0x3efc5d27,0x3f10d3cd,0x3eb263ef,0x3edc53c1,0x3f0242b1,0x3f1553b7,0x3eb8442a,0x3ee363fa,0x3f064b82,0x3f19c200,0x3ebe1d4a,0x3eea6681,0x3f0a48ad,0x3f1e1e22
.long 0x0,0x0,0x0,0x0,0x3cc90ab0,0x3ce22a7a,0x3cfb49ba,0x3d0a342f,0x3d48fb30,0x3d621469,0x3d7b2b74,0x3d8a200a,0x3d96a905,0x3da973ba,0x3dbc3ac3,0x3dcefdb7
.long 0x3dc8bd36,0x3de1bc2e,0x3dfab273,0x3e09cf86,0x3dfab273,0x3e0cec4a,0x3e1c76de,0x3e2bf804,0x3e164083,0x3e28defc,0x3e3b6ecf,0x3e4dee60,0x3e2f10a2,0x3e44b0b9,0x3e5a3997,0x3e6fa8b2
.long 0x3e47c5c2,0x3e605c13,0x3e78cfcc,0x3e888e93,0x3e605c13,0x3e7bdba4,0x3e8b9507,0x3e9920fe,0x3e78cfcc,0x3e8b9507,0x3e9aa086,0x3ea986c4,0x3e888e93,0x3e9920fe,0x3ea986c4,0x3eb9bb1e
.long 0x3e94a031,0x3ea68f12,0x3eb8442a,0x3ec9b953,0x3ea09ae5,0x3eb3dca5,0x3ec6d529,0x3ed97cb9,0x3eac7cd4,0x3ec1071e,0x3ed53641,0x3ee900b7,0x3eb8442a,0x3ece0bea,0x3ee363fa,0x3ef840c8
.long 0x3ec3ef15,0x3edae880,0x3ef15aea,0x3f039c3d,0x3ecf7bca,0x3ee79a5d,0x3eff17b2,0x3f0af1b7,0x3edae880,0x3ef41f07,0x3f064b82,0x3f121eb0,0x3ee63375,0x3f003a06,0x3f0cead0,0x3f19210f
.long 0x3ef15aea,0x3f064b82,0x3f13682a,0x3f1ff6cb,0x3efc5d27,0x3f0c42c9,0x3f19c200,0x3f269de3,0x3f039c3d,0x3f121eb0,0x3f1ff6cb,0x3f2d1469,0x3f08f59b,0x3f17de12,0x3f26050a,0x3f33587a
.long 0x3f0e39da,0x3f1d7fd1,0x3f2beb4a,0x3f396842,0x3f13682a,0x3f2302d3,0x3f31a81d,0x3f3f41fc,0x3f187fc0,0x3f286605,0x3f373a23,0x3f44e3f5,0x3f1d7fd1,0x3f2da859,0x3f3ca003,0x3f4a4c87
.long 0x3f226799,0x3f32c8c9,0x3f41d870,0x3f4f7a1f,0x3f273656,0x3f37c655,0x3f46e22a,0x3f546b3b,0x3f2beb4a,0x3f3ca003,0x3f4bbbf8,0x3f591e6a,0x3f3085bb,0x3f4154e1,0x3f5064af,0x3f5d924d
.long 0x0,0x0,0x0,0x0,0x3d16c32c,0x3d2351cb,0x3d2fe007,0x3d3c6dd5,0x3d96a905,0x3da3308c,0x3dafb680,0x3dbc3ac3,0x3de1bc2e,0x3df475c0,0x3e039502,0x3e0cec4a
.long 0x3e164083,0x3e22abb6,0x3e2f10a2,0x3e3b6ecf,0x3e3b6ecf,0x3e4ada4f,0x3e5a3997,0x3e698bba,0x3e605c13,0x3e72b651,0x3e827dc0,0x3e8b9507,0x3e827dc0,0x3e8d17c0,0x3e97a117,0x3ea21887
.long 0x3e94a031,0x3ea09ae5,0x3eac7cd4,0x3eb8442a,0x3ea68f12,0x3eb3dca5,0x3ec1071e,0x3ece0bea,0x3eb8442a,0x3ec6d529,0x3ed53641,0x3ee363fa,0x3ec9b953,0x3ed97cb9,0x3ee900b7,0x3ef840c8
.long 0x3edae880,0x3eebcbbb,0x3efc5d27,0x3f064b82,0x3eebcbbb,0x3efdbabb,0x3f07a136,0x3f102dd5,0x3efc5d27,0x3f07a136,0x3f10d3cd,0x3f19c200,0x3f064b82,0x3f102dd5,0x3f19c200,0x3f2302d3
.long 0x3f0e39da,0x3f187fc0,0x3f226799,0x3f2beb4a,0x3f15f6d9,0x3f209393,0x3f2ac082,0x3f34768f,0x3f1d7fd1,0x3f286605,0x3f32c8c9,0x3f3ca003,0x3f24d225,0x3f2ff3e6,0x3f3a7ca4,0x3f446337
.long 0x3f2beb4a,0x3f373a23,0x3f41d870,0x3f4bbbf8,0x3f32c8c9,0x3f3e35c5,0x3f48d8b3,0x3f52a649,0x3f396842,0x3f44e3f5,0x3f4f7a1f,0x3f591e6a,0x3f3fc767,0x3f4b41fa,0x3f55b993,0x3f5f20db
.long 0x3f45e403,0x3f514d3d,0x3f5b941a,0x3f64aa59,0x3f4bbbf8,0x3f570348,0x3f6106f2,0x3f69b7e4,0x3f514d3d,0x3f5c61c7,0x3f660f88,0x3f6e46be,0x3f5695e5,0x3f61668a,0x3f6aab7b,0x3f725470
.long 0x3f5b941a,0x3f660f88,0x3f6ed89e,0x3f75dec6,0x3f604621,0x3f6a5ad9,0x3f7294f8,0x3f78e3d6,0x3f64aa59,0x3f6e46be,0x3f75dec6,0x3f7b61fc,0x3f68bf3c,0x3f71d19f,0x3f78b47b,0x3f7d57de
.long 0x0,0x0,0x0,0x0,0x3d48fb30,0x3d55880e,0x3d621469,0x3d6ea038,0x3dc8bd36,0x3dd53db9,0x3de1bc2e,0x3dee3876,0x3e164083,0x3e1f917b,0x3e28defc,0x3e3228d4
.long 0x3e47c5c2,0x3e541501,0x3e605c13,0x3e6c9a7f,0x3e78cfcc,0x3e840270,0x3e8b9507,0x3e931f35,0x3e94a031,0x3e9d9e78,0x3ea68f12,0x3eaf713a,0x3eac7cd4,0x3eb6ccc3,0x3ec1071e,0x3ecb2aae
.long 0x3ec3ef15,0x3ecf7bca,0x3edae880,0x3ee63375,0x3edae880,0x3ee79a5d,0x3ef41f07,0x3f003a06,0x3ef15aea,0x3eff17b2,0x3f064b82,0x3f0cead0,0x3f039c3d,0x3f0af1b7,0x3f121eb0,0x3f19210f
.long 0x3f0e39da,0x3f15f6d9,0x3f1d7fd1,0x3f24d225,0x3f187fc0,0x3f209393,0x3f286605,0x3f2ff3e6,0x3f226799,0x3f2ac082,0x3f32c8c9,0x3f3a7ca4,0x3f2beb4a,0x3f34768f,0x3f3ca003,0x3f446337
.long 0x3f3504f3,0x3f3daef9,0x3f45e403,0x3f4d9f02,0x3f3daef9,0x3f466354,0x3f4e8d90,0x3f5627fe,0x3f45e403,0x3f4e8d90,0x3f5695e5,0x3f5df6be,0x3f4d9f02,0x3f5627fe,0x3f5df6be,0x3f650479
.long 0x3f54db31,0x3f5d2d53,0x3f64aa59,0x3f6b4b0c,0x3f5b941a,0x3f6398ac,0x3f6aab7b,0x3f70c501,0x3f61c598,0x3f696591,0x3f6ff573,0x3f756d97,0x3f676bd8,0x3f6e8ff8,0x3f748422,0x3f7940c0
.long 0x3f6c835e,0x3f731447,0x3f7853f8,0x3f7c3b28,0x3f710908,0x3f76ef5b,0x3f7b61fc,0x3f7e5a38,0x3f74fa0b,0x3f7a1e84,0x3f7dabcc,0x3f7f9c18,0x3f7853f8,0x3f7c9f8a,0x3f7f2f9d,0x3f7fffb1
.long 0x3f7b14be,0x3f7e70b0,0x3f7fec43,0x3f7f84ab,0x3f7d3aac,0x3f7f90b1,0x3f7fe129,0x3f7e2b72,0x3f7ec46d,0x3f7ffec4,0x3f7f0e58,0x3f7bf531,0x3f7fb10f,0x3f7fba9e,0x3f7d7474,0x3f78e3d6
.long 0x0,0x0,0x0,0x0,0x3d7b2b74,0x3d83db0a,0x3d8a200a,0x3d9064b4,0x3dfab273,0x3e039502,0x3e09cf86,0x3e1008b7,0x3e3b6ecf,0x3e44b0b9,0x3e4dee60,0x3e57278f
.long 0x3e78cfcc,0x3e827dc0,0x3e888e93,0x3e8e9a22,0x3e9aa086,0x3ea21887,0x3ea986c4,0x3eb0eacb,0x3eb8442a,0x3ec1071e,0x3ec9b953,0x3ed25a09,0x3ed53641,0x3edf28a9,0x3ee900b7,0x3ef2bd43
.long 0x3ef15aea,0x3efc5d27,0x3f039c3d,0x3f08f59b,0x3f064b82,0x3f0c42c9,0x3f121eb0,0x3f17de12,0x3f13682a,0x3f19c200,0x3f1ff6cb,0x3f26050a,0x3f1ff6cb,0x3f269de3,0x3f2d1469,0x3f33587a
.long 0x3f2beb4a,0x3f32c8c9,0x3f396842,0x3f3fc767,0x3f373a23,0x3f3e35c5,0x3f44e3f5,0x3f4b41fa,0x3f41d870,0x3f48d8b3,0x3f4f7a1f,0x3f55b993,0x3f4bbbf8,0x3f52a649,0x3f591e6a,0x3f5f20db
.long 0x3f54db31,0x3f5b941a,0x3f61c598,0x3f676bd8,0x3f5d2d53,0x3f6398ac,0x3f696591,0x3f6e8ff8,0x3f64aa59,0x3f6aab7b,0x3f6ff573,0x3f748422,0x3f6b4b0c,0x3f70c501,0x3f756d97,0x3f7940c0
.long 0x3f710908,0x3f75dec6,0x3f79c79d,0x3f7cbfc9,0x3f75dec6,0x3f79f35e,0x3f7cfe73,0x3f7efcc9,0x3f79c79d,0x3f7cfe73,0x3f7f0e58,0x3f7ff4e6,0x3f7cbfc9,0x3f7efcc9,0x3f7ff4e6,0x3f7fa6e3
.long 0x3f7ec46d,0x3f7fec43,0x3f7fb10f,0x3f7e1324,0x3f7fd397,0x3f7fcbe2,0x3f7e4323,0x3f7b3bab,0x3f7fec43,0x3f7e9bc9,0x3f7baccd,0x3f772417,0x3f7f0e58,0x3f7c5d3a,0x3f77f110,0x3f71d19f
.long 0x3f7d3aac,0x3f791298,0x3f731447,0x3f6b4b0c,0x3f7a7302,0x3f74bf62,0x3f6d1c1d,0x3f6398ac,0x3f76ba07,0x3f6f6830,0x3f660f88,0x3f5ac450,0x3f721352,0x3f6912ae,0x3f5df6be,0x3f50d937
.long 0x0,0x0,0x0,0x0,0x3d96a905,0x3d9cecf9,0x3da3308c,0x3da973ba,0x3e164083,0x3e1c76de,0x3e22abb6,0x3e28defc,0x3e605c13,0x3e698bba,0x3e72b651,0x3e7bdba4
.long 0x3e94a031,0x3e9aa086,0x3ea09ae5,0x3ea68f12,0x3eb8442a,0x3ebf926f,0x3ec6d529,0x3ece0bea,0x3edae880,0x3ee363fa,0x3eebcbbb,0x3ef41f07,0x3efc5d27,0x3f02ef9f,0x3f07a136,0x3f0c42c9
.long 0x3f0e39da,0x3f13682a,0x3f187fc0,0x3f1d7fd1,0x3f1d7fd1,0x3f2302d3,0x3f286605,0x3f2da859,0x3f2beb4a,0x3f31a81d,0x3f373a23,0x3f3ca003,0x3f396842,0x3f3f41fc,0x3f44e3f5,0x3f4a4c87
.long 0x3f45e403,0x3f4bbbf8,0x3f514d3d,0x3f5695e5,0x3f514d3d,0x3f570348,0x3f5c61c7,0x3f61668a,0x3f5b941a,0x3f6106f2,0x3f660f88,0x3f6aab7b,0x3f64aa59,0x3f69b7e4,0x3f6e46be,0x3f725470
.long 0x3f6c835e,0x3f710908,0x3f74fa0b,0x3f7853f8,0x3f731447,0x3f76ef5b,0x3f7a1e84,0x3f7c9f8a,0x3f7853f8,0x3f7b61fc,0x3f7dabcc,0x3f7f2f9d,0x3f7c3b28,0x3f7e5a38,0x3f7f9c18,0x3f7fffb1
.long 0x3f7ec46d,0x3f7fd397,0x3f7fec43,0x3f7f0e58,0x3f7fec43,0x3f7fcbe2,0x3f7e9bc9,0x3f7c5d3a,0x3f7fb10f,0x3f7e4323,0x3f7baccd,0x3f77f110,0x3f7e1324,0x3f7b3bab,0x3f772417,0x3f71d19f
.long 0x3f7b14be,0x3f76ba07,0x3f710908,0x3f6a09a7,0x3f76ba07,0x3f70c501,0x3f696591,0x3f60a6cf,0x3f710908,0x3f696591,0x3f604621,0x3f55b993,0x3f6a09a7,0x3f60a6cf,0x3f55b993,0x3f495521
.long 0x3f61c598,0x3f5695e5,0x3f49d112,0x3f3b8f3b,0x3f584853,0x3f4b41fa,0x3f3ca003,0x3f2c800f,0x3f4d9f02,0x3f3ebc1b,0x3f2e3bde,0x3f1c420c,0x3f41d870,0x3f311722,0x3f1ebc12,0x3f0af1b7
.long 0x0,0x0,0x0,0x0,0x3dafb680,0x3db5f8da,0x3dbc3ac3,0x3dc27c39,0x3e2f10a2,0x3e354098,0x3e3b6ecf,0x3e419b37,0x3e827dc0,0x3e870ada,0x3e8b9507,0x3e901c2c
.long 0x3eac7cd4,0x3eb263ef,0x3eb8442a,0x3ebe1d4a,0x3ed53641,0x3edc53c1,0x3ee363fa,0x3eea6681,0x3efc5d27,0x3f0242b1,0x3f064b82,0x3f0a48ad,0x3f10d3cd,0x3f1553b7,0x3f19c200,0x3f1e1e22
.long 0x3f226799,0x3f273656,0x3f2beb4a,0x3f3085bb,0x3f32c8c9,0x3f37c655,0x3f3ca003,0x3f4154e1,0x3f41d870,0x3f46e22a,0x3f4bbbf8,0x3f5064af,0x3f4f7a1f,0x3f546b3b,0x3f591e6a,0x3f5d924d
.long 0x3f5b941a,0x3f604621,0x3f64aa59,0x3f68bf3c,0x3f660f88,0x3f6a5ad9,0x3f6e46be,0x3f71d19f,0x3f6ed89e,0x3f7294f8,0x3f75dec6,0x3f78b47b,0x3f75dec6,0x3f78e3d6,0x3f7b61fc,0x3f7d57de
.long 0x3f7b14be,0x3f7d3aac,0x3f7ec46d,0x3f7fb10f,0x3f7e70b0,0x3f7f90b1,0x3f7ffec4,0x3f7fba9e,0x3f7fec43,0x3f7fe129,0x3f7f0e58,0x3f7d7474,0x3f7f84ab,0x3f7e2b72,0x3f7bf531,0x3f78e3d6
.long 0x3f7d3aac,0x3f7a7302,0x3f76ba07,0x3f721352,0x3f791298,0x3f74bf62,0x3f6f6830,0x3f6912ae,0x3f731447,0x3f6d1c1d,0x3f660f88,0x3f5df6be,0x3f6b4b0c,0x3f6398ac,0x3f5ac450,0x3f50d937
.long 0x3f61c598,0x3f584853,0x3f4d9f02,0x3f41d870,0x3f5695e5,0x3f4b41fa,0x3f3ebc1b,0x3f311722,0x3f49d112,0x3f3ca003,0x3f2e3bde,0x3f1ebc12,0x3f3b8f3b,0x3f2c800f,0x3f1c420c,0x3f0af1b7
.long 0x3f2beb4a,0x3f1b02c6,0x3f08f59b,0x3eebcbbb,0x3f1b02c6,0x3f084b92,0x3ee900b7,0x3ebf926f,0x3f08f59b,0x3ee900b7,0x3ebe1d4a,0x3e919ddd,0x3eebcbbb,0x3ebf926f,0x3e919ddd,0x3e44b0b9
.long 0x3f800000,0x3f7ec46d,0x3f7b14be,0x3f74fa0b,0x3f800000,0x3f7eb069,0x3f7ac516,0x3f74484b,0x3f800000,0x3f7e9bc9,0x3f7a7302,0x3f73913f,0x3f800000,0x3f7e868b,0x3f7a1e84,0x3f72d4eb
.long 0x3f800000,0x3f7e70b0,0x3f79c79d,0x3f721352,0x3f800000,0x3f7e5a38,0x3f796e4e,0x3f714c7a,0x3f800000,0x3f7e4323,0x3f791298,0x3f708066,0x3f800000,0x3f7e2b72,0x3f78b47b,0x3f6faf1b
.long 0x3f800000,0x3f7e1324,0x3f7853f8,0x3f6ed89e,0x3f800000,0x3f7dfa38,0x3f77f110,0x3f6dfcf2,0x3f800000,0x3f7de0b1,0x3f778bc5,0x3f6d1c1d,0x3f800000,0x3f7dc68c,0x3f772417,0x3f6c3624
.long 0x3f800000,0x3f7dabcc,0x3f76ba07,0x3f6b4b0c,0x3f800000,0x3f7d906e,0x3f764d97,0x3f6a5ad9,0x3f800000,0x3f7d7474,0x3f75dec6,0x3f696591,0x3f800000,0x3f7d57de,0x3f756d97,0x3f686b39
.long 0x3f800000,0x3f7d3aac,0x3f74fa0b,0x3f676bd8,0x3f800000,0x3f7d1cdd,0x3f748422,0x3f666771,0x3f800000,0x3f7cfe73,0x3f740bdd,0x3f655e0b,0x3f800000,0x3f7cdf6c,0x3f73913f,0x3f644fac
.long 0x3f800000,0x3f7cbfc9,0x3f731447,0x3f633c5a,0x3f800000,0x3f7c9f8a,0x3f7294f8,0x3f62241a,0x3f800000,0x3f7c7eb0,0x3f721352,0x3f6106f2,0x3f800000,0x3f7c5d3a,0x3f718f57,0x3f5fe4e9
.long 0x3f800000,0x3f7c3b28,0x3f710908,0x3f5ebe05,0x3f800000,0x3f7c187a,0x3f708066,0x3f5d924d,0x3f800000,0x3f7bf531,0x3f6ff573,0x3f5c61c7,0x3f800000,0x3f7bd14d,0x3f6f6830,0x3f5b2c79
.long 0x3f800000,0x3f7baccd,0x3f6ed89e,0x3f59f26a,0x3f800000,0x3f7b87b2,0x3f6e46be,0x3f58b3a1,0x3f800000,0x3f7b61fc,0x3f6db293,0x3f577026,0x3f800000,0x3f7b3bab,0x3f6d1c1d,0x3f5627fe
.long 0x3f6c835e,0x3f61c598,0x3f54db31,0x3f45e403,0x3f6b4b0c,0x3f5fe4e9,0x3f5233c6,0x3f425b89,0x3f6a09a7,0x3f5df6be,0x3f4f7a1f,0x3f3ebc1b,0x3f68bf3c,0x3f5bfb34,0x3f4cae79,0x3f3b0629
.long 0x3f676bd8,0x3f59f26a,0x3f49d112,0x3f373a23,0x3f660f88,0x3f57dc7f,0x3f46e22a,0x3f33587a,0x3f64aa59,0x3f55b993,0x3f43e200,0x3f2f61a5,0x3f633c5a,0x3f5389c7,0x3f40d0da,0x3f2b561b
.long 0x3f61c598,0x3f514d3d,0x3f3daef9,0x3f273656,0x3f604621,0x3f4f0417,0x3f3a7ca4,0x3f2302d3,0x3f5ebe05,0x3f4cae79,0x3f373a23,0x3f1ebc12,0x3f5d2d53,0x3f4a4c87,0x3f33e7bc,0x3f1a6293
.long 0x3f5b941a,0x3f47de65,0x3f3085bb,0x3f15f6d9,0x3f59f26a,0x3f456439,0x3f2d1469,0x3f11796b,0x3f584853,0x3f42de29,0x3f299415,0x3f0cead0,0x3f5695e5,0x3f404c5c,0x3f26050a,0x3f084b92
.long 0x3f54db31,0x3f3daef9,0x3f226799,0x3f039c3d,0x3f531849,0x3f3b0629,0x3f1ebc12,0x3efdbabb,0x3f514d3d,0x3f385216,0x3f1b02c6,0x3ef41f07,0x3f4f7a1f,0x3f3592e7,0x3f173c07,0x3eea6681
.long 0x3f4d9f02,0x3f32c8c9,0x3f13682a,0x3ee0924f,0x3f4bbbf8,0x3f2ff3e6,0x3f0f8784,0x3ed6a399,0x3f49d112,0x3f2d1469,0x3f0b9a6b,0x3ecc9b8b,0x3f47de65,0x3f2a2a80,0x3f07a136,0x3ec27b55
.long 0x3f45e403,0x3f273656,0x3f039c3d,0x3eb8442a,0x3f43e200,0x3f24381a,0x3eff17b2,0x3eadf73c,0x3f41d870,0x3f212ff9,0x3ef6e0cb,0x3ea395c5,0x3f3fc767,0x3f1e1e22,0x3eee9479,0x3e9920fe
.long 0x3f3daef9,0x3f1b02c6,0x3ee63375,0x3e8e9a22,0x3f3b8f3b,0x3f17de12,0x3eddbe79,0x3e840270,0x3f396842,0x3f14b039,0x3ed53641,0x3e72b651,0x3f373a23,0x3f11796b,0x3ecc9b8b,0x3e5d4b1a
.long 0x3f3504f3,0x3f226799,0x3f0e39da,0x3ef15aea,0x3f3085bb,0x3f1ce11f,0x3f07a136,0x3ee1fb6a,0x3f2beb4a,0x3f173c07,0x3f00e7e4,0x3ed25a09,0x3f273656,0x3f11796b,0x3ef41f07,0x3ec27b55
.long 0x3f226799,0x3f0b9a6b,0x3ee63375,0x3eb263ef,0x3f1d7fd1,0x3f05a02c,0x3ed8106b,0x3ea21887,0x3f187fc0,0x3eff17b2,0x3ec9b953,0x3e919ddd,0x3f13682a,0x3ef2bd43,0x3ebb31a0,0x3e80f8c0
.long 0x3f0e39da,0x3ee63375,0x3eac7cd4,0x3e605c13,0x3f08f59b,0x3ed97cb9,0x3e9d9e78,0x3e3e853e,0x3f039c3d,0x3ecc9b8b,0x3e8e9a22,0x3e1c76de,0x3efc5d27,0x3ebf926f,0x3e7ee6e1,0x3df475c0
.long 0x3ef15aea,0x3eb263ef,0x3e605c13,0x3dafb680,0x3ee63375,0x3ea5129f,0x3e419b37,0x3d55880e,0x3edae880,0x3e97a117,0x3e22abb6,0x3c96c9b6,0x3ecf7bca,0x3e8a11f7,0x3e039502,0xbc7b514b
.long 0x3ec3ef15,0x3e78cfcc,0x3dc8bd36,0xbd48fb30,0x3eb8442a,0x3e5d4b1a,0x3d8a200a,0xbda973ba,0x3eac7cd4,0x3e419b37,0x3d16c32c,0xbdee3876,0x3ea09ae5,0x3e25c58c,0x3bc90f88,0xbe195be0
.long 0x3e94a031,0x3e09cf86,0xbcc90ab0,0xbe3b6ecf,0x3e888e93,0x3ddb7d37,0xbd621469,0xbe5d4b1a,0x3e78cfcc,0x3da3308c,0xbdafb680,0xbe7ee6e1,0x3e605c13,0x3d55880e,0xbdee3876,0xbe901c2c
.long 0x3e47c5c2,0x3cc90ab0,0xbe164083,0xbea09ae5,0x3e2f10a2,0xbb490fc6,0xbe354098,0xbeb0eacb,0x3e164083,0xbcfb49ba,0xbe541501,0xbec1071e,0x3dfab273,0xbd6ea038,0xbe72b651,0xbed0eb2a
.long 0x3dc8bd36,0xbdafb680,0xbe888e93,0xbee0924f,0x3d96a905,0xbde7fa9a,0xbe97a117,0xbeeff7fb,0x3d48fb30,0xbe1008b7,0xbea68f12,0xbeff17b2,0x3cc90ab0,0xbe2bf804,0xbeb554ec,0xbf06f686
.long 0x3ec3ef15,0x3e94a031,0x3e47c5c2,0x3dc8bd36,0x3eb263ef,0x3e80f8c0,0x3e1c76de,0x3d55880e,0x3ea09ae5,0x3e5a3997,0x3de1bc2e,0x3bc90f88,0x3e8e9a22,0x3e3228d4,0x3d8a200a,0xbd2351cb
.long 0x3e78cfcc,0x3e09cf86,0x3cc90ab0,0xbdafb680,0x3e541501,0x3dc27c39,0xbc96c9b6,0xbe06b26e,0x3e2f10a2,0x3d621469,0xbd7b2b74,0xbe354098,0x3e09cf86,0x3c7b514b,0xbdd53db9,0xbe636c83
.long 0x3dc8bd36,0xbcc90ab0,0xbe164083,0xbe888e93,0x3d7b2b74,0xbd83db0a,0xbe419b37,0xbe9f1cdf,0x3cc90ab0,0xbdd53db9,0xbe6c9a7f,0xbeb554ec,0xbc490e90,0xbe1324ca,0xbe8b9507,0xbecb2aae
.long 0xbd48fb30,0xbe3b6ecf,0xbea09ae5,0xbee0924f,0xbdafb680,0xbe636c83,0xbeb554ec,0xbef58035,0xbdfab273,0xbe8586ce,0xbec9b953,0xbf04f484,0xbe22abb6,0xbe9920fe,0xbeddbe79,0xbf0ee0db
.long 0xbe47c5c2,0xbeac7cd4,0xbef15aea,0xbf187fc0,0xbe6c9a7f,0xbebf926f,0xbf0242b1,0xbf21cbfb,0xbe888e93,0xbed25a09,0xbf0b9a6b,0xbf2ac082,0xbe9aa086,0xbee4cbfe,0xbf14b039,0xbf33587a
.long 0xbeac7cd4,0xbef6e0cb,0xbf1d7fd1,0xbf3b8f3b,0xbebe1d4a,0xbf044889,0xbf26050a,0xbf436051,0xbecf7bca,0xbf0cead0,0xbf2e3bde,0xbf4ac77f,0xbee0924f,0xbf1553b7,0xbf36206c,0xbf51c0c2
.long 0xbef15aea,0xbf1d7fd1,0xbf3daef9,0xbf584853,0xbf00e7e4,0xbf256bcb,0xbf44e3f5,0xbf5e5aa6,0xbf08f59b,0xbf2d1469,0xbf4bbbf8,0xbf63f473,0xbf10d3cd,0xbf34768f,0xbf5233c6,0xbf6912ae
.long 0xbf187fc0,0xbf3b8f3b,0xbf584853,0xbf6db293,0xbf1ff6cb,0xbf425b89,0xbf5df6be,0xbf71d19f,0xbf273656,0xbf48d8b3,0xbf633c5a,0xbf756d97,0xbf2e3bde,0xbf4f0417,0xbf6816a8,0xbf788486
.long 0x248d3132,0xbdc8bd36,0xbe47c5c2,0xbe94a031,0xbd48fb30,0xbe195be0,0xbe7ee6e1,0xbeb0eacb,0xbdc8bd36,0xbe4dee60,0xbe9aa086,0xbecc9b8b,0xbe164083,0xbe80f8c0,0xbeb554ec,0xbee79a5d
.long 0xbe47c5c2,0xbe9aa086,0xbecf7bca,0xbf00e7e4,0xbe78cfcc,0xbeb3dca5,0xbee900b7,0xbf0d9281,0xbe94a031,0xbecc9b8b,0xbf00e7e4,0xbf19c200,0xbeac7cd4,0xbee4cbfe,0xbf0cead0,0xbf256bcb
.long 0xbec3ef15,0xbefc5d27,0xbf187fc0,0xbf3085bb,0xbedae880,0xbf099f4e,0xbf239da9,0xbf3b0629,0xbef15aea,0xbf14b039,0xbf2e3bde,0xbf44e3f5,0xbf039c3d,0xbf1f599f,0xbf385216,0xbf4e1689
.long 0xbf0e39da,0xbf299415,0xbf41d870,0xbf5695e5,0xbf187fc0,0xbf33587a,0xbf4ac77f,0xbf5e5aa6,0xbf226799,0xbf3ca003,0xbf531849,0xbf655e0b,0xbf2beb4a,0xbf456439,0xbf5ac450,0xbf6b99fb
.long 0xbf3504f3,0xbf4d9f02,0xbf61c598,0xbf710908,0xbf3daef9,0xbf554aa4,0xbf6816a8,0xbf75a67b,0xbf45e403,0xbf5c61c7,0xbf6db293,0xbf796e4e,0xbf4d9f02,0xbf62df7b,0xbf7294f8,0xbf7c5d3a
.long 0xbf54db31,0xbf68bf3c,0xbf76ba07,0xbf7e70b0,0xbf5b941a,0xbf6dfcf2,0xbf7a1e84,0xbf7fa6e3,0xbf61c598,0xbf7294f8,0xbf7cbfc9,0xbf7ffec4,0xbf676bd8,0xbf76841b,0xbf7e9bc9,0xbf7f7808
.long 0xbf6c835e,0xbf79c79d,0xbf7fb10f,0xbf7e1324,0xbf710908,0xbf7c5d3a,0xbf7ffec4,0xbf7bd14d,0xbf74fa0b,0xbf7e4323,0xbf7f84ab,0xbf78b47b,0xbf7853f8,0xbf7f7808,0xbf7e4323,0xbf74bf62
.long 0xbf7b14be,0xbf7ffb11,0xbf7c3b28,0xbf6ff573,0xbf7d3aac,0xbf7fcbe2,0xbf796e4e,0xbf6a5ad9,0xbf7ec46d,0xbf7eea9d,0xbf75dec6,0xbf63f473,0xbf7fb10f,0xbf7d57de,0xbf718f57,0xbf5cc7d1
.long 0xbec3ef15,0xbef15aea,0xbf0e39da,0xbf226799,0xbee0924f,0xbf06f686,0xbf1c420c,0xbf2ff3e6,0xbefc5d27,0xbf14b039,0xbf299415,0xbf3ca003,0xbf0b9a6b,0xbf21cbfb,0xbf36206c,0xbf485bca
.long 0xbf187fc0,0xbf2e3bde,0xbf41d870,0xbf531849,0xbf24d225,0xbf39f2ac,0xbf4cae79,0xbf5cc7d1,0xbf3085bb,0xbf44e3f5,0xbf5695e5,0xbf655e0b,0xbf3b8f3b,0xbf4f0417,0xbf5f8327,0xbf6cd007
.long 0xbf45e403,0xbf584853,0xbf676bd8,0xbf731447,0xbf4f7a1f,0xbf60a6cf,0xbf6e46be,0xbf7822d1,0xbf584853,0xbf6816a8,0xbf740bdd,0xbf7bf531,0xbf604621,0xbf6e8ff8,0xbf78b47b,0xbf7e868b
.long 0xbf676bd8,0xbf740bdd,0xbf7c3b28,0xbf7fd397,0xbf6db293,0xbf788486,0xbf7e9bc9,0xbf7fdaaf,0xbf731447,0xbf7bf531,0xbf7fd397,0xbf7e9bc9,0xbf778bc5,0xbf7e5a38,0xbf7fe129,0xbf7c187a
.long 0xbf7b14be,0xbf7fb10f,0xbf7ec46d,0xbf7853f8,0xbf7dabcc,0xbf7ff84a,0xbf7c7eb0,0xbf73530e,0xbf7f4e6d,0xbf7f2f9d,0xbf791298,0xbf6d1c1d,0xbf7ffb11,0xbf7d57de,0xbf748422,0xbf65b710
.long 0xbf7fb10f,0xbf7a7302,0xbf6ed89e,0xbf5d2d53,0xbf7e70b0,0xbf76841b,0xbf6816a8,0xbf5389c7,0xbf7c3b28,0xbf718f57,0xbf604621,0xbf48d8b3,0xbf791298,0xbf6b99fb,0xbf577026,0xbf3d27b8
.long 0xbf74fa0b,0xbf64aa59,0xbf4d9f02,0xbf3085bb,0xbf6ff573,0xbf5cc7d1,0xbf42de29,0xbf2302d3,0xbf6a09a7,0xbf53fac3,0xbf373a23,0xbf14b039,0xbf633c5a,0xbf4a4c87,0xbf2ac082,0xbf05a02c
.long 0xbf5b941a,0xbf3fc767,0xbf1d7fd1,0xbeebcbbb,0xbf531849,0xbf34768f,0xbf0f8784,0xbecb2aae,0xbf49d112,0xbf286605,0xbf00e7e4,0xbea986c4,0xbf3fc767,0xbf1ba299,0xbee363fa,0xbe870ada
.long 0xbf3504f3,0xbf45e403,0xbf54db31,0xbf61c598,0xbf41d870,0xbf51c0c2,0xbf5f8327,0xbf6afb8c,0xbf4d9f02,0xbf5c61c7,0xbf68bf3c,0xbf7294f8,0xbf584853,0xbf65b710,0xbf708066,0xbf788486
.long 0xbf61c598,0xbf6db293,0xbf76ba07,0xbf7cbfc9,0xbf6a09a7,0xbf74484b,0xbf7b61fc,0xbf7f3f54,0xbf710908,0xbf796e4e,0xbf7e70b0,0xbf7ffec4,0xbf76ba07,0xbf7d1cdd,0xbf7fe129,0xbf7efcc9
.long 0xbf7b14be,0xbf7f4e6d,0xbf7fb10f,0xbf7c3b28,0xbf7e1324,0xbf7fffb1,0xbf7de0b1,0xbf77beb7,0xbf7fb10f,0xbf7f2f9d,0xbf7a7302,0xbf718f57,0xbf7fec43,0xbf7cdf6c,0xbf756d97,0xbf69b7e4
.long 0xbf7ec46d,0xbf791298,0xbf6ed89e,0xbf604621,0xbf7c3b28,0xbf73ced9,0xbf66becc,0xbf554aa4,0xbf7853f8,0xbf6d1c1d,0xbf5d2d53,0xbf48d8b3,0xbf731447,0xbf650479,0xbf5233c6,0xbf3b0629
.long 0xbf6c835e,0xbf5b941a,0xbf45e403,0xbf2beb4a,0xbf64aa59,0xbf50d937,0xbf385216,0xbf1ba299,0xbf5b941a,0xbf44e3f5,0xbf299415,0xbf0a48ad,0xbf514d3d,0xbf37c655,0xbf19c200,0xbeeff7fb
.long 0xbf45e403,0xbf299415,0xbf08f59b,0xbec9b953,0xbf396842,0xbf1a6293,0xbeee9479,0xbea21887,0xbf2beb4a,0xbf0a48ad,0xbec9b953,0xbe72b651,0xbf1d7fd1,0xbef2bd43,0xbea395c5,0xbe1f917b
.long 0xbf0e39da,0xbecf7bca,0xbe78cfcc,0xbd96a905,0xbefc5d27,0xbeab0201,0xbe28defc,0x3c16cb58,0xbedae880,0xbe8586ce,0xbdafb680,0x3dbc3ac3,0xbeb8442a,0xbe3e853e,0xbbc90f88,0x3e3228d4
.long 0xbe94a031,0xbde1bc2e,0x3d96a905,0x3e827dc0,0xbe605c13,0xbd0a342f,0x3e1c76de,0x3eab0201,0xbe164083,0x3d2fe007,0x3e6c9a7f,0x3ed25a09,0xbd96a905,0x3df475c0,0x3e9d9e78,0x3ef840c8
.long 0xbf6c835e,0xbf74fa0b,0xbf7b14be,0xbf7ec46d,0xbf740bdd,0xbf7a9c59,0xbf7e9bc9,0xbf7fffb1,0xbf79c79d,0xbf7e4323,0xbf7ffb11,0xbf7eea9d,0xbf7dabcc,0xbf7fe705,0xbf7f2f9d,0xbf7b87b2
.long 0xbf7fb10f,0xbf7f84ab,0xbf7c3b28,0xbf75dec6,0xbf7fd397,0xbf7d1cdd,0xbf772417,0xbf6dfcf2,0xbf7e1324,0xbf78b47b,0xbf6ff573,0xbf63f473,0xbf7a7302,0xbf725470,0xbf66becc,0xbf57dc7f
.long 0xbf74fa0b,0xbf6a09a7,0xbf5b941a,0xbf49d112,0xbf6db293,0xbf5fe4e9,0xbf4e8d90,0xbf39f2ac,0xbf64aa59,0xbf53fac3,0xbf3fc767,0xbf286605,0xbf59f26a,0xbf466354,0xbf2f61a5,0xbf1553b7
.long 0xbf4d9f02,0xbf373a23,0xbf1d7fd1,0xbf00e7e4,0xbf3fc767,0xbf269de3,0xbf0a48ad,0xbed6a399,0xbf3085bb,0xbf14b039,0xbeebcbbb,0xbea986c4,0xbf1ff6cb,0xbf019573,0xbec1071e,0xbe75c35a
.long 0xbf0e39da,0xbedae880,0xbe94a031,0xbe164083,0xbef6e0cb,0xbeb0eacb,0xbe4dee60,0xbd55880e,0xbecf7bca,0xbe8586ce,0xbde1bc2e,0x3d2fe007,0xbea68f12,0xbe3228d4,0xbc96c9b6,0x3e0cec4a
.long 0xbe78cfcc,0xbdafb680,0x3d96a905,0x3e6c9a7f,0xbe22abb6,0x3b490fc6,0x3e28defc,0x3ea5129f,0xbd96a905,0x3dbc3ac3,0x3e827dc0,0x3ed25a09,0x3c490e90,0x3e3857ec,0x3eaf713a,0x3efdbabb
.long 0x3dc8bd36,0x3e888e93,0x3edae880,0x3f13682a,0x3e3b6ecf,0x3eb3dca5,0x3f0242b1,0x3f269de3,0x3e888e93,0x3eddbe79,0x3f15f6d9,0x3f385216,0x3eb263ef,0x3f02ef9f,0x3f286605,0x3f485bca
.long 0x3edae880,0x3f15f6d9,0x3f396842,0x3f5695e5,0x3f00e7e4,0x3f27ce61,0x3f48d8b3,0x3f62df7b,0x3f13682a,0x3f385216,0x3f5695e5,0x3f6d1c1d,0x3f24d225,0x3f476085,0x3f628210,0x3f75341d
.long 0x0,0x3dc8bd36,0x3e47c5c2,0x3e94a031,0x0,0x3dcefdb7,0x3e4dee60,0x3e9920fe,0x0,0x3dd53db9,0x3e541501,0x3e9d9e78,0x0,0x3ddb7d37,0x3e5a3997,0x3ea21887
.long 0x0,0x3de1bc2e,0x3e605c13,0x3ea68f12,0x0,0x3de7fa9a,0x3e667c66,0x3eab0201,0x0,0x3dee3876,0x3e6c9a7f,0x3eaf713a,0x0,0x3df475c0,0x3e72b651,0x3eb3dca5
.long 0x0,0x3dfab273,0x3e78cfcc,0x3eb8442a,0x0,0x3e007745,0x3e7ee6e1,0x3ebca7af,0x0,0x3e039502,0x3e827dc0,0x3ec1071e,0x0,0x3e06b26e,0x3e8586ce,0x3ec5625c
.long 0x0,0x3e09cf86,0x3e888e93,0x3ec9b953,0x0,0x3e0cec4a,0x3e8b9507,0x3ece0bea,0x0,0x3e1008b7,0x3e8e9a22,0x3ed25a09,0x0,0x3e1324ca,0x3e919ddd,0x3ed6a399
.long 0x0,0x3e164083,0x3e94a031,0x3edae880,0x0,0x3e195be0,0x3e97a117,0x3edf28a9,0x0,0x3e1c76de,0x3e9aa086,0x3ee363fa,0x0,0x3e1f917b,0x3e9d9e78,0x3ee79a5d
.long 0x0,0x3e22abb6,0x3ea09ae5,0x3eebcbbb,0x0,0x3e25c58c,0x3ea395c5,0x3eeff7fb,0x0,0x3e28defc,0x3ea68f12,0x3ef41f07,0x0,0x3e2bf804,0x3ea986c4,0x3ef840c8
.long 0x0,0x3e2f10a2,0x3eac7cd4,0x3efc5d27,0x0,0x3e3228d4,0x3eaf713a,0x3f003a06,0x0,0x3e354098,0x3eb263ef,0x3f0242b1,0x0,0x3e3857ec,0x3eb554ec,0x3f044889
.long 0x0,0x3e3b6ecf,0x3eb8442a,0x3f064b82,0x0,0x3e3e853e,0x3ebb31a0,0x3f084b92,0x0,0x3e419b37,0x3ebe1d4a,0x3f0a48ad,0x0,0x3e44b0b9,0x3ec1071e,0x3f0c42c9
.long 0x3ec3ef15,0x3ef15aea,0x3f0e39da,0x3f226799,0x3ec9b953,0x3ef840c8,0x3f121eb0,0x3f269de3,0x3ecf7bca,0x3eff17b2,0x3f15f6d9,0x3f2ac082,0x3ed53641,0x3f02ef9f,0x3f19c200,0x3f2ecef7
.long 0x3edae880,0x3f064b82,0x3f1d7fd1,0x3f32c8c9,0x3ee0924f,0x3f099f4e,0x3f212ff9,0x3f36ad7f,0x3ee63375,0x3f0cead0,0x3f24d225,0x3f3a7ca4,0x3eebcbbb,0x3f102dd5,0x3f286605,0x3f3e35c5
.long 0x3ef15aea,0x3f13682a,0x3f2beb4a,0x3f41d870,0x3ef6e0cb,0x3f16999f,0x3f2f61a5,0x3f456439,0x3efc5d27,0x3f19c200,0x3f32c8c9,0x3f48d8b3,0x3f00e7e4,0x3f1ce11f,0x3f36206c,0x3f4c3578
.long 0x3f039c3d,0x3f1ff6cb,0x3f396842,0x3f4f7a1f,0x3f064b82,0x3f2302d3,0x3f3ca003,0x3f52a649,0x3f08f59b,0x3f26050a,0x3f3fc767,0x3f55b993,0x3f0b9a6b,0x3f28fd41,0x3f42de29,0x3f58b3a1
.long 0x3f0e39da,0x3f2beb4a,0x3f45e403,0x3f5b941a,0x3f10d3cd,0x3f2ecef7,0x3f48d8b3,0x3f5e5aa6,0x3f13682a,0x3f31a81d,0x3f4bbbf8,0x3f6106f2,0x3f15f6d9,0x3f34768f,0x3f4e8d90,0x3f6398ac
.long 0x3f187fc0,0x3f373a23,0x3f514d3d,0x3f660f88,0x3f1b02c6,0x3f39f2ac,0x3f53fac3,0x3f686b39,0x3f1d7fd1,0x3f3ca003,0x3f5695e5,0x3f6aab7b,0x3f1ff6cb,0x3f3f41fc,0x3f591e6a,0x3f6cd007
.long 0x3f226799,0x3f41d870,0x3f5b941a,0x3f6ed89e,0x3f24d225,0x3f446337,0x3f5df6be,0x3f70c501,0x3f273656,0x3f46e22a,0x3f604621,0x3f7294f8,0x3f299415,0x3f495521,0x3f628210,0x3f74484b
.long 0x3f2beb4a,0x3f4bbbf8,0x3f64aa59,0x3f75dec6,0x3f2e3bde,0x3f4e1689,0x3f66becc,0x3f77583a,0x3f3085bb,0x3f5064af,0x3f68bf3c,0x3f78b47b,0x3f32c8c9,0x3f52a649,0x3f6aab7b,0x3f79f35e
.long 0x3f3504f3,0x3f45e403,0x3f54db31,0x3f61c598,0x3f396842,0x3f4a4c87,0x3f591e6a,0x3f65b710,0x3f3daef9,0x3f4e8d90,0x3f5d2d53,0x3f696591,0x3f41d870,0x3f52a649,0x3f6106f2,0x3f6cd007
.long 0x3f45e403,0x3f5695e5,0x3f64aa59,0x3f6ff573,0x3f49d112,0x3f5a5ba0,0x3f6816a8,0x3f72d4eb,0x3f4d9f02,0x3f5df6be,0x3f6b4b0c,0x3f756d97,0x3f514d3d,0x3f61668a,0x3f6e46be,0x3f77beb7
.long 0x3f54db31,0x3f64aa59,0x3f710908,0x3f79c79d,0x3f584853,0x3f67c187,0x3f73913f,0x3f7b87b2,0x3f5b941a,0x3f6aab7b,0x3f75dec6,0x3f7cfe73,0x3f5ebe05,0x3f6d67a1,0x3f77f110,0x3f7e2b72
.long 0x3f61c598,0x3f6ff573,0x3f79c79d,0x3f7f0e58,0x3f64aa59,0x3f725470,0x3f7b61fc,0x3f7fa6e3,0x3f676bd8,0x3f748422,0x3f7cbfc9,0x3f7ff4e6,0x3f6a09a7,0x3f76841b,0x3f7de0b1,0x3f7ff84a
.long 0x3f6c835e,0x3f7853f8,0x3f7ec46d,0x3f7fb10f,0x3f6ed89e,0x3f79f35e,0x3f7f6ac7,0x3f7f1f49,0x3f710908,0x3f7b61fc,0x3f7fd397,0x3f7e4323,0x3f731447,0x3f7c9f8a,0x3f7ffec4,0x3f7d1cdd
.long 0x3f74fa0b,0x3f7dabcc,0x3f7fec43,0x3f7baccd,0x3f76ba07,0x3f7e868b,0x3f7f9c18,0x3f79f35e,0x3f7853f8,0x3f7f2f9d,0x3f7f0e58,0x3f77f110,0x3f79c79d,0x3f7fa6e3,0x3f7e4323,0x3f75a67b
.long 0x3f7b14be,0x3f7fec43,0x3f7d3aac,0x3f731447,0x3f7c3b28,0x3f7fffb1,0x3f7bf531,0x3f703b37,0x3f7d3aac,0x3f7fe129,0x3f7a7302,0x3f6d1c1d,0x3f7e1324,0x3f7f90b1,0x3f78b47b,0x3f69b7e4
.long 0x3f7ec46d,0x3f7f0e58,0x3f76ba07,0x3f660f88,0x3f7f4e6d,0x3f7e5a38,0x3f748422,0x3f62241a,0x3f7fb10f,0x3f7d7474,0x3f721352,0x3f5df6be,0x3f7fec43,0x3f7c5d3a,0x3f6f6830,0x3f5988ad
.long 0x3f6c835e,0x3f74fa0b,0x3f7b14be,0x3f7ec46d,0x3f6ff573,0x3f77beb7,0x3f7cfe73,0x3f7fa6e3,0x3f731447,0x3f7a1e84,0x3f7e70b0,0x3f7ffec4,0x3f75dec6,0x3f7c187a,0x3f7f6ac7,0x3f7fcbe2
.long 0x3f7853f8,0x3f7dabcc,0x3f7fec43,0x3f7f0e58,0x3f7a7302,0x3f7ed7d4,0x3f7ff4e6,0x3f7dc68c,0x3f7c3b28,0x3f7f9c18,0x3f7f84ab,0x3f7bf531,0x3f7dabcc,0x3f7ff84a,0x3f7e9bc9,0x3f799b43
.long 0x3f7ec46d,0x3f7fec43,0x3f7d3aac,0x3f76ba07,0x3f7f84ab,0x3f7f7808,0x3f7b61fc,0x3f73530e,0x3f7fec43,0x3f7e9bc9,0x3f791298,0x3f6f6830,0x3f7ffb11,0x3f7d57de,0x3f764d97,0x3f6afb8c
.long 0x3f7fb10f,0x3f7baccd,0x3f731447,0x3f660f88,0x3f7f0e58,0x3f799b43,0x3f6f6830,0x3f60a6cf,0x3f7e1324,0x3f772417,0x3f6b4b0c,0x3f5ac450,0x3f7cbfc9,0x3f74484b,0x3f66becc,0x3f546b3b
.long 0x3f7b14be,0x3f710908,0x3f61c598,0x3f4d9f02,0x3f791298,0x3f6d67a1,0x3f5c61c7,0x3f466354,0x3f76ba07,0x3f696591,0x3f5695e5,0x3f3ebc1b,0x3f740bdd,0x3f650479,0x3f5064af,0x3f36ad7f
.long 0x3f710908,0x3f604621,0x3f49d112,0x3f2e3bde,0x3f6db293,0x3f5b2c79,0x3f42de29,0x3f256bcb,0x3f6a09a7,0x3f55b993,0x3f3b8f3b,0x3f1c420c,0x3f660f88,0x3f4fefa8,0x3f33e7bc,0x3f12c39a
.long 0x3f61c598,0x3f49d112,0x3f2beb4a,0x3f08f59b,0x3f5d2d53,0x3f436051,0x3f239da9,0x3efdbabb,0x3f584853,0x3f3ca003,0x3f1b02c6,0x3ee900b7,0x3f531849,0x3f3592e7,0x3f121eb0,0x3ed3c867
.long 0x3f4d9f02,0x3f2e3bde,0x3f08f59b,0x3ebe1d4a,0x3f47de65,0x3f269de3,0x3eff17b2,0x3ea80b1f,0x3f41d870,0x3f1ebc12,0x3eebcbbb,0x3e919ddd,0x3f3b8f3b,0x3f16999f,0x3ed8106b,0x3e75c35a
.long 0x3f800000,0x3f7ec46d,0x3f7b14be,0x3f74fa0b,0x3f7fb10f,0x3f7d1cdd,0x3f77f110,0x3f703b37,0x3f7ec46d,0x3f7ac516,0x3f740bdd,0x3f6aab7b,0x3f7d3aac,0x3f77beb7,0x3f6f6830,0x3f644fac
.long 0x3f7b14be,0x3f740bdd,0x3f6a09a7,0x3f5d2d53,0x3f7853f8,0x3f6faf1b,0x3f63f473,0x3f554aa4,0x3f74fa0b,0x3f6aab7b,0x3f5d2d53,0x3f4cae79,0x3f710908,0x3f650479,0x3f55b993,0x3f436051
.long 0x3f6c835e,0x3f5ebe05,0x3f4d9f02,0x3f396842,0x3f676bd8,0x3f57dc7f,0x3f44e3f5,0x3f2ecef7,0x3f61c598,0x3f5064af,0x3f3b8f3b,0x3f239da9,0x3f5b941a,0x3f485bca,0x3f31a81d,0x3f17de12
.long 0x3f54db31,0x3f3fc767,0x3f273656,0x3f0b9a6b,0x3f4d9f02,0x3f36ad7f,0x3f1c420c,0x3efdbabb,0x3f45e403,0x3f2d1469,0x3f10d3cd,0x3ee363fa,0x3f3daef9,0x3f2302d3,0x3f04f484,0x3ec8477c
.long 0x3f3504f3,0x3f187fc0,0x3ef15aea,0x3eac7cd4,0x3f2beb4a,0x3f0d9281,0x3ed8106b,0x3e901c2c,0x3f226799,0x3f0242b1,0x3ebe1d4a,0x3e667c66,0x3f187fc0,0x3eed3063,0x3ea395c5,0x3e2bf804
.long 0x3f0e39da,0x3ed53641,0x3e888e93,0x3de1bc2e,0x3f039c3d,0x3ebca7af,0x3e5a3997,0x3d55880e,0x3ef15aea,0x3ea395c5,0x3e22abb6,0xbbc90f88,0x3edae880,0x3e8a11f7,0x3dd53db9,0xbd83db0a
.long 0x3ec3ef15,0x3e605c13,0x3d48fb30,0xbdfab273,0x3eac7cd4,0x3e2bf804,0xbbc90f88,0xbe3857ec,0x3e94a031,0x3dee3876,0xbd7b2b74,0xbe72b651,0x3e78cfcc,0x3d83db0a,0xbdee3876,0xbe9620d2
.long 0x3e47c5c2,0x3c490e90,0xbe2f10a2,0xbeb263ef,0x3e164083,0xbd2351cb,0xbe667c66,0xbece0bea,0x3dc8bd36,0xbdbc3ac3,0xbe8e9a22,0xbee900b7,0x3d48fb30,0xbe1324ca,0xbea986c4,0xbf019573
.long 0x3f6c835e,0x3f61c598,0x3f54db31,0x3f45e403,0x3f660f88,0x3f5988ad,0x3f4ac77f,0x3f39f2ac,0x3f5ebe05,0x3f5064af,0x3f3fc767,0x3f2d1469,0x3f5695e5,0x3f466354,0x3f33e7bc,0x3f1f599f
.long 0x3f4d9f02,0x3f3b8f3b,0x3f273656,0x3f10d3cd,0x3f43e200,0x3f2ff3e6,0x3f19c200,0x3f019573,0x3f396842,0x3f239da9,0x3f0b9a6b,0x3ee363fa,0x3f2e3bde,0x3f16999f,0x3ef9a02d,0x3ec27b55
.long 0x3f226799,0x3f08f59b,0x3edae880,0x3ea09ae5,0x3f15f6d9,0x3ef58035,0x3ebb31a0,0x3e7bdba4,0x3f08f59b,0x3ed8106b,0x3e9aa086,0x3e354098,0x3ef6e0cb,0x3eb9bb1e,0x3e72b651,0x3ddb7d37
.long 0x3edae880,0x3e9aa086,0x3e2f10a2,0x3d16c32c,0x3ebe1d4a,0x3e75c35a,0x3dd53db9,0xbd0a342f,0x3ea09ae5,0x3e354098,0x3d16c32c,0xbdd53db9,0x3e827dc0,0x3de7fa9a,0xbcfb49ba,0xbe3228d4
.long 0x3e47c5c2,0x3d48fb30,0xbdc8bd36,0xbe78cfcc,0x3e09cf86,0xbc7b514b,0xbe28defc,0xbe9f1cdf,0x3d96a905,0xbda3308c,0xbe6c9a7f,0xbec1071e,0x3c490e90,0xbe1324ca,0xbe97a117,0xbee1fb6a
.long 0xbd48fb30,0xbe541501,0xbeb8442a,0xbf00e7e4,0xbde1bc2e,0xbe8a11f7,0xbed8106b,0xbf102dd5,0xbe2f10a2,0xbea986c4,0xbef6e0cb,0xbf1ebc12,0xbe6c9a7f,0xbec8477c,0xbf0a48ad,0xbf2c800f
.long 0xbe94a031,0xbee63375,0xbf187fc0,0xbf396842,0xbeb263ef,0xbf019573,0xbf26050a,0xbf456439,0xbecf7bca,0xbf0f8784,0xbf32c8c9,0xbf5064af,0xbeebcbbb,0xbf1ce11f,0xbf3ebc1b,0xbf5a5ba0
.long 0xbf039c3d,0xbf299415,0xbf49d112,0xbf633c5a,0xbf10d3cd,0xbf3592e7,0xbf53fac3,0xbf6afb8c,0xbf1d7fd1,0xbf40d0da,0xbf5d2d53,0xbf718f57,0xbf299415,0xbf4b41fa,0xbf655e0b,0xbf76ef5b
.long 0x3f3504f3,0x3f226799,0x3f0e39da,0x3ef15aea,0x3f273656,0x3f12c39a,0x3ef9a02d,0x3ecb2aae,0x3f187fc0,0x3f0242b1,0x3ed53641,0x3ea395c5,0x3f08f59b,0x3ee1fb6a,0x3eaf713a,0x3e75c35a
.long 0x3ef15aea,0x3ebe1d4a,0x3e888e93,0x3e22abb6,0x3ecf7bca,0x3e9920fe,0x3e419b37,0x3d9cecf9,0x3eac7cd4,0x3e667c66,0x3de1bc2e,0xbbc90f88,0x3e888e93,0x3e195be0,0x3cfb49ba,0xbdb5f8da
.long 0x3e47c5c2,0x3d96a905,0xbd48fb30,0xbe2f10a2,0x3dfab273,0xbb490fc6,0xbe039502,0xbe80f8c0,0x3d48fb30,0xbda3308c,0xbe541501,0xbea986c4,0xbcc90ab0,0xbe1f917b,0xbe919ddd,0xbed0eb2a
.long 0xbdc8bd36,0xbe6c9a7f,0xbeb8442a,0xbef6e0cb,0xbe2f10a2,0xbe9c1faf,0xbeddbe79,0xbf0d9281,0xbe78cfcc,0xbec1071e,0xbf00e7e4,0xbf1ebc12,0xbea09ae5,0xbee4cbfe,0xbf121eb0,0xbf2ecef7
.long 0xbec3ef15,0xbf039c3d,0xbf226799,0xbf3daef9,0xbee63375,0xbf140c5f,0xbf31a81d,0xbf4b41fa,0xbf039c3d,0xbf239da9,0xbf3fc767,0xbf577026,0xbf13682a,0xbf3238aa,0xbf4cae79,0xbf62241a
.long 0xbf226799,0xbf3fc767,0xbf584853,0xbf6b4b0c,0xbf3085bb,0xbf4c3578,0xbf628210,0xbf72d4eb,0xbf3daef9,0xbf577026,0xbf6b4b0c,0xbf78b47b,0xbf49d112,0xbf61668a,0xbf7294f8,0xbf7cdf6c
.long 0xbf54db31,0xbf6a09a7,0xbf7853f8,0xbf7f4e6d,0xbf5ebe05,0xbf714c7a,0xbf7c7eb0,0xbf7ffd39,0xbf676bd8,0xbf772417,0xbf7f0e58,0xbf7eea9d,0xbf6ed89e,0xbf7b87b2,0xbf7ffec4,0xbf7c187a
.long 0xbf74fa0b,0xbf7e70b0,0xbf7f4e6d,0xbf778bc5,0xbf79c79d,0xbf7fdaaf,0xbf7cfe73,0xbf714c7a,0xbf7d3aac,0xbf7fc38f,0xbf791298,0xbf696591,0xbf7f4e6d,0xbf7e2b72,0xbf73913f,0xbf5fe4e9
.long 0x3ec3ef15,0x3e94a031,0x3e47c5c2,0x3dc8bd36,0x3e9aa086,0x3e5101f1,0x3dd53db9,0x3b490fc6,0x3e605c13,0x3dee3876,0x3c490e90,0xbdbc3ac3,0x3e09cf86,0x3ce22a7a,0xbda3308c,0xbe3e853e
.long 0x3d48fb30,0xbd7b2b74,0xbe2f10a2,0xbe8e9a22,0xbd16c32c,0xbe195be0,0xbe8586ce,0xbebca7af,0xbdfab273,0xbe72b651,0xbeb263ef,0xbee900b7,0xbe541501,0xbea5129f,0xbeddbe79,0xbf099f4e
.long 0xbe94a031,0xbecf7bca,0xbf039c3d,0xbf1d7fd1,0xbebe1d4a,0xbef840c8,0xbf173c07,0xbf2ff3e6,0xbee63375,0xbf0f8784,0xbf299415,0xbf40d0da,0xbf064b82,0xbf21cbfb,0xbf3a7ca4,0xbf4fefa8
.long 0xbf187fc0,0xbf32c8c9,0xbf49d112,0xbf5d2d53,0xbf299415,0xbf425b89,0xbf577026,0xbf686b39,0xbf396842,0xbf5064af,0xbf633c5a,0xbf718f57,0xbf47de65,0xbf5cc7d1,0xbf6d1c1d,0xbf788486
.long 0xbf54db31,0xbf676bd8,0xbf74fa0b,0xbf7d3aac,0xbf604621,0xbf703b37,0xbf7ac516,0xbf7fa6e3,0xbf6a09a7,0xbf772417,0xbf7e70b0,0xbf7fc38f,0xbf721352,0xbf7c187a,0xbf7ff4e6,0xbf7d906e
.long 0xbf7853f8,0xbf7f0e58,0xbf7f4e6d,0xbf791298,0xbf7cbfc9,0xbf7fffb1,0xbf7c7eb0,0xbf725470,0xbf7f4e6d,0xbf7eea9d,0xbf778bc5,0xbf696591,0xbf7ffb11,0xbf7bd14d,0xbf708066,0xbf5e5aa6
.long 0xbf7ec46d,0xbf76ba07,0xbf676bd8,0xbf514d3d,0xbf7baccd,0xbf6faf1b,0xbf5c61c7,0xbf425b89,0xbf76ba07,0xbf66becc,0xbf4f7a1f,0xbf31a81d,0xbf6ff573,0xbf5bfb34,0xbf40d0da,0xbf1f599f
.long 0xbf676bd8,0xbf4f7a1f,0xbf3085bb,0xbf0b9a6b,0xbf5d2d53,0xbf4154e1,0xbf1ebc12,0xbeed3063,0xbf514d3d,0xbf31a81d,0xbf0b9a6b,0xbec1071e,0xbf43e200,0xbf209393,0xbeee9479,0xbe931f35
.long 0x3f800000,0x3f800000,0x3f800000,0x3f800000,0x3f800000,0x3f7fffb1,0x3f7ffec4,0x3f7ffd39,0x3f800000,0x3f7ffec4,0x3f7ffb11,0x3f7ff4e6,0x3f800000,0x3f7ffd39,0x3f7ff4e6,0x3f7fe705
.long 0x3f800000,0x3f7ffb11,0x3f7fec43,0x3f7fd397,0x3f800000,0x3f7ff84a,0x3f7fe129,0x3f7fba9e,0x3f800000,0x3f7ff4e6,0x3f7fd397,0x3f7f9c18,0x3f800000,0x3f7ff0e3,0x3f7fc38f,0x3f7f7808
.long 0x3f800000,0x3f7fec43,0x3f7fb10f,0x3f7f4e6d,0x3f800000,0x3f7fe705,0x3f7f9c18,0x3f7f1f49,0x3f800000,0x3f7fe129,0x3f7f84ab,0x3f7eea9d,0x3f800000,0x3f7fdaaf,0x3f7f6ac7,0x3f7eb069
.long 0x3f800000,0x3f7fd397,0x3f7f4e6d,0x3f7e70b0,0x3f800000,0x3f7fcbe2,0x3f7f2f9d,0x3f7e2b72,0x3f800000,0x3f7fc38f,0x3f7f0e58,0x3f7de0b1,0x3f800000,0x3f7fba9e,0x3f7eea9d,0x3f7d906e
.long 0x3f800000,0x3f7fb10f,0x3f7ec46d,0x3f7d3aac,0x3f800000,0x3f7fa6e3,0x3f7e9bc9,0x3f7cdf6c,0x3f800000,0x3f7f9c18,0x3f7e70b0,0x3f7c7eb0,0x3f800000,0x3f7f90b1,0x3f7e4323,0x3f7c187a
.long 0x3f800000,0x3f7f84ab,0x3f7e1324,0x3f7baccd,0x3f800000,0x3f7f7808,0x3f7de0b1,0x3f7b3bab,0x3f800000,0x3f7f6ac7,0x3f7dabcc,0x3f7ac516,0x3f800000,0x3f7f5ce9,0x3f7d7474,0x3f7a4910
.long 0x3f800000,0x3f7f4e6d,0x3f7d3aac,0x3f79c79d,0x3f800000,0x3f7f3f54,0x3f7cfe73,0x3f7940c0,0x3f800000,0x3f7f2f9d,0x3f7cbfc9,0x3f78b47b,0x3f800000,0x3f7f1f49,0x3f7c7eb0,0x3f7822d1
.long 0x3f800000,0x3f7f0e58,0x3f7c3b28,0x3f778bc5,0x3f800000,0x3f7efcc9,0x3f7bf531,0x3f76ef5b,0x3f800000,0x3f7eea9d,0x3f7baccd,0x3f764d97,0x3f800000,0x3f7ed7d4,0x3f7b61fc,0x3f75a67b
.long 0x3f800000,0x3f800000,0x3f800000,0x3f800000,0x3f7ffb11,0x3f7ff84a,0x3f7ff4e6,0x3f7ff0e3,0x3f7fec43,0x3f7fe129,0x3f7fd397,0x3f7fc38f,0x3f7fd397,0x3f7fba9e,0x3f7f9c18,0x3f7f7808
.long 0x3f7fb10f,0x3f7f84ab,0x3f7f4e6d,0x3f7f0e58,0x3f7f84ab,0x3f7f3f54,0x3f7eea9d,0x3f7e868b,0x3f7f4e6d,0x3f7eea9d,0x3f7e70b0,0x3f7de0b1,0x3f7f0e58,0x3f7e868b,0x3f7de0b1,0x3f7d1cdd
.long 0x3f7ec46d,0x3f7e1324,0x3f7d3aac,0x3f7c3b28,0x3f7e70b0,0x3f7d906e,0x3f7c7eb0,0x3f7b3bab,0x3f7e1324,0x3f7cfe73,0x3f7baccd,0x3f7a1e84,0x3f7dabcc,0x3f7c5d3a,0x3f7ac516,0x3f78e3d6
.long 0x3f7d3aac,0x3f7baccd,0x3f79c79d,0x3f778bc5,0x3f7cbfc9,0x3f7aed37,0x3f78b47b,0x3f76167a,0x3f7c3b28,0x3f7a1e84,0x3f778bc5,0x3f748422,0x3f7baccd,0x3f7940c0,0x3f764d97,0x3f72d4eb
.long 0x3f7b14be,0x3f7853f8,0x3f74fa0b,0x3f710908,0x3f7a7302,0x3f77583a,0x3f73913f,0x3f6f20b0,0x3f79c79d,0x3f764d97,0x3f721352,0x3f6d1c1d,0x3f791298,0x3f75341d,0x3f708066,0x3f6afb8c
.long 0x3f7853f8,0x3f740bdd,0x3f6ed89e,0x3f68bf3c,0x3f778bc5,0x3f72d4eb,0x3f6d1c1d,0x3f666771,0x3f76ba07,0x3f718f57,0x3f6b4b0c,0x3f63f473,0x3f75dec6,0x3f703b37,0x3f696591,0x3f61668a
.long 0x3f74fa0b,0x3f6ed89e,0x3f676bd8,0x3f5ebe05,0x3f740bdd,0x3f6d67a1,0x3f655e0b,0x3f5bfb34,0x3f731447,0x3f6be858,0x3f633c5a,0x3f591e6a,0x3f721352,0x3f6a5ad9,0x3f6106f2,0x3f5627fe
.long 0x3f710908,0x3f68bf3c,0x3f5ebe05,0x3f531849,0x3f6ff573,0x3f671599,0x3f5c61c7,0x3f4fefa8,0x3f6ed89e,0x3f655e0b,0x3f59f26a,0x3f4cae79,0x3f6db293,0x3f6398ac,0x3f577026,0x3f495521
.long 0x3f800000,0x3f800000,0x3f800000,0x3f800000,0x3f7fec43,0x3f7fe705,0x3f7fe129,0x3f7fdaaf,0x3f7fb10f,0x3f7f9c18,0x3f7f84ab,0x3f7f6ac7,0x3f7f4e6d,0x3f7f1f49,0x3f7eea9d,0x3f7eb069
.long 0x3f7ec46d,0x3f7e70b0,0x3f7e1324,0x3f7dabcc,0x3f7e1324,0x3f7d906e,0x3f7cfe73,0x3f7c5d3a,0x3f7d3aac,0x3f7c7eb0,0x3f7baccd,0x3f7ac516,0x3f7c3b28,0x3f7b3bab,0x3f7a1e84,0x3f78e3d6
.long 0x3f7b14be,0x3f79c79d,0x3f7853f8,0x3f76ba07,0x3f79c79d,0x3f7822d1,0x3f764d97,0x3f74484b,0x3f7853f8,0x3f764d97,0x3f740bdd,0x3f718f57,0x3f76ba07,0x3f74484b,0x3f718f57,0x3f6e8ff8
.long 0x3f74fa0b,0x3f721352,0x3f6ed89e,0x3f6b4b0c,0x3f731447,0x3f6faf1b,0x3f6be858,0x3f67c187,0x3f710908,0x3f6d1c1d,0x3f68bf3c,0x3f63f473,0x3f6ed89e,0x3f6a5ad9,0x3f655e0b,0x3f5fe4e9
.long 0x3f6c835e,0x3f676bd8,0x3f61c598,0x3f5b941a,0x3f6a09a7,0x3f644fac,0x3f5df6be,0x3f570348,0x3f676bd8,0x3f6106f2,0x3f59f26a,0x3f5233c6,0x3f64aa59,0x3f5d924d,0x3f55b993,0x3f4d26fd
.long 0x3f61c598,0x3f59f26a,0x3f514d3d,0x3f47de65,0x3f5ebe05,0x3f5627fe,0x3f4cae79,0x3f425b89,0x3f5b941a,0x3f5233c6,0x3f47de65,0x3f3ca003,0x3f584853,0x3f4e1689,0x3f42de29,0x3f36ad7f
.long 0x3f54db31,0x3f49d112,0x3f3daef9,0x3f3085bb,0x3f514d3d,0x3f456439,0x3f385216,0x3f2a2a80,0x3f4d9f02,0x3f40d0da,0x3f32c8c9,0x3f239da9,0x3f49d112,0x3f3c17d9,0x3f2d1469,0x3f1ce11f
.long 0x3f45e403,0x3f373a23,0x3f273656,0x3f15f6d9,0x3f41d870,0x3f3238aa,0x3f212ff9,0x3f0ee0db,0x3f3daef9,0x3f2d1469,0x3f1b02c6,0x3f07a136,0x3f396842,0x3f27ce61,0x3f14b039,0x3f003a06
.long 0x3f800000,0x3f800000,0x3f800000,0x3f800000,0x3f7fd397,0x3f7fcbe2,0x3f7fc38f,0x3f7fba9e,0x3f7f4e6d,0x3f7f2f9d,0x3f7f0e58,0x3f7eea9d,0x3f7e70b0,0x3f7e2b72,0x3f7de0b1,0x3f7d906e
.long 0x3f7d3aac,0x3f7cbfc9,0x3f7c3b28,0x3f7baccd,0x3f7baccd,0x3f7aed37,0x3f7a1e84,0x3f7940c0,0x3f79c79d,0x3f78b47b,0x3f778bc5,0x3f764d97,0x3f778bc5,0x3f76167a,0x3f748422,0x3f72d4eb
.long 0x3f74fa0b,0x3f731447,0x3f710908,0x3f6ed89e,0x3f721352,0x3f6faf1b,0x3f6d1c1d,0x3f6a5ad9,0x3f6ed89e,0x3f6be858,0x3f68bf3c,0x3f655e0b,0x3f6b4b0c,0x3f67c187,0x3f63f473,0x3f5fe4e9
.long 0x3f676bd8,0x3f633c5a,0x3f5ebe05,0x3f59f26a,0x3f633c5a,0x3f5e5aa6,0x3f591e6a,0x3f5389c7,0x3f5ebe05,0x3f591e6a,0x3f531849,0x3f4cae79,0x3f59f26a,0x3f5389c7,0x3f4cae79,0x3f456439
.long 0x3f54db31,0x3f4d9f02,0x3f45e403,0x3f3daef9,0x3f4f7a1f,0x3f476085,0x3f3ebc1b,0x3f3592e7,0x3f49d112,0x3f40d0da,0x3f373a23,0x3f2d1469,0x3f43e200,0x3f39f2ac,0x3f2f61a5,0x3f24381a
.long 0x3f3daef9,0x3f32c8c9,0x3f273656,0x3f1b02c6,0x3f373a23,0x3f2b561b,0x3f1ebc12,0x3f11796b,0x3f3085bb,0x3f239da9,0x3f15f6d9,0x3f07a136,0x3f299415,0x3f1ba299,0x3f0cead0,0x3efafef7
.long 0x3f226799,0x3f13682a,0x3f039c3d,0x3ee63375,0x3f1b02c6,0x3f0af1b7,0x3ef41f07,0x3ed0eb2a,0x3f13682a,0x3f0242b1,0x3ee0924f,0x3ebb31a0,0x3f0b9a6b,0x3ef2bd43,0x3ecc9b8b,0x3ea5129f
.long 0x3f039c3d,0x3ee0924f,0x3eb8442a,0x3e8e9a22,0x3ef6e0cb,0x3ece0bea,0x3ea395c5,0x3e6fa8b2,0x3ee63375,0x3ebb31a0,0x3e8e9a22,0x3e419b37,0x3ed53641,0x3ea80b1f,0x3e72b651,0x3e1324ca
.long 0x3f800000,0x3f800000,0x3f800000,0x3f800000,0x3f7fb10f,0x3f7fa6e3,0x3f7f9c18,0x3f7f90b1,0x3f7ec46d,0x3f7e9bc9,0x3f7e70b0,0x3f7e4323,0x3f7d3aac,0x3f7cdf6c,0x3f7c7eb0,0x3f7c187a
.long 0x3f7b14be,0x3f7a7302,0x3f79c79d,0x3f791298,0x3f7853f8,0x3f77583a,0x3f764d97,0x3f75341d,0x3f74fa0b,0x3f73913f,0x3f721352,0x3f708066,0x3f710908,0x3f6f20b0,0x3f6d1c1d,0x3f6afb8c
.long 0x3f6c835e,0x3f6a09a7,0x3f676bd8,0x3f64aa59,0x3f676bd8,0x3f644fac,0x3f6106f2,0x3f5d924d,0x3f61c598,0x3f5df6be,0x3f59f26a,0x3f55b993,0x3f5b941a,0x3f570348,0x3f5233c6,0x3f4d26fd
.long 0x3f54db31,0x3f4f7a1f,0x3f49d112,0x3f43e200,0x3f4d9f02,0x3f476085,0x3f40d0da,0x3f39f2ac,0x3f45e403,0x3f3ebc1b,0x3f373a23,0x3f2f61a5,0x3f3daef9,0x3f3592e7,0x3f2d1469,0x3f24381a
.long 0x3f3504f3,0x3f2beb4a,0x3f226799,0x3f187fc0,0x3f2beb4a,0x3f21cbfb,0x3f173c07,0x3f0c42c9,0x3f226799,0x3f173c07,0x3f0b9a6b,0x3eff17b2,0x3f187fc0,0x3f0c42c9,0x3eff17b2,0x3ee4cbfe
.long 0x3f0e39da,0x3f00e7e4,0x3ee63375,0x3ec9b953,0x3f039c3d,0x3eea6681,0x3ecc9b8b,0x3eadf73c,0x3ef15aea,0x3ed25a09,0x3eb263ef,0x3e919ddd,0x3edae880,0x3eb9bb1e,0x3e97a117,0x3e698bba
.long 0x3ec3ef15,0x3ea09ae5,0x3e78cfcc,0x3e2f10a2,0x3eac7cd4,0x3e870ada,0x3e419b37,0x3de7fa9a,0x3e94a031,0x3e5a3997,0x3e09cf86,0x3d621469,0x3e78cfcc,0x3e25c58c,0x3da3308c,0xbb490fc6
.long 0x3e47c5c2,0x3de1bc2e,0x3cc90ab0,0xbd7b2b74,0x3e164083,0x3d6ea038,0xbcfb49ba,0xbdf475c0,0x3dc8bd36,0x3bc90f88,0xbdafb680,0xbe354098,0x3d48fb30,0xbd3c6dd5,0xbe1008b7,0xbe6fa8b2
.long 0x3f800000,0x3f800000,0x3f800000,0x3f800000,0x3f7f84ab,0x3f7f7808,0x3f7f6ac7,0x3f7f5ce9,0x3f7e1324,0x3f7de0b1,0x3f7dabcc,0x3f7d7474,0x3f7baccd,0x3f7b3bab,0x3f7ac516,0x3f7a4910
.long 0x3f7853f8,0x3f778bc5,0x3f76ba07,0x3f75dec6,0x3f740bdd,0x3f72d4eb,0x3f718f57,0x3f703b37,0x3f6ed89e,0x3f6d1c1d,0x3f6b4b0c,0x3f696591,0x3f68bf3c,0x3f666771,0x3f63f473,0x3f61668a
.long 0x3f61c598,0x3f5ebe05,0x3f5b941a,0x3f584853,0x3f59f26a,0x3f5627fe,0x3f5233c6,0x3f4e1689,0x3f514d3d,0x3f4cae79,0x3f47de65,0x3f42de29,0x3f47de65,0x3f425b89,0x3f3ca003,0x3f36ad7f
.long 0x3f3daef9,0x3f373a23,0x3f3085bb,0x3f299415,0x3f32c8c9,0x3f2b561b,0x3f239da9,0x3f1ba299,0x3f273656,0x3f1ebc12,0x3f15f6d9,0x3f0cead0,0x3f1b02c6,0x3f11796b,0x3f07a136,0x3efafef7
.long 0x3f0e39da,0x3f039c3d,0x3ef15aea,0x3edae880,0x3f00e7e4,0x3eea6681,0x3ed25a09,0x3eb9bb1e,0x3ee63375,0x3ecc9b8b,0x3eb263ef,0x3e97a117,0x3ec9b953,0x3eadf73c,0x3e919ddd,0x3e698bba
.long 0x3eac7cd4,0x3e8e9a22,0x3e605c13,0x3e22abb6,0x3e8e9a22,0x3e5d4b1a,0x3e1c76de,0x3db5f8da,0x3e605c13,0x3e1c76de,0x3dafb680,0x3c96c9b6,0x3e22abb6,0x3db5f8da,0x3c96c9b6,0xbd55880e
.long 0x3dc8bd36,0x3cc90ab0,0xbd48fb30,0xbdfab273,0x3d16c32c,0xbd2351cb,0xbdee3876,0xbe44b0b9,0xbcc90ab0,0xbdd53db9,0xbe3b6ecf,0xbe8586ce,0xbdafb680,0xbe2bf804,0xbe7ee6e1,0xbea80b1f
.long 0xbe164083,0xbe6c9a7f,0xbea09ae5,0xbec9b953,0xbe541501,0xbe9620d2,0xbec1071e,0xbeea6681,0xbe888e93,0xbeb554ec,0xbee0924f,0xbf04f484,0xbea68f12,0xbed3c867,0xbeff17b2,0xbf140c5f
.long 0x3f800000,0x3f800000,0x3f800000,0x3f800000,0x3f7f4e6d,0x3f7f3f54,0x3f7f2f9d,0x3f7f1f49,0x3f7d3aac,0x3f7cfe73,0x3f7cbfc9,0x3f7c7eb0,0x3f79c79d,0x3f7940c0,0x3f78b47b,0x3f7822d1
.long 0x3f74fa0b,0x3f740bdd,0x3f731447,0x3f721352,0x3f6ed89e,0x3f6d67a1,0x3f6be858,0x3f6a5ad9,0x3f676bd8,0x3f655e0b,0x3f633c5a,0x3f6106f2,0x3f5ebe05,0x3f5bfb34,0x3f591e6a,0x3f5627fe
.long 0x3f54db31,0x3f514d3d,0x3f4d9f02,0x3f49d112,0x3f49d112,0x3f456439,0x3f40d0da,0x3f3c17d9,0x3f3daef9,0x3f385216,0x3f32c8c9,0x3f2d1469,0x3f3085bb,0x3f2a2a80,0x3f239da9,0x3f1ce11f
.long 0x3f226799,0x3f1b02c6,0x3f13682a,0x3f0b9a6b,0x3f13682a,0x3f0af1b7,0x3f0242b1,0x3ef2bd43,0x3f039c3d,0x3ef41f07,0x3ee0924f,0x3ecc9b8b,0x3ee63375,0x3ed0eb2a,0x3ebb31a0,0x3ea5129f
.long 0x3ec3ef15,0x3eac7cd4,0x3e94a031,0x3e78cfcc,0x3ea09ae5,0x3e870ada,0x3e5a3997,0x3e25c58c,0x3e78cfcc,0x3e419b37,0x3e09cf86,0x3da3308c,0x3e2f10a2,0x3de7fa9a,0x3d621469,0xbb490fc6
.long 0x3dc8bd36,0x3d16c32c,0xbcc90ab0,0xbdafb680,0x3cc90ab0,0xbd2351cb,0xbdd53db9,0xbe2bf804,0xbd48fb30,0xbdee3876,0xbe3b6ecf,0xbe7ee6e1,0xbdfab273,0xbe44b0b9,0xbe8586ce,0xbea80b1f
.long 0xbe47c5c2,0xbe888e93,0xbeac7cd4,0xbecf7bca,0xbe888e93,0xbeadf73c,0xbed25a09,0xbef58035,0xbeac7cd4,0xbed25a09,0xbef6e0cb,0xbf0cead0,0xbecf7bca,0xbef58035,0xbf0cead0,0xbf1e1e22
.long 0xbef15aea,0xbf0b9a6b,0xbf1d7fd1,0xbf2e3bde,0xbf08f59b,0xbf1ba299,0xbf2d1469,0xbf3d27b8,0xbf187fc0,0xbf2ac082,0xbf3b8f3b,0xbf4ac77f,0xbf273656,0xbf38dd65,0xbf48d8b3,0xbf570348
.long 0x3f800000,0x3f800000,0x3f800000,0x3f800000,0x3f7f0e58,0x3f7efcc9,0x3f7eea9d,0x3f7ed7d4,0x3f7c3b28,0x3f7bf531,0x3f7baccd,0x3f7b61fc,0x3f778bc5,0x3f76ef5b,0x3f764d97,0x3f75a67b
.long 0x3f710908,0x3f6ff573,0x3f6ed89e,0x3f6db293,0x3f68bf3c,0x3f671599,0x3f655e0b,0x3f6398ac,0x3f5ebe05,0x3f5c61c7,0x3f59f26a,0x3f577026,0x3f531849,0x3f4fefa8,0x3f4cae79,0x3f495521
.long 0x3f45e403,0x3f41d870,0x3f3daef9,0x3f396842,0x3f373a23,0x3f3238aa,0x3f2d1469,0x3f27ce61,0x3f273656,0x3f212ff9,0x3f1b02c6,0x3f14b039,0x3f15f6d9,0x3f0ee0db,0x3f07a136,0x3f003a06
.long 0x3f039c3d,0x3ef6e0cb,0x3ee63375,0x3ed53641,0x3ee0924f,0x3ece0bea,0x3ebb31a0,0x3ea80b1f,0x3eb8442a,0x3ea395c5,0x3e8e9a22,0x3e72b651,0x3e8e9a22,0x3e6fa8b2,0x3e419b37,0x3e1324ca
.long 0x3e47c5c2,0x3e164083,0x3dc8bd36,0x3d48fb30,0x3de1bc2e,0x3d6ea038,0x3bc90f88,0xbd3c6dd5,0x3cc90ab0,0xbcfb49ba,0xbdafb680,0xbe1008b7,0xbd7b2b74,0xbdf475c0,0xbe354098,0xbe6fa8b2
.long 0xbe164083,0xbe541501,0xbe888e93,0xbea68f12,0xbe6c9a7f,0xbe9620d2,0xbeb554ec,0xbed3c867,0xbea09ae5,0xbec1071e,0xbee0924f,0xbeff17b2,0xbec9b953,0xbeea6681,0xbf04f484,0xbf140c5f
.long 0xbef15aea,0xbf08f59b,0xbf187fc0,0xbf273656,0xbf0b9a6b,0xbf1ba299,0xbf2ac082,0xbf38dd65,0xbf1d7fd1,0xbf2d1469,0xbf3b8f3b,0xbf48d8b3,0xbf2e3bde,0xbf3d27b8,0xbf4ac77f,0xbf570348
.long 0xbf3daef9,0xbf4bbbf8,0xbf584853,0xbf633c5a,0xbf4bbbf8,0xbf58b3a1,0xbf63f473,0xbf6d67a1,0xbf584853,0xbf63f473,0xbf6db293,0xbf756d97,0xbf633c5a,0xbf6d67a1,0xbf756d97,0xbf7b3bab
.long 0x80000000,0x80000000,0x80000000,0x80000000,0x80000000,0xbb490fc6,0xbbc90f88,0xbc16cb58,0x80000000,0xbbc90f88,0xbc490e90,0xbc96c9b6,0x80000000,0xbc16cb58,0xbc96c9b6,0xbce22a7a
.long 0x80000000,0xbc490e90,0xbcc90ab0,0xbd16c32c,0x80000000,0xbc7b514b,0xbcfb49ba,0xbd3c6dd5,0x80000000,0xbc96c9b6,0xbd16c32c,0xbd621469,0x80000000,0xbcafea69,0xbd2fe007,0xbd83db0a
.long 0x80000000,0xbcc90ab0,0xbd48fb30,0xbd96a905,0x80000000,0xbce22a7a,0xbd621469,0xbda973ba,0x80000000,0xbcfb49ba,0xbd7b2b74,0xbdbc3ac3,0x80000000,0xbd0a342f,0xbd8a200a,0xbdcefdb7
.long 0x80000000,0xbd16c32c,0xbd96a905,0xbde1bc2e,0x80000000,0xbd2351cb,0xbda3308c,0xbdf475c0,0x80000000,0xbd2fe007,0xbdafb680,0xbe039502,0x80000000,0xbd3c6dd5,0xbdbc3ac3,0xbe0cec4a
.long 0x80000000,0xbd48fb30,0xbdc8bd36,0xbe164083,0x80000000,0xbd55880e,0xbdd53db9,0xbe1f917b,0x80000000,0xbd621469,0xbde1bc2e,0xbe28defc,0x80000000,0xbd6ea038,0xbdee3876,0xbe3228d4
.long 0x80000000,0xbd7b2b74,0xbdfab273,0xbe3b6ecf,0x80000000,0xbd83db0a,0xbe039502,0xbe44b0b9,0x80000000,0xbd8a200a,0xbe09cf86,0xbe4dee60,0x80000000,0xbd9064b4,0xbe1008b7,0xbe57278f
.long 0x80000000,0xbd96a905,0xbe164083,0xbe605c13,0x80000000,0xbd9cecf9,0xbe1c76de,0xbe698bba,0x80000000,0xbda3308c,0xbe22abb6,0xbe72b651,0x80000000,0xbda973ba,0xbe28defc,0xbe7bdba4
.long 0x80000000,0xbdafb680,0xbe2f10a2,0xbe827dc0,0x80000000,0xbdb5f8da,0xbe354098,0xbe870ada,0x80000000,0xbdbc3ac3,0xbe3b6ecf,0xbe8b9507,0x80000000,0xbdc27c39,0xbe419b37,0xbe901c2c
.long 0x80000000,0x80000000,0x80000000,0x80000000,0xbc490e90,0xbc7b514b,0xbc96c9b6,0xbcafea69,0xbcc90ab0,0xbcfb49ba,0xbd16c32c,0xbd2fe007,0xbd16c32c,0xbd3c6dd5,0xbd621469,0xbd83db0a
.long 0xbd48fb30,0xbd7b2b74,0xbd96a905,0xbdafb680,0xbd7b2b74,0xbd9cecf9,0xbdbc3ac3,0xbddb7d37,0xbd96a905,0xbdbc3ac3,0xbde1bc2e,0xbe039502,0xbdafb680,0xbddb7d37,0xbe039502,0xbe195be0
.long 0xbdc8bd36,0xbdfab273,0xbe164083,0xbe2f10a2,0xbde1bc2e,0xbe0cec4a,0xbe28defc,0xbe44b0b9,0xbdfab273,0xbe1c76de,0xbe3b6ecf,0xbe5a3997,0xbe09cf86,0xbe2bf804,0xbe4dee60,0xbe6fa8b2
.long 0xbe164083,0xbe3b6ecf,0xbe605c13,0xbe827dc0,0xbe22abb6,0xbe4ada4f,0xbe72b651,0xbe8d17c0,0xbe2f10a2,0xbe5a3997,0xbe827dc0,0xbe97a117,0xbe3b6ecf,0xbe698bba,0xbe8b9507,0xbea21887
.long 0xbe47c5c2,0xbe78cfcc,0xbe94a031,0xbeac7cd4,0xbe541501,0xbe840270,0xbe9d9e78,0xbeb6ccc3,0xbe605c13,0xbe8b9507,0xbea68f12,0xbec1071e,0xbe6c9a7f,0xbe931f35,0xbeaf713a,0xbecb2aae
.long 0xbe78cfcc,0xbe9aa086,0xbeb8442a,0xbed53641,0xbe827dc0,0xbea21887,0xbec1071e,0xbedf28a9,0xbe888e93,0xbea986c4,0xbec9b953,0xbee900b7,0xbe8e9a22,0xbeb0eacb,0xbed25a09,0xbef2bd43
.long 0xbe94a031,0xbeb8442a,0xbedae880,0xbefc5d27,0xbe9aa086,0xbebf926f,0xbee363fa,0xbf02ef9f,0xbea09ae5,0xbec6d529,0xbeebcbbb,0xbf07a136,0xbea68f12,0xbece0bea,0xbef41f07,0xbf0c42c9
.long 0xbeac7cd4,0xbed53641,0xbefc5d27,0xbf10d3cd,0xbeb263ef,0xbedc53c1,0xbf0242b1,0xbf1553b7,0xbeb8442a,0xbee363fa,0xbf064b82,0xbf19c200,0xbebe1d4a,0xbeea6681,0xbf0a48ad,0xbf1e1e22
.long 0x80000000,0x80000000,0x80000000,0x80000000,0xbcc90ab0,0xbce22a7a,0xbcfb49ba,0xbd0a342f,0xbd48fb30,0xbd621469,0xbd7b2b74,0xbd8a200a,0xbd96a905,0xbda973ba,0xbdbc3ac3,0xbdcefdb7
.long 0xbdc8bd36,0xbde1bc2e,0xbdfab273,0xbe09cf86,0xbdfab273,0xbe0cec4a,0xbe1c76de,0xbe2bf804,0xbe164083,0xbe28defc,0xbe3b6ecf,0xbe4dee60,0xbe2f10a2,0xbe44b0b9,0xbe5a3997,0xbe6fa8b2
.long 0xbe47c5c2,0xbe605c13,0xbe78cfcc,0xbe888e93,0xbe605c13,0xbe7bdba4,0xbe8b9507,0xbe9920fe,0xbe78cfcc,0xbe8b9507,0xbe9aa086,0xbea986c4,0xbe888e93,0xbe9920fe,0xbea986c4,0xbeb9bb1e
.long 0xbe94a031,0xbea68f12,0xbeb8442a,0xbec9b953,0xbea09ae5,0xbeb3dca5,0xbec6d529,0xbed97cb9,0xbeac7cd4,0xbec1071e,0xbed53641,0xbee900b7,0xbeb8442a,0xbece0bea,0xbee363fa,0xbef840c8
.long 0xbec3ef15,0xbedae880,0xbef15aea,0xbf039c3d,0xbecf7bca,0xbee79a5d,0xbeff17b2,0xbf0af1b7,0xbedae880,0xbef41f07,0xbf064b82,0xbf121eb0,0xbee63375,0xbf003a06,0xbf0cead0,0xbf19210f
.long 0xbef15aea,0xbf064b82,0xbf13682a,0xbf1ff6cb,0xbefc5d27,0xbf0c42c9,0xbf19c200,0xbf269de3,0xbf039c3d,0xbf121eb0,0xbf1ff6cb,0xbf2d1469,0xbf08f59b,0xbf17de12,0xbf26050a,0xbf33587a
.long 0xbf0e39da,0xbf1d7fd1,0xbf2beb4a,0xbf396842,0xbf13682a,0xbf2302d3,0xbf31a81d,0xbf3f41fc,0xbf187fc0,0xbf286605,0xbf373a23,0xbf44e3f5,0xbf1d7fd1,0xbf2da859,0xbf3ca003,0xbf4a4c87
.long 0xbf226799,0xbf32c8c9,0xbf41d870,0xbf4f7a1f,0xbf273656,0xbf37c655,0xbf46e22a,0xbf546b3b,0xbf2beb4a,0xbf3ca003,0xbf4bbbf8,0xbf591e6a,0xbf3085bb,0xbf4154e1,0xbf5064af,0xbf5d924d
.long 0x80000000,0x80000000,0x80000000,0x80000000,0xbd16c32c,0xbd2351cb,0xbd2fe007,0xbd3c6dd5,0xbd96a905,0xbda3308c,0xbdafb680,0xbdbc3ac3,0xbde1bc2e,0xbdf475c0,0xbe039502,0xbe0cec4a
.long 0xbe164083,0xbe22abb6,0xbe2f10a2,0xbe3b6ecf,0xbe3b6ecf,0xbe4ada4f,0xbe5a3997,0xbe698bba,0xbe605c13,0xbe72b651,0xbe827dc0,0xbe8b9507,0xbe827dc0,0xbe8d17c0,0xbe97a117,0xbea21887
.long 0xbe94a031,0xbea09ae5,0xbeac7cd4,0xbeb8442a,0xbea68f12,0xbeb3dca5,0xbec1071e,0xbece0bea,0xbeb8442a,0xbec6d529,0xbed53641,0xbee363fa,0xbec9b953,0xbed97cb9,0xbee900b7,0xbef840c8
.long 0xbedae880,0xbeebcbbb,0xbefc5d27,0xbf064b82,0xbeebcbbb,0xbefdbabb,0xbf07a136,0xbf102dd5,0xbefc5d27,0xbf07a136,0xbf10d3cd,0xbf19c200,0xbf064b82,0xbf102dd5,0xbf19c200,0xbf2302d3
.long 0xbf0e39da,0xbf187fc0,0xbf226799,0xbf2beb4a,0xbf15f6d9,0xbf209393,0xbf2ac082,0xbf34768f,0xbf1d7fd1,0xbf286605,0xbf32c8c9,0xbf3ca003,0xbf24d225,0xbf2ff3e6,0xbf3a7ca4,0xbf446337
.long 0xbf2beb4a,0xbf373a23,0xbf41d870,0xbf4bbbf8,0xbf32c8c9,0xbf3e35c5,0xbf48d8b3,0xbf52a649,0xbf396842,0xbf44e3f5,0xbf4f7a1f,0xbf591e6a,0xbf3fc767,0xbf4b41fa,0xbf55b993,0xbf5f20db
.long 0xbf45e403,0xbf514d3d,0xbf5b941a,0xbf64aa59,0xbf4bbbf8,0xbf570348,0xbf6106f2,0xbf69b7e4,0xbf514d3d,0xbf5c61c7,0xbf660f88,0xbf6e46be,0xbf5695e5,0xbf61668a,0xbf6aab7b,0xbf725470
.long 0xbf5b941a,0xbf660f88,0xbf6ed89e,0xbf75dec6,0xbf604621,0xbf6a5ad9,0xbf7294f8,0xbf78e3d6,0xbf64aa59,0xbf6e46be,0xbf75dec6,0xbf7b61fc,0xbf68bf3c,0xbf71d19f,0xbf78b47b,0xbf7d57de
.long 0x80000000,0x80000000,0x80000000,0x80000000,0xbd48fb30,0xbd55880e,0xbd621469,0xbd6ea038,0xbdc8bd36,0xbdd53db9,0xbde1bc2e,0xbdee3876,0xbe164083,0xbe1f917b,0xbe28defc,0xbe3228d4
.long 0xbe47c5c2,0xbe541501,0xbe605c13,0xbe6c9a7f,0xbe78cfcc,0xbe840270,0xbe8b9507,0xbe931f35,0xbe94a031,0xbe9d9e78,0xbea68f12,0xbeaf713a,0xbeac7cd4,0xbeb6ccc3,0xbec1071e,0xbecb2aae
.long 0xbec3ef15,0xbecf7bca,0xbedae880,0xbee63375,0xbedae880,0xbee79a5d,0xbef41f07,0xbf003a06,0xbef15aea,0xbeff17b2,0xbf064b82,0xbf0cead0,0xbf039c3d,0xbf0af1b7,0xbf121eb0,0xbf19210f
.long 0xbf0e39da,0xbf15f6d9,0xbf1d7fd1,0xbf24d225,0xbf187fc0,0xbf209393,0xbf286605,0xbf2ff3e6,0xbf226799,0xbf2ac082,0xbf32c8c9,0xbf3a7ca4,0xbf2beb4a,0xbf34768f,0xbf3ca003,0xbf446337
.long 0xbf3504f3,0xbf3daef9,0xbf45e403,0xbf4d9f02,0xbf3daef9,0xbf466354,0xbf4e8d90,0xbf5627fe,0xbf45e403,0xbf4e8d90,0xbf5695e5,0xbf5df6be,0xbf4d9f02,0xbf5627fe,0xbf5df6be,0xbf650479
.long 0xbf54db31,0xbf5d2d53,0xbf64aa59,0xbf6b4b0c,0xbf5b941a,0xbf6398ac,0xbf6aab7b,0xbf70c501,0xbf61c598,0xbf696591,0xbf6ff573,0xbf756d97,0xbf676bd8,0xbf6e8ff8,0xbf748422,0xbf7940c0
.long 0xbf6c835e,0xbf731447,0xbf7853f8,0xbf7c3b28,0xbf710908,0xbf76ef5b,0xbf7b61fc,0xbf7e5a38,0xbf74fa0b,0xbf7a1e84,0xbf7dabcc,0xbf7f9c18,0xbf7853f8,0xbf7c9f8a,0xbf7f2f9d,0xbf7fffb1
.long 0xbf7b14be,0xbf7e70b0,0xbf7fec43,0xbf7f84ab,0xbf7d3aac,0xbf7f90b1,0xbf7fe129,0xbf7e2b72,0xbf7ec46d,0xbf7ffec4,0xbf7f0e58,0xbf7bf531,0xbf7fb10f,0xbf7fba9e,0xbf7d7474,0xbf78e3d6
.long 0x80000000,0x80000000,0x80000000,0x80000000,0xbd7b2b74,0xbd83db0a,0xbd8a200a,0xbd9064b4,0xbdfab273,0xbe039502,0xbe09cf86,0xbe1008b7,0xbe3b6ecf,0xbe44b0b9,0xbe4dee60,0xbe57278f
.long 0xbe78cfcc,0xbe827dc0,0xbe888e93,0xbe8e9a22,0xbe9aa086,0xbea21887,0xbea986c4,0xbeb0eacb,0xbeb8442a,0xbec1071e,0xbec9b953,0xbed25a09,0xbed53641,0xbedf28a9,0xbee900b7,0xbef2bd43
.long 0xbef15aea,0xbefc5d27,0xbf039c3d,0xbf08f59b,0xbf064b82,0xbf0c42c9,0xbf121eb0,0xbf17de12,0xbf13682a,0xbf19c200,0xbf1ff6cb,0xbf26050a,0xbf1ff6cb,0xbf269de3,0xbf2d1469,0xbf33587a
.long 0xbf2beb4a,0xbf32c8c9,0xbf396842,0xbf3fc767,0xbf373a23,0xbf3e35c5,0xbf44e3f5,0xbf4b41fa,0xbf41d870,0xbf48d8b3,0xbf4f7a1f,0xbf55b993,0xbf4bbbf8,0xbf52a649,0xbf591e6a,0xbf5f20db
.long 0xbf54db31,0xbf5b941a,0xbf61c598,0xbf676bd8,0xbf5d2d53,0xbf6398ac,0xbf696591,0xbf6e8ff8,0xbf64aa59,0xbf6aab7b,0xbf6ff573,0xbf748422,0xbf6b4b0c,0xbf70c501,0xbf756d97,0xbf7940c0
.long 0xbf710908,0xbf75dec6,0xbf79c79d,0xbf7cbfc9,0xbf75dec6,0xbf79f35e,0xbf7cfe73,0xbf7efcc9,0xbf79c79d,0xbf7cfe73,0xbf7f0e58,0xbf7ff4e6,0xbf7cbfc9,0xbf7efcc9,0xbf7ff4e6,0xbf7fa6e3
.long 0xbf7ec46d,0xbf7fec43,0xbf7fb10f,0xbf7e1324,0xbf7fd397,0xbf7fcbe2,0xbf7e4323,0xbf7b3bab,0xbf7fec43,0xbf7e9bc9,0xbf7baccd,0xbf772417,0xbf7f0e58,0xbf7c5d3a,0xbf77f110,0xbf71d19f
.long 0xbf7d3aac,0xbf791298,0xbf731447,0xbf6b4b0c,0xbf7a7302,0xbf74bf62,0xbf6d1c1d,0xbf6398ac,0xbf76ba07,0xbf6f6830,0xbf660f88,0xbf5ac450,0xbf721352,0xbf6912ae,0xbf5df6be,0xbf50d937
.long 0x80000000,0x80000000,0x80000000,0x80000000,0xbd96a905,0xbd9cecf9,0xbda3308c,0xbda973ba,0xbe164083,0xbe1c76de,0xbe22abb6,0xbe28defc,0xbe605c13,0xbe698bba,0xbe72b651,0xbe7bdba4
.long 0xbe94a031,0xbe9aa086,0xbea09ae5,0xbea68f12,0xbeb8442a,0xbebf926f,0xbec6d529,0xbece0bea,0xbedae880,0xbee363fa,0xbeebcbbb,0xbef41f07,0xbefc5d27,0xbf02ef9f,0xbf07a136,0xbf0c42c9
.long 0xbf0e39da,0xbf13682a,0xbf187fc0,0xbf1d7fd1,0xbf1d7fd1,0xbf2302d3,0xbf286605,0xbf2da859,0xbf2beb4a,0xbf31a81d,0xbf373a23,0xbf3ca003,0xbf396842,0xbf3f41fc,0xbf44e3f5,0xbf4a4c87
.long 0xbf45e403,0xbf4bbbf8,0xbf514d3d,0xbf5695e5,0xbf514d3d,0xbf570348,0xbf5c61c7,0xbf61668a,0xbf5b941a,0xbf6106f2,0xbf660f88,0xbf6aab7b,0xbf64aa59,0xbf69b7e4,0xbf6e46be,0xbf725470
.long 0xbf6c835e,0xbf710908,0xbf74fa0b,0xbf7853f8,0xbf731447,0xbf76ef5b,0xbf7a1e84,0xbf7c9f8a,0xbf7853f8,0xbf7b61fc,0xbf7dabcc,0xbf7f2f9d,0xbf7c3b28,0xbf7e5a38,0xbf7f9c18,0xbf7fffb1
.long 0xbf7ec46d,0xbf7fd397,0xbf7fec43,0xbf7f0e58,0xbf7fec43,0xbf7fcbe2,0xbf7e9bc9,0xbf7c5d3a,0xbf7fb10f,0xbf7e4323,0xbf7baccd,0xbf77f110,0xbf7e1324,0xbf7b3bab,0xbf772417,0xbf71d19f
.long 0xbf7b14be,0xbf76ba07,0xbf710908,0xbf6a09a7,0xbf76ba07,0xbf70c501,0xbf696591,0xbf60a6cf,0xbf710908,0xbf696591,0xbf604621,0xbf55b993,0xbf6a09a7,0xbf60a6cf,0xbf55b993,0xbf495521
.long 0xbf61c598,0xbf5695e5,0xbf49d112,0xbf3b8f3b,0xbf584853,0xbf4b41fa,0xbf3ca003,0xbf2c800f,0xbf4d9f02,0xbf3ebc1b,0xbf2e3bde,0xbf1c420c,0xbf41d870,0xbf311722,0xbf1ebc12,0xbf0af1b7
.long 0x80000000,0x80000000,0x80000000,0x80000000,0xbdafb680,0xbdb5f8da,0xbdbc3ac3,0xbdc27c39,0xbe2f10a2,0xbe354098,0xbe3b6ecf,0xbe419b37,0xbe827dc0,0xbe870ada,0xbe8b9507,0xbe901c2c
.long 0xbeac7cd4,0xbeb263ef,0xbeb8442a,0xbebe1d4a,0xbed53641,0xbedc53c1,0xbee363fa,0xbeea6681,0xbefc5d27,0xbf0242b1,0xbf064b82,0xbf0a48ad,0xbf10d3cd,0xbf1553b7,0xbf19c200,0xbf1e1e22
.long 0xbf226799,0xbf273656,0xbf2beb4a,0xbf3085bb,0xbf32c8c9,0xbf37c655,0xbf3ca003,0xbf4154e1,0xbf41d870,0xbf46e22a,0xbf4bbbf8,0xbf5064af,0xbf4f7a1f,0xbf546b3b,0xbf591e6a,0xbf5d924d
.long 0xbf5b941a,0xbf604621,0xbf64aa59,0xbf68bf3c,0xbf660f88,0xbf6a5ad9,0xbf6e46be,0xbf71d19f,0xbf6ed89e,0xbf7294f8,0xbf75dec6,0xbf78b47b,0xbf75dec6,0xbf78e3d6,0xbf7b61fc,0xbf7d57de
.long 0xbf7b14be,0xbf7d3aac,0xbf7ec46d,0xbf7fb10f,0xbf7e70b0,0xbf7f90b1,0xbf7ffec4,0xbf7fba9e,0xbf7fec43,0xbf7fe129,0xbf7f0e58,0xbf7d7474,0xbf7f84ab,0xbf7e2b72,0xbf7bf531,0xbf78e3d6
.long 0xbf7d3aac,0xbf7a7302,0xbf76ba07,0xbf721352,0xbf791298,0xbf74bf62,0xbf6f6830,0xbf6912ae,0xbf731447,0xbf6d1c1d,0xbf660f88,0xbf5df6be,0xbf6b4b0c,0xbf6398ac,0xbf5ac450,0xbf50d937
.long 0xbf61c598,0xbf584853,0xbf4d9f02,0xbf41d870,0xbf5695e5,0xbf4b41fa,0xbf3ebc1b,0xbf311722,0xbf49d112,0xbf3ca003,0xbf2e3bde,0xbf1ebc12,0xbf3b8f3b,0xbf2c800f,0xbf1c420c,0xbf0af1b7
.long 0xbf2beb4a,0xbf1b02c6,0xbf08f59b,0xbeebcbbb,0xbf1b02c6,0xbf084b92,0xbee900b7,0xbebf926f,0xbf08f59b,0xbee900b7,0xbebe1d4a,0xbe919ddd,0xbeebcbbb,0xbebf926f,0xbe919ddd,0xbe44b0b9
.long 0x3f800000,0x3f800000,0x3f800000,0x3f800000,0x3f7ec46d,0x3f7eb069,0x3f7e9bc9,0x3f7e868b,0x3f7b14be,0x3f7ac516,0x3f7a7302,0x3f7a1e84,0x3f74fa0b,0x3f74484b,0x3f73913f,0x3f72d4eb
.long 0x3f6c835e,0x3f6b4b0c,0x3f6a09a7,0x3f68bf3c,0x3f61c598,0x3f5fe4e9,0x3f5df6be,0x3f5bfb34,0x3f54db31,0x3f5233c6,0x3f4f7a1f,0x3f4cae79,0x3f45e403,0x3f425b89,0x3f3ebc1b,0x3f3b0629
.long 0x3f3504f3,0x3f3085bb,0x3f2beb4a,0x3f273656,0x3f226799,0x3f1ce11f,0x3f173c07,0x3f11796b,0x3f0e39da,0x3f07a136,0x3f00e7e4,0x3ef41f07,0x3ef15aea,0x3ee1fb6a,0x3ed25a09,0x3ec27b55
.long 0x3ec3ef15,0x3eb263ef,0x3ea09ae5,0x3e8e9a22,0x3e94a031,0x3e80f8c0,0x3e5a3997,0x3e3228d4,0x3e47c5c2,0x3e1c76de,0x3de1bc2e,0x3d8a200a,0x3dc8bd36,0x3d55880e,0x3bc90f88,0xbd2351cb
.long 0x248d3132,0xbd48fb30,0xbdc8bd36,0xbe164083,0xbdc8bd36,0xbe195be0,0xbe4dee60,0xbe80f8c0,0xbe47c5c2,0xbe7ee6e1,0xbe9aa086,0xbeb554ec,0xbe94a031,0xbeb0eacb,0xbecc9b8b,0xbee79a5d
.long 0xbec3ef15,0xbee0924f,0xbefc5d27,0xbf0b9a6b,0xbef15aea,0xbf06f686,0xbf14b039,0xbf21cbfb,0xbf0e39da,0xbf1c420c,0xbf299415,0xbf36206c,0xbf226799,0xbf2ff3e6,0xbf3ca003,0xbf485bca
.long 0xbf3504f3,0xbf41d870,0xbf4d9f02,0xbf584853,0xbf45e403,0xbf51c0c2,0xbf5c61c7,0xbf65b710,0xbf54db31,0xbf5f8327,0xbf68bf3c,0xbf708066,0xbf61c598,0xbf6afb8c,0xbf7294f8,0xbf788486
.long 0xbf6c835e,0xbf740bdd,0xbf79c79d,0xbf7dabcc,0xbf74fa0b,0xbf7a9c59,0xbf7e4323,0xbf7fe705,0xbf7b14be,0xbf7e9bc9,0xbf7ffb11,0xbf7f2f9d,0xbf7ec46d,0xbf7fffb1,0xbf7eea9d,0xbf7b87b2
.long 0x3f800000,0x3f800000,0x3f800000,0x3f800000,0x3f7e70b0,0x3f7e5a38,0x3f7e4323,0x3f7e2b72,0x3f79c79d,0x3f796e4e,0x3f791298,0x3f78b47b,0x3f721352,0x3f714c7a,0x3f708066,0x3f6faf1b
.long 0x3f676bd8,0x3f660f88,0x3f64aa59,0x3f633c5a,0x3f59f26a,0x3f57dc7f,0x3f55b993,0x3f5389c7,0x3f49d112,0x3f46e22a,0x3f43e200,0x3f40d0da,0x3f373a23,0x3f33587a,0x3f2f61a5,0x3f2b561b
.long 0x3f226799,0x3f1d7fd1,0x3f187fc0,0x3f13682a,0x3f0b9a6b,0x3f05a02c,0x3eff17b2,0x3ef2bd43,0x3ee63375,0x3ed8106b,0x3ec9b953,0x3ebb31a0,0x3eb263ef,0x3ea21887,0x3e919ddd,0x3e80f8c0
.long 0x3e78cfcc,0x3e541501,0x3e2f10a2,0x3e09cf86,0x3e09cf86,0x3dc27c39,0x3d621469,0x3c7b514b,0x3cc90ab0,0xbc96c9b6,0xbd7b2b74,0xbdd53db9,0xbdafb680,0xbe06b26e,0xbe354098,0xbe636c83
.long 0xbe47c5c2,0xbe78cfcc,0xbe94a031,0xbeac7cd4,0xbe9aa086,0xbeb3dca5,0xbecc9b8b,0xbee4cbfe,0xbecf7bca,0xbee900b7,0xbf00e7e4,0xbf0cead0,0xbf00e7e4,0xbf0d9281,0xbf19c200,0xbf256bcb
.long 0xbf187fc0,0xbf24d225,0xbf3085bb,0xbf3b8f3b,0xbf2e3bde,0xbf39f2ac,0xbf44e3f5,0xbf4f0417,0xbf41d870,0xbf4cae79,0xbf5695e5,0xbf5f8327,0xbf531849,0xbf5cc7d1,0xbf655e0b,0xbf6cd007
.long 0xbf61c598,0xbf6a09a7,0xbf710908,0xbf76ba07,0xbf6db293,0xbf74484b,0xbf796e4e,0xbf7d1cdd,0xbf76ba07,0xbf7b61fc,0xbf7e70b0,0xbf7fe129,0xbf7cbfc9,0xbf7f3f54,0xbf7ffec4,0xbf7efcc9
.long 0xbf7fb10f,0xbf7fd397,0xbf7e1324,0xbf7a7302,0xbf7f84ab,0xbf7d1cdd,0xbf78b47b,0xbf725470,0xbf7c3b28,0xbf772417,0xbf6ff573,0xbf66becc,0xbf75dec6,0xbf6dfcf2,0xbf63f473,0xbf57dc7f
.long 0x3f800000,0x3f800000,0x3f800000,0x3f800000,0x3f7e1324,0x3f7dfa38,0x3f7de0b1,0x3f7dc68c,0x3f7853f8,0x3f77f110,0x3f778bc5,0x3f772417,0x3f6ed89e,0x3f6dfcf2,0x3f6d1c1d,0x3f6c3624
.long 0x3f61c598,0x3f604621,0x3f5ebe05,0x3f5d2d53,0x3f514d3d,0x3f4f0417,0x3f4cae79,0x3f4a4c87,0x3f3daef9,0x3f3a7ca4,0x3f373a23,0x3f33e7bc,0x3f273656,0x3f2302d3,0x3f1ebc12,0x3f1a6293
.long 0x3f0e39da,0x3f08f59b,0x3f039c3d,0x3efc5d27,0x3ee63375,0x3ed97cb9,0x3ecc9b8b,0x3ebf926f,0x3eac7cd4,0x3e9d9e78,0x3e8e9a22,0x3e7ee6e1,0x3e605c13,0x3e3e853e,0x3e1c76de,0x3df475c0
.long 0x3dc8bd36,0x3d7b2b74,0x3cc90ab0,0xbc490e90,0xbcc90ab0,0xbd83db0a,0xbdd53db9,0xbe1324ca,0xbe164083,0xbe419b37,0xbe6c9a7f,0xbe8b9507,0xbe888e93,0xbe9f1cdf,0xbeb554ec,0xbecb2aae
.long 0xbec3ef15,0xbedae880,0xbef15aea,0xbf039c3d,0xbefc5d27,0xbf099f4e,0xbf14b039,0xbf1f599f,0xbf187fc0,0xbf239da9,0xbf2e3bde,0xbf385216,0xbf3085bb,0xbf3b0629,0xbf44e3f5,0xbf4e1689
.long 0xbf45e403,0xbf4f7a1f,0xbf584853,0xbf604621,0xbf584853,0xbf60a6cf,0xbf6816a8,0xbf6e8ff8,0xbf676bd8,0xbf6e46be,0xbf740bdd,0xbf78b47b,0xbf731447,0xbf7822d1,0xbf7bf531,0xbf7e868b
.long 0xbf7b14be,0xbf7e1324,0xbf7fb10f,0xbf7fec43,0xbf7f4e6d,0xbf7fffb1,0xbf7f2f9d,0xbf7cdf6c,0xbf7fb10f,0xbf7de0b1,0xbf7a7302,0xbf756d97,0xbf7c3b28,0xbf77beb7,0xbf718f57,0xbf69b7e4
.long 0xbf74fa0b,0xbf6db293,0xbf64aa59,0xbf59f26a,0xbf6a09a7,0xbf5fe4e9,0xbf53fac3,0xbf466354,0xbf5b941a,0xbf4e8d90,0xbf3fc767,0xbf2f61a5,0xbf49d112,0xbf39f2ac,0xbf286605,0xbf1553b7
.long 0x3f800000,0x3f800000,0x3f800000,0x3f800000,0x3f7dabcc,0x3f7d906e,0x3f7d7474,0x3f7d57de,0x3f76ba07,0x3f764d97,0x3f75dec6,0x3f756d97,0x3f6b4b0c,0x3f6a5ad9,0x3f696591,0x3f686b39
.long 0x3f5b941a,0x3f59f26a,0x3f584853,0x3f5695e5,0x3f47de65,0x3f456439,0x3f42de29,0x3f404c5c,0x3f3085bb,0x3f2d1469,0x3f299415,0x3f26050a,0x3f15f6d9,0x3f11796b,0x3f0cead0,0x3f084b92
.long 0x3ef15aea,0x3ee63375,0x3edae880,0x3ecf7bca,0x3eb263ef,0x3ea5129f,0x3e97a117,0x3e8a11f7,0x3e605c13,0x3e419b37,0x3e22abb6,0x3e039502,0x3dafb680,0x3d55880e,0x3c96c9b6,0xbc7b514b
.long 0xbd48fb30,0xbdafb680,0xbdfab273,0xbe22abb6,0xbe3b6ecf,0xbe636c83,0xbe8586ce,0xbe9920fe,0xbea09ae5,0xbeb554ec,0xbec9b953,0xbeddbe79,0xbee0924f,0xbef58035,0xbf04f484,0xbf0ee0db
.long 0xbf0e39da,0xbf187fc0,0xbf226799,0xbf2beb4a,0xbf299415,0xbf33587a,0xbf3ca003,0xbf456439,0xbf41d870,0xbf4ac77f,0xbf531849,0xbf5ac450,0xbf5695e5,0xbf5e5aa6,0xbf655e0b,0xbf6b99fb
.long 0xbf676bd8,0xbf6db293,0xbf731447,0xbf778bc5,0xbf740bdd,0xbf788486,0xbf7bf531,0xbf7e5a38,0xbf7c3b28,0xbf7e9bc9,0xbf7fd397,0xbf7fe129,0xbf7fd397,0xbf7fdaaf,0xbf7e9bc9,0xbf7c187a
.long 0xbf7ec46d,0xbf7c3b28,0xbf7853f8,0xbf731447,0xbf791298,0xbf73ced9,0xbf6d1c1d,0xbf650479,0xbf6ed89e,0xbf66becc,0xbf5d2d53,0xbf5233c6,0xbf604621,0xbf554aa4,0xbf48d8b3,0xbf3b0629
.long 0xbf4d9f02,0xbf3fc767,0xbf3085bb,0xbf1ff6cb,0xbf373a23,0xbf269de3,0xbf14b039,0xbf019573,0xbf1d7fd1,0xbf0a48ad,0xbeebcbbb,0xbec1071e,0xbf00e7e4,0xbed6a399,0xbea986c4,0xbe75c35a
.long 0x3f800000,0x3f800000,0x3f800000,0x3f800000,0x3f7d3aac,0x3f7d1cdd,0x3f7cfe73,0x3f7cdf6c,0x3f74fa0b,0x3f748422,0x3f740bdd,0x3f73913f,0x3f676bd8,0x3f666771,0x3f655e0b,0x3f644fac
.long 0x3f54db31,0x3f531849,0x3f514d3d,0x3f4f7a1f,0x3f3daef9,0x3f3b0629,0x3f385216,0x3f3592e7,0x3f226799,0x3f1ebc12,0x3f1b02c6,0x3f173c07,0x3f039c3d,0x3efdbabb,0x3ef41f07,0x3eea6681
.long 0x3ec3ef15,0x3eb8442a,0x3eac7cd4,0x3ea09ae5,0x3e78cfcc,0x3e5d4b1a,0x3e419b37,0x3e25c58c,0x3dc8bd36,0x3d8a200a,0x3d16c32c,0x3bc90f88,0xbd48fb30,0xbda973ba,0xbdee3876,0xbe195be0
.long 0xbe47c5c2,0xbe6c9a7f,0xbe888e93,0xbe9aa086,0xbeac7cd4,0xbebf926f,0xbed25a09,0xbee4cbfe,0xbef15aea,0xbf0242b1,0xbf0b9a6b,0xbf14b039,0xbf187fc0,0xbf21cbfb,0xbf2ac082,0xbf33587a
.long 0xbf3504f3,0xbf3daef9,0xbf45e403,0xbf4d9f02,0xbf4d9f02,0xbf554aa4,0xbf5c61c7,0xbf62df7b,0xbf61c598,0xbf6816a8,0xbf6db293,0xbf7294f8,0xbf710908,0xbf75a67b,0xbf796e4e,0xbf7c5d3a
.long 0xbf7b14be,0xbf7dabcc,0xbf7f4e6d,0xbf7ffb11,0xbf7fb10f,0xbf7ff84a,0xbf7f2f9d,0xbf7d57de,0xbf7ec46d,0xbf7c7eb0,0xbf791298,0xbf748422,0xbf7853f8,0xbf73530e,0xbf6d1c1d,0xbf65b710
.long 0xbf6c835e,0xbf64aa59,0xbf5b941a,0xbf514d3d,0xbf5b941a,0xbf50d937,0xbf44e3f5,0xbf37c655,0xbf45e403,0xbf385216,0xbf299415,0xbf19c200,0xbf2beb4a,0xbf1ba299,0xbf0a48ad,0xbeeff7fb
.long 0xbf0e39da,0xbef6e0cb,0xbecf7bca,0xbea68f12,0xbedae880,0xbeb0eacb,0xbe8586ce,0xbe3228d4,0xbe94a031,0xbe4dee60,0xbde1bc2e,0xbc96c9b6,0xbe164083,0xbd55880e,0x3d2fe007,0x3e0cec4a
.long 0x3f800000,0x3f800000,0x3f800000,0x3f800000,0x3f7cbfc9,0x3f7c9f8a,0x3f7c7eb0,0x3f7c5d3a,0x3f731447,0x3f7294f8,0x3f721352,0x3f718f57,0x3f633c5a,0x3f62241a,0x3f6106f2,0x3f5fe4e9
.long 0x3f4d9f02,0x3f4bbbf8,0x3f49d112,0x3f47de65,0x3f32c8c9,0x3f2ff3e6,0x3f2d1469,0x3f2a2a80,0x3f13682a,0x3f0f8784,0x3f0b9a6b,0x3f07a136,0x3ee0924f,0x3ed6a399,0x3ecc9b8b,0x3ec27b55
.long 0x3e94a031,0x3e888e93,0x3e78cfcc,0x3e605c13,0x3e09cf86,0x3ddb7d37,0x3da3308c,0x3d55880e,0xbcc90ab0,0xbd621469,0xbdafb680,0xbdee3876,0xbe3b6ecf,0xbe5d4b1a,0xbe7ee6e1,0xbe901c2c
.long 0xbeac7cd4,0xbebe1d4a,0xbecf7bca,0xbee0924f,0xbef6e0cb,0xbf044889,0xbf0cead0,0xbf1553b7,0xbf1d7fd1,0xbf26050a,0xbf2e3bde,0xbf36206c,0xbf3b8f3b,0xbf436051,0xbf4ac77f,0xbf51c0c2
.long 0xbf54db31,0xbf5b941a,0xbf61c598,0xbf676bd8,0xbf68bf3c,0xbf6dfcf2,0xbf7294f8,0xbf76841b,0xbf76ba07,0xbf7a1e84,0xbf7cbfc9,0xbf7e9bc9,0xbf7e70b0,0xbf7fa6e3,0xbf7ffec4,0xbf7f7808
.long 0xbf7fb10f,0xbf7e70b0,0xbf7c3b28,0xbf791298,0xbf7a7302,0xbf76841b,0xbf718f57,0xbf6b99fb,0xbf6ed89e,0xbf6816a8,0xbf604621,0xbf577026,0xbf5d2d53,0xbf5389c7,0xbf48d8b3,0xbf3d27b8
.long 0xbf45e403,0xbf396842,0xbf2beb4a,0xbf1d7fd1,0xbf299415,0xbf1a6293,0xbf0a48ad,0xbef2bd43,0xbf08f59b,0xbeee9479,0xbec9b953,0xbea395c5,0xbec9b953,0xbea21887,0xbe72b651,0xbe1f917b
.long 0xbe78cfcc,0xbe22abb6,0xbd96a905,0x3c490e90,0xbdafb680,0x3b490fc6,0x3dbc3ac3,0x3e3857ec,0x3d96a905,0x3e28defc,0x3e827dc0,0x3eaf713a,0x3e6c9a7f,0x3ea5129f,0x3ed25a09,0x3efdbabb
.long 0x3f800000,0x3f800000,0x3f800000,0x3f800000,0x3f7c3b28,0x3f7c187a,0x3f7bf531,0x3f7bd14d,0x3f710908,0x3f708066,0x3f6ff573,0x3f6f6830,0x3f5ebe05,0x3f5d924d,0x3f5c61c7,0x3f5b2c79
.long 0x3f45e403,0x3f43e200,0x3f41d870,0x3f3fc767,0x3f273656,0x3f24381a,0x3f212ff9,0x3f1e1e22,0x3f039c3d,0x3eff17b2,0x3ef6e0cb,0x3eee9479,0x3eb8442a,0x3eadf73c,0x3ea395c5,0x3e9920fe
.long 0x3e47c5c2,0x3e2f10a2,0x3e164083,0x3dfab273,0x3cc90ab0,0xbb490fc6,0xbcfb49ba,0xbd6ea038,0xbe164083,0xbe354098,0xbe541501,0xbe72b651,0xbea09ae5,0xbeb0eacb,0xbec1071e,0xbed0eb2a
.long 0xbef15aea,0xbf00e7e4,0xbf08f59b,0xbf10d3cd,0xbf1d7fd1,0xbf256bcb,0xbf2d1469,0xbf34768f,0xbf3daef9,0xbf44e3f5,0xbf4bbbf8,0xbf5233c6,0xbf584853,0xbf5e5aa6,0xbf63f473,0xbf6912ae
.long 0xbf6c835e,0xbf710908,0xbf74fa0b,0xbf7853f8,0xbf79c79d,0xbf7c5d3a,0xbf7e4323,0xbf7f7808,0xbf7fb10f,0xbf7ffec4,0xbf7f84ab,0xbf7e4323,0xbf7e1324,0xbf7bd14d,0xbf78b47b,0xbf74bf62
.long 0xbf74fa0b,0xbf6ff573,0xbf6a09a7,0xbf633c5a,0xbf64aa59,0xbf5cc7d1,0xbf53fac3,0xbf4a4c87,0xbf4d9f02,0xbf42de29,0xbf373a23,0xbf2ac082,0xbf3085bb,0xbf2302d3,0xbf14b039,0xbf05a02c
.long 0xbf0e39da,0xbefc5d27,0xbedae880,0xbeb8442a,0xbecf7bca,0xbeab0201,0xbe8586ce,0xbe3e853e,0xbe78cfcc,0xbe28defc,0xbdafb680,0xbbc90f88,0xbd96a905,0x3c16cb58,0x3dbc3ac3,0x3e3228d4
.long 0x3dc8bd36,0x3e3b6ecf,0x3e888e93,0x3eb263ef,0x3e888e93,0x3eb3dca5,0x3eddbe79,0x3f02ef9f,0x3edae880,0x3f0242b1,0x3f15f6d9,0x3f286605,0x3f13682a,0x3f269de3,0x3f385216,0x3f485bca
.long 0x3f800000,0x3f800000,0x3f800000,0x3f800000,0x3f7baccd,0x3f7b87b2,0x3f7b61fc,0x3f7b3bab,0x3f6ed89e,0x3f6e46be,0x3f6db293,0x3f6d1c1d,0x3f59f26a,0x3f58b3a1,0x3f577026,0x3f5627fe
.long 0x3f3daef9,0x3f3b8f3b,0x3f396842,0x3f373a23,0x3f1b02c6,0x3f17de12,0x3f14b039,0x3f11796b,0x3ee63375,0x3eddbe79,0x3ed53641,0x3ecc9b8b,0x3e8e9a22,0x3e840270,0x3e72b651,0x3e5d4b1a
.long 0x3dc8bd36,0x3d96a905,0x3d48fb30,0x3cc90ab0,0xbdafb680,0xbde7fa9a,0xbe1008b7,0xbe2bf804,0xbe888e93,0xbe97a117,0xbea68f12,0xbeb554ec,0xbee0924f,0xbeeff7fb,0xbeff17b2,0xbf06f686
.long 0xbf187fc0,0xbf1ff6cb,0xbf273656,0xbf2e3bde,0xbf3b8f3b,0xbf425b89,0xbf48d8b3,0xbf4f0417,0xbf584853,0xbf5df6be,0xbf633c5a,0xbf6816a8,0xbf6db293,0xbf71d19f,0xbf756d97,0xbf788486
.long 0xbf7b14be,0xbf7d3aac,0xbf7ec46d,0xbf7fb10f,0xbf7ffb11,0xbf7fcbe2,0xbf7eea9d,0xbf7d57de,0xbf7c3b28,0xbf796e4e,0xbf75dec6,0xbf718f57,0xbf6ff573,0xbf6a5ad9,0xbf63f473,0xbf5cc7d1
.long 0xbf5b941a,0xbf531849,0xbf49d112,0xbf3fc767,0xbf3fc767,0xbf34768f,0xbf286605,0xbf1ba299,0xbf1d7fd1,0xbf0f8784,0xbf00e7e4,0xbee363fa,0xbeebcbbb,0xbecb2aae,0xbea986c4,0xbe870ada
.long 0xbe94a031,0xbe605c13,0xbe164083,0xbd96a905,0xbde1bc2e,0xbd0a342f,0x3d2fe007,0x3df475c0,0x3d96a905,0x3e1c76de,0x3e6c9a7f,0x3e9d9e78,0x3e827dc0,0x3eab0201,0x3ed25a09,0x3ef840c8
.long 0x3edae880,0x3f00e7e4,0x3f13682a,0x3f24d225,0x3f15f6d9,0x3f27ce61,0x3f385216,0x3f476085,0x3f396842,0x3f48d8b3,0x3f5695e5,0x3f628210,0x3f5695e5,0x3f62df7b,0x3f6d1c1d,0x3f75341d
.long 0x80000000,0x80000000,0x80000000,0x80000000,0xbdc8bd36,0xbdcefdb7,0xbdd53db9,0xbddb7d37,0xbe47c5c2,0xbe4dee60,0xbe541501,0xbe5a3997,0xbe94a031,0xbe9920fe,0xbe9d9e78,0xbea21887
.long 0xbec3ef15,0xbec9b953,0xbecf7bca,0xbed53641,0xbef15aea,0xbef840c8,0xbeff17b2,0xbf02ef9f,0xbf0e39da,0xbf121eb0,0xbf15f6d9,0xbf19c200,0xbf226799,0xbf269de3,0xbf2ac082,0xbf2ecef7
.long 0xbf3504f3,0xbf396842,0xbf3daef9,0xbf41d870,0xbf45e403,0xbf4a4c87,0xbf4e8d90,0xbf52a649,0xbf54db31,0xbf591e6a,0xbf5d2d53,0xbf6106f2,0xbf61c598,0xbf65b710,0xbf696591,0xbf6cd007
.long 0xbf6c835e,0xbf6ff573,0xbf731447,0xbf75dec6,0xbf74fa0b,0xbf77beb7,0xbf7a1e84,0xbf7c187a,0xbf7b14be,0xbf7cfe73,0xbf7e70b0,0xbf7f6ac7,0xbf7ec46d,0xbf7fa6e3,0xbf7ffec4,0xbf7fcbe2
.long 0xbf800000,0xbf7fb10f,0xbf7ec46d,0xbf7d3aac,0xbf7ec46d,0xbf7d1cdd,0xbf7ac516,0xbf77beb7,0xbf7b14be,0xbf77f110,0xbf740bdd,0xbf6f6830,0xbf74fa0b,0xbf703b37,0xbf6aab7b,0xbf644fac
.long 0xbf6c835e,0xbf660f88,0xbf5ebe05,0xbf5695e5,0xbf61c598,0xbf5988ad,0xbf5064af,0xbf466354,0xbf54db31,0xbf4ac77f,0xbf3fc767,0xbf33e7bc,0xbf45e403,0xbf39f2ac,0xbf2d1469,0xbf1f599f
.long 0xbf3504f3,0xbf273656,0xbf187fc0,0xbf08f59b,0xbf226799,0xbf12c39a,0xbf0242b1,0xbee1fb6a,0xbf0e39da,0xbef9a02d,0xbed53641,0xbeaf713a,0xbef15aea,0xbecb2aae,0xbea395c5,0xbe75c35a
.long 0xbec3ef15,0xbe9aa086,0xbe605c13,0xbe09cf86,0xbe94a031,0xbe5101f1,0xbdee3876,0xbce22a7a,0xbe47c5c2,0xbdd53db9,0xbc490e90,0x3da3308c,0xbdc8bd36,0xbb490fc6,0x3dbc3ac3,0x3e3e853e
.long 0x80000000,0x80000000,0x80000000,0x80000000,0xbde1bc2e,0xbde7fa9a,0xbdee3876,0xbdf475c0,0xbe605c13,0xbe667c66,0xbe6c9a7f,0xbe72b651,0xbea68f12,0xbeab0201,0xbeaf713a,0xbeb3dca5
.long 0xbedae880,0xbee0924f,0xbee63375,0xbeebcbbb,0xbf064b82,0xbf099f4e,0xbf0cead0,0xbf102dd5,0xbf1d7fd1,0xbf212ff9,0xbf24d225,0xbf286605,0xbf32c8c9,0xbf36ad7f,0xbf3a7ca4,0xbf3e35c5
.long 0xbf45e403,0xbf49d112,0xbf4d9f02,0xbf514d3d,0xbf5695e5,0xbf5a5ba0,0xbf5df6be,0xbf61668a,0xbf64aa59,0xbf6816a8,0xbf6b4b0c,0xbf6e46be,0xbf6ff573,0xbf72d4eb,0xbf756d97,0xbf77beb7
.long 0xbf7853f8,0xbf7a7302,0xbf7c3b28,0xbf7dabcc,0xbf7dabcc,0xbf7ed7d4,0xbf7f9c18,0xbf7ff84a,0xbf7fec43,0xbf7ff4e6,0xbf7f84ab,0xbf7e9bc9,0xbf7f0e58,0xbf7dc68c,0xbf7bf531,0xbf799b43
.long 0xbf7b14be,0xbf7853f8,0xbf74fa0b,0xbf710908,0xbf740bdd,0xbf6faf1b,0xbf6aab7b,0xbf650479,0xbf6a09a7,0xbf63f473,0xbf5d2d53,0xbf55b993,0xbf5d2d53,0xbf554aa4,0xbf4cae79,0xbf436051
.long 0xbf4d9f02,0xbf43e200,0xbf396842,0xbf2e3bde,0xbf3b8f3b,0xbf2ff3e6,0xbf239da9,0xbf16999f,0xbf273656,0xbf19c200,0xbf0b9a6b,0xbef9a02d,0xbf10d3cd,0xbf019573,0xbee363fa,0xbec27b55
.long 0xbef15aea,0xbecf7bca,0xbeac7cd4,0xbe888e93,0xbebe1d4a,0xbe9920fe,0xbe667c66,0xbe195be0,0xbe888e93,0xbe419b37,0xbde1bc2e,0xbcfb49ba,0xbe22abb6,0xbd9cecf9,0x3bc90f88,0x3db5f8da
.long 0xbd48fb30,0x3d16c32c,0x3dfab273,0x3e541501,0x3d7b2b74,0x3e195be0,0x3e72b651,0x3ea5129f,0x3e2f10a2,0x3e8586ce,0x3eb263ef,0x3eddbe79,0x3e8e9a22,0x3ebca7af,0x3ee900b7,0x3f099f4e
.long 0x80000000,0x80000000,0x80000000,0x80000000,0xbdfab273,0xbe007745,0xbe039502,0xbe06b26e,0xbe78cfcc,0xbe7ee6e1,0xbe827dc0,0xbe8586ce,0xbeb8442a,0xbebca7af,0xbec1071e,0xbec5625c
.long 0xbef15aea,0xbef6e0cb,0xbefc5d27,0xbf00e7e4,0xbf13682a,0xbf16999f,0xbf19c200,0xbf1ce11f,0xbf2beb4a,0xbf2f61a5,0xbf32c8c9,0xbf36206c,0xbf41d870,0xbf456439,0xbf48d8b3,0xbf4c3578
.long 0xbf54db31,0xbf584853,0xbf5b941a,0xbf5ebe05,0xbf64aa59,0xbf67c187,0xbf6aab7b,0xbf6d67a1,0xbf710908,0xbf73913f,0xbf75dec6,0xbf77f110,0xbf79c79d,0xbf7b87b2,0xbf7cfe73,0xbf7e2b72
.long 0xbf7ec46d,0xbf7f84ab,0xbf7fec43,0xbf7ffb11,0xbf7fec43,0xbf7f7808,0xbf7e9bc9,0xbf7d57de,0xbf7d3aac,0xbf7b61fc,0xbf791298,0xbf764d97,0xbf76ba07,0xbf73530e,0xbf6f6830,0xbf6afb8c
.long 0xbf6c835e,0xbf676bd8,0xbf61c598,0xbf5b941a,0xbf5ebe05,0xbf57dc7f,0xbf5064af,0xbf485bca,0xbf4d9f02,0xbf44e3f5,0xbf3b8f3b,0xbf31a81d,0xbf396842,0xbf2ecef7,0xbf239da9,0xbf17de12
.long 0xbf226799,0xbf15f6d9,0xbf08f59b,0xbef6e0cb,0xbf08f59b,0xbef58035,0xbed8106b,0xbeb9bb1e,0xbedae880,0xbebb31a0,0xbe9aa086,0xbe72b651,0xbea09ae5,0xbe7bdba4,0xbe354098,0xbddb7d37
.long 0xbe47c5c2,0xbdfab273,0xbd48fb30,0x3cc90ab0,0xbd96a905,0x3b490fc6,0x3da3308c,0x3e1f917b,0x3d48fb30,0x3e039502,0x3e541501,0x3e919ddd,0x3e2f10a2,0x3e80f8c0,0x3ea986c4,0x3ed0eb2a
.long 0x3e94a031,0x3ebe1d4a,0x3ee63375,0x3f064b82,0x3ecf7bca,0x3ef840c8,0x3f0f8784,0x3f21cbfb,0x3f039c3d,0x3f173c07,0x3f299415,0x3f3a7ca4,0x3f1d7fd1,0x3f2ff3e6,0x3f40d0da,0x3f4fefa8
.long 0x80000000,0x80000000,0x80000000,0x80000000,0xbe09cf86,0xbe0cec4a,0xbe1008b7,0xbe1324ca,0xbe888e93,0xbe8b9507,0xbe8e9a22,0xbe919ddd,0xbec9b953,0xbece0bea,0xbed25a09,0xbed6a399
.long 0xbf039c3d,0xbf064b82,0xbf08f59b,0xbf0b9a6b,0xbf1ff6cb,0xbf2302d3,0xbf26050a,0xbf28fd41,0xbf396842,0xbf3ca003,0xbf3fc767,0xbf42de29,0xbf4f7a1f,0xbf52a649,0xbf55b993,0xbf58b3a1
.long 0xbf61c598,0xbf64aa59,0xbf676bd8,0xbf6a09a7,0xbf6ff573,0xbf725470,0xbf748422,0xbf76841b,0xbf79c79d,0xbf7b61fc,0xbf7cbfc9,0xbf7de0b1,0xbf7f0e58,0xbf7fa6e3,0xbf7ff4e6,0xbf7ff84a
.long 0xbf7fb10f,0xbf7f0e58,0xbf7e1324,0xbf7cbfc9,0xbf7baccd,0xbf799b43,0xbf772417,0xbf74484b,0xbf731447,0xbf6f6830,0xbf6b4b0c,0xbf66becc,0xbf660f88,0xbf60a6cf,0xbf5ac450,0xbf546b3b
.long 0xbf54db31,0xbf4d9f02,0xbf45e403,0xbf3daef9,0xbf3fc767,0xbf36ad7f,0xbf2d1469,0xbf2302d3,0xbf273656,0xbf1c420c,0xbf10d3cd,0xbf04f484,0xbf0b9a6b,0xbefdbabb,0xbee363fa,0xbec8477c
.long 0xbedae880,0xbebe1d4a,0xbea09ae5,0xbe827dc0,0xbe9aa086,0xbe75c35a,0xbe354098,0xbde7fa9a,0xbe2f10a2,0xbdd53db9,0xbd16c32c,0x3cfb49ba,0xbd16c32c,0x3d0a342f,0x3dd53db9,0x3e3228d4
.long 0x3dc8bd36,0x3e2f10a2,0x3e78cfcc,0x3ea09ae5,0x3e6c9a7f,0x3e9c1faf,0x3ec1071e,0x3ee4cbfe,0x3eb8442a,0x3eddbe79,0x3f00e7e4,0x3f121eb0,0x3ef6e0cb,0x3f0d9281,0x3f1ebc12,0x3f2ecef7
.long 0x3f187fc0,0x3f299415,0x3f396842,0x3f47de65,0x3f32c8c9,0x3f425b89,0x3f5064af,0x3f5cc7d1,0x3f49d112,0x3f577026,0x3f633c5a,0x3f6d1c1d,0x3f5d2d53,0x3f686b39,0x3f718f57,0x3f788486
.long 0x80000000,0x80000000,0x80000000,0x80000000,0xbe164083,0xbe195be0,0xbe1c76de,0xbe1f917b,0xbe94a031,0xbe97a117,0xbe9aa086,0xbe9d9e78,0xbedae880,0xbedf28a9,0xbee363fa,0xbee79a5d
.long 0xbf0e39da,0xbf10d3cd,0xbf13682a,0xbf15f6d9,0xbf2beb4a,0xbf2ecef7,0xbf31a81d,0xbf34768f,0xbf45e403,0xbf48d8b3,0xbf4bbbf8,0xbf4e8d90,0xbf5b941a,0xbf5e5aa6,0xbf6106f2,0xbf6398ac
.long 0xbf6c835e,0xbf6ed89e,0xbf710908,0xbf731447,0xbf7853f8,0xbf79f35e,0xbf7b61fc,0xbf7c9f8a,0xbf7ec46d,0xbf7f6ac7,0xbf7fd397,0xbf7ffec4,0xbf7fb10f,0xbf7f1f49,0xbf7e4323,0xbf7d1cdd
.long 0xbf7b14be,0xbf791298,0xbf76ba07,0xbf740bdd,0xbf710908,0xbf6d67a1,0xbf696591,0xbf650479,0xbf61c598,0xbf5c61c7,0xbf5695e5,0xbf5064af,0xbf4d9f02,0xbf466354,0xbf3ebc1b,0xbf36ad7f
.long 0xbf3504f3,0xbf2beb4a,0xbf226799,0xbf187fc0,0xbf187fc0,0xbf0d9281,0xbf0242b1,0xbeed3063,0xbef15aea,0xbed8106b,0xbebe1d4a,0xbea395c5,0xbeac7cd4,0xbe901c2c,0xbe667c66,0xbe2bf804
.long 0xbe47c5c2,0xbe09cf86,0xbd96a905,0xbc490e90,0xbd48fb30,0x3c7b514b,0x3da3308c,0x3e1324ca,0x3dc8bd36,0x3e28defc,0x3e6c9a7f,0x3e97a117,0x3e78cfcc,0x3e9f1cdf,0x3ec1071e,0x3ee1fb6a
.long 0x3ec3ef15,0x3ee63375,0x3f039c3d,0x3f13682a,0x3f039c3d,0x3f140c5f,0x3f239da9,0x3f3238aa,0x3f226799,0x3f31a81d,0x3f3fc767,0x3f4cae79,0x3f3daef9,0x3f4b41fa,0x3f577026,0x3f62241a
.long 0x3f54db31,0x3f604621,0x3f6a09a7,0x3f721352,0x3f676bd8,0x3f703b37,0x3f772417,0x3f7c187a,0x3f74fa0b,0x3f7ac516,0x3f7e70b0,0x3f7ff4e6,0x3f7d3aac,0x3f7fa6e3,0x3f7fc38f,0x3f7d906e
.long 0x80000000,0x80000000,0x80000000,0x80000000,0xbe22abb6,0xbe25c58c,0xbe28defc,0xbe2bf804,0xbea09ae5,0xbea395c5,0xbea68f12,0xbea986c4,0xbeebcbbb,0xbeeff7fb,0xbef41f07,0xbef840c8
.long 0xbf187fc0,0xbf1b02c6,0xbf1d7fd1,0xbf1ff6cb,0xbf373a23,0xbf39f2ac,0xbf3ca003,0xbf3f41fc,0xbf514d3d,0xbf53fac3,0xbf5695e5,0xbf591e6a,0xbf660f88,0xbf686b39,0xbf6aab7b,0xbf6cd007
.long 0xbf74fa0b,0xbf76ba07,0xbf7853f8,0xbf79c79d,0xbf7dabcc,0xbf7e868b,0xbf7f2f9d,0xbf7fa6e3,0xbf7fec43,0xbf7f9c18,0xbf7f0e58,0xbf7e4323,0xbf7baccd,0xbf79f35e,0xbf77f110,0xbf75a67b
.long 0xbf710908,0xbf6db293,0xbf6a09a7,0xbf660f88,0xbf604621,0xbf5b2c79,0xbf55b993,0xbf4fefa8,0xbf49d112,0xbf42de29,0xbf3b8f3b,0xbf33e7bc,0xbf2e3bde,0xbf256bcb,0xbf1c420c,0xbf12c39a
.long 0xbf0e39da,0xbf039c3d,0xbef15aea,0xbedae880,0xbed53641,0xbebca7af,0xbea395c5,0xbe8a11f7,0xbe888e93,0xbe5a3997,0xbe22abb6,0xbdd53db9,0xbde1bc2e,0xbd55880e,0x3bc90f88,0x3d83db0a
.long 0x3d48fb30,0x3de1bc2e,0x3e2f10a2,0x3e6c9a7f,0x3e541501,0x3e8a11f7,0x3ea986c4,0x3ec8477c,0x3eb8442a,0x3ed8106b,0x3ef6e0cb,0x3f0a48ad,0x3f00e7e4,0x3f102dd5,0x3f1ebc12,0x3f2c800f
.long 0x3f226799,0x3f3085bb,0x3f3daef9,0x3f49d112,0x3f3fc767,0x3f4c3578,0x3f577026,0x3f61668a,0x3f584853,0x3f628210,0x3f6b4b0c,0x3f7294f8,0x3f6b4b0c,0x3f72d4eb,0x3f78b47b,0x3f7cdf6c
.long 0x3f7853f8,0x3f7cbfc9,0x3f7f4e6d,0x3f7ffb11,0x3f7f0e58,0x3f7fffb1,0x3f7eea9d,0x3f7bd14d,0x3f7f4e6d,0x3f7c7eb0,0x3f778bc5,0x3f708066,0x3f791298,0x3f725470,0x3f696591,0x3f5e5aa6
.long 0x80000000,0x80000000,0x80000000,0x80000000,0xbe2f10a2,0xbe3228d4,0xbe354098,0xbe3857ec,0xbeac7cd4,0xbeaf713a,0xbeb263ef,0xbeb554ec,0xbefc5d27,0xbf003a06,0xbf0242b1,0xbf044889
.long 0xbf226799,0xbf24d225,0xbf273656,0xbf299415,0xbf41d870,0xbf446337,0xbf46e22a,0xbf495521,0xbf5b941a,0xbf5df6be,0xbf604621,0xbf628210,0xbf6ed89e,0xbf70c501,0xbf7294f8,0xbf74484b
.long 0xbf7b14be,0xbf7c3b28,0xbf7d3aac,0xbf7e1324,0xbf7fec43,0xbf7fffb1,0xbf7fe129,0xbf7f90b1,0xbf7d3aac,0xbf7bf531,0xbf7a7302,0xbf78b47b,0xbf731447,0xbf703b37,0xbf6d1c1d,0xbf69b7e4
.long 0xbf61c598,0xbf5d2d53,0xbf584853,0xbf531849,0xbf49d112,0xbf436051,0xbf3ca003,0xbf3592e7,0xbf2beb4a,0xbf239da9,0xbf1b02c6,0xbf121eb0,0xbf08f59b,0xbefdbabb,0xbee900b7,0xbed3c867
.long 0xbec3ef15,0xbeac7cd4,0xbe94a031,0xbe78cfcc,0xbe605c13,0xbe2bf804,0xbdee3876,0xbd83db0a,0xbd48fb30,0x3bc90f88,0x3d7b2b74,0x3dee3876,0x3dfab273,0x3e3857ec,0x3e72b651,0x3e9620d2
.long 0x3e94a031,0x3eb263ef,0x3ecf7bca,0x3eebcbbb,0x3ee63375,0x3f019573,0x3f0f8784,0x3f1ce11f,0x3f187fc0,0x3f26050a,0x3f32c8c9,0x3f3ebc1b,0x3f396842,0x3f456439,0x3f5064af,0x3f5a5ba0
.long 0x3f54db31,0x3f5ebe05,0x3f676bd8,0x3f6ed89e,0x3f6a09a7,0x3f714c7a,0x3f772417,0x3f7b87b2,0x3f7853f8,0x3f7c7eb0,0x3f7f0e58,0x3f7ffec4,0x3f7f4e6d,0x3f7ffd39,0x3f7eea9d,0x3f7c187a
.long 0x3f7ec46d,0x3f7baccd,0x3f76ba07,0x3f6ff573,0x3f76ba07,0x3f6faf1b,0x3f66becc,0x3f5bfb34,0x3f676bd8,0x3f5c61c7,0x3f4f7a1f,0x3f40d0da,0x3f514d3d,0x3f425b89,0x3f31a81d,0x3f1f599f
.long 0x80000000,0x80000000,0x80000000,0x80000000,0xbe3b6ecf,0xbe3e853e,0xbe419b37,0xbe44b0b9,0xbeb8442a,0xbebb31a0,0xbebe1d4a,0xbec1071e,0xbf064b82,0xbf084b92,0xbf0a48ad,0xbf0c42c9
.long 0xbf2beb4a,0xbf2e3bde,0xbf3085bb,0xbf32c8c9,0xbf4bbbf8,0xbf4e1689,0xbf5064af,0xbf52a649,0xbf64aa59,0xbf66becc,0xbf68bf3c,0xbf6aab7b,0xbf75dec6,0xbf77583a,0xbf78b47b,0xbf79f35e
.long 0xbf7ec46d,0xbf7f4e6d,0xbf7fb10f,0xbf7fec43,0xbf7f0e58,0xbf7e5a38,0xbf7d7474,0xbf7c5d3a,0xbf76ba07,0xbf748422,0xbf721352,0xbf6f6830,0xbf660f88,0xbf62241a,0xbf5df6be,0xbf5988ad
.long 0xbf4d9f02,0xbf47de65,0xbf41d870,0xbf3b8f3b,0xbf2e3bde,0xbf269de3,0xbf1ebc12,0xbf16999f,0xbf08f59b,0xbeff17b2,0xbeebcbbb,0xbed8106b,0xbebe1d4a,0xbea80b1f,0xbe919ddd,0xbe75c35a
.long 0xbe47c5c2,0xbe164083,0xbdc8bd36,0xbd48fb30,0xbc490e90,0x3d2351cb,0x3dbc3ac3,0x3e1324ca,0x3e2f10a2,0x3e667c66,0x3e8e9a22,0x3ea986c4,0x3eb263ef,0x3ece0bea,0x3ee900b7,0x3f019573
.long 0x3f039c3d,0x3f10d3cd,0x3f1d7fd1,0x3f299415,0x3f299415,0x3f3592e7,0x3f40d0da,0x3f4b41fa,0x3f49d112,0x3f53fac3,0x3f5d2d53,0x3f655e0b,0x3f633c5a,0x3f6afb8c,0x3f718f57,0x3f76ef5b
.long 0x3f74fa0b,0x3f79c79d,0x3f7d3aac,0x3f7f4e6d,0x3f7e70b0,0x3f7fdaaf,0x3f7fc38f,0x3f7e2b72,0x3f7f4e6d,0x3f7cfe73,0x3f791298,0x3f73913f,0x3f778bc5,0x3f714c7a,0x3f696591,0x3f5fe4e9
.long 0x3f676bd8,0x3f5d2d53,0x3f514d3d,0x3f43e200,0x3f4f7a1f,0x3f4154e1,0x3f31a81d,0x3f209393,0x3f3085bb,0x3f1ebc12,0x3f0b9a6b,0x3eee9479,0x3f0b9a6b,0x3eed3063,0x3ec1071e,0x3e931f35
.long 0x3f803f80,0x3f803f80,0x3f803f80,0x3f803f80,0x3f8c3f80,0x3fa03f49,0x3fb42500,0x3fadbe8d,0x3f973f80,0x3fb23f0b,0x3f49bf80,0x3e8dbfa7,0x3fa03f80,0x3fb43e8d,0xbed2bfb5,0xbf8cbf97
.long 0x3fa73f80,0x3fa72500,0xbfa7bf80,0xbfa7a580,0x3fad3f80,0x3f8cbe8d,0xbfa0a580,0xbe0e3f97,0x3fb23f80,0x3f49bf0b,0xbe8d3f80,0x3f973fa7,0x3fb43f80,0x3ed2bf49,0x3f663fb5,0x3fa03e8d
.long 0x3fb53f80,0x2500bf80,0x3fb53f80,0x26f0bf80,0x3fb43f80,0xbed2bf97,0x3f6625c0,0xbfa0bfb2,0x3fb23f80,0xbf49bfa7,0xbe8dbf80,0xbf97bf0b,0x3fad3f80,0xbf8cbfb2,0xbfa0bfb5,0x3e0e3f49
.long 0x3fa73f80,0xbfa7bfb5,0xbfa7bf80,0x3fa73fb5,0x3fa03f80,0xbfb4bfb2,0xbed22660,0x3f8c3f49,0x3f973f80,0xbfb2bfa7,0x3f493f80,0xbe8dbf0b,0x3f8c3f80,0xbfa0bf97,0x3fb43fb5,0xbfadbfb2
.long 0x3f803f80,0xbf80bf80,0x3f803f80,0xbf80bf80,0x3f663f80,0xbf2bbf49,0xbe0ea620,0x3ed23e8d,0x3f493f80,0xbe8dbf0b,0xbf97bf80,0x3fb23fa7,0x3f2b3f80,0x3e0ebe8d,0xbfadbfb5,0x3f663f97
.long 0x3f0b3f80,0x3f0ba580,0xbf0bbf80,0xbf0ba500,0x3ed23f80,0x3f663e8d,0x3f2b25c0,0xbfb4bf97,0x3e8d3f80,0x3f973f0b,0x3fb23f80,0xbf49bfa7,0x3e0e3f80,0x3fad3f49,0x3f8c3fb5,0x3f2bbe8d
.long 0x25003f80,0x3fb53f80,0x27283f80,0x3fb53f80,0xbe0e3f80,0x3fad3f97,0xbf8ca500,0x3f2b3fb2,0xbe8d3f80,0x3f973fa7,0xbfb2bf80,0xbf493f0b,0xbed23f80,0x3f663fb2,0xbf2bbfb5,0xbfb4bf49
.long 0xbf0b3f80,0x3f0b3fb5,0x3f0bbf80,0xbf0bbfb5,0xbf2b3f80,0x3e0e3fb2,0x3fad0000,0x3f66bf49,0xbf493f80,0xbe8d3fa7,0x3f973f80,0x3fb23f0b,0xbf663f80,0xbf2b3f97,0x3e0e3fb5,0x3ed23fb2
.long 0x3f803f80,0x3f803f80,0x3f803f80,0x3f803f80,0x3fad3f0b,0x3fb43e8d,0x3fa0bf0b,0x3f8cbf49,0x3fb22500,0x3f97bf0b,0xbe8dbfb5,0xbf49bfa7,0x3f8cbf0b,0x3ed2bf97,0xbfb4bf0b,0xbfa03e8d
.long 0x3f0bbf80,0xbf0bbfb5,0xbf0b3f80,0x3f0b3fb5,0xbe0ebfa7,0xbfa0bf97,0x3f8c3fa7,0x3fad3e8d,0xbf49bfb5,0xbfb2bf0b,0x3f9725c0,0xbe8dbfa7,0xbfa0bfa7,0xbf663e8d,0xbed2bfa7,0xbfb4bf49
.long 0xbfb5bf80,0xa5c03f80,0xbfb5bf80,0xa7083f80,0xbfa0bf0b,0x3f663fb2,0xbed23f0b,0x3fb43f97,0xbf49a580,0x3fb23fa7,0x3f973fb5,0x3e8dbf0b,0xbe0e3f0b,0x3fa03f49,0x3f8c3f0b,0xbfadbfb2
.long 0x3f0b3f80,0x3f0b25c0,0xbf0bbf80,0xbf0b25c0,0x3f8c3fa7,0xbed2bf49,0xbfb4bfa7,0x3fa03fb2,0x3fb23fb5,0xbf97bfa7,0xbe8d25c0,0x3f493f0b,0x3fad3fa7,0xbfb4bfb2,0x3fa03fa7,0xbf8cbf97
.long 0x3f803f80,0xbf80bf80,0x3f803f80,0xbf80bf80,0x3ed23f0b,0xbe0ebe8d,0xbf2bbf0b,0x3f663f49,0xbe8d25c0,0x3f493f0b,0xbfb2bfb5,0x3f973fa7,0xbf66bf0b,0x3fad3f97,0xbe0ebf0b,0xbf2bbe8d
.long 0xbfa7bf80,0x3fa73fb5,0x3fa73f80,0xbfa7bfb5,0xbfb4bfa7,0x3f2b3f97,0x3f663fa7,0x3ed2be8d,0xbf97bfb5,0xbe8d3f0b,0xbf4927bc,0x3fb23fa7,0xbf2bbfa7,0xbf8cbe8d,0xbfadbfa7,0xbe0e3f49
.long 0xa708bf80,0xbfb5bf80,0xa758bf80,0xbfb5bf80,0x3f2bbf0b,0xbf8cbfb2,0x3fad3f0b,0xbe0ebf97,0x3f972660,0xbe8dbfa7,0x3f493fb5,0x3fb23f0b,0x3fb43f0b,0x3f2bbf49,0xbf663f0b,0x3ed23fb2
.long 0x3fa73f80,0x3fa725c0,0xbfa7bf80,0xbfa727d4,0x3f663fa7,0x3fad3f49,0x3e0ebfa7,0xbf2bbfb2,0x3e8d3fb5,0x3f493fa7,0x3fb2a842,0x3f97bf0b,0xbed23fa7,0xbe0e3fb2,0x3f2b3fa7,0x3f663f97
.long 0x3f803f80,0x3f803f80,0x3f803f80,0x3f803f80,0x3f66bf80,0x3f2bbf97,0xbe0ebfb5,0xbed2bfb2,0xbf97bf80,0xbfb2bf0b,0xbf493f80,0xbe8d3fa7,0xbf2b3f80,0x3e0e3fb2,0x3fad25c0,0x3f66bf49
.long 0x3fa73f80,0x3fa725c0,0xbfa7bf80,0xbfa72660,0x3ed2bf80,0xbf66bfb2,0x3f2b3fb5,0x3fb43f49,0xbfb2bf80,0xbf493f0b,0x3e8dbf80,0xbf97bfa7,0xbe0e3f80,0x3fad3f97,0xbf8c25c0,0x3f2b3fb2
.long 0x3fb53f80,0x2718bf80,0x3fb53f80,0x2728bf80,0xbe0ebf80,0xbfadbf49,0xbf8cbfb5,0xbf2b3e8d,0xbfb2bf80,0x3f493fa7,0x3e8d3f80,0x3f973f0b,0x3ed23f80,0x3f663e8d,0x3f2b27bc,0xbfb4bf97
.long 0x3fa73f80,0xbfa7bfb5,0xbfa7bf80,0x3fa73fb5,0xbf2bbf80,0xbe0e3e8d,0x3fad3fb5,0xbf66bf97,0xbf97bf80,0x3fb23fa7,0xbf49bf80,0x3e8d3f0b,0x3f663f80,0xbf2bbf49,0xbe0ea842,0x3ed23e8d
.long 0x3f803f80,0xbf80bf80,0x3f803f80,0xbf80bf80,0xbf8cbf80,0x3fa03f97,0xbfb4bfb5,0x3fad3fb2,0xbf49bf80,0x3e8d3f0b,0x3f973f80,0xbfb2bfa7,0x3fa03f80,0xbfb4bfb2,0xbed227e4,0x3f8c3f49
.long 0x3f0b3f80,0x3f0ba660,0xbf0bbf80,0xbf0b27ec,0xbfadbf80,0x3f8c3fb2,0x3fa03fb5,0xbe0ebf49,0xbe8dbf80,0xbf97bf0b,0xbfb2bf80,0x3f493fa7,0x3fb43f80,0xbed2bf97,0x3f66a6f0,0xbfa0bfb2
.long 0x27783f80,0x3fb53f80,0x27a43f80,0x3fb53f80,0xbfb4bf80,0xbed23f49,0xbf66bfb5,0xbfa0be8d,0x3e8dbf80,0xbf97bfa7,0x3fb23f80,0x3f49bf0b,0x3fad3f80,0x3f8cbe8d,0xbfa02802,0xbe0e3f97
.long 0xbf0b3f80,0x3f0b3fb5,0x3f0bbf80,0xbf0bbfb5,0xbfa0bf80,0xbfb4be8d,0x3ed23fb5,0x3f8c3f97,0x3f49bf80,0x3e8dbfa7,0xbf97bf80,0xbfb2bf0b,0x3f8c3f80,0x3fa03f49,0x3fb4a866,0x3fadbe8d
.long 0x3f803f80,0x3f803f80,0x3f803f80,0x3f803f80,0x3ed2bfa7,0x3e0ebfb2,0xbf2bbfa7,0xbf66bf97,0xbfb2a580,0xbf973f0b,0x3e8d3fb5,0x3f493fa7,0x3f663fa7,0x3fad3f49,0x3e0ebfa7,0xbf2bbfb2
.long 0x3f0bbf80,0xbf0bbfb5,0xbf0b3f80,0x3f0b3fb5,0xbfb4bf0b,0xbf2b3f49,0x3f66bf0b,0xbed2bfb2,0x3f493fb5,0x3fb23f0b,0xbf9725c0,0x3e8d3fa7,0x3f2bbf0b,0xbf8cbfb2,0x3fad3f0b,0xbe0ebf97
.long 0xbfb5bf80,0xa7283f80,0xbfb5bf80,0xa7383f80,0x3f2b3fa7,0x3f8c3e8d,0x3fad3fa7,0x3e0ebf49,0x3f49a500,0xbfb2bfa7,0xbf97bfb5,0xbe8d3f0b,0xbfb4bfa7,0x3f2b3f97,0x3f663fa7,0x3ed2be8d
.long 0x3f0b3f80,0x3f0b2500,0xbf0bbf80,0xbf0ba660,0x3f663f0b,0xbfadbf97,0x3e0e3f0b,0x3f2b3e8d,0xbfb2bfb5,0x3f973fa7,0x3e8d27d4,0xbf49bf0b,0x3ed23f0b,0xbe0ebe8d,0xbf2bbf0b,0x3f663f49
.long 0x3f803f80,0xbf80bf80,0x3f803f80,0xbf80bf80,0xbfadbfa7,0x3fb43fb2,0xbfa0bfa7,0x3f8c3f97,0x3e8da660,0xbf49bf0b,0x3fb23fb5,0xbf97bfa7,0x3f8c3fa7,0xbed2bf49,0xbfb4bfa7,0x3fa03fb2
.long 0xbfa7bf80,0x3fa73fb5,0x3fa73f80,0xbfa7bfb5,0x3e0ebf0b,0xbfa0bf49,0xbf8cbf0b,0x3fad3fb2,0x3f973fb5,0x3e8dbf0b,0x3f49a85a,0xbfb2bfa7,0xbfa0bf0b,0x3f663fb2,0xbed23f0b,0x3fb43f97
.long 0x2690bf80,0xbfb5bf80,0xa836bf80,0xbfb5bf80,0x3fa03fa7,0x3f66be8d,0x3ed23fa7,0x3fb43f49,0xbf97a778,0x3e8d3fa7,0xbf49bfb5,0xbfb2bf0b,0xbe0ebfa7,0xbfa0bf97,0x3f8c3fa7,0x3fad3e8d
.long 0x3fa73f80,0x3fa7a718,0xbfa7bf80,0xbfa7a6f0,0xbf8c3f0b,0xbed23f97,0x3fb43f0b,0x3fa0be8d,0xbe8dbfb5,0xbf49bfa7,0xbfb228a5,0xbf973f0b,0x3fad3f0b,0x3fb43e8d,0x3fa0bf0b,0x3f8cbf49
.long 0x3f80bf80,0x3f80bf80,0x3f80bf80,0x3f80bf80,0x3f66bf80,0x3f2bbf97,0xbe0ebfb5,0xbed2bfb2,0x3f49bf80,0x3e8dbfa7,0xbf97bf80,0xbfb2bf0b,0x3f2bbf80,0xbe0ebfb2,0xbfada500,0xbf663f49
.long 0x3f0bbf80,0xbf0bbfb5,0xbf0b3f80,0x3f0b3fb5,0x3ed2bf80,0xbf66bfb2,0x3f2b3fb5,0x3fb43f49,0x3e8dbf80,0xbf97bfa7,0x3fb23f80,0x3f49bf0b,0x3e0ebf80,0xbfadbf97,0x3f8c25c0,0xbf2bbfb2
.long 0x2500bf80,0xbfb5bf80,0x25c0bf80,0xbfb5bf80,0xbe0ebf80,0xbfadbf49,0xbf8cbfb5,0xbf2b3e8d,0xbe8dbf80,0xbf97bf0b,0xbfb2bf80,0x3f493fa7,0xbed2bf80,0xbf66be8d,0xbf2ba6f0,0x3fb43f97
.long 0xbf0bbf80,0xbf0ba500,0x3f0b3f80,0x3f0b2708,0xbf2bbf80,0xbe0e3e8d,0x3fad3fb5,0xbf66bf97,0xbf49bf80,0x3e8d3f0b,0x3f973f80,0xbfb2bfa7,0xbf66bf80,0x3f2b3f49,0x3e0e2708,0xbed2be8d
.long 0xbf80bf80,0x3f803f80,0xbf80bf80,0x3f803f80,0xbf8cbf80,0x3fa03f97,0xbfb4bfb5,0x3fad3fb2,0xbf97bf80,0x3fb23fa7,0xbf49bf80,0x3e8d3f0b,0xbfa0bf80,0x3fb43fb2,0x3ed2a718,0xbf8cbf49
.long 0xbfa7bf80,0x3fa73fb5,0x3fa73f80,0xbfa7bfb5,0xbfadbf80,0x3f8c3fb2,0x3fa03fb5,0xbe0ebf49,0xbfb2bf80,0x3f493fa7,0x3e8d3f80,0x3f973f0b,0xbfb4bf80,0x3ed23f97,0xbf662728,0x3fa03fb2
.long 0xbfb5bf80,0x25c03f80,0xbfb5bf80,0x25003f80,0xbfb4bf80,0xbed23f49,0xbf66bfb5,0xbfa0be8d,0xbfb2bf80,0xbf493f0b,0x3e8dbf80,0xbf97bfa7,0xbfadbf80,0xbf8c3e8d,0x3fa0a728,0x3e0ebf97
.long 0xbfa7bf80,0xbfa725c0,0x3fa73f80,0x3fa7a748,0xbfa0bf80,0xbfb4be8d,0x3ed23fb5,0x3f8c3f97,0xbf97bf80,0xbfb2bf0b,0xbf493f80,0xbe8d3fa7,0xbf8cbf80,0xbfa0bf49,0xbfb42738,0xbfad3e8d
.long 0x3f80bf80,0x3f80bf80,0x3f80bf80,0x3f80bf80,0x3ed2bfa7,0x3e0ebfb2,0xbf2bbfa7,0xbf66bf97,0xbe8dbfb5,0xbf49bfa7,0xbfb2a500,0xbf973f0b,0xbf66bfa7,0xbfadbf49,0xbe0e3fa7,0x3f2b3fb2
.long 0xbfa7bf80,0xbfa7a500,0x3fa73f80,0x3fa725c0,0xbfb4bf0b,0xbf2b3f49,0x3f66bf0b,0xbed2bfb2,0xbf97a500,0x3e8d3fa7,0xbf49bfb5,0xbfb2bf0b,0xbf2b3f0b,0x3f8c3fb2,0xbfadbf0b,0x3e0e3f97
.long 0xa5803f80,0x3fb53f80,0x26603f80,0x3fb53f80,0x3f2b3fa7,0x3f8c3e8d,0x3fad3fa7,0x3e0ebf49,0x3f973fb5,0x3e8dbf0b,0x3f492708,0xbfb2bfa7,0x3fb43fa7,0xbf2bbf97,0xbf66bfa7,0xbed23e8d
.long 0x3fa73f80,0xbfa7bfb5,0xbfa7bf80,0x3fa73fb5,0x3f663f0b,0xbfadbf97,0x3e0e3f0b,0x3f2b3e8d,0x3e8d25c0,0xbf49bf0b,0x3fb23fb5,0xbf97bfa7,0xbed2bf0b,0x3e0e3e8d,0x3f2b3f0b,0xbf66bf49
.long 0xbf80bf80,0x3f803f80,0xbf80bf80,0x3f803f80,0xbfadbfa7,0x3fb43fb2,0xbfa0bfa7,0x3f8c3f97,0xbfb2bfb5,0x3f973fa7,0x3e8da728,0xbf49bf0b,0xbf8cbfa7,0x3ed23f49,0x3fb43fa7,0xbfa0bfb2
.long 0xbf0bbf80,0xbf0b2708,0x3f0b3f80,0x3f0ba748,0x3e0ebf0b,0xbfa0bf49,0xbf8cbf0b,0x3fad3fb2,0x3f49a6f0,0xbfb2bfa7,0xbf97bfb5,0xbe8d3f0b,0x3fa03f0b,0xbf66bfb2,0x3ed2bf0b,0xbfb4bf97
.long 0x3fb53f80,0x25c0bf80,0x3fb53f80,0xa660bf80,0x3fa03fa7,0x3f66be8d,0x3ed23fa7,0x3fb43f49,0x3f493fb5,0x3fb23f0b,0xbf97a718,0x3e8d3fa7,0x3e0e3fa7,0x3fa03f97,0xbf8cbfa7,0xbfadbe8d
.long 0xbf0b3f80,0x3f0b3fb5,0x3f0bbf80,0xbf0bbfb5,0xbf8c3f0b,0xbed23f97,0x3fb43f0b,0x3fa0be8d,0xbfb22708,0xbf973f0b,0x3e8d3fb5,0x3f493fa7,0xbfadbf0b,0xbfb4be8d,0xbfa03f0b,0xbf8c3f49
.long 0x3f80bf80,0x3f80bf80,0x3f80bf80,0x3f80bf80,0xbf8cbf80,0xbfa0bf49,0xbfb4a500,0xbfad3e8d,0xbf493f80,0xbe8d3fa7,0x3f973f80,0x3fb23f0b,0x3fa03f80,0x3fb43e8d,0xbed2bfb5,0xbf8cbf97
.long 0x3f0bbf80,0xbf0bbfb5,0xbf0b3f80,0x3f0b3fb5,0xbfadbf80,0xbf8c3e8d,0x3fa02708,0x3e0ebf97,0xbe8d3f80,0x3f973fa7,0xbfb2bf80,0xbf493f0b,0x3fb43f80,0x3ed2bf49,0x3f663fb5,0x3fa03e8d
.long 0xa620bf80,0xbfb5bf80,0xa500bf80,0xbfb5bf80,0xbfb4bf80,0x3ed23f97,0xbf66a728,0x3fa03fb2,0x3e8d3f80,0x3f973f0b,0x3fb23f80,0xbf49bfa7,0x3fad3f80,0xbf8cbfb2,0xbfa0bfb5,0x3e0e3f49
.long 0xbf0bbf80,0xbf0ba728,0x3f0b3f80,0x3f0b2758,0xbfa0bf80,0x3fb43fb2,0x3ed2a718,0xbf8cbf49,0x3f493f80,0xbe8dbf0b,0xbf97bf80,0x3fb23fa7,0x3f8c3f80,0xbfa0bf97,0x3fb43fb5,0xbfadbfb2
.long 0xbf80bf80,0x3f803f80,0xbf80bf80,0x3f803f80,0xbf66bf80,0x3f2b3f49,0x3e0e27ec,0xbed2be8d,0x3f973f80,0xbfb2bfa7,0x3f493f80,0xbe8dbf0b,0x3f2b3f80,0x3e0ebe8d,0xbfadbfb5,0x3f663f97
.long 0xbfa7bf80,0x3fa73fb5,0x3fa73f80,0xbfa7bfb5,0xbed2bf80,0xbf66be8d,0xbf2ba690,0x3fb43f97,0x3fb23f80,0xbf49bfa7,0xbe8dbf80,0xbf97bf0b,0x3e0e3f80,0x3fad3f49,0x3f8c3fb5,0x3f2bbe8d
.long 0xbfb5bf80,0x27e43f80,0xbfb5bf80,0x28023f80,0x3e0ebf80,0xbfadbf97,0x3f8ca7a4,0xbf2bbfb2,0x3fb23f80,0x3f49bf0b,0xbe8d3f80,0x3f973fa7,0xbed23f80,0x3f663fb2,0xbf2bbfb5,0xbfb4bf49
.long 0xbfa7bf80,0xbfa7a690,0x3fa73f80,0x3fa7a7bc,0x3f2bbf80,0xbe0ebfb2,0xbfad2836,0xbf663f49,0x3f973f80,0x3fb23f0b,0x3f49bf80,0x3e8dbfa7,0xbf663f80,0xbf2b3f97,0x3e0e3fb5,0x3ed23fb2
.long 0x3f80bf80,0x3f80bf80,0x3f80bf80,0x3f80bf80,0xbfadbf0b,0xbfb4be8d,0xbfa03f0b,0xbf8c3f49,0x3e8d3fb5,0x3f493fa7,0x3fb225c0,0x3f97bf0b,0x3f8cbf0b,0x3ed2bf97,0xbfb4bf0b,0xbfa03e8d
.long 0xbfa7bf80,0xbfa7a6f0,0x3fa73f80,0x3fa72708,0x3e0e3fa7,0x3fa03f97,0xbf8cbfa7,0xbfadbe8d,0x3f972708,0xbe8dbfa7,0x3f493fb5,0x3fb23f0b,0xbfa0bfa7,0xbf663e8d,0xbed2bfa7,0xbfb4bf49
.long 0x25c03f80,0x3fb53f80,0x80003f80,0x3fb53f80,0x3fa03f0b,0xbf66bfb2,0x3ed2bf0b,0xbfb4bf97,0xbf97bfb5,0xbe8d3f0b,0xbf49a748,0x3fb23fa7,0xbe0e3f0b,0x3fa03f49,0x3f8c3f0b,0xbfadbfb2
.long 0x3fa73f80,0xbfa7bfb5,0xbfa7bf80,0x3fa73fb5,0xbf8cbfa7,0x3ed23f49,0x3fb43fa7,0xbfa0bfb2,0xbe8da748,0x3f493f0b,0xbfb2bfb5,0x3f973fa7,0x3fad3fa7,0xbfb4bfb2,0x3fa03fa7,0xbf8cbf97
.long 0xbf80bf80,0x3f803f80,0xbf80bf80,0x3f803f80,0xbed2bf0b,0x3e0e3e8d,0x3f2b3f0b,0xbf66bf49,0x3fb23fb5,0xbf97bfa7,0xbe8da690,0x3f493f0b,0xbf66bf0b,0x3fad3f97,0xbe0ebf0b,0xbf2bbe8d
.long 0xbf0bbf80,0xbf0ba6d0,0x3f0b3f80,0x3f0ba7a4,0x3fb43fa7,0xbf2bbf97,0xbf66bfa7,0xbed23e8d,0xbf49281c,0x3fb23fa7,0x3f973fb5,0x3e8dbf0b,0xbf2bbfa7,0xbf8cbe8d,0xbfadbfa7,0xbe0e3f49
.long 0x3fb53f80,0xa6f0bf80,0x3fb53f80,0xa866bf80,0xbf2b3f0b,0x3f8c3fb2,0xbfadbf0b,0x3e0e3f97,0xbf49bfb5,0xbfb2bf0b,0x3f972887,0xbe8dbfa7,0x3fb43f0b,0x3f2bbf49,0xbf663f0b,0x3ed23fb2
.long 0xbf0b3f80,0x3f0b3fb5,0x3f0bbf80,0xbf0bbfb5,0xbf66bfa7,0xbfadbf49,0xbe0e3fa7,0x3f2b3fb2,0x3fb2a7a4,0x3f97bf0b,0xbe8dbfb5,0xbf49bfa7,0xbed23fa7,0xbe0e3fb2,0x3f2b3fa7,0x3f663f97
.long 0x3f803f80,0x3f803f80,0x3f803f80,0x3f803f80,0xbf8cbf80,0xbfa0bf49,0xbfb4a580,0xbfad3e8d,0x3f973f80,0x3fb23f0b,0x3f49bf80,0x3e8dbfa7,0xbfa0bf80,0xbfb4be8d,0x3ed23fb5,0x3f8c3f97
.long 0x3fa73f80,0x3fa7a620,0xbfa7bf80,0xbfa725c0,0xbfadbf80,0xbf8c3e8d,0x3fa0a500,0x3e0ebf97,0x3fb23f80,0x3f49bf0b,0xbe8d3f80,0x3f973fa7,0xbfb4bf80,0xbed23f49,0xbf66bfb5,0xbfa0be8d
.long 0x3fb53f80,0x2748bf80,0x3fb53f80,0x2760bf80,0xbfb4bf80,0x3ed23f97,0xbf66a660,0x3fa03fb2,0x3fb23f80,0xbf49bfa7,0xbe8dbf80,0xbf97bf0b,0xbfadbf80,0x3f8c3fb2,0x3fa03fb5,0xbe0ebf49
.long 0x3fa73f80,0xbfa7bfb5,0xbfa7bf80,0x3fa73fb5,0xbfa0bf80,0x3fb43fb2,0x3ed2a778,0xbf8cbf49,0x3f973f80,0xbfb2bfa7,0x3f493f80,0xbe8dbf0b,0xbf8cbf80,0x3fa03f97,0xbfb4bfb5,0x3fad3fb2
.long 0x3f803f80,0xbf80bf80,0x3f803f80,0xbf80bf80,0xbf66bf80,0x3f2b3f49,0x3e0ea728,0xbed2be8d,0x3f493f80,0xbe8dbf0b,0xbf97bf80,0x3fb23fa7,0xbf2bbf80,0xbe0e3e8d,0x3fad3fb5,0xbf66bf97
.long 0x3f0b3f80,0x3f0ba728,0xbf0bbf80,0xbf0ba6f0,0xbed2bf80,0xbf66be8d,0xbf2ba6f0,0x3fb43f97,0x3e8d3f80,0x3f973f0b,0x3fb23f80,0xbf49bfa7,0xbe0ebf80,0xbfadbf49,0xbf8cbfb5,0xbf2b3e8d
.long 0xa7a43f80,0x3fb53f80,0x27ec3f80,0x3fb53f80,0x3e0ebf80,0xbfadbf97,0x3f8c27d4,0xbf2bbfb2,0xbe8d3f80,0x3f973fa7,0xbfb2bf80,0xbf493f0b,0x3ed2bf80,0xbf66bfb2,0x3f2b3fb5,0x3fb43f49
.long 0xbf0b3f80,0x3f0b3fb5,0x3f0bbf80,0xbf0bbfb5,0x3f2bbf80,0xbe0ebfb2,0xbfada836,0xbf663f49,0xbf493f80,0xbe8d3fa7,0x3f973f80,0x3fb23f0b,0x3f66bf80,0x3f2bbf97,0xbe0ebfb5,0xbed2bfb2
.long 0x3f803f80,0x3f803f80,0x3f803f80,0x3f803f80,0xbfadbf0b,0xbfb4be8d,0xbfa03f0b,0xbf8c3f49,0x3fb225c0,0x3f97bf0b,0xbe8dbfb5,0xbf49bfa7,0xbf8c3f0b,0xbed23f97,0x3fb43f0b,0x3fa0be8d
.long 0x3f0bbf80,0xbf0bbfb5,0xbf0b3f80,0x3f0b3fb5,0x3e0e3fa7,0x3fa03f97,0xbf8cbfa7,0xbfadbe8d,0xbf49bfb5,0xbfb2bf0b,0x3f972500,0xbe8dbfa7,0x3fa03fa7,0x3f66be8d,0x3ed23fa7,0x3fb43f49
.long 0xbfb5bf80,0xa7583f80,0xbfb5bf80,0x26f03f80,0x3fa03f0b,0xbf66bfb2,0x3ed2bf0b,0xbfb4bf97,0xbf49a660,0x3fb23fa7,0x3f973fb5,0x3e8dbf0b,0x3e0ebf0b,0xbfa0bf49,0xbf8cbf0b,0x3fad3fb2
.long 0x3f0b3f80,0x3f0b27e4,0xbf0bbf80,0xbf0ba6f0,0xbf8cbfa7,0x3ed23f49,0x3fb43fa7,0xbfa0bfb2,0x3fb23fb5,0xbf97bfa7,0xbe8da718,0x3f493f0b,0xbfadbfa7,0x3fb43fb2,0xbfa0bfa7,0x3f8c3f97
.long 0x3f803f80,0xbf80bf80,0x3f803f80,0xbf80bf80,0xbed2bf0b,0x3e0e3e8d,0x3f2b3f0b,0xbf66bf49,0xbe8d2802,0x3f493f0b,0xbfb2bfb5,0x3f973fa7,0x3f663f0b,0xbfadbf97,0x3e0e3f0b,0x3f2b3e8d
.long 0xbfa7bf80,0x3fa73fb5,0x3fa73f80,0xbfa7bfb5,0x3fb43fa7,0xbf2bbf97,0xbf66bfa7,0xbed23e8d,0xbf97bfb5,0xbe8d3f0b,0xbf4928ab,0x3fb23fa7,0x3f2b3fa7,0x3f8c3e8d,0x3fad3fa7,0x3e0ebf49
.long 0xa690bf80,0xbfb5bf80,0xa85abf80,0xbfb5bf80,0xbf2b3f0b,0x3f8c3fb2,0xbfadbf0b,0x3e0e3f97,0x3f97a78c,0xbe8dbfa7,0x3f493fb5,0x3fb23f0b,0xbfb4bf0b,0xbf2b3f49,0x3f66bf0b,0xbed2bfb2
.long 0x3fa73f80,0x3fa7a7a4,0xbfa7bf80,0xbfa72842,0xbf66bfa7,0xbfadbf49,0xbe0e3fa7,0x3f2b3fb2,0x3e8d3fb5,0x3f493fa7,0x3fb2a8ea,0x3f97bf0b,0x3ed2bfa7,0x3e0ebfb2,0xbf2bbfa7,0xbf66bf97
.long 0x3f803f80,0x3f803f80,0x3f803f80,0x3f803f80,0xbf663f80,0xbf2b3f97,0x3e0e3fb5,0x3ed23fb2,0xbf97bf80,0xbfb2bf0b,0xbf493f80,0xbe8d3fa7,0x3f2bbf80,0xbe0ebfb2,0xbfad25c0,0xbf663f49
.long 0x3fa73f80,0x3fa7a500,0xbfa7bf80,0xbfa70000,0xbed23f80,0x3f663fb2,0xbf2bbfb5,0xbfb4bf49,0xbfb2bf80,0xbf493f0b,0x3e8dbf80,0xbf97bfa7,0x3e0ebf80,0xbfadbf97,0x3f8c27d4,0xbf2bbfb2
.long 0x3fb53f80,0x2778bf80,0x3fb53f80,0x278cbf80,0x3e0e3f80,0x3fad3f49,0x3f8c3fb5,0x3f2bbe8d,0xbfb2bf80,0x3f493fa7,0x3e8d3f80,0x3f973f0b,0xbed2bf80,0xbf66be8d,0xbf2ba85a,0x3fb43f97
.long 0x3fa73f80,0xbfa7bfb5,0xbfa7bf80,0x3fa73fb5,0x3f2b3f80,0x3e0ebe8d,0xbfadbfb5,0x3f663f97,0xbf97bf80,0x3fb23fa7,0xbf49bf80,0x3e8d3f0b,0xbf66bf80,0x3f2b3f49,0x3e0e28a5,0xbed2be8d
.long 0x3f803f80,0xbf80bf80,0x3f803f80,0xbf80bf80,0x3f8c3f80,0xbfa0bf97,0x3fb43fb5,0xbfadbfb2,0xbf49bf80,0x3e8d3f0b,0x3f973f80,0xbfb2bfa7,0xbfa0bf80,0x3fb43fb2,0x3ed2a8dd,0xbf8cbf49
.long 0x3f0b3f80,0x3f0ba880,0xbf0bbf80,0xbf0b2836,0x3fad3f80,0xbf8cbfb2,0xbfa0bfb5,0x3e0e3f49,0xbe8dbf80,0xbf97bf0b,0xbfb2bf80,0x3f493fa7,0xbfb4bf80,0x3ed23f97,0xbf662842,0x3fa03fb2
.long 0xa7283f80,0x3fb53f80,0x281c3f80,0x3fb53f80,0x3fb43f80,0x3ed2bf49,0x3f663fb5,0x3fa03e8d,0x3e8dbf80,0xbf97bfa7,0x3fb23f80,0x3f49bf0b,0xbfadbf80,0xbf8c3e8d,0x3fa0a927,0x3e0ebf97
.long 0xbf0b3f80,0x3f0b3fb5,0x3f0bbf80,0xbf0bbfb5,0x3fa03f80,0x3fb43e8d,0xbed2bfb5,0xbf8cbf97,0x3f49bf80,0x3e8dbfa7,0xbf97bf80,0xbfb2bf0b,0xbf8cbf80,0xbfa0bf49,0xbfb428d1,0xbfad3e8d
.long 0x3f803f80,0x3f803f80,0x3f803f80,0x3f803f80,0xbed23fa7,0xbe0e3fb2,0x3f2b3fa7,0x3f663f97,0xbfb22660,0xbf973f0b,0x3e8d3fb5,0x3f493fa7,0xbf66bfa7,0xbfadbf49,0xbe0e3fa7,0x3f2b3fb2
.long 0x3f0bbf80,0xbf0bbfb5,0xbf0b3f80,0x3f0b3fb5,0x3fb43f0b,0x3f2bbf49,0xbf663f0b,0x3ed23fb2,0x3f493fb5,0x3fb23f0b,0xbf97a660,0x3e8d3fa7,0xbf2b3f0b,0x3f8c3fb2,0xbfadbf0b,0x3e0e3f97
.long 0xbfb5bf80,0x26d03f80,0xbfb5bf80,0x26903f80,0xbf2bbfa7,0xbf8cbe8d,0xbfadbfa7,0xbe0e3f49,0x3f4927ec,0xbfb2bfa7,0xbf97bfb5,0xbe8d3f0b,0x3fb43fa7,0xbf2bbf97,0xbf66bfa7,0xbed23e8d
.long 0x3f0b3f80,0x3f0b2802,0xbf0bbf80,0xbf0ba866,0xbf66bf0b,0x3fad3f97,0xbe0ebf0b,0xbf2bbe8d,0xbfb2bfb5,0x3f973fa7,0x3e8da6f0,0xbf49bf0b,0xbed2bf0b,0x3e0e3e8d,0x3f2b3f0b,0xbf66bf49
.long 0x3f803f80,0xbf80bf80,0x3f803f80,0xbf80bf80,0x3fad3fa7,0xbfb4bfb2,0x3fa03fa7,0xbf8cbf97,0x3e8da78c,0xbf49bf0b,0x3fb23fb5,0xbf97bfa7,0xbf8cbfa7,0x3ed23f49,0x3fb43fa7,0xbfa0bfb2
.long 0xbfa7bf80,0x3fa73fb5,0x3fa73f80,0xbfa7bfb5,0xbe0e3f0b,0x3fa03f49,0x3f8c3f0b,0xbfadbfb2,0x3f973fb5,0x3e8dbf0b,0x3f49a8ea,0xbfb2bfa7,0x3fa03f0b,0xbf66bfb2,0x3ed2bf0b,0xbfb4bf97
.long 0xa760bf80,0xbfb5bf80,0xa880bf80,0xbfb5bf80,0xbfa0bfa7,0xbf663e8d,0xbed2bfa7,0xbfb4bf49,0xbf972690,0x3e8d3fa7,0xbf49bfb5,0xbfb2bf0b,0x3e0e3fa7,0x3fa03f97,0xbf8cbfa7,0xbfadbe8d
.long 0x3fa73f80,0x3fa72760,0xbfa7bf80,0xbfa728d1,0x3f8cbf0b,0x3ed2bf97,0xbfb4bf0b,0xbfa03e8d,0xbe8dbfb5,0xbf49bfa7,0xbfb22872,0xbf973f0b,0xbfadbf0b,0xbfb4be8d,0xbfa03f0b,0xbf8c3f49
.long 0x3f80bf80,0x3f80bf80,0x3f80bf80,0x3f80bf80,0xbf663f80,0xbf2b3f97,0x3e0e3fb5,0x3ed23fb2,0x3f49bf80,0x3e8dbfa7,0xbf97bf80,0xbfb2bf0b,0xbf2b3f80,0x3e0e3fb2,0x3fad2708,0x3f66bf49
.long 0x3f0bbf80,0xbf0bbfb5,0xbf0b3f80,0x3f0b3fb5,0xbed23f80,0x3f663fb2,0xbf2bbfb5,0xbfb4bf49,0x3e8dbf80,0xbf97bfa7,0x3fb23f80,0x3f49bf0b,0xbe0e3f80,0x3fad3f97,0xbf8ca748,0x3f2b3fb2
.long 0x2500bf80,0xbfb5bf80,0x27c8bf80,0xbfb5bf80,0x3e0e3f80,0x3fad3f49,0x3f8c3fb5,0x3f2bbe8d,0xbe8dbf80,0xbf97bf0b,0xbfb2bf80,0x3f493fa7,0x3ed23f80,0x3f663e8d,0x3f2b281c,0xbfb4bf97
.long 0xbf0bbf80,0xbf0ba778,0x3f0b3f80,0x3f0ba690,0x3f2b3f80,0x3e0ebe8d,0xbfadbfb5,0x3f663f97,0xbf49bf80,0x3e8d3f0b,0x3f973f80,0xbfb2bfa7,0x3f663f80,0xbf2bbf49,0xbe0ea7a4,0x3ed23e8d
.long 0xbf80bf80,0x3f803f80,0xbf80bf80,0x3f803f80,0x3f8c3f80,0xbfa0bf97,0x3fb43fb5,0xbfadbfb2,0xbf97bf80,0x3fb23fa7,0xbf49bf80,0x3e8d3f0b,0x3fa03f80,0xbfb4bfb2,0xbed225c0,0x3f8c3f49
.long 0xbfa7bf80,0x3fa73fb5,0x3fa73f80,0xbfa7bfb5,0x3fad3f80,0xbf8cbfb2,0xbfa0bfb5,0x3e0e3f49,0xbfb2bf80,0x3f493fa7,0x3e8d3f80,0x3f973f0b,0x3fb43f80,0xbed2bf97,0x3f66a893,0xbfa0bfb2
.long 0xbfb5bf80,0xa6f03f80,0xbfb5bf80,0x282a3f80,0x3fb43f80,0x3ed2bf49,0x3f663fb5,0x3fa03e8d,0xbfb2bf80,0xbf493f0b,0x3e8dbf80,0xbf97bfa7,0x3fad3f80,0x3f8cbe8d,0xbfa0285a,0xbe0e3f97
.long 0xbfa7bf80,0xbfa7284e,0x3fa73f80,0x3fa72728,0x3fa03f80,0x3fb43e8d,0xbed2bfb5,0xbf8cbf97,0xbf97bf80,0xbfb2bf0b,0xbf493f80,0xbe8d3fa7,0x3f8c3f80,0x3fa03f49,0x3fb4a80e,0x3fadbe8d
.long 0x3f80bf80,0x3f80bf80,0x3f80bf80,0x3f80bf80,0xbed23fa7,0xbe0e3fb2,0x3f2b3fa7,0x3f663f97,0xbe8dbfb5,0xbf49bfa7,0xbfb2a6f0,0xbf973f0b,0x3f663fa7,0x3fad3f49,0x3e0ebfa7,0xbf2bbfb2
.long 0xbfa7bf80,0xbfa7a718,0x3fa73f80,0x3fa72728,0x3fb43f0b,0x3f2bbf49,0xbf663f0b,0x3ed23fb2,0xbf97a728,0x3e8d3fa7,0xbf49bfb5,0xbfb2bf0b,0x3f2bbf0b,0xbf8cbfb2,0x3fad3f0b,0xbe0ebf97
.long 0xa5c03f80,0x3fb53f80,0xa6603f80,0x3fb53f80,0xbf2bbfa7,0xbf8cbe8d,0xbfadbfa7,0xbe0e3f49,0x3f973fb5,0x3e8dbf0b,0x3f49a6d0,0xbfb2bfa7,0xbfb4bfa7,0x3f2b3f97,0x3f663fa7,0x3ed2be8d
.long 0x3fa73f80,0xbfa7bfb5,0xbfa7bf80,0x3fa73fb5,0xbf66bf0b,0x3fad3f97,0xbe0ebf0b,0xbf2bbe8d,0x3e8da690,0xbf49bf0b,0x3fb23fb5,0xbf97bfa7,0x3ed23f0b,0xbe0ebe8d,0xbf2bbf0b,0x3f663f49
.long 0xbf80bf80,0x3f803f80,0xbf80bf80,0x3f803f80,0x3fad3fa7,0xbfb4bfb2,0x3fa03fa7,0xbf8cbf97,0xbfb2bfb5,0x3f973fa7,0x3e8d27a4,0xbf49bf0b,0x3f8c3fa7,0xbed2bf49,0xbfb4bfa7,0x3fa03fb2
.long 0xbf0bbf80,0xbf0b25c0,0x3f0b3f80,0x3f0b278c,0xbe0e3f0b,0x3fa03f49,0x3f8c3f0b,0xbfadbfb2,0x3f49a88d,0xbfb2bfa7,0xbf97bfb5,0xbe8d3f0b,0xbfa0bf0b,0x3f663fb2,0xbed23f0b,0x3fb43f97
.long 0x3fb53f80,0xa78cbf80,0x3fb53f80,0xa887bf80,0xbfa0bfa7,0xbf663e8d,0xbed2bfa7,0xbfb4bf49,0x3f493fb5,0x3fb23f0b,0xbf97a89f,0x3e8d3fa7,0xbe0ebfa7,0xbfa0bf97,0x3f8c3fa7,0x3fad3e8d
.long 0xbf0b3f80,0x3f0b3fb5,0x3f0bbf80,0xbf0bbfb5,0x3f8cbf0b,0x3ed2bf97,0xbfb4bf0b,0xbfa03e8d,0xbfb2285a,0xbf973f0b,0x3e8d3fb5,0x3f493fa7,0x3fad3f0b,0x3fb43e8d,0x3fa0bf0b,0x3f8cbf49
.long 0x3f80bf80,0x3f80bf80,0x3f80bf80,0x3f80bf80,0x3f8c3f80,0x3fa03f49,0x3fb425c0,0x3fadbe8d,0xbf493f80,0xbe8d3fa7,0x3f973f80,0x3fb23f0b,0xbfa0bf80,0xbfb4be8d,0x3ed23fb5,0x3f8c3f97
.long 0x3f0bbf80,0xbf0bbfb5,0xbf0b3f80,0x3f0b3fb5,0x3fad3f80,0x3f8cbe8d,0xbfa0a748,0xbe0e3f97,0xbe8d3f80,0x3f973fa7,0xbfb2bf80,0xbf493f0b,0xbfb4bf80,0xbed23f49,0xbf66bfb5,0xbfa0be8d
.long 0x27d4bf80,0xbfb5bf80,0x27e4bf80,0xbfb5bf80,0x3fb43f80,0xbed2bf97,0x3f66a690,0xbfa0bfb2,0x3e8d3f80,0x3f973f0b,0x3fb23f80,0xbf49bfa7,0xbfadbf80,0x3f8c3fb2,0x3fa03fb5,0xbe0ebf49
.long 0xbf0bbf80,0xbf0ba7a4,0x3f0b3f80,0x3f0b2836,0x3fa03f80,0xbfb4bfb2,0xbed22887,0x3f8c3f49,0x3f493f80,0xbe8dbf0b,0xbf97bf80,0x3fb23fa7,0xbf8cbf80,0x3fa03f97,0xbfb4bfb5,0x3fad3fb2
.long 0xbf80bf80,0x3f803f80,0xbf80bf80,0x3f803f80,0x3f663f80,0xbf2bbf49,0xbe0ea81c,0x3ed23e8d,0x3f973f80,0xbfb2bfa7,0x3f493f80,0xbe8dbf0b,0xbf2bbf80,0xbe0e3e8d,0x3fad3fb5,0xbf66bf97
.long 0xbfa7bf80,0x3fa73fb5,0x3fa73f80,0xbfa7bfb5,0x3ed23f80,0x3f663e8d,0x3f2b2728,0xbfb4bf97,0x3fb23f80,0xbf49bfa7,0xbe8dbf80,0xbf97bf0b,0xbe0ebf80,0xbfadbf49,0xbf8cbfb5,0xbf2b3e8d
.long 0xbfb5bf80,0x25c03f80,0xbfb5bf80,0xa81c3f80,0xbe0e3f80,0x3fad3f97,0xbf8ca893,0x3f2b3fb2,0x3fb23f80,0x3f49bf0b,0xbe8d3f80,0x3f973fa7,0x3ed2bf80,0xbf66bfb2,0x3f2b3fb5,0x3fb43f49
.long 0xbfa7bf80,0xbfa728d7,0x3fa73f80,0x3fa7a836,0xbf2b3f80,0x3e0e3fb2,0x3fada836,0x3f66bf49,0x3f973f80,0x3fb23f0b,0x3f49bf80,0x3e8dbfa7,0x3f66bf80,0x3f2bbf97,0xbe0ebfb5,0xbed2bfb2
.long 0x3f80bf80,0x3f80bf80,0x3f80bf80,0x3f80bf80,0x3fad3f0b,0x3fb43e8d,0x3fa0bf0b,0x3f8cbf49,0x3e8d3fb5,0x3f493fa7,0x3fb22708,0x3f97bf0b,0xbf8c3f0b,0xbed23f97,0x3fb43f0b,0x3fa0be8d
.long 0xbfa7bf80,0xbfa7a728,0x3fa73f80,0x3fa72738,0xbe0ebfa7,0xbfa0bf97,0x3f8c3fa7,0x3fad3e8d,0x3f972758,0xbe8dbfa7,0x3f493fb5,0x3fb23f0b,0x3fa03fa7,0x3f66be8d,0x3ed23fa7,0x3fb43f49
.long 0xa6903f80,0x3fb53f80,0xa6d03f80,0x3fb53f80,0xbfa0bf0b,0x3f663fb2,0xbed23f0b,0x3fb43f97,0xbf97bfb5,0xbe8d3f0b,0xbf49a7a4,0x3fb23fa7,0x3e0ebf0b,0xbfa0bf49,0xbf8cbf0b,0x3fad3fb2
.long 0x3fa73f80,0xbfa7bfb5,0xbfa7bf80,0x3fa73fb5,0x3f8c3fa7,0xbed2bf49,0xbfb4bfa7,0x3fa03fb2,0xbe8da7bc,0x3f493f0b,0xbfb2bfb5,0x3f973fa7,0xbfadbfa7,0x3fb43fb2,0xbfa0bfa7,0x3f8c3f97
.long 0xbf80bf80,0x3f803f80,0xbf80bf80,0x3f803f80,0x3ed23f0b,0xbe0ebe8d,0xbf2bbf0b,0x3f663f49,0x3fb23fb5,0xbf97bfa7,0xbe8d285a,0x3f493f0b,0x3f663f0b,0xbfadbf97,0x3e0e3f0b,0x3f2b3e8d
.long 0xbf0bbf80,0xbf0b285a,0x3f0b3f80,0x3f0ba80e,0xbfb4bfa7,0x3f2b3f97,0x3f663fa7,0x3ed2be8d,0xbf4928cb,0x3fb23fa7,0x3f973fb5,0x3e8dbf0b,0x3f2b3fa7,0x3f8c3e8d,0x3fad3fa7,0x3e0ebf49
.long 0x3fb53f80,0xa8eabf80,0x3fb53f80,0x2760bf80,0x3f2bbf0b,0xbf8cbfb2,0x3fad3f0b,0xbe0ebf97,0xbf49bfb5,0xbfb2bf0b,0x3f9728b9,0xbe8dbfa7,0xbfb4bf0b,0xbf2b3f49,0x3f66bf0b,0xbed2bfb2
.long 0xbf0b3f80,0x3f0b3fb5,0x3f0bbf80,0xbf0bbfb5,0x3f663fa7,0x3fad3f49,0x3e0ebfa7,0xbf2bbfb2,0x3fb2a8b2,0x3f97bf0b,0xbe8dbfb5,0xbf49bfa7,0x3ed2bfa7,0x3e0ebfb2,0xbf2bbfa7,0xbf66bf97
.long 0xbf803f80,0xbf803f80,0xbf803f80,0xbf803f80,0xbf663f80,0xbf2b3f97,0x3e0e3fb5,0x3ed23fb2,0xbf493f80,0xbe8d3fa7,0x3f973f80,0x3fb23f0b,0xbf2b3f80,0x3e0e3fb2,0x3fad2500,0x3f66bf49
.long 0xbf0b3f80,0x3f0b3fb5,0x3f0bbf80,0xbf0bbfb5,0xbed23f80,0x3f663fb2,0xbf2bbfb5,0xbfb4bf49,0xbe8d3f80,0x3f973fa7,0xbfb2bf80,0xbf493f0b,0xbe0e3f80,0x3fad3f97,0xbf8ca5c0,0x3f2b3fb2
.long 0xa5003f80,0x3fb53f80,0xa5c03f80,0x3fb53f80,0x3e0e3f80,0x3fad3f49,0x3f8c3fb5,0x3f2bbe8d,0x3e8d3f80,0x3f973f0b,0x3fb23f80,0xbf49bfa7,0x3ed23f80,0x3f663e8d,0x3f2b26f0,0xbfb4bf97
.long 0x3f0b3f80,0x3f0b2500,0xbf0bbf80,0xbf0ba708,0x3f2b3f80,0x3e0ebe8d,0xbfadbfb5,0x3f663f97,0x3f493f80,0xbe8dbf0b,0xbf97bf80,0x3fb23fa7,0x3f663f80,0xbf2bbf49,0xbe0ea708,0x3ed23e8d
.long 0x3f803f80,0xbf80bf80,0x3f803f80,0xbf80bf80,0x3f8c3f80,0xbfa0bf97,0x3fb43fb5,0xbfadbfb2,0x3f973f80,0xbfb2bfa7,0x3f493f80,0xbe8dbf0b,0x3fa03f80,0xbfb4bfb2,0xbed22718,0x3f8c3f49
.long 0x3fa73f80,0xbfa7bfb5,0xbfa7bf80,0x3fa73fb5,0x3fad3f80,0xbf8cbfb2,0xbfa0bfb5,0x3e0e3f49,0x3fb23f80,0xbf49bfa7,0xbe8dbf80,0xbf97bf0b,0x3fb43f80,0xbed2bf97,0x3f66a728,0xbfa0bfb2
.long 0x3fb53f80,0xa5c0bf80,0x3fb53f80,0xa500bf80,0x3fb43f80,0x3ed2bf49,0x3f663fb5,0x3fa03e8d,0x3fb23f80,0x3f49bf0b,0xbe8d3f80,0x3f973fa7,0x3fad3f80,0x3f8cbe8d,0xbfa02728,0xbe0e3f97
.long 0x3fa73f80,0x3fa7a5c0,0xbfa7bf80,0xbfa72748,0x3fa03f80,0x3fb43e8d,0xbed2bfb5,0xbf8cbf97,0x3f973f80,0x3fb23f0b,0x3f49bf80,0x3e8dbfa7,0x3f8c3f80,0x3fa03f49,0x3fb4a738,0x3fadbe8d
.long 0xbf803f80,0xbf803f80,0xbf803f80,0xbf803f80,0xbed23fa7,0xbe0e3fb2,0x3f2b3fa7,0x3f663f97,0x3e8d3fb5,0x3f493fa7,0x3fb22500,0x3f97bf0b,0x3f663fa7,0x3fad3f49,0x3e0ebfa7,0xbf2bbfb2
.long 0x3fa73f80,0x3fa72500,0xbfa7bf80,0xbfa7a5c0,0x3fb43f0b,0x3f2bbf49,0xbf663f0b,0x3ed23fb2,0x3f972500,0xbe8dbfa7,0x3f493fb5,0x3fb23f0b,0x3f2bbf0b,0xbf8cbfb2,0x3fad3f0b,0xbe0ebf97
.long 0x2580bf80,0xbfb5bf80,0xa660bf80,0xbfb5bf80,0xbf2bbfa7,0xbf8cbe8d,0xbfadbfa7,0xbe0e3f49,0xbf97bfb5,0xbe8d3f0b,0xbf49a708,0x3fb23fa7,0xbfb4bfa7,0x3f2b3f97,0x3f663fa7,0x3ed2be8d
.long 0xbfa7bf80,0x3fa73fb5,0x3fa73f80,0xbfa7bfb5,0xbf66bf0b,0x3fad3f97,0xbe0ebf0b,0xbf2bbe8d,0xbe8da5c0,0x3f493f0b,0xbfb2bfb5,0x3f973fa7,0x3ed23f0b,0xbe0ebe8d,0xbf2bbf0b,0x3f663f49
.long 0x3f803f80,0xbf80bf80,0x3f803f80,0xbf80bf80,0x3fad3fa7,0xbfb4bfb2,0x3fa03fa7,0xbf8cbf97,0x3fb23fb5,0xbf97bfa7,0xbe8d2728,0x3f493f0b,0x3f8c3fa7,0xbed2bf49,0xbfb4bfa7,0x3fa03fb2
.long 0x3f0b3f80,0x3f0ba708,0xbf0bbf80,0xbf0b2748,0xbe0e3f0b,0x3fa03f49,0x3f8c3f0b,0xbfadbfb2,0xbf4926f0,0x3fb23fa7,0x3f973fb5,0x3e8dbf0b,0xbfa0bf0b,0x3f663fb2,0xbed23f0b,0x3fb43f97
.long 0xbfb5bf80,0xa5c03f80,0xbfb5bf80,0x26603f80,0xbfa0bfa7,0xbf663e8d,0xbed2bfa7,0xbfb4bf49,0xbf49bfb5,0xbfb2bf0b,0x3f972718,0xbe8dbfa7,0xbe0ebfa7,0xbfa0bf97,0x3f8c3fa7,0x3fad3e8d
.long 0x3f0bbf80,0xbf0bbfb5,0xbf0b3f80,0x3f0b3fb5,0x3f8cbf0b,0x3ed2bf97,0xbfb4bf0b,0xbfa03e8d,0x3fb2a708,0x3f97bf0b,0xbe8dbfb5,0xbf49bfa7,0x3fad3f0b,0x3fb43e8d,0x3fa0bf0b,0x3f8cbf49
.long 0xbf803f80,0xbf803f80,0xbf803f80,0xbf803f80,0x3f8c3f80,0x3fa03f49,0x3fb42500,0x3fadbe8d,0x3f49bf80,0x3e8dbfa7,0xbf97bf80,0xbfb2bf0b,0xbfa0bf80,0xbfb4be8d,0x3ed23fb5,0x3f8c3f97
.long 0xbf0b3f80,0x3f0b3fb5,0x3f0bbf80,0xbf0bbfb5,0x3fad3f80,0x3f8cbe8d,0xbfa0a708,0xbe0e3f97,0x3e8dbf80,0xbf97bfa7,0x3fb23f80,0x3f49bf0b,0xbfb4bf80,0xbed23f49,0xbf66bfb5,0xbfa0be8d
.long 0x26203f80,0x3fb53f80,0x25003f80,0x3fb53f80,0x3fb43f80,0xbed2bf97,0x3f662728,0xbfa0bfb2,0xbe8dbf80,0xbf97bf0b,0xbfb2bf80,0x3f493fa7,0xbfadbf80,0x3f8c3fb2,0x3fa03fb5,0xbe0ebf49
.long 0x3f0b3f80,0x3f0b2728,0xbf0bbf80,0xbf0ba758,0x3fa03f80,0xbfb4bfb2,0xbed22718,0x3f8c3f49,0xbf49bf80,0x3e8d3f0b,0x3f973f80,0xbfb2bfa7,0xbf8cbf80,0x3fa03f97,0xbfb4bfb5,0x3fad3fb2
.long 0x3f803f80,0xbf80bf80,0x3f803f80,0xbf80bf80,0x3f663f80,0xbf2bbf49,0xbe0ea7ec,0x3ed23e8d,0xbf97bf80,0x3fb23fa7,0xbf49bf80,0x3e8d3f0b,0xbf2bbf80,0xbe0e3e8d,0x3fad3fb5,0xbf66bf97
.long 0x3fa73f80,0xbfa7bfb5,0xbfa7bf80,0x3fa73fb5,0x3ed23f80,0x3f663e8d,0x3f2b2690,0xbfb4bf97,0xbfb2bf80,0x3f493fa7,0x3e8d3f80,0x3f973f0b,0xbe0ebf80,0xbfadbf49,0xbf8cbfb5,0xbf2b3e8d
.long 0x3fb53f80,0xa7e4bf80,0x3fb53f80,0xa802bf80,0xbe0e3f80,0x3fad3f97,0xbf8c27a4,0x3f2b3fb2,0xbfb2bf80,0xbf493f0b,0x3e8dbf80,0xbf97bfa7,0x3ed2bf80,0xbf66bfb2,0x3f2b3fb5,0x3fb43f49
.long 0x3fa73f80,0x3fa72690,0xbfa7bf80,0xbfa727bc,0xbf2b3f80,0x3e0e3fb2,0x3fada836,0x3f66bf49,0xbf97bf80,0xbfb2bf0b,0xbf493f80,0xbe8d3fa7,0x3f66bf80,0x3f2bbf97,0xbe0ebfb5,0xbed2bfb2
.long 0xbf803f80,0xbf803f80,0xbf803f80,0xbf803f80,0x3fad3f0b,0x3fb43e8d,0x3fa0bf0b,0x3f8cbf49,0xbe8dbfb5,0xbf49bfa7,0xbfb2a5c0,0xbf973f0b,0xbf8c3f0b,0xbed23f97,0x3fb43f0b,0x3fa0be8d
.long 0x3fa73f80,0x3fa726f0,0xbfa7bf80,0xbfa7a708,0xbe0ebfa7,0xbfa0bf97,0x3f8c3fa7,0x3fad3e8d,0xbf97a708,0x3e8d3fa7,0xbf49bfb5,0xbfb2bf0b,0x3fa03fa7,0x3f66be8d,0x3ed23fa7,0x3fb43f49
.long 0xa5c0bf80,0xbfb5bf80,0xbf80,0xbfb5bf80,0xbfa0bf0b,0x3f663fb2,0xbed23f0b,0x3fb43f97,0x3f973fb5,0x3e8dbf0b,0x3f492748,0xbfb2bfa7,0x3e0ebf0b,0xbfa0bf49,0xbf8cbf0b,0x3fad3fb2
.long 0xbfa7bf80,0x3fa73fb5,0x3fa73f80,0xbfa7bfb5,0x3f8c3fa7,0xbed2bf49,0xbfb4bfa7,0x3fa03fb2,0x3e8d2748,0xbf49bf0b,0x3fb23fb5,0xbf97bfa7,0xbfadbfa7,0x3fb43fb2,0xbfa0bfa7,0x3f8c3f97
.long 0x3f803f80,0xbf80bf80,0x3f803f80,0xbf80bf80,0x3ed23f0b,0xbe0ebe8d,0xbf2bbf0b,0x3f663f49,0xbfb2bfb5,0x3f973fa7,0x3e8d2690,0xbf49bf0b,0x3f663f0b,0xbfadbf97,0x3e0e3f0b,0x3f2b3e8d
.long 0x3f0b3f80,0x3f0b26d0,0xbf0bbf80,0xbf0b27a4,0xbfb4bfa7,0x3f2b3f97,0x3f663fa7,0x3ed2be8d,0x3f49a81c,0xbfb2bfa7,0xbf97bfb5,0xbe8d3f0b,0x3f2b3fa7,0x3f8c3e8d,0x3fad3fa7,0x3e0ebf49
.long 0xbfb5bf80,0x26f03f80,0xbfb5bf80,0x28663f80,0x3f2bbf0b,0xbf8cbfb2,0x3fad3f0b,0xbe0ebf97,0x3f493fb5,0x3fb23f0b,0xbf97a887,0x3e8d3fa7,0xbfb4bf0b,0xbf2b3f49,0x3f66bf0b,0xbed2bfb2
.long 0x3f0bbf80,0xbf0bbfb5,0xbf0b3f80,0x3f0b3fb5,0x3f663fa7,0x3fad3f49,0x3e0ebfa7,0xbf2bbfb2,0xbfb227a4,0xbf973f0b,0x3e8d3fb5,0x3f493fa7,0x3ed2bfa7,0x3e0ebfb2,0xbf2bbfa7,0xbf66bf97
.long 0x3f803f80,0x3f803f80,0x3f803f80,0x3f803f80,0x3f8c3f80,0x3fa03f49,0x3fb42500,0x3fadbe8d,0x3f973f80,0x3fb23f0b,0x3f49bf80,0x3e8dbfa7,0x3fa03f80,0x3fb43e8d,0xbed2bfb5,0xbf8cbf97
.long 0x3fa73f80,0x3fa72500,0xbfa7bf80,0xbfa7a580,0x3fad3f80,0x3f8cbe8d,0xbfa0a580,0xbe0e3f97,0x3fb23f80,0x3f49bf0b,0xbe8d3f80,0x3f973fa7,0x3fb43f80,0x3ed2bf49,0x3f663fb5,0x3fa03e8d
.long 0x3fb53f80,0x2500bf80,0x3fb53f80,0x26f0bf80,0x3fb43f80,0xbed2bf97,0x3f6625c0,0xbfa0bfb2,0x3fb23f80,0xbf49bfa7,0xbe8dbf80,0xbf97bf0b,0x3fad3f80,0xbf8cbfb2,0xbfa0bfb5,0x3e0e3f49
.long 0x3fa73f80,0xbfa7bfb5,0xbfa7bf80,0x3fa73fb5,0x3fa03f80,0xbfb4bfb2,0xbed22660,0x3f8c3f49,0x3f973f80,0xbfb2bfa7,0x3f493f80,0xbe8dbf0b,0x3f8c3f80,0xbfa0bf97,0x3fb43fb5,0xbfadbfb2
.long 0x3f803f80,0xbf80bf80,0x3f803f80,0xbf80bf80,0x3f663f80,0xbf2bbf49,0xbe0ea620,0x3ed23e8d,0x3f493f80,0xbe8dbf0b,0xbf97bf80,0x3fb23fa7,0x3f2b3f80,0x3e0ebe8d,0xbfadbfb5,0x3f663f97
.long 0x3f0b3f80,0x3f0ba580,0xbf0bbf80,0xbf0ba500,0x3ed23f80,0x3f663e8d,0x3f2b25c0,0xbfb4bf97,0x3e8d3f80,0x3f973f0b,0x3fb23f80,0xbf49bfa7,0x3e0e3f80,0x3fad3f49,0x3f8c3fb5,0x3f2bbe8d
.long 0x25003f80,0x3fb53f80,0x27283f80,0x3fb53f80,0xbe0e3f80,0x3fad3f97,0xbf8ca500,0x3f2b3fb2,0xbe8d3f80,0x3f973fa7,0xbfb2bf80,0xbf493f0b,0xbed23f80,0x3f663fb2,0xbf2bbfb5,0xbfb4bf49
.long 0xbf0b3f80,0x3f0b3fb5,0x3f0bbf80,0xbf0bbfb5,0xbf2b3f80,0x3e0e3fb2,0x3fad0000,0x3f66bf49,0xbf493f80,0xbe8d3fa7,0x3f973f80,0x3fb23f0b,0xbf663f80,0xbf2b3f97,0x3e0e3fb5,0x3ed23fb2
.long 0x3f803f80,0x3f803f80,0x3f803f80,0x3f803f80,0x3fad3f0b,0x3fb43e8d,0x3fa0bf0b,0x3f8cbf49,0x3fb22500,0x3f97bf0b,0xbe8dbfb5,0xbf49bfa7,0x3f8cbf0b,0x3ed2bf97,0xbfb4bf0b,0xbfa03e8d
.long 0x3f0bbf80,0xbf0bbfb5,0xbf0b3f80,0x3f0b3fb5,0xbe0ebfa7,0xbfa0bf97,0x3f8c3fa7,0x3fad3e8d,0xbf49bfb5,0xbfb2bf0b,0x3f9725c0,0xbe8dbfa7,0xbfa0bfa7,0xbf663e8d,0xbed2bfa7,0xbfb4bf49
.long 0xbfb5bf80,0xa5c03f80,0xbfb5bf80,0xa7083f80,0xbfa0bf0b,0x3f663fb2,0xbed23f0b,0x3fb43f97,0xbf49a580,0x3fb23fa7,0x3f973fb5,0x3e8dbf0b,0xbe0e3f0b,0x3fa03f49,0x3f8c3f0b,0xbfadbfb2
.long 0x3f0b3f80,0x3f0b25c0,0xbf0bbf80,0xbf0b25c0,0x3f8c3fa7,0xbed2bf49,0xbfb4bfa7,0x3fa03fb2,0x3fb23fb5,0xbf97bfa7,0xbe8d25c0,0x3f493f0b,0x3fad3fa7,0xbfb4bfb2,0x3fa03fa7,0xbf8cbf97
.long 0x3f803f80,0xbf80bf80,0x3f803f80,0xbf80bf80,0x3ed23f0b,0xbe0ebe8d,0xbf2bbf0b,0x3f663f49,0xbe8d25c0,0x3f493f0b,0xbfb2bfb5,0x3f973fa7,0xbf66bf0b,0x3fad3f97,0xbe0ebf0b,0xbf2bbe8d
.long 0xbfa7bf80,0x3fa73fb5,0x3fa73f80,0xbfa7bfb5,0xbfb4bfa7,0x3f2b3f97,0x3f663fa7,0x3ed2be8d,0xbf97bfb5,0xbe8d3f0b,0xbf4927bc,0x3fb23fa7,0xbf2bbfa7,0xbf8cbe8d,0xbfadbfa7,0xbe0e3f49
.long 0xa708bf80,0xbfb5bf80,0xa758bf80,0xbfb5bf80,0x3f2bbf0b,0xbf8cbfb2,0x3fad3f0b,0xbe0ebf97,0x3f972660,0xbe8dbfa7,0x3f493fb5,0x3fb23f0b,0x3fb43f0b,0x3f2bbf49,0xbf663f0b,0x3ed23fb2
.long 0x3fa73f80,0x3fa725c0,0xbfa7bf80,0xbfa727d4,0x3f663fa7,0x3fad3f49,0x3e0ebfa7,0xbf2bbfb2,0x3e8d3fb5,0x3f493fa7,0x3fb2a842,0x3f97bf0b,0xbed23fa7,0xbe0e3fb2,0x3f2b3fa7,0x3f663f97
.long 0x3f803f80,0x3f803f80,0x3f803f80,0x3f803f80,0x3f66bf80,0x3f2bbf97,0xbe0ebfb5,0xbed2bfb2,0xbf97bf80,0xbfb2bf0b,0xbf493f80,0xbe8d3fa7,0xbf2b3f80,0x3e0e3fb2,0x3fad25c0,0x3f66bf49
.long 0x3fa73f80,0x3fa725c0,0xbfa7bf80,0xbfa72660,0x3ed2bf80,0xbf66bfb2,0x3f2b3fb5,0x3fb43f49,0xbfb2bf80,0xbf493f0b,0x3e8dbf80,0xbf97bfa7,0xbe0e3f80,0x3fad3f97,0xbf8c25c0,0x3f2b3fb2
.long 0x3fb53f80,0x2718bf80,0x3fb53f80,0x2728bf80,0xbe0ebf80,0xbfadbf49,0xbf8cbfb5,0xbf2b3e8d,0xbfb2bf80,0x3f493fa7,0x3e8d3f80,0x3f973f0b,0x3ed23f80,0x3f663e8d,0x3f2b27bc,0xbfb4bf97
.long 0x3fa73f80,0xbfa7bfb5,0xbfa7bf80,0x3fa73fb5,0xbf2bbf80,0xbe0e3e8d,0x3fad3fb5,0xbf66bf97,0xbf97bf80,0x3fb23fa7,0xbf49bf80,0x3e8d3f0b,0x3f663f80,0xbf2bbf49,0xbe0ea842,0x3ed23e8d
.long 0x3f803f80,0xbf80bf80,0x3f803f80,0xbf80bf80,0xbf8cbf80,0x3fa03f97,0xbfb4bfb5,0x3fad3fb2,0xbf49bf80,0x3e8d3f0b,0x3f973f80,0xbfb2bfa7,0x3fa03f80,0xbfb4bfb2,0xbed227e4,0x3f8c3f49
.long 0x3f0b3f80,0x3f0ba660,0xbf0bbf80,0xbf0b27ec,0xbfadbf80,0x3f8c3fb2,0x3fa03fb5,0xbe0ebf49,0xbe8dbf80,0xbf97bf0b,0xbfb2bf80,0x3f493fa7,0x3fb43f80,0xbed2bf97,0x3f66a6f0,0xbfa0bfb2
.long 0x27783f80,0x3fb53f80,0x27a43f80,0x3fb53f80,0xbfb4bf80,0xbed23f49,0xbf66bfb5,0xbfa0be8d,0x3e8dbf80,0xbf97bfa7,0x3fb23f80,0x3f49bf0b,0x3fad3f80,0x3f8cbe8d,0xbfa02802,0xbe0e3f97
.long 0xbf0b3f80,0x3f0b3fb5,0x3f0bbf80,0xbf0bbfb5,0xbfa0bf80,0xbfb4be8d,0x3ed23fb5,0x3f8c3f97,0x3f49bf80,0x3e8dbfa7,0xbf97bf80,0xbfb2bf0b,0x3f8c3f80,0x3fa03f49,0x3fb4a866,0x3fadbe8d
.long 0x3f803f80,0x3f803f80,0x3f803f80,0x3f803f80,0x3ed2bfa7,0x3e0ebfb2,0xbf2bbfa7,0xbf66bf97,0xbfb2a580,0xbf973f0b,0x3e8d3fb5,0x3f493fa7,0x3f663fa7,0x3fad3f49,0x3e0ebfa7,0xbf2bbfb2
.long 0x3f0bbf80,0xbf0bbfb5,0xbf0b3f80,0x3f0b3fb5,0xbfb4bf0b,0xbf2b3f49,0x3f66bf0b,0xbed2bfb2,0x3f493fb5,0x3fb23f0b,0xbf9725c0,0x3e8d3fa7,0x3f2bbf0b,0xbf8cbfb2,0x3fad3f0b,0xbe0ebf97
.long 0xbfb5bf80,0xa7283f80,0xbfb5bf80,0xa7383f80,0x3f2b3fa7,0x3f8c3e8d,0x3fad3fa7,0x3e0ebf49,0x3f49a500,0xbfb2bfa7,0xbf97bfb5,0xbe8d3f0b,0xbfb4bfa7,0x3f2b3f97,0x3f663fa7,0x3ed2be8d
.long 0x3f0b3f80,0x3f0b2500,0xbf0bbf80,0xbf0ba660,0x3f663f0b,0xbfadbf97,0x3e0e3f0b,0x3f2b3e8d,0xbfb2bfb5,0x3f973fa7,0x3e8d27d4,0xbf49bf0b,0x3ed23f0b,0xbe0ebe8d,0xbf2bbf0b,0x3f663f49
.long 0x3f803f80,0xbf80bf80,0x3f803f80,0xbf80bf80,0xbfadbfa7,0x3fb43fb2,0xbfa0bfa7,0x3f8c3f97,0x3e8da660,0xbf49bf0b,0x3fb23fb5,0xbf97bfa7,0x3f8c3fa7,0xbed2bf49,0xbfb4bfa7,0x3fa03fb2
.long 0xbfa7bf80,0x3fa73fb5,0x3fa73f80,0xbfa7bfb5,0x3e0ebf0b,0xbfa0bf49,0xbf8cbf0b,0x3fad3fb2,0x3f973fb5,0x3e8dbf0b,0x3f49a85a,0xbfb2bfa7,0xbfa0bf0b,0x3f663fb2,0xbed23f0b,0x3fb43f97
.long 0x2690bf80,0xbfb5bf80,0xa836bf80,0xbfb5bf80,0x3fa03fa7,0x3f66be8d,0x3ed23fa7,0x3fb43f49,0xbf97a778,0x3e8d3fa7,0xbf49bfb5,0xbfb2bf0b,0xbe0ebfa7,0xbfa0bf97,0x3f8c3fa7,0x3fad3e8d
.long 0x3fa73f80,0x3fa7a718,0xbfa7bf80,0xbfa7a6f0,0xbf8c3f0b,0xbed23f97,0x3fb43f0b,0x3fa0be8d,0xbe8dbfb5,0xbf49bfa7,0xbfb228a5,0xbf973f0b,0x3fad3f0b,0x3fb43e8d,0x3fa0bf0b,0x3f8cbf49
.long 0xbf803f80,0xbf803f80,0xbf803f80,0xbf803f80,0x3f66bf80,0x3f2bbf97,0xbe0ebfb5,0xbed2bfb2,0xbf493f80,0xbe8d3fa7,0x3f973f80,0x3fb23f0b,0x3f2bbf80,0xbe0ebfb2,0xbfada708,0xbf663f49
.long 0xbf0b3f80,0x3f0b3fb5,0x3f0bbf80,0xbf0bbfb5,0x3ed2bf80,0xbf66bfb2,0x3f2b3fb5,0x3fb43f49,0xbe8d3f80,0x3f973fa7,0xbfb2bf80,0xbf493f0b,0x3e0ebf80,0xbfadbf97,0x3f8c2748,0xbf2bbfb2
.long 0xa5003f80,0x3fb53f80,0xa7c83f80,0x3fb53f80,0xbe0ebf80,0xbfadbf49,0xbf8cbfb5,0xbf2b3e8d,0x3e8d3f80,0x3f973f0b,0x3fb23f80,0xbf49bfa7,0xbed2bf80,0xbf66be8d,0xbf2ba81c,0x3fb43f97
.long 0x3f0b3f80,0x3f0b2778,0xbf0bbf80,0xbf0b2690,0xbf2bbf80,0xbe0e3e8d,0x3fad3fb5,0xbf66bf97,0x3f493f80,0xbe8dbf0b,0xbf97bf80,0x3fb23fa7,0xbf66bf80,0x3f2b3f49,0x3e0e27a4,0xbed2be8d
.long 0x3f803f80,0xbf80bf80,0x3f803f80,0xbf80bf80,0xbf8cbf80,0x3fa03f97,0xbfb4bfb5,0x3fad3fb2,0x3f973f80,0xbfb2bfa7,0x3f493f80,0xbe8dbf0b,0xbfa0bf80,0x3fb43fb2,0x3ed2a5c0,0xbf8cbf49
.long 0x3fa73f80,0xbfa7bfb5,0xbfa7bf80,0x3fa73fb5,0xbfadbf80,0x3f8c3fb2,0x3fa03fb5,0xbe0ebf49,0x3fb23f80,0xbf49bfa7,0xbe8dbf80,0xbf97bf0b,0xbfb4bf80,0x3ed23f97,0xbf662893,0x3fa03fb2
.long 0x3fb53f80,0x26f0bf80,0x3fb53f80,0xa82abf80,0xbfb4bf80,0xbed23f49,0xbf66bfb5,0xbfa0be8d,0x3fb23f80,0x3f49bf0b,0xbe8d3f80,0x3f973fa7,0xbfadbf80,0xbf8c3e8d,0x3fa0a85a,0x3e0ebf97
.long 0x3fa73f80,0x3fa7a84e,0xbfa7bf80,0xbfa7a728,0xbfa0bf80,0xbfb4be8d,0x3ed23fb5,0x3f8c3f97,0x3f973f80,0x3fb23f0b,0x3f49bf80,0x3e8dbfa7,0xbf8cbf80,0xbfa0bf49,0xbfb4280e,0xbfad3e8d
.long 0xbf803f80,0xbf803f80,0xbf803f80,0xbf803f80,0x3ed2bfa7,0x3e0ebfb2,0xbf2bbfa7,0xbf66bf97,0x3e8d3fb5,0x3f493fa7,0x3fb226f0,0x3f97bf0b,0xbf66bfa7,0xbfadbf49,0xbe0e3fa7,0x3f2b3fb2
.long 0x3fa73f80,0x3fa72718,0xbfa7bf80,0xbfa7a728,0xbfb4bf0b,0xbf2b3f49,0x3f66bf0b,0xbed2bfb2,0x3f972728,0xbe8dbfa7,0x3f493fb5,0x3fb23f0b,0xbf2b3f0b,0x3f8c3fb2,0xbfadbf0b,0x3e0e3f97
.long 0x25c0bf80,0xbfb5bf80,0x2660bf80,0xbfb5bf80,0x3f2b3fa7,0x3f8c3e8d,0x3fad3fa7,0x3e0ebf49,0xbf97bfb5,0xbe8d3f0b,0xbf4926d0,0x3fb23fa7,0x3fb43fa7,0xbf2bbf97,0xbf66bfa7,0xbed23e8d
.long 0xbfa7bf80,0x3fa73fb5,0x3fa73f80,0xbfa7bfb5,0x3f663f0b,0xbfadbf97,0x3e0e3f0b,0x3f2b3e8d,0xbe8d2690,0x3f493f0b,0xbfb2bfb5,0x3f973fa7,0xbed2bf0b,0x3e0e3e8d,0x3f2b3f0b,0xbf66bf49
.long 0x3f803f80,0xbf80bf80,0x3f803f80,0xbf80bf80,0xbfadbfa7,0x3fb43fb2,0xbfa0bfa7,0x3f8c3f97,0x3fb23fb5,0xbf97bfa7,0xbe8da7a4,0x3f493f0b,0xbf8cbfa7,0x3ed23f49,0x3fb43fa7,0xbfa0bfb2
.long 0x3f0b3f80,0x3f0ba5c0,0xbf0bbf80,0xbf0ba78c,0x3e0ebf0b,0xbfa0bf49,0xbf8cbf0b,0x3fad3fb2,0xbf49288d,0x3fb23fa7,0x3f973fb5,0x3e8dbf0b,0x3fa03f0b,0xbf66bfb2,0x3ed2bf0b,0xbfb4bf97
.long 0xbfb5bf80,0x278c3f80,0xbfb5bf80,0x28873f80,0x3fa03fa7,0x3f66be8d,0x3ed23fa7,0x3fb43f49,0xbf49bfb5,0xbfb2bf0b,0x3f97289f,0xbe8dbfa7,0x3e0e3fa7,0x3fa03f97,0xbf8cbfa7,0xbfadbe8d
.long 0x3f0bbf80,0xbf0bbfb5,0xbf0b3f80,0x3f0b3fb5,0xbf8c3f0b,0xbed23f97,0x3fb43f0b,0x3fa0be8d,0x3fb2a85a,0x3f97bf0b,0xbe8dbfb5,0xbf49bfa7,0xbfadbf0b,0xbfb4be8d,0xbfa03f0b,0xbf8c3f49
.long 0xbf803f80,0xbf803f80,0xbf803f80,0xbf803f80,0xbf8cbf80,0xbfa0bf49,0xbfb4a5c0,0xbfad3e8d,0x3f49bf80,0x3e8dbfa7,0xbf97bf80,0xbfb2bf0b,0x3fa03f80,0x3fb43e8d,0xbed2bfb5,0xbf8cbf97
.long 0xbf0b3f80,0x3f0b3fb5,0x3f0bbf80,0xbf0bbfb5,0xbfadbf80,0xbf8c3e8d,0x3fa02748,0x3e0ebf97,0x3e8dbf80,0xbf97bfa7,0x3fb23f80,0x3f49bf0b,0x3fb43f80,0x3ed2bf49,0x3f663fb5,0x3fa03e8d
.long 0xa7d43f80,0x3fb53f80,0xa7e43f80,0x3fb53f80,0xbfb4bf80,0x3ed23f97,0xbf662690,0x3fa03fb2,0xbe8dbf80,0xbf97bf0b,0xbfb2bf80,0x3f493fa7,0x3fad3f80,0xbf8cbfb2,0xbfa0bfb5,0x3e0e3f49
.long 0x3f0b3f80,0x3f0b27a4,0xbf0bbf80,0xbf0ba836,0xbfa0bf80,0x3fb43fb2,0x3ed2a887,0xbf8cbf49,0xbf49bf80,0x3e8d3f0b,0x3f973f80,0xbfb2bfa7,0x3f8c3f80,0xbfa0bf97,0x3fb43fb5,0xbfadbfb2
.long 0x3f803f80,0xbf80bf80,0x3f803f80,0xbf80bf80,0xbf66bf80,0x3f2b3f49,0x3e0e281c,0xbed2be8d,0xbf97bf80,0x3fb23fa7,0xbf49bf80,0x3e8d3f0b,0x3f2b3f80,0x3e0ebe8d,0xbfadbfb5,0x3f663f97
.long 0x3fa73f80,0xbfa7bfb5,0xbfa7bf80,0x3fa73fb5,0xbed2bf80,0xbf66be8d,0xbf2ba728,0x3fb43f97,0xbfb2bf80,0x3f493fa7,0x3e8d3f80,0x3f973f0b,0x3e0e3f80,0x3fad3f49,0x3f8c3fb5,0x3f2bbe8d
.long 0x3fb53f80,0xa5c0bf80,0x3fb53f80,0x281cbf80,0x3e0ebf80,0xbfadbf97,0x3f8c2893,0xbf2bbfb2,0xbfb2bf80,0xbf493f0b,0x3e8dbf80,0xbf97bfa7,0xbed23f80,0x3f663fb2,0xbf2bbfb5,0xbfb4bf49
.long 0x3fa73f80,0x3fa7a8d7,0xbfa7bf80,0xbfa72836,0x3f2bbf80,0xbe0ebfb2,0xbfad2836,0xbf663f49,0xbf97bf80,0xbfb2bf0b,0xbf493f80,0xbe8d3fa7,0xbf663f80,0xbf2b3f97,0x3e0e3fb5,0x3ed23fb2
.long 0xbf803f80,0xbf803f80,0xbf803f80,0xbf803f80,0xbfadbf0b,0xbfb4be8d,0xbfa03f0b,0xbf8c3f49,0xbe8dbfb5,0xbf49bfa7,0xbfb2a708,0xbf973f0b,0x3f8cbf0b,0x3ed2bf97,0xbfb4bf0b,0xbfa03e8d
.long 0x3fa73f80,0x3fa72728,0xbfa7bf80,0xbfa7a738,0x3e0e3fa7,0x3fa03f97,0xbf8cbfa7,0xbfadbe8d,0xbf97a758,0x3e8d3fa7,0xbf49bfb5,0xbfb2bf0b,0xbfa0bfa7,0xbf663e8d,0xbed2bfa7,0xbfb4bf49
.long 0x2690bf80,0xbfb5bf80,0x26d0bf80,0xbfb5bf80,0x3fa03f0b,0xbf66bfb2,0x3ed2bf0b,0xbfb4bf97,0x3f973fb5,0x3e8dbf0b,0x3f4927a4,0xbfb2bfa7,0xbe0e3f0b,0x3fa03f49,0x3f8c3f0b,0xbfadbfb2
.long 0xbfa7bf80,0x3fa73fb5,0x3fa73f80,0xbfa7bfb5,0xbf8cbfa7,0x3ed23f49,0x3fb43fa7,0xbfa0bfb2,0x3e8d27bc,0xbf49bf0b,0x3fb23fb5,0xbf97bfa7,0x3fad3fa7,0xbfb4bfb2,0x3fa03fa7,0xbf8cbf97
.long 0x3f803f80,0xbf80bf80,0x3f803f80,0xbf80bf80,0xbed2bf0b,0x3e0e3e8d,0x3f2b3f0b,0xbf66bf49,0xbfb2bfb5,0x3f973fa7,0x3e8da85a,0xbf49bf0b,0xbf66bf0b,0x3fad3f97,0xbe0ebf0b,0xbf2bbe8d
.long 0x3f0b3f80,0x3f0ba85a,0xbf0bbf80,0xbf0b280e,0x3fb43fa7,0xbf2bbf97,0xbf66bfa7,0xbed23e8d,0x3f49a8cb,0xbfb2bfa7,0xbf97bfb5,0xbe8d3f0b,0xbf2bbfa7,0xbf8cbe8d,0xbfadbfa7,0xbe0e3f49
.long 0xbfb5bf80,0x28ea3f80,0xbfb5bf80,0xa7603f80,0xbf2b3f0b,0x3f8c3fb2,0xbfadbf0b,0x3e0e3f97,0x3f493fb5,0x3fb23f0b,0xbf97a8b9,0x3e8d3fa7,0x3fb43f0b,0x3f2bbf49,0xbf663f0b,0x3ed23fb2
.long 0x3f0bbf80,0xbf0bbfb5,0xbf0b3f80,0x3f0b3fb5,0xbf66bfa7,0xbfadbf49,0xbe0e3fa7,0x3f2b3fb2,0xbfb228b2,0xbf973f0b,0x3e8d3fb5,0x3f493fa7,0xbed23fa7,0xbe0e3fb2,0x3f2b3fa7,0x3f663f97
.long 0x3f803f80,0x3f803f80,0x3f803f80,0x3f803f80,0xbf8cbf80,0xbfa0bf49,0xbfb4a580,0xbfad3e8d,0x3f973f80,0x3fb23f0b,0x3f49bf80,0x3e8dbfa7,0xbfa0bf80,0xbfb4be8d,0x3ed23fb5,0x3f8c3f97
.long 0x3fa73f80,0x3fa7a620,0xbfa7bf80,0xbfa725c0,0xbfadbf80,0xbf8c3e8d,0x3fa0a500,0x3e0ebf97,0x3fb23f80,0x3f49bf0b,0xbe8d3f80,0x3f973fa7,0xbfb4bf80,0xbed23f49,0xbf66bfb5,0xbfa0be8d
.long 0x3fb53f80,0x2748bf80,0x3fb53f80,0x2760bf80,0xbfb4bf80,0x3ed23f97,0xbf66a660,0x3fa03fb2,0x3fb23f80,0xbf49bfa7,0xbe8dbf80,0xbf97bf0b,0xbfadbf80,0x3f8c3fb2,0x3fa03fb5,0xbe0ebf49
.long 0x3fa73f80,0xbfa7bfb5,0xbfa7bf80,0x3fa73fb5,0xbfa0bf80,0x3fb43fb2,0x3ed2a778,0xbf8cbf49,0x3f973f80,0xbfb2bfa7,0x3f493f80,0xbe8dbf0b,0xbf8cbf80,0x3fa03f97,0xbfb4bfb5,0x3fad3fb2
.long 0x3f803f80,0xbf80bf80,0x3f803f80,0xbf80bf80,0xbf66bf80,0x3f2b3f49,0x3e0ea728,0xbed2be8d,0x3f493f80,0xbe8dbf0b,0xbf97bf80,0x3fb23fa7,0xbf2bbf80,0xbe0e3e8d,0x3fad3fb5,0xbf66bf97
.long 0x3f0b3f80,0x3f0ba728,0xbf0bbf80,0xbf0ba6f0,0xbed2bf80,0xbf66be8d,0xbf2ba6f0,0x3fb43f97,0x3e8d3f80,0x3f973f0b,0x3fb23f80,0xbf49bfa7,0xbe0ebf80,0xbfadbf49,0xbf8cbfb5,0xbf2b3e8d
.long 0xa7a43f80,0x3fb53f80,0x27ec3f80,0x3fb53f80,0x3e0ebf80,0xbfadbf97,0x3f8c27d4,0xbf2bbfb2,0xbe8d3f80,0x3f973fa7,0xbfb2bf80,0xbf493f0b,0x3ed2bf80,0xbf66bfb2,0x3f2b3fb5,0x3fb43f49
.long 0xbf0b3f80,0x3f0b3fb5,0x3f0bbf80,0xbf0bbfb5,0x3f2bbf80,0xbe0ebfb2,0xbfada836,0xbf663f49,0xbf493f80,0xbe8d3fa7,0x3f973f80,0x3fb23f0b,0x3f66bf80,0x3f2bbf97,0xbe0ebfb5,0xbed2bfb2
.long 0x3f803f80,0x3f803f80,0x3f803f80,0x3f803f80,0xbfadbf0b,0xbfb4be8d,0xbfa03f0b,0xbf8c3f49,0x3fb225c0,0x3f97bf0b,0xbe8dbfb5,0xbf49bfa7,0xbf8c3f0b,0xbed23f97,0x3fb43f0b,0x3fa0be8d
.long 0x3f0bbf80,0xbf0bbfb5,0xbf0b3f80,0x3f0b3fb5,0x3e0e3fa7,0x3fa03f97,0xbf8cbfa7,0xbfadbe8d,0xbf49bfb5,0xbfb2bf0b,0x3f972500,0xbe8dbfa7,0x3fa03fa7,0x3f66be8d,0x3ed23fa7,0x3fb43f49
.long 0xbfb5bf80,0xa7583f80,0xbfb5bf80,0x26f03f80,0x3fa03f0b,0xbf66bfb2,0x3ed2bf0b,0xbfb4bf97,0xbf49a660,0x3fb23fa7,0x3f973fb5,0x3e8dbf0b,0x3e0ebf0b,0xbfa0bf49,0xbf8cbf0b,0x3fad3fb2
.long 0x3f0b3f80,0x3f0b27e4,0xbf0bbf80,0xbf0ba6f0,0xbf8cbfa7,0x3ed23f49,0x3fb43fa7,0xbfa0bfb2,0x3fb23fb5,0xbf97bfa7,0xbe8da718,0x3f493f0b,0xbfadbfa7,0x3fb43fb2,0xbfa0bfa7,0x3f8c3f97
.long 0x3f803f80,0xbf80bf80,0x3f803f80,0xbf80bf80,0xbed2bf0b,0x3e0e3e8d,0x3f2b3f0b,0xbf66bf49,0xbe8d2802,0x3f493f0b,0xbfb2bfb5,0x3f973fa7,0x3f663f0b,0xbfadbf97,0x3e0e3f0b,0x3f2b3e8d
.long 0xbfa7bf80,0x3fa73fb5,0x3fa73f80,0xbfa7bfb5,0x3fb43fa7,0xbf2bbf97,0xbf66bfa7,0xbed23e8d,0xbf97bfb5,0xbe8d3f0b,0xbf4928ab,0x3fb23fa7,0x3f2b3fa7,0x3f8c3e8d,0x3fad3fa7,0x3e0ebf49
.long 0xa690bf80,0xbfb5bf80,0xa85abf80,0xbfb5bf80,0xbf2b3f0b,0x3f8c3fb2,0xbfadbf0b,0x3e0e3f97,0x3f97a78c,0xbe8dbfa7,0x3f493fb5,0x3fb23f0b,0xbfb4bf0b,0xbf2b3f49,0x3f66bf0b,0xbed2bfb2
.long 0x3fa73f80,0x3fa7a7a4,0xbfa7bf80,0xbfa72842,0xbf66bfa7,0xbfadbf49,0xbe0e3fa7,0x3f2b3fb2,0x3e8d3fb5,0x3f493fa7,0x3fb2a8ea,0x3f97bf0b,0x3ed2bfa7,0x3e0ebfb2,0xbf2bbfa7,0xbf66bf97
.long 0x3f803f80,0x3f803f80,0x3f803f80,0x3f803f80,0xbf663f80,0xbf2b3f97,0x3e0e3fb5,0x3ed23fb2,0xbf97bf80,0xbfb2bf0b,0xbf493f80,0xbe8d3fa7,0x3f2bbf80,0xbe0ebfb2,0xbfad25c0,0xbf663f49
.long 0x3fa73f80,0x3fa7a500,0xbfa7bf80,0xbfa70000,0xbed23f80,0x3f663fb2,0xbf2bbfb5,0xbfb4bf49,0xbfb2bf80,0xbf493f0b,0x3e8dbf80,0xbf97bfa7,0x3e0ebf80,0xbfadbf97,0x3f8c27d4,0xbf2bbfb2
.long 0x3fb53f80,0x2778bf80,0x3fb53f80,0x278cbf80,0x3e0e3f80,0x3fad3f49,0x3f8c3fb5,0x3f2bbe8d,0xbfb2bf80,0x3f493fa7,0x3e8d3f80,0x3f973f0b,0xbed2bf80,0xbf66be8d,0xbf2ba85a,0x3fb43f97
.long 0x3fa73f80,0xbfa7bfb5,0xbfa7bf80,0x3fa73fb5,0x3f2b3f80,0x3e0ebe8d,0xbfadbfb5,0x3f663f97,0xbf97bf80,0x3fb23fa7,0xbf49bf80,0x3e8d3f0b,0xbf66bf80,0x3f2b3f49,0x3e0e28a5,0xbed2be8d
.long 0x3f803f80,0xbf80bf80,0x3f803f80,0xbf80bf80,0x3f8c3f80,0xbfa0bf97,0x3fb43fb5,0xbfadbfb2,0xbf49bf80,0x3e8d3f0b,0x3f973f80,0xbfb2bfa7,0xbfa0bf80,0x3fb43fb2,0x3ed2a8dd,0xbf8cbf49
.long 0x3f0b3f80,0x3f0ba880,0xbf0bbf80,0xbf0b2836,0x3fad3f80,0xbf8cbfb2,0xbfa0bfb5,0x3e0e3f49,0xbe8dbf80,0xbf97bf0b,0xbfb2bf80,0x3f493fa7,0xbfb4bf80,0x3ed23f97,0xbf662842,0x3fa03fb2
.long 0xa7283f80,0x3fb53f80,0x281c3f80,0x3fb53f80,0x3fb43f80,0x3ed2bf49,0x3f663fb5,0x3fa03e8d,0x3e8dbf80,0xbf97bfa7,0x3fb23f80,0x3f49bf0b,0xbfadbf80,0xbf8c3e8d,0x3fa0a927,0x3e0ebf97
.long 0xbf0b3f80,0x3f0b3fb5,0x3f0bbf80,0xbf0bbfb5,0x3fa03f80,0x3fb43e8d,0xbed2bfb5,0xbf8cbf97,0x3f49bf80,0x3e8dbfa7,0xbf97bf80,0xbfb2bf0b,0xbf8cbf80,0xbfa0bf49,0xbfb428d1,0xbfad3e8d
.long 0x3f803f80,0x3f803f80,0x3f803f80,0x3f803f80,0xbed23fa7,0xbe0e3fb2,0x3f2b3fa7,0x3f663f97,0xbfb22660,0xbf973f0b,0x3e8d3fb5,0x3f493fa7,0xbf66bfa7,0xbfadbf49,0xbe0e3fa7,0x3f2b3fb2
.long 0x3f0bbf80,0xbf0bbfb5,0xbf0b3f80,0x3f0b3fb5,0x3fb43f0b,0x3f2bbf49,0xbf663f0b,0x3ed23fb2,0x3f493fb5,0x3fb23f0b,0xbf97a660,0x3e8d3fa7,0xbf2b3f0b,0x3f8c3fb2,0xbfadbf0b,0x3e0e3f97
.long 0xbfb5bf80,0x26d03f80,0xbfb5bf80,0x26903f80,0xbf2bbfa7,0xbf8cbe8d,0xbfadbfa7,0xbe0e3f49,0x3f4927ec,0xbfb2bfa7,0xbf97bfb5,0xbe8d3f0b,0x3fb43fa7,0xbf2bbf97,0xbf66bfa7,0xbed23e8d
.long 0x3f0b3f80,0x3f0b2802,0xbf0bbf80,0xbf0ba866,0xbf66bf0b,0x3fad3f97,0xbe0ebf0b,0xbf2bbe8d,0xbfb2bfb5,0x3f973fa7,0x3e8da6f0,0xbf49bf0b,0xbed2bf0b,0x3e0e3e8d,0x3f2b3f0b,0xbf66bf49
.long 0x3f803f80,0xbf80bf80,0x3f803f80,0xbf80bf80,0x3fad3fa7,0xbfb4bfb2,0x3fa03fa7,0xbf8cbf97,0x3e8da78c,0xbf49bf0b,0x3fb23fb5,0xbf97bfa7,0xbf8cbfa7,0x3ed23f49,0x3fb43fa7,0xbfa0bfb2
.long 0xbfa7bf80,0x3fa73fb5,0x3fa73f80,0xbfa7bfb5,0xbe0e3f0b,0x3fa03f49,0x3f8c3f0b,0xbfadbfb2,0x3f973fb5,0x3e8dbf0b,0x3f49a8ea,0xbfb2bfa7,0x3fa03f0b,0xbf66bfb2,0x3ed2bf0b,0xbfb4bf97
.long 0xa760bf80,0xbfb5bf80,0xa880bf80,0xbfb5bf80,0xbfa0bfa7,0xbf663e8d,0xbed2bfa7,0xbfb4bf49,0xbf972690,0x3e8d3fa7,0xbf49bfb5,0xbfb2bf0b,0x3e0e3fa7,0x3fa03f97,0xbf8cbfa7,0xbfadbe8d
.long 0x3fa73f80,0x3fa72760,0xbfa7bf80,0xbfa728d1,0x3f8cbf0b,0x3ed2bf97,0xbfb4bf0b,0xbfa03e8d,0xbe8dbfb5,0xbf49bfa7,0xbfb22872,0xbf973f0b,0xbfadbf0b,0xbfb4be8d,0xbfa03f0b,0xbf8c3f49
.long 0x3f803f80,0x3f803f80,0x3f803f80,0x3f803f80,0x3f663f80,0x3f2b3f97,0xbe0e3fb5,0xbed23fb2,0x3f493f80,0x3e8d3fa7,0xbf973f80,0xbfb23f0b,0x3f2b3f80,0xbe0e3fb2,0xbfad2500,0xbf66bf49
.long 0x3f0b3f80,0xbf0b3fb5,0xbf0bbf80,0x3f0bbfb5,0x3ed23f80,0xbf663fb2,0x3f2bbfb5,0x3fb4bf49,0x3e8d3f80,0xbf973fa7,0x3fb2bf80,0x3f493f0b,0x3e0e3f80,0xbfad3f97,0x3f8ca5c0,0xbf2b3fb2
.long 0x25003f80,0xbfb53f80,0x25c03f80,0xbfb53f80,0xbe0e3f80,0xbfad3f49,0xbf8c3fb5,0xbf2bbe8d,0xbe8d3f80,0xbf973f0b,0xbfb23f80,0x3f49bfa7,0xbed23f80,0xbf663e8d,0xbf2b26f0,0x3fb4bf97
.long 0xbf0b3f80,0xbf0b2500,0x3f0bbf80,0x3f0ba708,0xbf2b3f80,0xbe0ebe8d,0x3fadbfb5,0xbf663f97,0xbf493f80,0x3e8dbf0b,0x3f97bf80,0xbfb23fa7,0xbf663f80,0x3f2bbf49,0x3e0ea708,0xbed23e8d
.long 0xbf803f80,0x3f80bf80,0xbf803f80,0x3f80bf80,0xbf8c3f80,0x3fa0bf97,0xbfb43fb5,0x3fadbfb2,0xbf973f80,0x3fb2bfa7,0xbf493f80,0x3e8dbf0b,0xbfa03f80,0x3fb4bfb2,0x3ed22718,0xbf8c3f49
.long 0xbfa73f80,0x3fa7bfb5,0x3fa7bf80,0xbfa73fb5,0xbfad3f80,0x3f8cbfb2,0x3fa0bfb5,0xbe0e3f49,0xbfb23f80,0x3f49bfa7,0x3e8dbf80,0x3f97bf0b,0xbfb43f80,0x3ed2bf97,0xbf66a728,0x3fa0bfb2
.long 0xbfb53f80,0x25c0bf80,0xbfb53f80,0x2500bf80,0xbfb43f80,0xbed2bf49,0xbf663fb5,0xbfa03e8d,0xbfb23f80,0xbf49bf0b,0x3e8d3f80,0xbf973fa7,0xbfad3f80,0xbf8cbe8d,0x3fa02728,0x3e0e3f97
.long 0xbfa73f80,0xbfa7a5c0,0x3fa7bf80,0x3fa72748,0xbfa03f80,0xbfb43e8d,0x3ed2bfb5,0x3f8cbf97,0xbf973f80,0xbfb23f0b,0xbf49bf80,0xbe8dbfa7,0xbf8c3f80,0xbfa03f49,0xbfb4a738,0xbfadbe8d
.long 0x3f803f80,0x3f803f80,0x3f803f80,0x3f803f80,0x3ed23fa7,0x3e0e3fb2,0xbf2b3fa7,0xbf663f97,0xbe8d3fb5,0xbf493fa7,0xbfb22500,0xbf97bf0b,0xbf663fa7,0xbfad3f49,0xbe0ebfa7,0x3f2bbfb2
.long 0xbfa73f80,0xbfa72500,0x3fa7bf80,0x3fa7a5c0,0xbfb43f0b,0xbf2bbf49,0x3f663f0b,0xbed23fb2,0xbf972500,0x3e8dbfa7,0xbf493fb5,0xbfb23f0b,0xbf2bbf0b,0x3f8cbfb2,0xbfad3f0b,0x3e0ebf97
.long 0xa580bf80,0x3fb5bf80,0x2660bf80,0x3fb5bf80,0x3f2bbfa7,0x3f8cbe8d,0x3fadbfa7,0x3e0e3f49,0x3f97bfb5,0x3e8d3f0b,0x3f49a708,0xbfb23fa7,0x3fb4bfa7,0xbf2b3f97,0xbf663fa7,0xbed2be8d
.long 0x3fa7bf80,0xbfa73fb5,0xbfa73f80,0x3fa7bfb5,0x3f66bf0b,0xbfad3f97,0x3e0ebf0b,0x3f2bbe8d,0x3e8da5c0,0xbf493f0b,0x3fb2bfb5,0xbf973fa7,0xbed23f0b,0x3e0ebe8d,0x3f2bbf0b,0xbf663f49
.long 0xbf803f80,0x3f80bf80,0xbf803f80,0x3f80bf80,0xbfad3fa7,0x3fb4bfb2,0xbfa03fa7,0x3f8cbf97,0xbfb23fb5,0x3f97bfa7,0x3e8d2728,0xbf493f0b,0xbf8c3fa7,0x3ed2bf49,0x3fb4bfa7,0xbfa03fb2
.long 0xbf0b3f80,0xbf0ba708,0x3f0bbf80,0x3f0b2748,0x3e0e3f0b,0xbfa03f49,0xbf8c3f0b,0x3fadbfb2,0x3f4926f0,0xbfb23fa7,0xbf973fb5,0xbe8dbf0b,0x3fa0bf0b,0xbf663fb2,0x3ed23f0b,0xbfb43f97
.long 0x3fb5bf80,0x25c03f80,0x3fb5bf80,0xa6603f80,0x3fa0bfa7,0x3f663e8d,0x3ed2bfa7,0x3fb4bf49,0x3f49bfb5,0x3fb2bf0b,0xbf972718,0x3e8dbfa7,0x3e0ebfa7,0x3fa0bf97,0xbf8c3fa7,0xbfad3e8d
.long 0xbf0bbf80,0x3f0bbfb5,0x3f0b3f80,0xbf0b3fb5,0xbf8cbf0b,0xbed2bf97,0x3fb4bf0b,0x3fa03e8d,0xbfb2a708,0xbf97bf0b,0x3e8dbfb5,0x3f49bfa7,0xbfad3f0b,0xbfb43e8d,0xbfa0bf0b,0xbf8cbf49
.long 0x3f803f80,0x3f803f80,0x3f803f80,0x3f803f80,0xbf8c3f80,0xbfa03f49,0xbfb42500,0xbfadbe8d,0xbf49bf80,0xbe8dbfa7,0x3f97bf80,0x3fb2bf0b,0x3fa0bf80,0x3fb4be8d,0xbed23fb5,0xbf8c3f97
.long 0x3f0b3f80,0xbf0b3fb5,0xbf0bbf80,0x3f0bbfb5,0xbfad3f80,0xbf8cbe8d,0x3fa0a708,0x3e0e3f97,0xbe8dbf80,0x3f97bfa7,0xbfb23f80,0xbf49bf0b,0x3fb4bf80,0x3ed23f49,0x3f66bfb5,0x3fa0be8d
.long 0xa6203f80,0xbfb53f80,0xa5003f80,0xbfb53f80,0xbfb43f80,0x3ed2bf97,0xbf662728,0x3fa0bfb2,0x3e8dbf80,0x3f97bf0b,0x3fb2bf80,0xbf493fa7,0x3fadbf80,0xbf8c3fb2,0xbfa03fb5,0x3e0ebf49
.long 0xbf0b3f80,0xbf0b2728,0x3f0bbf80,0x3f0ba758,0xbfa03f80,0x3fb4bfb2,0x3ed22718,0xbf8c3f49,0x3f49bf80,0xbe8d3f0b,0xbf973f80,0x3fb2bfa7,0x3f8cbf80,0xbfa03f97,0x3fb4bfb5,0xbfad3fb2
.long 0xbf803f80,0x3f80bf80,0xbf803f80,0x3f80bf80,0xbf663f80,0x3f2bbf49,0x3e0ea7ec,0xbed23e8d,0x3f97bf80,0xbfb23fa7,0x3f49bf80,0xbe8d3f0b,0x3f2bbf80,0x3e0e3e8d,0xbfad3fb5,0x3f66bf97
.long 0xbfa73f80,0x3fa7bfb5,0x3fa7bf80,0xbfa73fb5,0xbed23f80,0xbf663e8d,0xbf2b2690,0x3fb4bf97,0x3fb2bf80,0xbf493fa7,0xbe8d3f80,0xbf973f0b,0x3e0ebf80,0x3fadbf49,0x3f8cbfb5,0x3f2b3e8d
.long 0xbfb53f80,0x27e4bf80,0xbfb53f80,0x2802bf80,0x3e0e3f80,0xbfad3f97,0x3f8c27a4,0xbf2b3fb2,0x3fb2bf80,0x3f493f0b,0xbe8dbf80,0x3f97bfa7,0xbed2bf80,0x3f66bfb2,0xbf2b3fb5,0xbfb43f49
.long 0xbfa73f80,0xbfa72690,0x3fa7bf80,0x3fa727bc,0x3f2b3f80,0xbe0e3fb2,0xbfada836,0xbf66bf49,0x3f97bf80,0x3fb2bf0b,0x3f493f80,0x3e8d3fa7,0xbf66bf80,0xbf2bbf97,0x3e0ebfb5,0x3ed2bfb2
.long 0x3f803f80,0x3f803f80,0x3f803f80,0x3f803f80,0xbfad3f0b,0xbfb43e8d,0xbfa0bf0b,0xbf8cbf49,0x3e8dbfb5,0x3f49bfa7,0x3fb2a5c0,0x3f973f0b,0x3f8c3f0b,0x3ed23f97,0xbfb43f0b,0xbfa0be8d
.long 0xbfa73f80,0xbfa726f0,0x3fa7bf80,0x3fa7a708,0x3e0ebfa7,0x3fa0bf97,0xbf8c3fa7,0xbfad3e8d,0x3f97a708,0xbe8d3fa7,0x3f49bfb5,0x3fb2bf0b,0xbfa03fa7,0xbf66be8d,0xbed23fa7,0xbfb43f49
.long 0x25c0bf80,0x3fb5bf80,0xbf80,0x3fb5bf80,0x3fa0bf0b,0xbf663fb2,0x3ed23f0b,0xbfb43f97,0xbf973fb5,0xbe8dbf0b,0xbf492748,0x3fb2bfa7,0xbe0ebf0b,0x3fa0bf49,0x3f8cbf0b,0xbfad3fb2
.long 0x3fa7bf80,0xbfa73fb5,0xbfa73f80,0x3fa7bfb5,0xbf8c3fa7,0x3ed2bf49,0x3fb4bfa7,0xbfa03fb2,0xbe8d2748,0x3f49bf0b,0xbfb23fb5,0x3f97bfa7,0x3fadbfa7,0xbfb43fb2,0x3fa0bfa7,0xbf8c3f97
.long 0xbf803f80,0x3f80bf80,0xbf803f80,0x3f80bf80,0xbed23f0b,0x3e0ebe8d,0x3f2bbf0b,0xbf663f49,0x3fb2bfb5,0xbf973fa7,0xbe8d2690,0x3f49bf0b,0xbf663f0b,0x3fadbf97,0xbe0e3f0b,0xbf2b3e8d
.long 0xbf0b3f80,0xbf0b26d0,0x3f0bbf80,0x3f0b27a4,0x3fb4bfa7,0xbf2b3f97,0xbf663fa7,0xbed2be8d,0xbf49a81c,0x3fb2bfa7,0x3f97bfb5,0x3e8d3f0b,0xbf2b3fa7,0xbf8c3e8d,0xbfad3fa7,0xbe0ebf49
.long 0x3fb5bf80,0xa6f03f80,0x3fb5bf80,0xa8663f80,0xbf2bbf0b,0x3f8cbfb2,0xbfad3f0b,0x3e0ebf97,0xbf493fb5,0xbfb23f0b,0x3f97a887,0xbe8d3fa7,0x3fb4bf0b,0x3f2b3f49,0xbf66bf0b,0x3ed2bfb2
.long 0xbf0bbf80,0x3f0bbfb5,0x3f0b3f80,0xbf0b3fb5,0xbf663fa7,0xbfad3f49,0xbe0ebfa7,0x3f2bbfb2,0x3fb227a4,0x3f973f0b,0xbe8d3fb5,0xbf493fa7,0xbed2bfa7,0xbe0ebfb2,0x3f2bbfa7,0x3f66bf97
.long 0xbf803f80,0xbf803f80,0xbf803f80,0xbf803f80,0xbf8c3f80,0xbfa03f49,0xbfb42500,0xbfadbe8d,0xbf973f80,0xbfb23f0b,0xbf49bf80,0xbe8dbfa7,0xbfa03f80,0xbfb43e8d,0x3ed2bfb5,0x3f8cbf97
.long 0xbfa73f80,0xbfa72500,0x3fa7bf80,0x3fa7a580,0xbfad3f80,0xbf8cbe8d,0x3fa0a580,0x3e0e3f97,0xbfb23f80,0xbf49bf0b,0x3e8d3f80,0xbf973fa7,0xbfb43f80,0xbed2bf49,0xbf663fb5,0xbfa03e8d
.long 0xbfb53f80,0xa500bf80,0xbfb53f80,0xa6f0bf80,0xbfb43f80,0x3ed2bf97,0xbf6625c0,0x3fa0bfb2,0xbfb23f80,0x3f49bfa7,0x3e8dbf80,0x3f97bf0b,0xbfad3f80,0x3f8cbfb2,0x3fa0bfb5,0xbe0e3f49
.long 0xbfa73f80,0x3fa7bfb5,0x3fa7bf80,0xbfa73fb5,0xbfa03f80,0x3fb4bfb2,0x3ed22660,0xbf8c3f49,0xbf973f80,0x3fb2bfa7,0xbf493f80,0x3e8dbf0b,0xbf8c3f80,0x3fa0bf97,0xbfb43fb5,0x3fadbfb2
.long 0xbf803f80,0x3f80bf80,0xbf803f80,0x3f80bf80,0xbf663f80,0x3f2bbf49,0x3e0ea620,0xbed23e8d,0xbf493f80,0x3e8dbf0b,0x3f97bf80,0xbfb23fa7,0xbf2b3f80,0xbe0ebe8d,0x3fadbfb5,0xbf663f97
.long 0xbf0b3f80,0xbf0ba580,0x3f0bbf80,0x3f0ba500,0xbed23f80,0xbf663e8d,0xbf2b25c0,0x3fb4bf97,0xbe8d3f80,0xbf973f0b,0xbfb23f80,0x3f49bfa7,0xbe0e3f80,0xbfad3f49,0xbf8c3fb5,0xbf2bbe8d
.long 0xa5003f80,0xbfb53f80,0xa7283f80,0xbfb53f80,0x3e0e3f80,0xbfad3f97,0x3f8ca500,0xbf2b3fb2,0x3e8d3f80,0xbf973fa7,0x3fb2bf80,0x3f493f0b,0x3ed23f80,0xbf663fb2,0x3f2bbfb5,0x3fb4bf49
.long 0x3f0b3f80,0xbf0b3fb5,0xbf0bbf80,0x3f0bbfb5,0x3f2b3f80,0xbe0e3fb2,0xbfad0000,0xbf66bf49,0x3f493f80,0x3e8d3fa7,0xbf973f80,0xbfb23f0b,0x3f663f80,0x3f2b3f97,0xbe0e3fb5,0xbed23fb2
.long 0xbf803f80,0xbf803f80,0xbf803f80,0xbf803f80,0xbfad3f0b,0xbfb43e8d,0xbfa0bf0b,0xbf8cbf49,0xbfb22500,0xbf97bf0b,0x3e8dbfb5,0x3f49bfa7,0xbf8cbf0b,0xbed2bf97,0x3fb4bf0b,0x3fa03e8d
.long 0xbf0bbf80,0x3f0bbfb5,0x3f0b3f80,0xbf0b3fb5,0x3e0ebfa7,0x3fa0bf97,0xbf8c3fa7,0xbfad3e8d,0x3f49bfb5,0x3fb2bf0b,0xbf9725c0,0x3e8dbfa7,0x3fa0bfa7,0x3f663e8d,0x3ed2bfa7,0x3fb4bf49
.long 0x3fb5bf80,0x25c03f80,0x3fb5bf80,0x27083f80,0x3fa0bf0b,0xbf663fb2,0x3ed23f0b,0xbfb43f97,0x3f49a580,0xbfb23fa7,0xbf973fb5,0xbe8dbf0b,0x3e0e3f0b,0xbfa03f49,0xbf8c3f0b,0x3fadbfb2
.long 0xbf0b3f80,0xbf0b25c0,0x3f0bbf80,0x3f0b25c0,0xbf8c3fa7,0x3ed2bf49,0x3fb4bfa7,0xbfa03fb2,0xbfb23fb5,0x3f97bfa7,0x3e8d25c0,0xbf493f0b,0xbfad3fa7,0x3fb4bfb2,0xbfa03fa7,0x3f8cbf97
.long 0xbf803f80,0x3f80bf80,0xbf803f80,0x3f80bf80,0xbed23f0b,0x3e0ebe8d,0x3f2bbf0b,0xbf663f49,0x3e8d25c0,0xbf493f0b,0x3fb2bfb5,0xbf973fa7,0x3f66bf0b,0xbfad3f97,0x3e0ebf0b,0x3f2bbe8d
.long 0x3fa7bf80,0xbfa73fb5,0xbfa73f80,0x3fa7bfb5,0x3fb4bfa7,0xbf2b3f97,0xbf663fa7,0xbed2be8d,0x3f97bfb5,0x3e8d3f0b,0x3f4927bc,0xbfb23fa7,0x3f2bbfa7,0x3f8cbe8d,0x3fadbfa7,0x3e0e3f49
.long 0x2708bf80,0x3fb5bf80,0x2758bf80,0x3fb5bf80,0xbf2bbf0b,0x3f8cbfb2,0xbfad3f0b,0x3e0ebf97,0xbf972660,0x3e8dbfa7,0xbf493fb5,0xbfb23f0b,0xbfb43f0b,0xbf2bbf49,0x3f663f0b,0xbed23fb2
.long 0xbfa73f80,0xbfa725c0,0x3fa7bf80,0x3fa727d4,0xbf663fa7,0xbfad3f49,0xbe0ebfa7,0x3f2bbfb2,0xbe8d3fb5,0xbf493fa7,0xbfb2a842,0xbf97bf0b,0x3ed23fa7,0x3e0e3fb2,0xbf2b3fa7,0xbf663f97
.long 0xbf803f80,0xbf803f80,0xbf803f80,0xbf803f80,0xbf66bf80,0xbf2bbf97,0x3e0ebfb5,0x3ed2bfb2,0x3f97bf80,0x3fb2bf0b,0x3f493f80,0x3e8d3fa7,0x3f2b3f80,0xbe0e3fb2,0xbfad25c0,0xbf66bf49
.long 0xbfa73f80,0xbfa725c0,0x3fa7bf80,0x3fa72660,0xbed2bf80,0x3f66bfb2,0xbf2b3fb5,0xbfb43f49,0x3fb2bf80,0x3f493f0b,0xbe8dbf80,0x3f97bfa7,0x3e0e3f80,0xbfad3f97,0x3f8c25c0,0xbf2b3fb2
.long 0xbfb53f80,0xa718bf80,0xbfb53f80,0xa728bf80,0x3e0ebf80,0x3fadbf49,0x3f8cbfb5,0x3f2b3e8d,0x3fb2bf80,0xbf493fa7,0xbe8d3f80,0xbf973f0b,0xbed23f80,0xbf663e8d,0xbf2b27bc,0x3fb4bf97
.long 0xbfa73f80,0x3fa7bfb5,0x3fa7bf80,0xbfa73fb5,0x3f2bbf80,0x3e0e3e8d,0xbfad3fb5,0x3f66bf97,0x3f97bf80,0xbfb23fa7,0x3f49bf80,0xbe8d3f0b,0xbf663f80,0x3f2bbf49,0x3e0ea842,0xbed23e8d
.long 0xbf803f80,0x3f80bf80,0xbf803f80,0x3f80bf80,0x3f8cbf80,0xbfa03f97,0x3fb4bfb5,0xbfad3fb2,0x3f49bf80,0xbe8d3f0b,0xbf973f80,0x3fb2bfa7,0xbfa03f80,0x3fb4bfb2,0x3ed227e4,0xbf8c3f49
.long 0xbf0b3f80,0xbf0ba660,0x3f0bbf80,0x3f0b27ec,0x3fadbf80,0xbf8c3fb2,0xbfa03fb5,0x3e0ebf49,0x3e8dbf80,0x3f97bf0b,0x3fb2bf80,0xbf493fa7,0xbfb43f80,0x3ed2bf97,0xbf66a6f0,0x3fa0bfb2
.long 0xa7783f80,0xbfb53f80,0xa7a43f80,0xbfb53f80,0x3fb4bf80,0x3ed23f49,0x3f66bfb5,0x3fa0be8d,0xbe8dbf80,0x3f97bfa7,0xbfb23f80,0xbf49bf0b,0xbfad3f80,0xbf8cbe8d,0x3fa02802,0x3e0e3f97
.long 0x3f0b3f80,0xbf0b3fb5,0xbf0bbf80,0x3f0bbfb5,0x3fa0bf80,0x3fb4be8d,0xbed23fb5,0xbf8c3f97,0xbf49bf80,0xbe8dbfa7,0x3f97bf80,0x3fb2bf0b,0xbf8c3f80,0xbfa03f49,0xbfb4a866,0xbfadbe8d
.long 0xbf803f80,0xbf803f80,0xbf803f80,0xbf803f80,0xbed2bfa7,0xbe0ebfb2,0x3f2bbfa7,0x3f66bf97,0x3fb2a580,0x3f973f0b,0xbe8d3fb5,0xbf493fa7,0xbf663fa7,0xbfad3f49,0xbe0ebfa7,0x3f2bbfb2
.long 0xbf0bbf80,0x3f0bbfb5,0x3f0b3f80,0xbf0b3fb5,0x3fb4bf0b,0x3f2b3f49,0xbf66bf0b,0x3ed2bfb2,0xbf493fb5,0xbfb23f0b,0x3f9725c0,0xbe8d3fa7,0xbf2bbf0b,0x3f8cbfb2,0xbfad3f0b,0x3e0ebf97
.long 0x3fb5bf80,0x27283f80,0x3fb5bf80,0x27383f80,0xbf2b3fa7,0xbf8c3e8d,0xbfad3fa7,0xbe0ebf49,0xbf49a500,0x3fb2bfa7,0x3f97bfb5,0x3e8d3f0b,0x3fb4bfa7,0xbf2b3f97,0xbf663fa7,0xbed2be8d
.long 0xbf0b3f80,0xbf0b2500,0x3f0bbf80,0x3f0ba660,0xbf663f0b,0x3fadbf97,0xbe0e3f0b,0xbf2b3e8d,0x3fb2bfb5,0xbf973fa7,0xbe8d27d4,0x3f49bf0b,0xbed23f0b,0x3e0ebe8d,0x3f2bbf0b,0xbf663f49
.long 0xbf803f80,0x3f80bf80,0xbf803f80,0x3f80bf80,0x3fadbfa7,0xbfb43fb2,0x3fa0bfa7,0xbf8c3f97,0xbe8da660,0x3f49bf0b,0xbfb23fb5,0x3f97bfa7,0xbf8c3fa7,0x3ed2bf49,0x3fb4bfa7,0xbfa03fb2
.long 0x3fa7bf80,0xbfa73fb5,0xbfa73f80,0x3fa7bfb5,0xbe0ebf0b,0x3fa0bf49,0x3f8cbf0b,0xbfad3fb2,0xbf973fb5,0xbe8dbf0b,0xbf49a85a,0x3fb2bfa7,0x3fa0bf0b,0xbf663fb2,0x3ed23f0b,0xbfb43f97
.long 0xa690bf80,0x3fb5bf80,0x2836bf80,0x3fb5bf80,0xbfa03fa7,0xbf66be8d,0xbed23fa7,0xbfb43f49,0x3f97a778,0xbe8d3fa7,0x3f49bfb5,0x3fb2bf0b,0x3e0ebfa7,0x3fa0bf97,0xbf8c3fa7,0xbfad3e8d
.long 0xbfa73f80,0xbfa7a718,0x3fa7bf80,0x3fa7a6f0,0x3f8c3f0b,0x3ed23f97,0xbfb43f0b,0xbfa0be8d,0x3e8dbfb5,0x3f49bfa7,0x3fb228a5,0x3f973f0b,0xbfad3f0b,0xbfb43e8d,0xbfa0bf0b,0xbf8cbf49
.long 0x3f803f80,0x3f803f80,0x3f803f80,0x3f803f80,0xbf66bf80,0xbf2bbf97,0x3e0ebfb5,0x3ed2bfb2,0x3f493f80,0x3e8d3fa7,0xbf973f80,0xbfb23f0b,0xbf2bbf80,0x3e0ebfb2,0x3fada708,0x3f663f49
.long 0x3f0b3f80,0xbf0b3fb5,0xbf0bbf80,0x3f0bbfb5,0xbed2bf80,0x3f66bfb2,0xbf2b3fb5,0xbfb43f49,0x3e8d3f80,0xbf973fa7,0x3fb2bf80,0x3f493f0b,0xbe0ebf80,0x3fadbf97,0xbf8c2748,0x3f2bbfb2
.long 0x25003f80,0xbfb53f80,0x27c83f80,0xbfb53f80,0x3e0ebf80,0x3fadbf49,0x3f8cbfb5,0x3f2b3e8d,0xbe8d3f80,0xbf973f0b,0xbfb23f80,0x3f49bfa7,0x3ed2bf80,0x3f66be8d,0x3f2ba81c,0xbfb43f97
.long 0xbf0b3f80,0xbf0b2778,0x3f0bbf80,0x3f0b2690,0x3f2bbf80,0x3e0e3e8d,0xbfad3fb5,0x3f66bf97,0xbf493f80,0x3e8dbf0b,0x3f97bf80,0xbfb23fa7,0x3f66bf80,0xbf2b3f49,0xbe0e27a4,0x3ed2be8d
.long 0xbf803f80,0x3f80bf80,0xbf803f80,0x3f80bf80,0x3f8cbf80,0xbfa03f97,0x3fb4bfb5,0xbfad3fb2,0xbf973f80,0x3fb2bfa7,0xbf493f80,0x3e8dbf0b,0x3fa0bf80,0xbfb43fb2,0xbed2a5c0,0x3f8cbf49
.long 0xbfa73f80,0x3fa7bfb5,0x3fa7bf80,0xbfa73fb5,0x3fadbf80,0xbf8c3fb2,0xbfa03fb5,0x3e0ebf49,0xbfb23f80,0x3f49bfa7,0x3e8dbf80,0x3f97bf0b,0x3fb4bf80,0xbed23f97,0x3f662893,0xbfa03fb2
.long 0xbfb53f80,0xa6f0bf80,0xbfb53f80,0x282abf80,0x3fb4bf80,0x3ed23f49,0x3f66bfb5,0x3fa0be8d,0xbfb23f80,0xbf49bf0b,0x3e8d3f80,0xbf973fa7,0x3fadbf80,0x3f8c3e8d,0xbfa0a85a,0xbe0ebf97
.long 0xbfa73f80,0xbfa7a84e,0x3fa7bf80,0x3fa7a728,0x3fa0bf80,0x3fb4be8d,0xbed23fb5,0xbf8c3f97,0xbf973f80,0xbfb23f0b,0xbf49bf80,0xbe8dbfa7,0x3f8cbf80,0x3fa0bf49,0x3fb4280e,0x3fad3e8d
.long 0x3f803f80,0x3f803f80,0x3f803f80,0x3f803f80,0xbed2bfa7,0xbe0ebfb2,0x3f2bbfa7,0x3f66bf97,0xbe8d3fb5,0xbf493fa7,0xbfb226f0,0xbf97bf0b,0x3f66bfa7,0x3fadbf49,0x3e0e3fa7,0xbf2b3fb2
.long 0xbfa73f80,0xbfa72718,0x3fa7bf80,0x3fa7a728,0x3fb4bf0b,0x3f2b3f49,0xbf66bf0b,0x3ed2bfb2,0xbf972728,0x3e8dbfa7,0xbf493fb5,0xbfb23f0b,0x3f2b3f0b,0xbf8c3fb2,0x3fadbf0b,0xbe0e3f97
.long 0xa5c0bf80,0x3fb5bf80,0xa660bf80,0x3fb5bf80,0xbf2b3fa7,0xbf8c3e8d,0xbfad3fa7,0xbe0ebf49,0x3f97bfb5,0x3e8d3f0b,0x3f4926d0,0xbfb23fa7,0xbfb43fa7,0x3f2bbf97,0x3f66bfa7,0x3ed23e8d
.long 0x3fa7bf80,0xbfa73fb5,0xbfa73f80,0x3fa7bfb5,0xbf663f0b,0x3fadbf97,0xbe0e3f0b,0xbf2b3e8d,0x3e8d2690,0xbf493f0b,0x3fb2bfb5,0xbf973fa7,0x3ed2bf0b,0xbe0e3e8d,0xbf2b3f0b,0x3f66bf49
.long 0xbf803f80,0x3f80bf80,0xbf803f80,0x3f80bf80,0x3fadbfa7,0xbfb43fb2,0x3fa0bfa7,0xbf8c3f97,0xbfb23fb5,0x3f97bfa7,0x3e8da7a4,0xbf493f0b,0x3f8cbfa7,0xbed23f49,0xbfb43fa7,0x3fa0bfb2
.long 0xbf0b3f80,0xbf0ba5c0,0x3f0bbf80,0x3f0ba78c,0xbe0ebf0b,0x3fa0bf49,0x3f8cbf0b,0xbfad3fb2,0x3f49288d,0xbfb23fa7,0xbf973fb5,0xbe8dbf0b,0xbfa03f0b,0x3f66bfb2,0xbed2bf0b,0x3fb4bf97
.long 0x3fb5bf80,0xa78c3f80,0x3fb5bf80,0xa8873f80,0xbfa03fa7,0xbf66be8d,0xbed23fa7,0xbfb43f49,0x3f49bfb5,0x3fb2bf0b,0xbf97289f,0x3e8dbfa7,0xbe0e3fa7,0xbfa03f97,0x3f8cbfa7,0x3fadbe8d
.long 0xbf0bbf80,0x3f0bbfb5,0x3f0b3f80,0xbf0b3fb5,0x3f8c3f0b,0x3ed23f97,0xbfb43f0b,0xbfa0be8d,0xbfb2a85a,0xbf97bf0b,0x3e8dbfb5,0x3f49bfa7,0x3fadbf0b,0x3fb4be8d,0x3fa03f0b,0x3f8c3f49
.long 0x3f803f80,0x3f803f80,0x3f803f80,0x3f803f80,0x3f8cbf80,0x3fa0bf49,0x3fb4a5c0,0x3fad3e8d,0xbf49bf80,0xbe8dbfa7,0x3f97bf80,0x3fb2bf0b,0xbfa03f80,0xbfb43e8d,0x3ed2bfb5,0x3f8cbf97
.long 0x3f0b3f80,0xbf0b3fb5,0xbf0bbf80,0x3f0bbfb5,0x3fadbf80,0x3f8c3e8d,0xbfa02748,0xbe0ebf97,0xbe8dbf80,0x3f97bfa7,0xbfb23f80,0xbf49bf0b,0xbfb43f80,0xbed2bf49,0xbf663fb5,0xbfa03e8d
.long 0x27d43f80,0xbfb53f80,0x27e43f80,0xbfb53f80,0x3fb4bf80,0xbed23f97,0x3f662690,0xbfa03fb2,0x3e8dbf80,0x3f97bf0b,0x3fb2bf80,0xbf493fa7,0xbfad3f80,0x3f8cbfb2,0x3fa0bfb5,0xbe0e3f49
.long 0xbf0b3f80,0xbf0b27a4,0x3f0bbf80,0x3f0ba836,0x3fa0bf80,0xbfb43fb2,0xbed2a887,0x3f8cbf49,0x3f49bf80,0xbe8d3f0b,0xbf973f80,0x3fb2bfa7,0xbf8c3f80,0x3fa0bf97,0xbfb43fb5,0x3fadbfb2
.long 0xbf803f80,0x3f80bf80,0xbf803f80,0x3f80bf80,0x3f66bf80,0xbf2b3f49,0xbe0e281c,0x3ed2be8d,0x3f97bf80,0xbfb23fa7,0x3f49bf80,0xbe8d3f0b,0xbf2b3f80,0xbe0ebe8d,0x3fadbfb5,0xbf663f97
.long 0xbfa73f80,0x3fa7bfb5,0x3fa7bf80,0xbfa73fb5,0x3ed2bf80,0x3f66be8d,0x3f2ba728,0xbfb43f97,0x3fb2bf80,0xbf493fa7,0xbe8d3f80,0xbf973f0b,0xbe0e3f80,0xbfad3f49,0xbf8c3fb5,0xbf2bbe8d
.long 0xbfb53f80,0x25c0bf80,0xbfb53f80,0xa81cbf80,0xbe0ebf80,0x3fadbf97,0xbf8c2893,0x3f2bbfb2,0x3fb2bf80,0x3f493f0b,0xbe8dbf80,0x3f97bfa7,0x3ed23f80,0xbf663fb2,0x3f2bbfb5,0x3fb4bf49
.long 0xbfa73f80,0xbfa7a8d7,0x3fa7bf80,0x3fa72836,0xbf2bbf80,0x3e0ebfb2,0x3fad2836,0x3f663f49,0x3f97bf80,0x3fb2bf0b,0x3f493f80,0x3e8d3fa7,0x3f663f80,0x3f2b3f97,0xbe0e3fb5,0xbed23fb2
.long 0x3f803f80,0x3f803f80,0x3f803f80,0x3f803f80,0x3fadbf0b,0x3fb4be8d,0x3fa03f0b,0x3f8c3f49,0x3e8dbfb5,0x3f49bfa7,0x3fb2a708,0x3f973f0b,0xbf8cbf0b,0xbed2bf97,0x3fb4bf0b,0x3fa03e8d
.long 0xbfa73f80,0xbfa72728,0x3fa7bf80,0x3fa7a738,0xbe0e3fa7,0xbfa03f97,0x3f8cbfa7,0x3fadbe8d,0x3f97a758,0xbe8d3fa7,0x3f49bfb5,0x3fb2bf0b,0x3fa0bfa7,0x3f663e8d,0x3ed2bfa7,0x3fb4bf49
.long 0xa690bf80,0x3fb5bf80,0xa6d0bf80,0x3fb5bf80,0xbfa03f0b,0x3f66bfb2,0xbed2bf0b,0x3fb4bf97,0xbf973fb5,0xbe8dbf0b,0xbf4927a4,0x3fb2bfa7,0x3e0e3f0b,0xbfa03f49,0xbf8c3f0b,0x3fadbfb2
.long 0x3fa7bf80,0xbfa73fb5,0xbfa73f80,0x3fa7bfb5,0x3f8cbfa7,0xbed23f49,0xbfb43fa7,0x3fa0bfb2,0xbe8d27bc,0x3f49bf0b,0xbfb23fb5,0x3f97bfa7,0xbfad3fa7,0x3fb4bfb2,0xbfa03fa7,0x3f8cbf97
.long 0xbf803f80,0x3f80bf80,0xbf803f80,0x3f80bf80,0x3ed2bf0b,0xbe0e3e8d,0xbf2b3f0b,0x3f66bf49,0x3fb2bfb5,0xbf973fa7,0xbe8da85a,0x3f49bf0b,0x3f66bf0b,0xbfad3f97,0x3e0ebf0b,0x3f2bbe8d
.long 0xbf0b3f80,0xbf0ba85a,0x3f0bbf80,0x3f0b280e,0xbfb43fa7,0x3f2bbf97,0x3f66bfa7,0x3ed23e8d,0xbf49a8cb,0x3fb2bfa7,0x3f97bfb5,0x3e8d3f0b,0x3f2bbfa7,0x3f8cbe8d,0x3fadbfa7,0x3e0e3f49
.long 0x3fb5bf80,0xa8ea3f80,0x3fb5bf80,0x27603f80,0x3f2b3f0b,0xbf8c3fb2,0x3fadbf0b,0xbe0e3f97,0xbf493fb5,0xbfb23f0b,0x3f97a8b9,0xbe8d3fa7,0xbfb43f0b,0xbf2bbf49,0x3f663f0b,0xbed23fb2
.long 0xbf0bbf80,0x3f0bbfb5,0x3f0b3f80,0xbf0b3fb5,0x3f66bfa7,0x3fadbf49,0x3e0e3fa7,0xbf2b3fb2,0x3fb228b2,0x3f973f0b,0xbe8d3fb5,0xbf493fa7,0x3ed23fa7,0x3e0e3fb2,0xbf2b3fa7,0xbf663f97
.long 0xbf803f80,0xbf803f80,0xbf803f80,0xbf803f80,0x3f8cbf80,0x3fa0bf49,0x3fb4a580,0x3fad3e8d,0xbf973f80,0xbfb23f0b,0xbf49bf80,0xbe8dbfa7,0x3fa0bf80,0x3fb4be8d,0xbed23fb5,0xbf8c3f97
.long 0xbfa73f80,0xbfa7a620,0x3fa7bf80,0x3fa725c0,0x3fadbf80,0x3f8c3e8d,0xbfa0a500,0xbe0ebf97,0xbfb23f80,0xbf49bf0b,0x3e8d3f80,0xbf973fa7,0x3fb4bf80,0x3ed23f49,0x3f66bfb5,0x3fa0be8d
.long 0xbfb53f80,0xa748bf80,0xbfb53f80,0xa760bf80,0x3fb4bf80,0xbed23f97,0x3f66a660,0xbfa03fb2,0xbfb23f80,0x3f49bfa7,0x3e8dbf80,0x3f97bf0b,0x3fadbf80,0xbf8c3fb2,0xbfa03fb5,0x3e0ebf49
.long 0xbfa73f80,0x3fa7bfb5,0x3fa7bf80,0xbfa73fb5,0x3fa0bf80,0xbfb43fb2,0xbed2a778,0x3f8cbf49,0xbf973f80,0x3fb2bfa7,0xbf493f80,0x3e8dbf0b,0x3f8cbf80,0xbfa03f97,0x3fb4bfb5,0xbfad3fb2
.long 0xbf803f80,0x3f80bf80,0xbf803f80,0x3f80bf80,0x3f66bf80,0xbf2b3f49,0xbe0ea728,0x3ed2be8d,0xbf493f80,0x3e8dbf0b,0x3f97bf80,0xbfb23fa7,0x3f2bbf80,0x3e0e3e8d,0xbfad3fb5,0x3f66bf97
.long 0xbf0b3f80,0xbf0ba728,0x3f0bbf80,0x3f0ba6f0,0x3ed2bf80,0x3f66be8d,0x3f2ba6f0,0xbfb43f97,0xbe8d3f80,0xbf973f0b,0xbfb23f80,0x3f49bfa7,0x3e0ebf80,0x3fadbf49,0x3f8cbfb5,0x3f2b3e8d
.long 0x27a43f80,0xbfb53f80,0xa7ec3f80,0xbfb53f80,0xbe0ebf80,0x3fadbf97,0xbf8c27d4,0x3f2bbfb2,0x3e8d3f80,0xbf973fa7,0x3fb2bf80,0x3f493f0b,0xbed2bf80,0x3f66bfb2,0xbf2b3fb5,0xbfb43f49
.long 0x3f0b3f80,0xbf0b3fb5,0xbf0bbf80,0x3f0bbfb5,0xbf2bbf80,0x3e0ebfb2,0x3fada836,0x3f663f49,0x3f493f80,0x3e8d3fa7,0xbf973f80,0xbfb23f0b,0xbf66bf80,0xbf2bbf97,0x3e0ebfb5,0x3ed2bfb2
.long 0xbf803f80,0xbf803f80,0xbf803f80,0xbf803f80,0x3fadbf0b,0x3fb4be8d,0x3fa03f0b,0x3f8c3f49,0xbfb225c0,0xbf97bf0b,0x3e8dbfb5,0x3f49bfa7,0x3f8c3f0b,0x3ed23f97,0xbfb43f0b,0xbfa0be8d
.long 0xbf0bbf80,0x3f0bbfb5,0x3f0b3f80,0xbf0b3fb5,0xbe0e3fa7,0xbfa03f97,0x3f8cbfa7,0x3fadbe8d,0x3f49bfb5,0x3fb2bf0b,0xbf972500,0x3e8dbfa7,0xbfa03fa7,0xbf66be8d,0xbed23fa7,0xbfb43f49
.long 0x3fb5bf80,0x27583f80,0x3fb5bf80,0xa6f03f80,0xbfa03f0b,0x3f66bfb2,0xbed2bf0b,0x3fb4bf97,0x3f49a660,0xbfb23fa7,0xbf973fb5,0xbe8dbf0b,0xbe0ebf0b,0x3fa0bf49,0x3f8cbf0b,0xbfad3fb2
.long 0xbf0b3f80,0xbf0b27e4,0x3f0bbf80,0x3f0ba6f0,0x3f8cbfa7,0xbed23f49,0xbfb43fa7,0x3fa0bfb2,0xbfb23fb5,0x3f97bfa7,0x3e8da718,0xbf493f0b,0x3fadbfa7,0xbfb43fb2,0x3fa0bfa7,0xbf8c3f97
.long 0xbf803f80,0x3f80bf80,0xbf803f80,0x3f80bf80,0x3ed2bf0b,0xbe0e3e8d,0xbf2b3f0b,0x3f66bf49,0x3e8d2802,0xbf493f0b,0x3fb2bfb5,0xbf973fa7,0xbf663f0b,0x3fadbf97,0xbe0e3f0b,0xbf2b3e8d
.long 0x3fa7bf80,0xbfa73fb5,0xbfa73f80,0x3fa7bfb5,0xbfb43fa7,0x3f2bbf97,0x3f66bfa7,0x3ed23e8d,0x3f97bfb5,0x3e8d3f0b,0x3f4928ab,0xbfb23fa7,0xbf2b3fa7,0xbf8c3e8d,0xbfad3fa7,0xbe0ebf49
.long 0x2690bf80,0x3fb5bf80,0x285abf80,0x3fb5bf80,0x3f2b3f0b,0xbf8c3fb2,0x3fadbf0b,0xbe0e3f97,0xbf97a78c,0x3e8dbfa7,0xbf493fb5,0xbfb23f0b,0x3fb4bf0b,0x3f2b3f49,0xbf66bf0b,0x3ed2bfb2
.long 0xbfa73f80,0xbfa7a7a4,0x3fa7bf80,0x3fa72842,0x3f66bfa7,0x3fadbf49,0x3e0e3fa7,0xbf2b3fb2,0xbe8d3fb5,0xbf493fa7,0xbfb2a8ea,0xbf97bf0b,0xbed2bfa7,0xbe0ebfb2,0x3f2bbfa7,0x3f66bf97
.long 0xbf803f80,0xbf803f80,0xbf803f80,0xbf803f80,0x3f663f80,0x3f2b3f97,0xbe0e3fb5,0xbed23fb2,0x3f97bf80,0x3fb2bf0b,0x3f493f80,0x3e8d3fa7,0xbf2bbf80,0x3e0ebfb2,0x3fad25c0,0x3f663f49
.long 0xbfa73f80,0xbfa7a500,0x3fa7bf80,0x3fa70000,0x3ed23f80,0xbf663fb2,0x3f2bbfb5,0x3fb4bf49,0x3fb2bf80,0x3f493f0b,0xbe8dbf80,0x3f97bfa7,0xbe0ebf80,0x3fadbf97,0xbf8c27d4,0x3f2bbfb2
.long 0xbfb53f80,0xa778bf80,0xbfb53f80,0xa78cbf80,0xbe0e3f80,0xbfad3f49,0xbf8c3fb5,0xbf2bbe8d,0x3fb2bf80,0xbf493fa7,0xbe8d3f80,0xbf973f0b,0x3ed2bf80,0x3f66be8d,0x3f2ba85a,0xbfb43f97
.long 0xbfa73f80,0x3fa7bfb5,0x3fa7bf80,0xbfa73fb5,0xbf2b3f80,0xbe0ebe8d,0x3fadbfb5,0xbf663f97,0x3f97bf80,0xbfb23fa7,0x3f49bf80,0xbe8d3f0b,0x3f66bf80,0xbf2b3f49,0xbe0e28a5,0x3ed2be8d
.long 0xbf803f80,0x3f80bf80,0xbf803f80,0x3f80bf80,0xbf8c3f80,0x3fa0bf97,0xbfb43fb5,0x3fadbfb2,0x3f49bf80,0xbe8d3f0b,0xbf973f80,0x3fb2bfa7,0x3fa0bf80,0xbfb43fb2,0xbed2a8dd,0x3f8cbf49
.long 0xbf0b3f80,0xbf0ba880,0x3f0bbf80,0x3f0b2836,0xbfad3f80,0x3f8cbfb2,0x3fa0bfb5,0xbe0e3f49,0x3e8dbf80,0x3f97bf0b,0x3fb2bf80,0xbf493fa7,0x3fb4bf80,0xbed23f97,0x3f662842,0xbfa03fb2
.long 0x27283f80,0xbfb53f80,0xa81c3f80,0xbfb53f80,0xbfb43f80,0xbed2bf49,0xbf663fb5,0xbfa03e8d,0xbe8dbf80,0x3f97bfa7,0xbfb23f80,0xbf49bf0b,0x3fadbf80,0x3f8c3e8d,0xbfa0a927,0xbe0ebf97
.long 0x3f0b3f80,0xbf0b3fb5,0xbf0bbf80,0x3f0bbfb5,0xbfa03f80,0xbfb43e8d,0x3ed2bfb5,0x3f8cbf97,0xbf49bf80,0xbe8dbfa7,0x3f97bf80,0x3fb2bf0b,0x3f8cbf80,0x3fa0bf49,0x3fb428d1,0x3fad3e8d
.long 0xbf803f80,0xbf803f80,0xbf803f80,0xbf803f80,0x3ed23fa7,0x3e0e3fb2,0xbf2b3fa7,0xbf663f97,0x3fb22660,0x3f973f0b,0xbe8d3fb5,0xbf493fa7,0x3f66bfa7,0x3fadbf49,0x3e0e3fa7,0xbf2b3fb2
.long 0xbf0bbf80,0x3f0bbfb5,0x3f0b3f80,0xbf0b3fb5,0xbfb43f0b,0xbf2bbf49,0x3f663f0b,0xbed23fb2,0xbf493fb5,0xbfb23f0b,0x3f97a660,0xbe8d3fa7,0x3f2b3f0b,0xbf8c3fb2,0x3fadbf0b,0xbe0e3f97
.long 0x3fb5bf80,0xa6d03f80,0x3fb5bf80,0xa6903f80,0x3f2bbfa7,0x3f8cbe8d,0x3fadbfa7,0x3e0e3f49,0xbf4927ec,0x3fb2bfa7,0x3f97bfb5,0x3e8d3f0b,0xbfb43fa7,0x3f2bbf97,0x3f66bfa7,0x3ed23e8d
.long 0xbf0b3f80,0xbf0b2802,0x3f0bbf80,0x3f0ba866,0x3f66bf0b,0xbfad3f97,0x3e0ebf0b,0x3f2bbe8d,0x3fb2bfb5,0xbf973fa7,0xbe8da6f0,0x3f49bf0b,0x3ed2bf0b,0xbe0e3e8d,0xbf2b3f0b,0x3f66bf49
.long 0xbf803f80,0x3f80bf80,0xbf803f80,0x3f80bf80,0xbfad3fa7,0x3fb4bfb2,0xbfa03fa7,0x3f8cbf97,0xbe8da78c,0x3f49bf0b,0xbfb23fb5,0x3f97bfa7,0x3f8cbfa7,0xbed23f49,0xbfb43fa7,0x3fa0bfb2
.long 0x3fa7bf80,0xbfa73fb5,0xbfa73f80,0x3fa7bfb5,0x3e0e3f0b,0xbfa03f49,0xbf8c3f0b,0x3fadbfb2,0xbf973fb5,0xbe8dbf0b,0xbf49a8ea,0x3fb2bfa7,0xbfa03f0b,0x3f66bfb2,0xbed2bf0b,0x3fb4bf97
.long 0x2760bf80,0x3fb5bf80,0x2880bf80,0x3fb5bf80,0x3fa0bfa7,0x3f663e8d,0x3ed2bfa7,0x3fb4bf49,0x3f972690,0xbe8d3fa7,0x3f49bfb5,0x3fb2bf0b,0xbe0e3fa7,0xbfa03f97,0x3f8cbfa7,0x3fadbe8d
.long 0xbfa73f80,0xbfa72760,0x3fa7bf80,0x3fa728d1,0xbf8cbf0b,0xbed2bf97,0x3fb4bf0b,0x3fa03e8d,0x3e8dbfb5,0x3f49bfa7,0x3fb22872,0x3f973f0b,0x3fadbf0b,0x3fb4be8d,0x3fa03f0b,0x3f8c3f49
.long 0xbf803f80,0xbf803f80,0xbf803f80,0xbf803f80,0xbf8c3f80,0xbfa03f49,0xbfb42500,0xbfadbe8d,0xbf973f80,0xbfb23f0b,0xbf49bf80,0xbe8dbfa7,0xbfa03f80,0xbfb43e8d,0x3ed2bfb5,0x3f8cbf97
.long 0xbfa73f80,0xbfa72500,0x3fa7bf80,0x3fa7a580,0xbfad3f80,0xbf8cbe8d,0x3fa0a580,0x3e0e3f97,0xbfb23f80,0xbf49bf0b,0x3e8d3f80,0xbf973fa7,0xbfb43f80,0xbed2bf49,0xbf663fb5,0xbfa03e8d
.long 0xbfb53f80,0xa500bf80,0xbfb53f80,0xa6f0bf80,0xbfb43f80,0x3ed2bf97,0xbf6625c0,0x3fa0bfb2,0xbfb23f80,0x3f49bfa7,0x3e8dbf80,0x3f97bf0b,0xbfad3f80,0x3f8cbfb2,0x3fa0bfb5,0xbe0e3f49
.long 0xbfa73f80,0x3fa7bfb5,0x3fa7bf80,0xbfa73fb5,0xbfa03f80,0x3fb4bfb2,0x3ed22660,0xbf8c3f49,0xbf973f80,0x3fb2bfa7,0xbf493f80,0x3e8dbf0b,0xbf8c3f80,0x3fa0bf97,0xbfb43fb5,0x3fadbfb2
.long 0xbf803f80,0x3f80bf80,0xbf803f80,0x3f80bf80,0xbf663f80,0x3f2bbf49,0x3e0ea620,0xbed23e8d,0xbf493f80,0x3e8dbf0b,0x3f97bf80,0xbfb23fa7,0xbf2b3f80,0xbe0ebe8d,0x3fadbfb5,0xbf663f97
.long 0xbf0b3f80,0xbf0ba580,0x3f0bbf80,0x3f0ba500,0xbed23f80,0xbf663e8d,0xbf2b25c0,0x3fb4bf97,0xbe8d3f80,0xbf973f0b,0xbfb23f80,0x3f49bfa7,0xbe0e3f80,0xbfad3f49,0xbf8c3fb5,0xbf2bbe8d
.long 0xa5003f80,0xbfb53f80,0xa7283f80,0xbfb53f80,0x3e0e3f80,0xbfad3f97,0x3f8ca500,0xbf2b3fb2,0x3e8d3f80,0xbf973fa7,0x3fb2bf80,0x3f493f0b,0x3ed23f80,0xbf663fb2,0x3f2bbfb5,0x3fb4bf49
.long 0x3f0b3f80,0xbf0b3fb5,0xbf0bbf80,0x3f0bbfb5,0x3f2b3f80,0xbe0e3fb2,0xbfad0000,0xbf66bf49,0x3f493f80,0x3e8d3fa7,0xbf973f80,0xbfb23f0b,0x3f663f80,0x3f2b3f97,0xbe0e3fb5,0xbed23fb2
.long 0xbf803f80,0xbf803f80,0xbf803f80,0xbf803f80,0xbfad3f0b,0xbfb43e8d,0xbfa0bf0b,0xbf8cbf49,0xbfb22500,0xbf97bf0b,0x3e8dbfb5,0x3f49bfa7,0xbf8cbf0b,0xbed2bf97,0x3fb4bf0b,0x3fa03e8d
.long 0xbf0bbf80,0x3f0bbfb5,0x3f0b3f80,0xbf0b3fb5,0x3e0ebfa7,0x3fa0bf97,0xbf8c3fa7,0xbfad3e8d,0x3f49bfb5,0x3fb2bf0b,0xbf9725c0,0x3e8dbfa7,0x3fa0bfa7,0x3f663e8d,0x3ed2bfa7,0x3fb4bf49
.long 0x3fb5bf80,0x25c03f80,0x3fb5bf80,0x27083f80,0x3fa0bf0b,0xbf663fb2,0x3ed23f0b,0xbfb43f97,0x3f49a580,0xbfb23fa7,0xbf973fb5,0xbe8dbf0b,0x3e0e3f0b,0xbfa03f49,0xbf8c3f0b,0x3fadbfb2
.long 0xbf0b3f80,0xbf0b25c0,0x3f0bbf80,0x3f0b25c0,0xbf8c3fa7,0x3ed2bf49,0x3fb4bfa7,0xbfa03fb2,0xbfb23fb5,0x3f97bfa7,0x3e8d25c0,0xbf493f0b,0xbfad3fa7,0x3fb4bfb2,0xbfa03fa7,0x3f8cbf97
.long 0xbf803f80,0x3f80bf80,0xbf803f80,0x3f80bf80,0xbed23f0b,0x3e0ebe8d,0x3f2bbf0b,0xbf663f49,0x3e8d25c0,0xbf493f0b,0x3fb2bfb5,0xbf973fa7,0x3f66bf0b,0xbfad3f97,0x3e0ebf0b,0x3f2bbe8d
.long 0x3fa7bf80,0xbfa73fb5,0xbfa73f80,0x3fa7bfb5,0x3fb4bfa7,0xbf2b3f97,0xbf663fa7,0xbed2be8d,0x3f97bfb5,0x3e8d3f0b,0x3f4927bc,0xbfb23fa7,0x3f2bbfa7,0x3f8cbe8d,0x3fadbfa7,0x3e0e3f49
.long 0x2708bf80,0x3fb5bf80,0x2758bf80,0x3fb5bf80,0xbf2bbf0b,0x3f8cbfb2,0xbfad3f0b,0x3e0ebf97,0xbf972660,0x3e8dbfa7,0xbf493fb5,0xbfb23f0b,0xbfb43f0b,0xbf2bbf49,0x3f663f0b,0xbed23fb2
.long 0xbfa73f80,0xbfa725c0,0x3fa7bf80,0x3fa727d4,0xbf663fa7,0xbfad3f49,0xbe0ebfa7,0x3f2bbfb2,0xbe8d3fb5,0xbf493fa7,0xbfb2a842,0xbf97bf0b,0x3ed23fa7,0x3e0e3fb2,0xbf2b3fa7,0xbf663f97
.long 0xbf803f80,0xbf803f80,0xbf803f80,0xbf803f80,0xbf66bf80,0xbf2bbf97,0x3e0ebfb5,0x3ed2bfb2,0x3f97bf80,0x3fb2bf0b,0x3f493f80,0x3e8d3fa7,0x3f2b3f80,0xbe0e3fb2,0xbfad25c0,0xbf66bf49
.long 0xbfa73f80,0xbfa725c0,0x3fa7bf80,0x3fa72660,0xbed2bf80,0x3f66bfb2,0xbf2b3fb5,0xbfb43f49,0x3fb2bf80,0x3f493f0b,0xbe8dbf80,0x3f97bfa7,0x3e0e3f80,0xbfad3f97,0x3f8c25c0,0xbf2b3fb2
.long 0xbfb53f80,0xa718bf80,0xbfb53f80,0xa728bf80,0x3e0ebf80,0x3fadbf49,0x3f8cbfb5,0x3f2b3e8d,0x3fb2bf80,0xbf493fa7,0xbe8d3f80,0xbf973f0b,0xbed23f80,0xbf663e8d,0xbf2b27bc,0x3fb4bf97
.long 0xbfa73f80,0x3fa7bfb5,0x3fa7bf80,0xbfa73fb5,0x3f2bbf80,0x3e0e3e8d,0xbfad3fb5,0x3f66bf97,0x3f97bf80,0xbfb23fa7,0x3f49bf80,0xbe8d3f0b,0xbf663f80,0x3f2bbf49,0x3e0ea842,0xbed23e8d
.long 0xbf803f80,0x3f80bf80,0xbf803f80,0x3f80bf80,0x3f8cbf80,0xbfa03f97,0x3fb4bfb5,0xbfad3fb2,0x3f49bf80,0xbe8d3f0b,0xbf973f80,0x3fb2bfa7,0xbfa03f80,0x3fb4bfb2,0x3ed227e4,0xbf8c3f49
.long 0xbf0b3f80,0xbf0ba660,0x3f0bbf80,0x3f0b27ec,0x3fadbf80,0xbf8c3fb2,0xbfa03fb5,0x3e0ebf49,0x3e8dbf80,0x3f97bf0b,0x3fb2bf80,0xbf493fa7,0xbfb43f80,0x3ed2bf97,0xbf66a6f0,0x3fa0bfb2
.long 0xa7783f80,0xbfb53f80,0xa7a43f80,0xbfb53f80,0x3fb4bf80,0x3ed23f49,0x3f66bfb5,0x3fa0be8d,0xbe8dbf80,0x3f97bfa7,0xbfb23f80,0xbf49bf0b,0xbfad3f80,0xbf8cbe8d,0x3fa02802,0x3e0e3f97
.long 0x3f0b3f80,0xbf0b3fb5,0xbf0bbf80,0x3f0bbfb5,0x3fa0bf80,0x3fb4be8d,0xbed23fb5,0xbf8c3f97,0xbf49bf80,0xbe8dbfa7,0x3f97bf80,0x3fb2bf0b,0xbf8c3f80,0xbfa03f49,0xbfb4a866,0xbfadbe8d
.long 0xbf803f80,0xbf803f80,0xbf803f80,0xbf803f80,0xbed2bfa7,0xbe0ebfb2,0x3f2bbfa7,0x3f66bf97,0x3fb2a580,0x3f973f0b,0xbe8d3fb5,0xbf493fa7,0xbf663fa7,0xbfad3f49,0xbe0ebfa7,0x3f2bbfb2
.long 0xbf0bbf80,0x3f0bbfb5,0x3f0b3f80,0xbf0b3fb5,0x3fb4bf0b,0x3f2b3f49,0xbf66bf0b,0x3ed2bfb2,0xbf493fb5,0xbfb23f0b,0x3f9725c0,0xbe8d3fa7,0xbf2bbf0b,0x3f8cbfb2,0xbfad3f0b,0x3e0ebf97
.long 0x3fb5bf80,0x27283f80,0x3fb5bf80,0x27383f80,0xbf2b3fa7,0xbf8c3e8d,0xbfad3fa7,0xbe0ebf49,0xbf49a500,0x3fb2bfa7,0x3f97bfb5,0x3e8d3f0b,0x3fb4bfa7,0xbf2b3f97,0xbf663fa7,0xbed2be8d
.long 0xbf0b3f80,0xbf0b2500,0x3f0bbf80,0x3f0ba660,0xbf663f0b,0x3fadbf97,0xbe0e3f0b,0xbf2b3e8d,0x3fb2bfb5,0xbf973fa7,0xbe8d27d4,0x3f49bf0b,0xbed23f0b,0x3e0ebe8d,0x3f2bbf0b,0xbf663f49
.long 0xbf803f80,0x3f80bf80,0xbf803f80,0x3f80bf80,0x3fadbfa7,0xbfb43fb2,0x3fa0bfa7,0xbf8c3f97,0xbe8da660,0x3f49bf0b,0xbfb23fb5,0x3f97bfa7,0xbf8c3fa7,0x3ed2bf49,0x3fb4bfa7,0xbfa03fb2
.long 0x3fa7bf80,0xbfa73fb5,0xbfa73f80,0x3fa7bfb5,0xbe0ebf0b,0x3fa0bf49,0x3f8cbf0b,0xbfad3fb2,0xbf973fb5,0xbe8dbf0b,0xbf49a85a,0x3fb2bfa7,0x3fa0bf0b,0xbf663fb2,0x3ed23f0b,0xbfb43f97
.long 0xa690bf80,0x3fb5bf80,0x2836bf80,0x3fb5bf80,0xbfa03fa7,0xbf66be8d,0xbed23fa7,0xbfb43f49,0x3f97a778,0xbe8d3fa7,0x3f49bfb5,0x3fb2bf0b,0x3e0ebfa7,0x3fa0bf97,0xbf8c3fa7,0xbfad3e8d
.long 0xbfa73f80,0xbfa7a718,0x3fa7bf80,0x3fa7a6f0,0x3f8c3f0b,0x3ed23f97,0xbfb43f0b,0xbfa0be8d,0x3e8dbfb5,0x3f49bfa7,0x3fb228a5,0x3f973f0b,0xbfad3f0b,0xbfb43e8d,0xbfa0bf0b,0xbf8cbf49
.long 0xbf80bf80,0xbf80bf80,0xbf80bf80,0xbf80bf80,0xbf66bf80,0xbf2bbf97,0x3e0ebfb5,0x3ed2bfb2,0xbf49bf80,0xbe8dbfa7,0x3f97bf80,0x3fb2bf0b,0xbf2bbf80,0x3e0ebfb2,0x3fada500,0x3f663f49
.long 0xbf0bbf80,0x3f0bbfb5,0x3f0b3f80,0xbf0b3fb5,0xbed2bf80,0x3f66bfb2,0xbf2b3fb5,0xbfb43f49,0xbe8dbf80,0x3f97bfa7,0xbfb23f80,0xbf49bf0b,0xbe0ebf80,0x3fadbf97,0xbf8c25c0,0x3f2bbfb2
.long 0xa500bf80,0x3fb5bf80,0xa5c0bf80,0x3fb5bf80,0x3e0ebf80,0x3fadbf49,0x3f8cbfb5,0x3f2b3e8d,0x3e8dbf80,0x3f97bf0b,0x3fb2bf80,0xbf493fa7,0x3ed2bf80,0x3f66be8d,0x3f2ba6f0,0xbfb43f97
.long 0x3f0bbf80,0x3f0ba500,0xbf0b3f80,0xbf0b2708,0x3f2bbf80,0x3e0e3e8d,0xbfad3fb5,0x3f66bf97,0x3f49bf80,0xbe8d3f0b,0xbf973f80,0x3fb2bfa7,0x3f66bf80,0xbf2b3f49,0xbe0e2708,0x3ed2be8d
.long 0x3f80bf80,0xbf803f80,0x3f80bf80,0xbf803f80,0x3f8cbf80,0xbfa03f97,0x3fb4bfb5,0xbfad3fb2,0x3f97bf80,0xbfb23fa7,0x3f49bf80,0xbe8d3f0b,0x3fa0bf80,0xbfb43fb2,0xbed2a718,0x3f8cbf49
.long 0x3fa7bf80,0xbfa73fb5,0xbfa73f80,0x3fa7bfb5,0x3fadbf80,0xbf8c3fb2,0xbfa03fb5,0x3e0ebf49,0x3fb2bf80,0xbf493fa7,0xbe8d3f80,0xbf973f0b,0x3fb4bf80,0xbed23f97,0x3f662728,0xbfa03fb2
.long 0x3fb5bf80,0xa5c03f80,0x3fb5bf80,0xa5003f80,0x3fb4bf80,0x3ed23f49,0x3f66bfb5,0x3fa0be8d,0x3fb2bf80,0x3f493f0b,0xbe8dbf80,0x3f97bfa7,0x3fadbf80,0x3f8c3e8d,0xbfa0a728,0xbe0ebf97
.long 0x3fa7bf80,0x3fa725c0,0xbfa73f80,0xbfa7a748,0x3fa0bf80,0x3fb4be8d,0xbed23fb5,0xbf8c3f97,0x3f97bf80,0x3fb2bf0b,0x3f493f80,0x3e8d3fa7,0x3f8cbf80,0x3fa0bf49,0x3fb42738,0x3fad3e8d
.long 0xbf80bf80,0xbf80bf80,0xbf80bf80,0xbf80bf80,0xbed2bfa7,0xbe0ebfb2,0x3f2bbfa7,0x3f66bf97,0x3e8dbfb5,0x3f49bfa7,0x3fb2a500,0x3f973f0b,0x3f66bfa7,0x3fadbf49,0x3e0e3fa7,0xbf2b3fb2
.long 0x3fa7bf80,0x3fa7a500,0xbfa73f80,0xbfa725c0,0x3fb4bf0b,0x3f2b3f49,0xbf66bf0b,0x3ed2bfb2,0x3f97a500,0xbe8d3fa7,0x3f49bfb5,0x3fb2bf0b,0x3f2b3f0b,0xbf8c3fb2,0x3fadbf0b,0xbe0e3f97
.long 0x25803f80,0xbfb53f80,0xa6603f80,0xbfb53f80,0xbf2b3fa7,0xbf8c3e8d,0xbfad3fa7,0xbe0ebf49,0xbf973fb5,0xbe8dbf0b,0xbf492708,0x3fb2bfa7,0xbfb43fa7,0x3f2bbf97,0x3f66bfa7,0x3ed23e8d
.long 0xbfa73f80,0x3fa7bfb5,0x3fa7bf80,0xbfa73fb5,0xbf663f0b,0x3fadbf97,0xbe0e3f0b,0xbf2b3e8d,0xbe8d25c0,0x3f49bf0b,0xbfb23fb5,0x3f97bfa7,0x3ed2bf0b,0xbe0e3e8d,0xbf2b3f0b,0x3f66bf49
.long 0x3f80bf80,0xbf803f80,0x3f80bf80,0xbf803f80,0x3fadbfa7,0xbfb43fb2,0x3fa0bfa7,0xbf8c3f97,0x3fb2bfb5,0xbf973fa7,0xbe8da728,0x3f49bf0b,0x3f8cbfa7,0xbed23f49,0xbfb43fa7,0x3fa0bfb2
.long 0x3f0bbf80,0x3f0b2708,0xbf0b3f80,0xbf0ba748,0xbe0ebf0b,0x3fa0bf49,0x3f8cbf0b,0xbfad3fb2,0xbf49a6f0,0x3fb2bfa7,0x3f97bfb5,0x3e8d3f0b,0xbfa03f0b,0x3f66bfb2,0xbed2bf0b,0x3fb4bf97
.long 0xbfb53f80,0xa5c0bf80,0xbfb53f80,0x2660bf80,0xbfa03fa7,0xbf66be8d,0xbed23fa7,0xbfb43f49,0xbf493fb5,0xbfb23f0b,0x3f97a718,0xbe8d3fa7,0xbe0e3fa7,0xbfa03f97,0x3f8cbfa7,0x3fadbe8d
.long 0x3f0b3f80,0xbf0b3fb5,0xbf0bbf80,0x3f0bbfb5,0x3f8c3f0b,0x3ed23f97,0xbfb43f0b,0xbfa0be8d,0x3fb22708,0x3f973f0b,0xbe8d3fb5,0xbf493fa7,0x3fadbf0b,0x3fb4be8d,0x3fa03f0b,0x3f8c3f49
.long 0xbf80bf80,0xbf80bf80,0xbf80bf80,0xbf80bf80,0x3f8cbf80,0x3fa0bf49,0x3fb4a500,0x3fad3e8d,0x3f493f80,0x3e8d3fa7,0xbf973f80,0xbfb23f0b,0xbfa03f80,0xbfb43e8d,0x3ed2bfb5,0x3f8cbf97
.long 0xbf0bbf80,0x3f0bbfb5,0x3f0b3f80,0xbf0b3fb5,0x3fadbf80,0x3f8c3e8d,0xbfa02708,0xbe0ebf97,0x3e8d3f80,0xbf973fa7,0x3fb2bf80,0x3f493f0b,0xbfb43f80,0xbed2bf49,0xbf663fb5,0xbfa03e8d
.long 0x2620bf80,0x3fb5bf80,0x2500bf80,0x3fb5bf80,0x3fb4bf80,0xbed23f97,0x3f66a728,0xbfa03fb2,0xbe8d3f80,0xbf973f0b,0xbfb23f80,0x3f49bfa7,0xbfad3f80,0x3f8cbfb2,0x3fa0bfb5,0xbe0e3f49
.long 0x3f0bbf80,0x3f0ba728,0xbf0b3f80,0xbf0b2758,0x3fa0bf80,0xbfb43fb2,0xbed2a718,0x3f8cbf49,0xbf493f80,0x3e8dbf0b,0x3f97bf80,0xbfb23fa7,0xbf8c3f80,0x3fa0bf97,0xbfb43fb5,0x3fadbfb2
.long 0x3f80bf80,0xbf803f80,0x3f80bf80,0xbf803f80,0x3f66bf80,0xbf2b3f49,0xbe0e27ec,0x3ed2be8d,0xbf973f80,0x3fb2bfa7,0xbf493f80,0x3e8dbf0b,0xbf2b3f80,0xbe0ebe8d,0x3fadbfb5,0xbf663f97
.long 0x3fa7bf80,0xbfa73fb5,0xbfa73f80,0x3fa7bfb5,0x3ed2bf80,0x3f66be8d,0x3f2ba690,0xbfb43f97,0xbfb23f80,0x3f49bfa7,0x3e8dbf80,0x3f97bf0b,0xbe0e3f80,0xbfad3f49,0xbf8c3fb5,0xbf2bbe8d
.long 0x3fb5bf80,0xa7e43f80,0x3fb5bf80,0xa8023f80,0xbe0ebf80,0x3fadbf97,0xbf8ca7a4,0x3f2bbfb2,0xbfb23f80,0xbf49bf0b,0x3e8d3f80,0xbf973fa7,0x3ed23f80,0xbf663fb2,0x3f2bbfb5,0x3fb4bf49
.long 0x3fa7bf80,0x3fa7a690,0xbfa73f80,0xbfa7a7bc,0xbf2bbf80,0x3e0ebfb2,0x3fad2836,0x3f663f49,0xbf973f80,0xbfb23f0b,0xbf49bf80,0xbe8dbfa7,0x3f663f80,0x3f2b3f97,0xbe0e3fb5,0xbed23fb2
.long 0xbf80bf80,0xbf80bf80,0xbf80bf80,0xbf80bf80,0x3fadbf0b,0x3fb4be8d,0x3fa03f0b,0x3f8c3f49,0xbe8d3fb5,0xbf493fa7,0xbfb225c0,0xbf97bf0b,0xbf8cbf0b,0xbed2bf97,0x3fb4bf0b,0x3fa03e8d
.long 0x3fa7bf80,0x3fa7a6f0,0xbfa73f80,0xbfa72708,0xbe0e3fa7,0xbfa03f97,0x3f8cbfa7,0x3fadbe8d,0xbf972708,0x3e8dbfa7,0xbf493fb5,0xbfb23f0b,0x3fa0bfa7,0x3f663e8d,0x3ed2bfa7,0x3fb4bf49
.long 0xa5c03f80,0xbfb53f80,0x80003f80,0xbfb53f80,0xbfa03f0b,0x3f66bfb2,0xbed2bf0b,0x3fb4bf97,0x3f97bfb5,0x3e8d3f0b,0x3f49a748,0xbfb23fa7,0x3e0e3f0b,0xbfa03f49,0xbf8c3f0b,0x3fadbfb2
.long 0xbfa73f80,0x3fa7bfb5,0x3fa7bf80,0xbfa73fb5,0x3f8cbfa7,0xbed23f49,0xbfb43fa7,0x3fa0bfb2,0x3e8da748,0xbf493f0b,0x3fb2bfb5,0xbf973fa7,0xbfad3fa7,0x3fb4bfb2,0xbfa03fa7,0x3f8cbf97
.long 0x3f80bf80,0xbf803f80,0x3f80bf80,0xbf803f80,0x3ed2bf0b,0xbe0e3e8d,0xbf2b3f0b,0x3f66bf49,0xbfb23fb5,0x3f97bfa7,0x3e8da690,0xbf493f0b,0x3f66bf0b,0xbfad3f97,0x3e0ebf0b,0x3f2bbe8d
.long 0x3f0bbf80,0x3f0ba6d0,0xbf0b3f80,0xbf0ba7a4,0xbfb43fa7,0x3f2bbf97,0x3f66bfa7,0x3ed23e8d,0x3f49281c,0xbfb23fa7,0xbf973fb5,0xbe8dbf0b,0x3f2bbfa7,0x3f8cbe8d,0x3fadbfa7,0x3e0e3f49
.long 0xbfb53f80,0x26f0bf80,0xbfb53f80,0x2866bf80,0x3f2b3f0b,0xbf8c3fb2,0x3fadbf0b,0xbe0e3f97,0x3f49bfb5,0x3fb2bf0b,0xbf972887,0x3e8dbfa7,0xbfb43f0b,0xbf2bbf49,0x3f663f0b,0xbed23fb2
.long 0x3f0b3f80,0xbf0b3fb5,0xbf0bbf80,0x3f0bbfb5,0x3f66bfa7,0x3fadbf49,0x3e0e3fa7,0xbf2b3fb2,0xbfb2a7a4,0xbf97bf0b,0x3e8dbfb5,0x3f49bfa7,0x3ed23fa7,0x3e0e3fb2,0xbf2b3fa7,0xbf663f97
.long 0xbf803f80,0xbf803f80,0xbf803f80,0xbf803f80,0x3f8cbf80,0x3fa0bf49,0x3fb4a580,0x3fad3e8d,0xbf973f80,0xbfb23f0b,0xbf49bf80,0xbe8dbfa7,0x3fa0bf80,0x3fb4be8d,0xbed23fb5,0xbf8c3f97
.long 0xbfa73f80,0xbfa7a620,0x3fa7bf80,0x3fa725c0,0x3fadbf80,0x3f8c3e8d,0xbfa0a500,0xbe0ebf97,0xbfb23f80,0xbf49bf0b,0x3e8d3f80,0xbf973fa7,0x3fb4bf80,0x3ed23f49,0x3f66bfb5,0x3fa0be8d
.long 0xbfb53f80,0xa748bf80,0xbfb53f80,0xa760bf80,0x3fb4bf80,0xbed23f97,0x3f66a660,0xbfa03fb2,0xbfb23f80,0x3f49bfa7,0x3e8dbf80,0x3f97bf0b,0x3fadbf80,0xbf8c3fb2,0xbfa03fb5,0x3e0ebf49
.long 0xbfa73f80,0x3fa7bfb5,0x3fa7bf80,0xbfa73fb5,0x3fa0bf80,0xbfb43fb2,0xbed2a778,0x3f8cbf49,0xbf973f80,0x3fb2bfa7,0xbf493f80,0x3e8dbf0b,0x3f8cbf80,0xbfa03f97,0x3fb4bfb5,0xbfad3fb2
.long 0xbf803f80,0x3f80bf80,0xbf803f80,0x3f80bf80,0x3f66bf80,0xbf2b3f49,0xbe0ea728,0x3ed2be8d,0xbf493f80,0x3e8dbf0b,0x3f97bf80,0xbfb23fa7,0x3f2bbf80,0x3e0e3e8d,0xbfad3fb5,0x3f66bf97
.long 0xbf0b3f80,0xbf0ba728,0x3f0bbf80,0x3f0ba6f0,0x3ed2bf80,0x3f66be8d,0x3f2ba6f0,0xbfb43f97,0xbe8d3f80,0xbf973f0b,0xbfb23f80,0x3f49bfa7,0x3e0ebf80,0x3fadbf49,0x3f8cbfb5,0x3f2b3e8d
.long 0x27a43f80,0xbfb53f80,0xa7ec3f80,0xbfb53f80,0xbe0ebf80,0x3fadbf97,0xbf8c27d4,0x3f2bbfb2,0x3e8d3f80,0xbf973fa7,0x3fb2bf80,0x3f493f0b,0xbed2bf80,0x3f66bfb2,0xbf2b3fb5,0xbfb43f49
.long 0x3f0b3f80,0xbf0b3fb5,0xbf0bbf80,0x3f0bbfb5,0xbf2bbf80,0x3e0ebfb2,0x3fada836,0x3f663f49,0x3f493f80,0x3e8d3fa7,0xbf973f80,0xbfb23f0b,0xbf66bf80,0xbf2bbf97,0x3e0ebfb5,0x3ed2bfb2
.long 0xbf803f80,0xbf803f80,0xbf803f80,0xbf803f80,0x3fadbf0b,0x3fb4be8d,0x3fa03f0b,0x3f8c3f49,0xbfb225c0,0xbf97bf0b,0x3e8dbfb5,0x3f49bfa7,0x3f8c3f0b,0x3ed23f97,0xbfb43f0b,0xbfa0be8d
.long 0xbf0bbf80,0x3f0bbfb5,0x3f0b3f80,0xbf0b3fb5,0xbe0e3fa7,0xbfa03f97,0x3f8cbfa7,0x3fadbe8d,0x3f49bfb5,0x3fb2bf0b,0xbf972500,0x3e8dbfa7,0xbfa03fa7,0xbf66be8d,0xbed23fa7,0xbfb43f49
.long 0x3fb5bf80,0x27583f80,0x3fb5bf80,0xa6f03f80,0xbfa03f0b,0x3f66bfb2,0xbed2bf0b,0x3fb4bf97,0x3f49a660,0xbfb23fa7,0xbf973fb5,0xbe8dbf0b,0xbe0ebf0b,0x3fa0bf49,0x3f8cbf0b,0xbfad3fb2
.long 0xbf0b3f80,0xbf0b27e4,0x3f0bbf80,0x3f0ba6f0,0x3f8cbfa7,0xbed23f49,0xbfb43fa7,0x3fa0bfb2,0xbfb23fb5,0x3f97bfa7,0x3e8da718,0xbf493f0b,0x3fadbfa7,0xbfb43fb2,0x3fa0bfa7,0xbf8c3f97
.long 0xbf803f80,0x3f80bf80,0xbf803f80,0x3f80bf80,0x3ed2bf0b,0xbe0e3e8d,0xbf2b3f0b,0x3f66bf49,0x3e8d2802,0xbf493f0b,0x3fb2bfb5,0xbf973fa7,0xbf663f0b,0x3fadbf97,0xbe0e3f0b,0xbf2b3e8d
.long 0x3fa7bf80,0xbfa73fb5,0xbfa73f80,0x3fa7bfb5,0xbfb43fa7,0x3f2bbf97,0x3f66bfa7,0x3ed23e8d,0x3f97bfb5,0x3e8d3f0b,0x3f4928ab,0xbfb23fa7,0xbf2b3fa7,0xbf8c3e8d,0xbfad3fa7,0xbe0ebf49
.long 0x2690bf80,0x3fb5bf80,0x285abf80,0x3fb5bf80,0x3f2b3f0b,0xbf8c3fb2,0x3fadbf0b,0xbe0e3f97,0xbf97a78c,0x3e8dbfa7,0xbf493fb5,0xbfb23f0b,0x3fb4bf0b,0x3f2b3f49,0xbf66bf0b,0x3ed2bfb2
.long 0xbfa73f80,0xbfa7a7a4,0x3fa7bf80,0x3fa72842,0x3f66bfa7,0x3fadbf49,0x3e0e3fa7,0xbf2b3fb2,0xbe8d3fb5,0xbf493fa7,0xbfb2a8ea,0xbf97bf0b,0xbed2bfa7,0xbe0ebfb2,0x3f2bbfa7,0x3f66bf97
.long 0xbf803f80,0xbf803f80,0xbf803f80,0xbf803f80,0x3f663f80,0x3f2b3f97,0xbe0e3fb5,0xbed23fb2,0x3f97bf80,0x3fb2bf0b,0x3f493f80,0x3e8d3fa7,0xbf2bbf80,0x3e0ebfb2,0x3fad25c0,0x3f663f49
.long 0xbfa73f80,0xbfa7a500,0x3fa7bf80,0x3fa70000,0x3ed23f80,0xbf663fb2,0x3f2bbfb5,0x3fb4bf49,0x3fb2bf80,0x3f493f0b,0xbe8dbf80,0x3f97bfa7,0xbe0ebf80,0x3fadbf97,0xbf8c27d4,0x3f2bbfb2
.long 0xbfb53f80,0xa778bf80,0xbfb53f80,0xa78cbf80,0xbe0e3f80,0xbfad3f49,0xbf8c3fb5,0xbf2bbe8d,0x3fb2bf80,0xbf493fa7,0xbe8d3f80,0xbf973f0b,0x3ed2bf80,0x3f66be8d,0x3f2ba85a,0xbfb43f97
.long 0xbfa73f80,0x3fa7bfb5,0x3fa7bf80,0xbfa73fb5,0xbf2b3f80,0xbe0ebe8d,0x3fadbfb5,0xbf663f97,0x3f97bf80,0xbfb23fa7,0x3f49bf80,0xbe8d3f0b,0x3f66bf80,0xbf2b3f49,0xbe0e28a5,0x3ed2be8d
.long 0xbf803f80,0x3f80bf80,0xbf803f80,0x3f80bf80,0xbf8c3f80,0x3fa0bf97,0xbfb43fb5,0x3fadbfb2,0x3f49bf80,0xbe8d3f0b,0xbf973f80,0x3fb2bfa7,0x3fa0bf80,0xbfb43fb2,0xbed2a8dd,0x3f8cbf49
.long 0xbf0b3f80,0xbf0ba880,0x3f0bbf80,0x3f0b2836,0xbfad3f80,0x3f8cbfb2,0x3fa0bfb5,0xbe0e3f49,0x3e8dbf80,0x3f97bf0b,0x3fb2bf80,0xbf493fa7,0x3fb4bf80,0xbed23f97,0x3f662842,0xbfa03fb2
.long 0x27283f80,0xbfb53f80,0xa81c3f80,0xbfb53f80,0xbfb43f80,0xbed2bf49,0xbf663fb5,0xbfa03e8d,0xbe8dbf80,0x3f97bfa7,0xbfb23f80,0xbf49bf0b,0x3fadbf80,0x3f8c3e8d,0xbfa0a927,0xbe0ebf97
.long 0x3f0b3f80,0xbf0b3fb5,0xbf0bbf80,0x3f0bbfb5,0xbfa03f80,0xbfb43e8d,0x3ed2bfb5,0x3f8cbf97,0xbf49bf80,0xbe8dbfa7,0x3f97bf80,0x3fb2bf0b,0x3f8cbf80,0x3fa0bf49,0x3fb428d1,0x3fad3e8d
.long 0xbf803f80,0xbf803f80,0xbf803f80,0xbf803f80,0x3ed23fa7,0x3e0e3fb2,0xbf2b3fa7,0xbf663f97,0x3fb22660,0x3f973f0b,0xbe8d3fb5,0xbf493fa7,0x3f66bfa7,0x3fadbf49,0x3e0e3fa7,0xbf2b3fb2
.long 0xbf0bbf80,0x3f0bbfb5,0x3f0b3f80,0xbf0b3fb5,0xbfb43f0b,0xbf2bbf49,0x3f663f0b,0xbed23fb2,0xbf493fb5,0xbfb23f0b,0x3f97a660,0xbe8d3fa7,0x3f2b3f0b,0xbf8c3fb2,0x3fadbf0b,0xbe0e3f97
.long 0x3fb5bf80,0xa6d03f80,0x3fb5bf80,0xa6903f80,0x3f2bbfa7,0x3f8cbe8d,0x3fadbfa7,0x3e0e3f49,0xbf4927ec,0x3fb2bfa7,0x3f97bfb5,0x3e8d3f0b,0xbfb43fa7,0x3f2bbf97,0x3f66bfa7,0x3ed23e8d
.long 0xbf0b3f80,0xbf0b2802,0x3f0bbf80,0x3f0ba866,0x3f66bf0b,0xbfad3f97,0x3e0ebf0b,0x3f2bbe8d,0x3fb2bfb5,0xbf973fa7,0xbe8da6f0,0x3f49bf0b,0x3ed2bf0b,0xbe0e3e8d,0xbf2b3f0b,0x3f66bf49
.long 0xbf803f80,0x3f80bf80,0xbf803f80,0x3f80bf80,0xbfad3fa7,0x3fb4bfb2,0xbfa03fa7,0x3f8cbf97,0xbe8da78c,0x3f49bf0b,0xbfb23fb5,0x3f97bfa7,0x3f8cbfa7,0xbed23f49,0xbfb43fa7,0x3fa0bfb2
.long 0x3fa7bf80,0xbfa73fb5,0xbfa73f80,0x3fa7bfb5,0x3e0e3f0b,0xbfa03f49,0xbf8c3f0b,0x3fadbfb2,0xbf973fb5,0xbe8dbf0b,0xbf49a8ea,0x3fb2bfa7,0xbfa03f0b,0x3f66bfb2,0xbed2bf0b,0x3fb4bf97
.long 0x2760bf80,0x3fb5bf80,0x2880bf80,0x3fb5bf80,0x3fa0bfa7,0x3f663e8d,0x3ed2bfa7,0x3fb4bf49,0x3f972690,0xbe8d3fa7,0x3f49bfb5,0x3fb2bf0b,0xbe0e3fa7,0xbfa03f97,0x3f8cbfa7,0x3fadbe8d
.long 0xbfa73f80,0xbfa72760,0x3fa7bf80,0x3fa728d1,0xbf8cbf0b,0xbed2bf97,0x3fb4bf0b,0x3fa03e8d,0x3e8dbfb5,0x3f49bfa7,0x3fb22872,0x3f973f0b,0x3fadbf0b,0x3fb4be8d,0x3fa03f0b,0x3f8c3f49
.long 0xbf80bf80,0xbf80bf80,0xbf80bf80,0xbf80bf80,0x3f663f80,0x3f2b3f97,0xbe0e3fb5,0xbed23fb2,0xbf49bf80,0xbe8dbfa7,0x3f97bf80,0x3fb2bf0b,0x3f2b3f80,0xbe0e3fb2,0xbfad2708,0xbf66bf49
.long 0xbf0bbf80,0x3f0bbfb5,0x3f0b3f80,0xbf0b3fb5,0x3ed23f80,0xbf663fb2,0x3f2bbfb5,0x3fb4bf49,0xbe8dbf80,0x3f97bfa7,0xbfb23f80,0xbf49bf0b,0x3e0e3f80,0xbfad3f97,0x3f8ca748,0xbf2b3fb2
.long 0xa500bf80,0x3fb5bf80,0xa7c8bf80,0x3fb5bf80,0xbe0e3f80,0xbfad3f49,0xbf8c3fb5,0xbf2bbe8d,0x3e8dbf80,0x3f97bf0b,0x3fb2bf80,0xbf493fa7,0xbed23f80,0xbf663e8d,0xbf2b281c,0x3fb4bf97
.long 0x3f0bbf80,0x3f0ba778,0xbf0b3f80,0xbf0ba690,0xbf2b3f80,0xbe0ebe8d,0x3fadbfb5,0xbf663f97,0x3f49bf80,0xbe8d3f0b,0xbf973f80,0x3fb2bfa7,0xbf663f80,0x3f2bbf49,0x3e0ea7a4,0xbed23e8d
.long 0x3f80bf80,0xbf803f80,0x3f80bf80,0xbf803f80,0xbf8c3f80,0x3fa0bf97,0xbfb43fb5,0x3fadbfb2,0x3f97bf80,0xbfb23fa7,0x3f49bf80,0xbe8d3f0b,0xbfa03f80,0x3fb4bfb2,0x3ed225c0,0xbf8c3f49
.long 0x3fa7bf80,0xbfa73fb5,0xbfa73f80,0x3fa7bfb5,0xbfad3f80,0x3f8cbfb2,0x3fa0bfb5,0xbe0e3f49,0x3fb2bf80,0xbf493fa7,0xbe8d3f80,0xbf973f0b,0xbfb43f80,0x3ed2bf97,0xbf66a893,0x3fa0bfb2
.long 0x3fb5bf80,0x26f03f80,0x3fb5bf80,0xa82a3f80,0xbfb43f80,0xbed2bf49,0xbf663fb5,0xbfa03e8d,0x3fb2bf80,0x3f493f0b,0xbe8dbf80,0x3f97bfa7,0xbfad3f80,0xbf8cbe8d,0x3fa0285a,0x3e0e3f97
.long 0x3fa7bf80,0x3fa7284e,0xbfa73f80,0xbfa72728,0xbfa03f80,0xbfb43e8d,0x3ed2bfb5,0x3f8cbf97,0x3f97bf80,0x3fb2bf0b,0x3f493f80,0x3e8d3fa7,0xbf8c3f80,0xbfa03f49,0xbfb4a80e,0xbfadbe8d
.long 0xbf80bf80,0xbf80bf80,0xbf80bf80,0xbf80bf80,0x3ed23fa7,0x3e0e3fb2,0xbf2b3fa7,0xbf663f97,0x3e8dbfb5,0x3f49bfa7,0x3fb2a6f0,0x3f973f0b,0xbf663fa7,0xbfad3f49,0xbe0ebfa7,0x3f2bbfb2
.long 0x3fa7bf80,0x3fa7a718,0xbfa73f80,0xbfa72728,0xbfb43f0b,0xbf2bbf49,0x3f663f0b,0xbed23fb2,0x3f97a728,0xbe8d3fa7,0x3f49bfb5,0x3fb2bf0b,0xbf2bbf0b,0x3f8cbfb2,0xbfad3f0b,0x3e0ebf97
.long 0x25c03f80,0xbfb53f80,0x26603f80,0xbfb53f80,0x3f2bbfa7,0x3f8cbe8d,0x3fadbfa7,0x3e0e3f49,0xbf973fb5,0xbe8dbf0b,0xbf49a6d0,0x3fb2bfa7,0x3fb4bfa7,0xbf2b3f97,0xbf663fa7,0xbed2be8d
.long 0xbfa73f80,0x3fa7bfb5,0x3fa7bf80,0xbfa73fb5,0x3f66bf0b,0xbfad3f97,0x3e0ebf0b,0x3f2bbe8d,0xbe8da690,0x3f49bf0b,0xbfb23fb5,0x3f97bfa7,0xbed23f0b,0x3e0ebe8d,0x3f2bbf0b,0xbf663f49
.long 0x3f80bf80,0xbf803f80,0x3f80bf80,0xbf803f80,0xbfad3fa7,0x3fb4bfb2,0xbfa03fa7,0x3f8cbf97,0x3fb2bfb5,0xbf973fa7,0xbe8d27a4,0x3f49bf0b,0xbf8c3fa7,0x3ed2bf49,0x3fb4bfa7,0xbfa03fb2
.long 0x3f0bbf80,0x3f0b25c0,0xbf0b3f80,0xbf0b278c,0x3e0e3f0b,0xbfa03f49,0xbf8c3f0b,0x3fadbfb2,0xbf49a88d,0x3fb2bfa7,0x3f97bfb5,0x3e8d3f0b,0x3fa0bf0b,0xbf663fb2,0x3ed23f0b,0xbfb43f97
.long 0xbfb53f80,0x278cbf80,0xbfb53f80,0x2887bf80,0x3fa0bfa7,0x3f663e8d,0x3ed2bfa7,0x3fb4bf49,0xbf493fb5,0xbfb23f0b,0x3f97a89f,0xbe8d3fa7,0x3e0ebfa7,0x3fa0bf97,0xbf8c3fa7,0xbfad3e8d
.long 0x3f0b3f80,0xbf0b3fb5,0xbf0bbf80,0x3f0bbfb5,0xbf8cbf0b,0xbed2bf97,0x3fb4bf0b,0x3fa03e8d,0x3fb2285a,0x3f973f0b,0xbe8d3fb5,0xbf493fa7,0xbfad3f0b,0xbfb43e8d,0xbfa0bf0b,0xbf8cbf49
.long 0xbf80bf80,0xbf80bf80,0xbf80bf80,0xbf80bf80,0xbf8c3f80,0xbfa03f49,0xbfb425c0,0xbfadbe8d,0x3f493f80,0x3e8d3fa7,0xbf973f80,0xbfb23f0b,0x3fa0bf80,0x3fb4be8d,0xbed23fb5,0xbf8c3f97
.long 0xbf0bbf80,0x3f0bbfb5,0x3f0b3f80,0xbf0b3fb5,0xbfad3f80,0xbf8cbe8d,0x3fa0a748,0x3e0e3f97,0x3e8d3f80,0xbf973fa7,0x3fb2bf80,0x3f493f0b,0x3fb4bf80,0x3ed23f49,0x3f66bfb5,0x3fa0be8d
.long 0xa7d4bf80,0x3fb5bf80,0xa7e4bf80,0x3fb5bf80,0xbfb43f80,0x3ed2bf97,0xbf66a690,0x3fa0bfb2,0xbe8d3f80,0xbf973f0b,0xbfb23f80,0x3f49bfa7,0x3fadbf80,0xbf8c3fb2,0xbfa03fb5,0x3e0ebf49
.long 0x3f0bbf80,0x3f0ba7a4,0xbf0b3f80,0xbf0b2836,0xbfa03f80,0x3fb4bfb2,0x3ed22887,0xbf8c3f49,0xbf493f80,0x3e8dbf0b,0x3f97bf80,0xbfb23fa7,0x3f8cbf80,0xbfa03f97,0x3fb4bfb5,0xbfad3fb2
.long 0x3f80bf80,0xbf803f80,0x3f80bf80,0xbf803f80,0xbf663f80,0x3f2bbf49,0x3e0ea81c,0xbed23e8d,0xbf973f80,0x3fb2bfa7,0xbf493f80,0x3e8dbf0b,0x3f2bbf80,0x3e0e3e8d,0xbfad3fb5,0x3f66bf97
.long 0x3fa7bf80,0xbfa73fb5,0xbfa73f80,0x3fa7bfb5,0xbed23f80,0xbf663e8d,0xbf2b2728,0x3fb4bf97,0xbfb23f80,0x3f49bfa7,0x3e8dbf80,0x3f97bf0b,0x3e0ebf80,0x3fadbf49,0x3f8cbfb5,0x3f2b3e8d
.long 0x3fb5bf80,0xa5c03f80,0x3fb5bf80,0x281c3f80,0x3e0e3f80,0xbfad3f97,0x3f8ca893,0xbf2b3fb2,0xbfb23f80,0xbf49bf0b,0x3e8d3f80,0xbf973fa7,0xbed2bf80,0x3f66bfb2,0xbf2b3fb5,0xbfb43f49
.long 0x3fa7bf80,0x3fa728d7,0xbfa73f80,0xbfa7a836,0x3f2b3f80,0xbe0e3fb2,0xbfada836,0xbf66bf49,0xbf973f80,0xbfb23f0b,0xbf49bf80,0xbe8dbfa7,0xbf66bf80,0xbf2bbf97,0x3e0ebfb5,0x3ed2bfb2
.long 0xbf80bf80,0xbf80bf80,0xbf80bf80,0xbf80bf80,0xbfad3f0b,0xbfb43e8d,0xbfa0bf0b,0xbf8cbf49,0xbe8d3fb5,0xbf493fa7,0xbfb22708,0xbf97bf0b,0x3f8c3f0b,0x3ed23f97,0xbfb43f0b,0xbfa0be8d
.long 0x3fa7bf80,0x3fa7a728,0xbfa73f80,0xbfa72738,0x3e0ebfa7,0x3fa0bf97,0xbf8c3fa7,0xbfad3e8d,0xbf972758,0x3e8dbfa7,0xbf493fb5,0xbfb23f0b,0xbfa03fa7,0xbf66be8d,0xbed23fa7,0xbfb43f49
.long 0x26903f80,0xbfb53f80,0x26d03f80,0xbfb53f80,0x3fa0bf0b,0xbf663fb2,0x3ed23f0b,0xbfb43f97,0x3f97bfb5,0x3e8d3f0b,0x3f49a7a4,0xbfb23fa7,0xbe0ebf0b,0x3fa0bf49,0x3f8cbf0b,0xbfad3fb2
.long 0xbfa73f80,0x3fa7bfb5,0x3fa7bf80,0xbfa73fb5,0xbf8c3fa7,0x3ed2bf49,0x3fb4bfa7,0xbfa03fb2,0x3e8da7bc,0xbf493f0b,0x3fb2bfb5,0xbf973fa7,0x3fadbfa7,0xbfb43fb2,0x3fa0bfa7,0xbf8c3f97
.long 0x3f80bf80,0xbf803f80,0x3f80bf80,0xbf803f80,0xbed23f0b,0x3e0ebe8d,0x3f2bbf0b,0xbf663f49,0xbfb23fb5,0x3f97bfa7,0x3e8d285a,0xbf493f0b,0xbf663f0b,0x3fadbf97,0xbe0e3f0b,0xbf2b3e8d
.long 0x3f0bbf80,0x3f0b285a,0xbf0b3f80,0xbf0ba80e,0x3fb4bfa7,0xbf2b3f97,0xbf663fa7,0xbed2be8d,0x3f4928cb,0xbfb23fa7,0xbf973fb5,0xbe8dbf0b,0xbf2b3fa7,0xbf8c3e8d,0xbfad3fa7,0xbe0ebf49
.long 0xbfb53f80,0x28eabf80,0xbfb53f80,0xa760bf80,0xbf2bbf0b,0x3f8cbfb2,0xbfad3f0b,0x3e0ebf97,0x3f49bfb5,0x3fb2bf0b,0xbf9728b9,0x3e8dbfa7,0x3fb4bf0b,0x3f2b3f49,0xbf66bf0b,0x3ed2bfb2
.long 0x3f0b3f80,0xbf0b3fb5,0xbf0bbf80,0x3f0bbfb5,0xbf663fa7,0xbfad3f49,0xbe0ebfa7,0x3f2bbfb2,0xbfb2a8b2,0xbf97bf0b,0x3e8dbfb5,0x3f49bfa7,0xbed2bfa7,0xbe0ebfb2,0x3f2bbfa7,0x3f66bf97
.long 0x3f803f80,0x3f803f80,0x3f803f80,0x3f803f80,0x3f7f3f80,0x3f753f7b,0x3f223f35,0x3ef13f0e,0x3f7b3f80,0x3f553f6d,0xbe48248d,0xbf0ebec4,0x3f753f80,0x3f223f55,0xbf62bf35,0xbf7fbf7b
.long 0x3f6d3f80,0x3ec43f35,0xbf6dbf80,0xbec4bf35,0x3f623f80,0x3dc93f0e,0xbe95bf35,0x3f223e48,0x3f553f80,0xbe483ec4,0x3f0ea554,0x3f7b3f6d,0x3f463f80,0xbef13e48,0x3f7f3f35,0x3e953f55
.long 0x3f353f80,0xbf35248d,0x3f353f80,0xbf3525b0,0x3f223f80,0xbf62be48,0xbdc93f35,0xbf75bf55,0x3f0e3f80,0xbf7bbec4,0xbf5525b0,0xbe48bf6d,0x3ef13f80,0xbf7fbf0e,0xbf75bf35,0x3f46be48
.long 0x3ec43f80,0xbf6dbf35,0xbec4bf80,0x3f6d3f35,0x3e953f80,0xbf46bf55,0x3ef1bf35,0x3dc93f7b,0x3e483f80,0xbf0ebf6d,0x3f7ba5f7,0xbf553ec4,0x3dc93f80,0xbe95bf7b,0x3f463f35,0xbf62bf0e
.long 0x248d3f80,0xa554bf80,0x261f3f80,0xa731bf80,0xbdc93f80,0x3e95bf7b,0xbf463f35,0x3f62bf0e,0xbe483f80,0x3f0ebf6d,0xbf7b261f,0x3f553ec4,0xbe953f80,0x3f46bf55,0xbef1bf35,0xbdc93f7b
.long 0xbec43f80,0x3f6dbf35,0x3ec4bf80,0xbf6d3f35,0xbef13f80,0x3f7fbf0e,0x3f75bf35,0xbf46be48,0xbf0e3f80,0x3f7bbec4,0x3f55a731,0x3e48bf6d,0xbf223f80,0x3f62be48,0x3dc93f35,0x3f75bf55
.long 0xbf353f80,0x3f35a554,0xbf353f80,0x3f35a742,0xbf463f80,0x3ef13e48,0xbf7f3f35,0xbe953f55,0xbf553f80,0x3e483ec4,0xbf0ea68d,0xbf7b3f6d,0xbf623f80,0xbdc93f0e,0x3e95bf35,0xbf223e48
.long 0xbf6d3f80,0xbec43f35,0x3f6dbf80,0x3ec4bf35,0xbf753f80,0xbf223f55,0x3f62bf35,0x3f7fbf7b,0xbf7b3f80,0xbf553f6d,0x3e48a742,0x3f0ebec4,0xbf7f3f80,0xbf753f7b,0xbf223f35,0xbef13f0e
.long 0x3f803f80,0x3f803f80,0x3f803f80,0x3f803f80,0x3f623f6d,0x3f463f55,0x3e953ec4,0x3dc93e48,0x3f0e3f35,0x3e483ec4,0xbf55bf35,0xbf7bbf6d,0x3dc93ec4,0xbef1be48,0xbf46bf6d,0xbe95bf0e
.long 0xbec4248d,0xbf6dbf35,0x3ec4a554,0x3f6d3f35,0xbf46bec4,0xbf75bf7b,0x3f7f3f6d,0x3ef13f55,0xbf7bbf35,0xbf0ebf6d,0x3e483f35,0xbf55bec4,0xbf75bf6d,0x3dc9bf0e,0xbf62bec4,0xbf22bf7b
.long 0xbf35bf80,0x3f35a554,0xbf35bf80,0x3f35a5f7,0xbe95bf6d,0x3f7f3f0e,0x3ef1bec4,0x3f463f7b,0x3e48bf35,0x3f553f6d,0x3f7b3f35,0xbf0e3ec4,0x3f22bec4,0x3e953f7b,0x3dc93f6d,0xbf62bf55
.long 0x3f6da554,0xbec43f35,0xbf6d261f,0x3ec4bf35,0x3f7f3ec4,0xbf623e48,0xbf22bf6d,0x3f753f0e,0x3f553f35,0xbf7bbec4,0x3f0ebf35,0xbe483f6d,0x3ef13f6d,0xbf22bf55,0x3f753ec4,0xbf7fbe48
.long 0x25b03f80,0xa5f7bf80,0xa68d3f80,0xa742bf80,0xbef13f6d,0x3f22bf55,0xbf753ec4,0x3f7fbe48,0xbf553f35,0x3f7bbec4,0xbf0ebf35,0x3e483f6d,0xbf7f3ec4,0x3f623e48,0x3f22bf6d,0xbf753f0e
.long 0xbf6d25b0,0x3ec43f35,0x3f6da742,0xbec4bf35,0xbf22bec4,0xbe953f7b,0xbdc93f6d,0x3f62bf55,0xbe48bf35,0xbf553f6d,0xbf7b3f35,0x3f0e3ec4,0x3e95bf6d,0xbf7f3f0e,0xbef1bec4,0xbf463f7b
.long 0x3f35bf80,0xbf35261f,0x3f35bf80,0xbf35a60d,0x3f75bf6d,0xbdc9bf0e,0x3f62bec4,0x3f22bf7b,0x3f7bbf35,0x3f0ebf6d,0xbe483f35,0x3f55bec4,0x3f46bec4,0x3f75bf7b,0xbf7f3f6d,0xbef13f55
.long 0x3ec4a5f7,0x3f6dbf35,0xbec4a60d,0xbf6d3f35,0xbdc93ec4,0x3ef1be48,0x3f46bf6d,0x3e95bf0e,0xbf0e3f35,0xbe483ec4,0x3f55bf35,0x3f7bbf6d,0xbf623f6d,0xbf463f55,0xbe953ec4,0xbdc93e48
.long 0x3f803f80,0x3f803f80,0x3f803f80,0x3f803f80,0xbdc9248d,0xbe95be48,0xbf46bf35,0xbf62bf55,0xbf7bbf80,0xbf55bf6d,0x3e48a554,0x3f0e3ec4,0x3e95a554,0x3f463f0e,0x3ef13f35,0xbdc93e48
.long 0x3f6d3f80,0x3ec43f35,0xbf6dbf80,0xbec4bf35,0xbef125b0,0xbf7fbf55,0x3f753f35,0x3f463f7b,0xbf55bf80,0x3e48bec4,0xbf0e261f,0xbf7bbf6d,0x3f22a5f7,0x3f623f7b,0xbdc9bf35,0x3f753f0e
.long 0x3f353f80,0xbf35261f,0x3f353f80,0xbf35a68d,0xbf46261f,0xbef1bf7b,0xbf7fbf35,0x3e95bf0e,0xbf0ebf80,0x3f7b3ec4,0x3f55a742,0x3e483f6d,0x3f62a731,0xbdc93f55,0xbe953f35,0xbf22bf7b
.long 0x3ec43f80,0xbf6dbf35,0xbec4bf80,0x3f6d3f35,0xbf75a68d,0x3f22bf0e,0x3f623f35,0xbf7fbe48,0xbe48bf80,0x3f0e3f6d,0xbf7ba60d,0x3f55bec4,0x3f7fa742,0xbf753e48,0x3f22bf35,0xbef13f55
.long 0xa6543f80,0xa754bf80,0xa58e3f80,0xa777bf80,0xbf7fa654,0x3f753e48,0xbf22bf35,0x3ef13f55,0x3e48bf80,0xbf0e3f6d,0x3f7ba777,0xbf55bec4,0x3f75a754,0xbf22bf0e,0xbf623f35,0x3f7fbe48
.long 0xbec43f80,0x3f6dbf35,0x3ec4bf80,0xbf6d3f35,0xbf62a60d,0x3dc93f55,0x3e953f35,0x3f22bf7b,0x3f0ebf80,0xbf7b3ec4,0xbf552804,0xbe483f6d,0x3f46a765,0x3ef1bf7b,0x3f7fbf35,0xbe95bf0e
.long 0xbf353f80,0x3f35a777,0xbf353f80,0x3f35a796,0xbf22a58e,0xbf623f7b,0x3dc9bf35,0xbf753f0e,0x3f55bf80,0xbe48bec4,0x3f0e2754,0x3f7bbf6d,0x3ef1a777,0x3f7fbf55,0xbf753f35,0xbf463f7b
.long 0xbf6d3f80,0xbec43f35,0x3f6dbf80,0x3ec4bf35,0xbe95a137,0xbf463f0e,0xbef13f35,0x3dc93e48,0x3f7bbf80,0x3f55bf6d,0xbe482889,0xbf0e3ec4,0x3dc9a784,0x3e95be48,0x3f46bf35,0x3f62bf55
.long 0x3f803f80,0x3f803f80,0x3f803f80,0x3f803f80,0xbef1bec4,0xbf22bf0e,0xbf75bf6d,0xbf7fbf7b,0xbf0ebf35,0xbe48bec4,0x3f553f35,0x3f7b3f6d,0x3f7f3f6d,0x3f623f7b,0xbf22bec4,0xbf75bf55
.long 0xbec425b0,0xbf6dbf35,0x3ec4a5f7,0x3f6d3f35,0xbf22bf6d,0x3e95be48,0xbdc93ec4,0xbf62bf0e,0x3f7b3f35,0x3f0e3f6d,0xbe48bf35,0x3f553ec4,0xbe953ec4,0xbf7fbf55,0x3ef13f6d,0xbf46be48
.long 0xbf35bf80,0x3f35a731,0xbf35bf80,0x3f35a742,0x3f753ec4,0x3dc93f55,0x3f623f6d,0xbf223e48,0xbe483f35,0xbf55bf6d,0xbf7bbf35,0x3f0ebec4,0xbf46bf6d,0x3f753e48,0x3f7f3ec4,0xbef13f0e
.long 0x3f6da742,0xbec43f35,0xbf6da60d,0x3ec4bf35,0xbdc93f6d,0xbef1bf7b,0x3f46bec4,0xbe953f55,0xbf55bf35,0x3f7b3ec4,0xbf0e3f35,0x3e48bf6d,0x3f62bec4,0xbf463f0e,0x3e95bf6d,0xbdc93f7b
.long 0xa60d3f80,0xa765bf80,0xa1373f80,0xa784bf80,0xbf62bec4,0x3f463f0e,0xbe95bf6d,0x3dc93f7b,0x3f55bf35,0xbf7b3ec4,0x3f0e3f35,0xbe48bf6d,0x3dc93f6d,0x3ef1bf7b,0xbf46bec4,0x3e953f55
.long 0xbf6da58e,0x3ec43f35,0x3f6da78d,0xbec4bf35,0x3f46bf6d,0xbf753e48,0xbf7f3ec4,0x3ef13f0e,0x3e483f35,0x3f55bf6d,0x3f7bbf35,0xbf0ebec4,0xbf753ec4,0xbdc93f55,0xbf623f6d,0x3f223e48
.long 0x3f35bf80,0xbf35258d,0x3f35bf80,0xbf35268d,0x3e953ec4,0x3f7fbf55,0xbef13f6d,0x3f46be48,0xbf7b3f35,0xbf0e3f6d,0x3e48bf35,0xbf553ec4,0x3f22bf6d,0xbe95be48,0x3dc93ec4,0x3f62bf0e
.long 0x3ec4a78d,0x3f6dbf35,0xbec42816,0xbf6d3f35,0xbf7f3f6d,0xbf623f7b,0x3f22bec4,0x3f75bf55,0x3f0ebf35,0x3e48bec4,0xbf553f35,0xbf7b3f6d,0x3ef1bec4,0x3f22bf0e,0x3f75bf6d,0x3f7fbf7b
.long 0x80008000,0x80008000,0x80008000,0x80008000,0xbdc98000,0xbe95be48,0xbf46bf35,0xbf62bf55,0xbe488000,0xbf0ebec4,0xbf7bbf80,0xbf55bf6d,0xbe958000,0xbf46bf0e,0xbef1bf35,0x3dc9be48
.long 0xbec48000,0xbf6dbf35,0x3ec4a50d,0x3f6d3f35,0xbef18000,0xbf7fbf55,0x3f753f35,0x3f463f7b,0xbf0e8000,0xbf7bbf6d,0x3f553f80,0xbe483ec4,0xbf228000,0xbf62bf7b,0x3dc93f35,0xbf75bf0e
.long 0xbf358000,0xbf35bf80,0xbf35258d,0xbf35bf80,0xbf468000,0xbef1bf7b,0xbf7fbf35,0x3e95bf0e,0xbf558000,0xbe48bf6d,0xbf0ebf80,0x3f7b3ec4,0xbf628000,0x3dc9bf55,0x3e95bf35,0x3f223f7b
.long 0xbf6d8000,0x3ec4bf35,0x3f6da5d4,0xbec43f35,0xbf758000,0x3f22bf0e,0x3f623f35,0xbf7fbe48,0xbf7b8000,0x3f55bec4,0x3e483f80,0xbf0ebf6d,0xbf7f8000,0x3f75be48,0xbf223f35,0x3ef1bf55
.long 0xbf808000,0x3f80a50d,0xbf80260d,0x3f80a630,0xbf7f8000,0x3f753e48,0xbf22bf35,0x3ef13f55,0xbf7b8000,0x3f553ec4,0x3e48bf80,0xbf0e3f6d,0xbf758000,0x3f223f0e,0x3f62bf35,0xbf7f3e48
.long 0xbf6d8000,0x3ec43f35,0x3f6da630,0xbec4bf35,0xbf628000,0x3dc93f55,0x3e953f35,0x3f22bf7b,0xbf558000,0xbe483f6d,0xbf0e3f80,0x3f7bbec4,0xbf468000,0xbef13f7b,0xbf7f3f35,0x3e953f0e
.long 0xbf358000,0xbf353f80,0xbf352654,0xbf353f80,0xbf228000,0xbf623f7b,0x3dc9bf35,0xbf753f0e,0xbf0e8000,0xbf7b3f6d,0x3f55bf80,0xbe48bec4,0xbef18000,0xbf7f3f55,0x3f75bf35,0x3f46bf7b
.long 0xbec48000,0xbf6d3f35,0x3ec4a677,0x3f6dbf35,0xbe958000,0xbf463f0e,0xbef13f35,0x3dc93e48,0xbe488000,0xbf0e3ec4,0xbf7b3f80,0xbf553f6d,0xbdc98000,0xbe953e48,0xbf463f35,0xbf623f55
.long 0x80008000,0x80008000,0x80008000,0x80008000,0xbef1bec4,0xbf22bf0e,0xbf75bf6d,0xbf7fbf7b,0xbf55bf35,0xbf7bbf6d,0xbf0ebf35,0xbe48bec4,0xbf7fbf6d,0xbf62bf7b,0x3f223ec4,0x3f753f55
.long 0xbf6dbf80,0xbec4bf35,0x3f6d3f80,0x3ec43f35,0xbf22bf6d,0x3e95be48,0xbdc93ec4,0xbf62bf0e,0xbe48bf35,0x3f553ec4,0xbf7bbf35,0xbf0ebf6d,0x3e95bec4,0x3f7f3f55,0xbef1bf6d,0x3f463e48
.long 0x3f35a50d,0x3f353f80,0x3f35a5d4,0x3f353f80,0x3f753ec4,0x3dc93f55,0x3f623f6d,0xbf223e48,0x3f7b3f35,0xbf0e3ec4,0xbe483f35,0xbf55bf6d,0x3f463f6d,0xbf75be48,0xbf7fbec4,0x3ef1bf0e
.long 0x3ec43f80,0xbf6dbf35,0xbec4bf80,0x3f6d3f35,0xbdc93f6d,0xbef1bf7b,0x3f46bec4,0xbe953f55,0xbf0e3f35,0x3e48bf6d,0x3f553f35,0xbf7bbec4,0xbf623ec4,0x3f46bf0e,0xbe953f6d,0x3dc9bf7b
.long 0xbf80258d,0x3f80a5d4,0xbf802654,0x3f80a677,0xbf62bec4,0x3f463f0e,0xbe95bf6d,0x3dc93f7b,0xbf0ebf35,0x3e483f6d,0x3f55bf35,0xbf7b3ec4,0xbdc9bf6d,0xbef13f7b,0x3f463ec4,0xbe95bf55
.long 0x3ec4bf80,0xbf6d3f35,0xbec43f80,0x3f6dbf35,0x3f46bf6d,0xbf753e48,0xbf7f3ec4,0x3ef13f0e,0x3f7bbf35,0xbf0ebec4,0xbe48bf35,0xbf553f6d,0x3f75bec4,0x3dc9bf55,0x3f62bf6d,0xbf22be48
.long 0x3f35a5d4,0x3f35bf80,0x3f35a69f,0x3f35bf80,0x3e953ec4,0x3f7fbf55,0xbef13f6d,0x3f46be48,0xbe483f35,0x3f55bec4,0xbf7b3f35,0xbf0e3f6d,0xbf223f6d,0x3e953e48,0xbdc9bec4,0xbf623f0e
.long 0xbf6d3f80,0xbec43f35,0x3f6dbf80,0x3ec4bf35,0xbf7f3f6d,0xbf623f7b,0x3f22bec4,0x3f75bf55,0xbf553f35,0xbf7b3f6d,0xbf0e3f35,0xbe483ec4,0xbef13ec4,0xbf223f0e,0xbf753f6d,0xbf7f3f7b
.long 0x80008000,0x80008000,0x80008000,0x80008000,0xbf7fbf80,0xbf75bf7b,0xbf22bf35,0xbef1bf0e,0x3e48a50d,0x3f0e3ec4,0x3f7b3f80,0x3f553f6d,0x3f753f80,0x3f223f55,0xbf62bf35,0xbf7fbf7b
.long 0xbec4258d,0xbf6dbf35,0x3ec4a5d4,0x3f6d3f35,0xbf62bf80,0xbdc9bf0e,0x3e953f35,0xbf22be48,0x3f0ea5d4,0x3f7b3f6d,0xbf55bf80,0x3e48bec4,0x3f463f80,0xbef13e48,0x3f7f3f35,0x3e953f55
.long 0xbf35260d,0xbf35bf80,0xbf352654,0xbf35bf80,0xbf22bf80,0x3f623e48,0x3dc9bf35,0x3f753f55,0x3f55a630,0x3e483f6d,0x3f0e3f80,0xbf7bbec4,0x3ef13f80,0xbf7fbf0e,0xbf75bf35,0x3f46be48
.long 0xbf6d2654,0x3ec4bf35,0x3f6da69f,0xbec43f35,0xbe95bf80,0x3f463f55,0xbef13f35,0xbdc9bf7b,0x3f7ba677,0xbf553ec4,0xbe48bf80,0x3f0e3f6d,0x3dc93f80,0xbe95bf7b,0x3f463f35,0xbf62bf0e
.long 0xbf80268d,0x3f80a69f,0xbf8026d4,0x3f80270d,0x3dc9bf80,0xbe953f7b,0x3f46bf35,0xbf623f0e,0x3f7ba69f,0xbf55bec4,0xbe483f80,0x3f0ebf6d,0xbe953f80,0x3f46bf55,0xbef1bf35,0xbdc93f7b
.long 0xbf6d26b0,0x3ec43f35,0x3f6da7c2,0xbec4bf35,0x3ef1bf80,0xbf7f3f0e,0xbf753f35,0x3f463e48,0x3f55a7b1,0x3e48bf6d,0x3f0ebf80,0xbf7b3ec4,0xbf223f80,0x3f62be48,0x3dc93f35,0x3f75bf55
.long 0xbf3526d4,0xbf353f80,0xbf35271f,0xbf353f80,0x3f46bf80,0xbef1be48,0x3f7fbf35,0x3e95bf55,0x3f0e270d,0x3f7bbf6d,0xbf553f80,0x3e483ec4,0xbf623f80,0xbdc93f0e,0x3e95bf35,0xbf223e48
.long 0xbec426f7,0xbf6d3f35,0x3ec4268d,0x3f6dbf35,0x3f75bf80,0x3f22bf55,0xbf623f35,0xbf7f3f7b,0x3e48a7c2,0x3f0ebec4,0x3f7bbf80,0x3f55bf6d,0xbf7f3f80,0xbf753f7b,0xbf223f35,0xbef13f0e
.long 0x80008000,0x80008000,0x80008000,0x80008000,0xbf62bf6d,0xbf46bf55,0xbe95bec4,0xbdc9be48,0x3f553f35,0x3f7b3f6d,0x3f0e3f35,0x3e483ec4,0x3dc93ec4,0xbef1be48,0xbf46bf6d,0xbe95bf0e
.long 0xbf6dbf80,0xbec4bf35,0x3f6d3f80,0x3ec43f35,0x3f463ec4,0x3f753f7b,0xbf7fbf6d,0xbef1bf55,0x3e483f35,0xbf55bec4,0x3f7b3f35,0x3f0e3f6d,0xbf75bf6d,0x3dc9bf0e,0xbf62bec4,0xbf22bf7b
.long 0x3f35a630,0x3f353f80,0x3f35a677,0x3f353f80,0x3e953f6d,0xbf7fbf0e,0xbef13ec4,0xbf46bf7b,0xbf7bbf35,0x3f0ebec4,0x3e48bf35,0x3f553f6d,0x3f22bec4,0x3e953f7b,0x3dc93f6d,0xbf62bf55
.long 0x3ec43f80,0xbf6dbf35,0xbec4bf80,0x3f6d3f35,0xbf7fbec4,0x3f62be48,0x3f223f6d,0xbf75bf0e,0x3f0ebf35,0xbe483f6d,0xbf55bf35,0x3f7b3ec4,0x3ef13f6d,0xbf22bf55,0x3f753ec4,0xbf7fbe48
.long 0xbf8026b0,0x3f80a7b1,0xbf8026f7,0x3f80a7c2,0x3ef1bf6d,0xbf223f55,0x3f75bec4,0xbf7f3e48,0x3f0e3f35,0xbe48bf6d,0xbf553f35,0x3f7bbec4,0xbf7f3ec4,0x3f623e48,0x3f22bf6d,0xbf753f0e
.long 0x3ec4bf80,0xbf6d3f35,0xbec43f80,0x3f6dbf35,0x3f223ec4,0x3e95bf7b,0x3dc9bf6d,0xbf623f55,0xbf7b3f35,0x3f0e3ec4,0x3e483f35,0x3f55bf6d,0x3e95bf6d,0xbf7f3f0e,0xbef1bec4,0xbf463f7b
.long 0x3f35a7c2,0x3f35bf80,0x3f35268d,0x3f35bf80,0xbf753f6d,0x3dc93f0e,0xbf623ec4,0xbf223f7b,0x3e48bf35,0xbf553ec4,0x3f7bbf35,0x3f0ebf6d,0x3f46bec4,0x3f75bf7b,0xbf7f3f6d,0xbef13f55
.long 0xbf6d3f80,0xbec43f35,0x3f6dbf80,0x3ec4bf35,0x3dc9bec4,0xbef13e48,0xbf463f6d,0xbe953f0e,0x3f55bf35,0x3f7bbf6d,0x3f0ebf35,0x3e48bec4,0xbf623f6d,0xbf463f55,0xbe953ec4,0xbdc93e48
.long 0x3f803f80,0x3f803f80,0x3f803f80,0x3f803f80,0xbf7fbf80,0xbf75bf7b,0xbf22bf35,0xbef1bf0e,0x3f7b3f80,0x3f553f6d,0xbe4825b0,0xbf0ebec4,0xbf75bf80,0xbf22bf55,0x3f623f35,0x3f7f3f7b
.long 0x3f6d3f80,0x3ec43f35,0xbf6dbf80,0xbec4bf35,0xbf62bf80,0xbdc9bf0e,0x3e953f35,0xbf22be48,0x3f553f80,0xbe483ec4,0x3f0ea742,0x3f7b3f6d,0xbf46bf80,0x3ef1be48,0xbf7fbf35,0xbe95bf55
.long 0x3f353f80,0xbf35a654,0x3f353f80,0xbf35a60d,0xbf22bf80,0x3f623e48,0x3dc9bf35,0x3f753f55,0x3f0e3f80,0xbf7bbec4,0xbf55a58e,0xbe48bf6d,0xbef1bf80,0x3f7f3f0e,0x3f753f35,0xbf463e48
.long 0x3ec43f80,0xbf6dbf35,0xbec4bf80,0x3f6d3f35,0xbe95bf80,0x3f463f55,0xbef13f35,0xbdc9bf7b,0x3e483f80,0xbf0ebf6d,0x3f7ba78d,0xbf553ec4,0xbdc9bf80,0x3e953f7b,0xbf46bf35,0x3f623f0e
.long 0x258d3f80,0xa78dbf80,0x280d3f80,0xa79fbf80,0x3dc9bf80,0xbe953f7b,0x3f46bf35,0xbf623f0e,0xbe483f80,0x3f0ebf6d,0xbf7b268d,0x3f553ec4,0x3e95bf80,0xbf463f55,0x3ef13f35,0x3dc9bf7b
.long 0xbec43f80,0x3f6dbf35,0x3ec4bf80,0xbf6d3f35,0x3ef1bf80,0xbf7f3f0e,0xbf753f35,0x3f463e48,0xbf0e3f80,0x3f7bbec4,0x3f55a85d,0x3e48bf6d,0x3f22bf80,0xbf623e48,0xbdc9bf35,0xbf753f55
.long 0xbf353f80,0x3f35a7b1,0xbf353f80,0x3f3526d4,0x3f46bf80,0xbef1be48,0x3f7fbf35,0x3e95bf55,0xbf553f80,0x3e483ec4,0xbf0ea7b1,0xbf7b3f6d,0x3f62bf80,0x3dc9bf0e,0xbe953f35,0x3f22be48
.long 0xbf6d3f80,0xbec43f35,0x3f6dbf80,0x3ec4bf35,0x3f75bf80,0x3f22bf55,0xbf623f35,0xbf7f3f7b,0xbf7b3f80,0xbf553f6d,0x3e48a7e5,0x3f0ebec4,0x3f7fbf80,0x3f75bf7b,0x3f22bf35,0x3ef1bf0e
.long 0x3f803f80,0x3f803f80,0x3f803f80,0x3f803f80,0xbf62bf6d,0xbf46bf55,0xbe95bec4,0xbdc9be48,0x3f0e3f35,0x3e483ec4,0xbf55bf35,0xbf7bbf6d,0xbdc9bec4,0x3ef13e48,0x3f463f6d,0x3e953f0e
.long 0xbec4261f,0xbf6dbf35,0x3ec4a731,0x3f6d3f35,0x3f463ec4,0x3f753f7b,0xbf7fbf6d,0xbef1bf55,0xbf7bbf35,0xbf0ebf6d,0x3e483f35,0xbf55bec4,0x3f753f6d,0xbdc93f0e,0x3f623ec4,0x3f223f7b
.long 0xbf35bf80,0x3f35a754,0xbf35bf80,0x3f35a765,0x3e953f6d,0xbf7fbf0e,0xbef13ec4,0xbf46bf7b,0x3e48bf35,0x3f553f6d,0x3f7b3f35,0xbf0e3ec4,0xbf223ec4,0xbe95bf7b,0xbdc9bf6d,0x3f623f55
.long 0x3f6da777,0xbec43f35,0xbf6d258d,0x3ec4bf35,0xbf7fbec4,0x3f62be48,0x3f223f6d,0xbf75bf0e,0x3f553f35,0xbf7bbec4,0x3f0ebf35,0xbe483f6d,0xbef1bf6d,0x3f223f55,0xbf75bec4,0x3f7f3e48
.long 0x260d3f80,0xa796bf80,0x268d3f80,0x2731bf80,0x3ef1bf6d,0xbf223f55,0x3f75bec4,0xbf7f3e48,0xbf553f35,0x3f7bbec4,0xbf0ebf35,0x3e483f6d,0x3f7fbec4,0xbf62be48,0xbf223f6d,0x3f75bf0e
.long 0xbf6d268d,0x3ec43f35,0x3f6d270d,0xbec4bf35,0x3f223ec4,0x3e95bf7b,0x3dc9bf6d,0xbf623f55,0xbe48bf35,0xbf553f6d,0xbf7b3f35,0x3f0e3ec4,0xbe953f6d,0x3f7fbf0e,0x3ef13ec4,0x3f46bf7b
.long 0x3f35bf80,0xbf35281f,0x3f35bf80,0xbf352730,0xbf753f6d,0x3dc93f0e,0xbf623ec4,0xbf223f7b,0x3f7bbf35,0x3f0ebf6d,0xbe483f35,0x3f55bec4,0xbf463ec4,0xbf753f7b,0x3f7fbf6d,0x3ef1bf55
.long 0x3ec426d4,0x3f6dbf35,0xbec42754,0xbf6d3f35,0x3dc9bec4,0xbef13e48,0xbf463f6d,0xbe953f0e,0xbf0e3f35,0xbe483ec4,0x3f55bf35,0x3f7bbf6d,0x3f62bf6d,0x3f46bf55,0x3e95bec4,0x3dc9be48
.long 0x3f803f80,0x3f803f80,0x3f803f80,0x3f803f80,0x3dc9a554,0x3e953e48,0x3f463f35,0x3f623f55,0xbf7bbf80,0xbf55bf6d,0x3e48a5f7,0x3f0e3ec4,0xbe95261f,0xbf46bf0e,0xbef1bf35,0x3dc9be48
.long 0x3f6d3f80,0x3ec43f35,0xbf6dbf80,0xbec4bf35,0x3ef1a742,0x3f7f3f55,0xbf75bf35,0xbf46bf7b,0xbf55bf80,0x3e48bec4,0xbf0ea60d,0xbf7bbf6d,0xbf22a60d,0xbf62bf7b,0x3dc93f35,0xbf75bf0e
.long 0x3f353f80,0xbf35a58e,0x3f353f80,0xbf35a137,0x3f46a777,0x3ef13f7b,0x3f7f3f35,0xbe953f0e,0xbf0ebf80,0x3f7b3ec4,0x3f55a78d,0x3e483f6d,0xbf622804,0x3dc9bf55,0x3e95bf35,0x3f223f7b
.long 0x3ec43f80,0xbf6dbf35,0xbec4bf80,0x3f6d3f35,0x3f752754,0xbf223f0e,0xbf62bf35,0x3f7f3e48,0xbe48bf80,0x3f0e3f6d,0xbf7b2816,0x3f55bec4,0xbf7f2889,0x3f75be48,0xbf223f35,0x3ef1bf55
.long 0x28163f80,0xa7b1bf80,0x281f3f80,0xa7c2bf80,0x3f7f2828,0xbf75be48,0x3f223f35,0xbef1bf55,0x3e48bf80,0xbf0e3f6d,0x3f7b26d4,0xbf55bec4,0xbf75281f,0x3f223f0e,0x3f62bf35,0xbf7f3e48
.long 0xbec43f80,0x3f6dbf35,0x3ec4bf80,0xbf6d3f35,0x3f6226d4,0xbdc9bf55,0xbe95bf35,0xbf223f7b,0x3f0ebf80,0xbf7b3ec4,0xbf55289a,0xbe483f6d,0xbf462730,0xbef13f7b,0xbf7f3f35,0x3e953f0e
.long 0xbf353f80,0x3f35a7e5,0xbf353f80,0x3f35a880,0x3f22a7e5,0x3f62bf7b,0xbdc93f35,0x3f75bf0e,0x3f55bf80,0xbe48bec4,0x3f0e28be,0x3f7bbf6d,0xbef12839,0xbf7f3f55,0x3f75bf35,0x3f46bf7b
.long 0xbf6d3f80,0xbec43f35,0x3f6dbf80,0x3ec4bf35,0x3e95a880,0x3f46bf0e,0x3ef1bf35,0xbdc9be48,0x3f7bbf80,0x3f55bf6d,0xbe4828ea,0xbf0e3ec4,0xbdc928a3,0xbe953e48,0xbf463f35,0xbf623f55
.long 0x3f803f80,0x3f803f80,0x3f803f80,0x3f803f80,0x3ef13ec4,0x3f223f0e,0x3f753f6d,0x3f7f3f7b,0xbf0ebf35,0xbe48bec4,0x3f553f35,0x3f7b3f6d,0xbf7fbf6d,0xbf62bf7b,0x3f223ec4,0x3f753f55
.long 0xbec4a68d,0xbf6dbf35,0x3ec4a742,0x3f6d3f35,0x3f223f6d,0xbe953e48,0x3dc9bec4,0x3f623f0e,0x3f7b3f35,0x3f0e3f6d,0xbe48bf35,0x3f553ec4,0x3e95bec4,0x3f7f3f55,0xbef1bf6d,0x3f463e48
.long 0xbf35bf80,0x3f35a777,0xbf35bf80,0x3f35a784,0xbf75bec4,0xbdc9bf55,0xbf62bf6d,0x3f22be48,0xbe483f35,0xbf55bf6d,0xbf7bbf35,0x3f0ebec4,0x3f463f6d,0xbf75be48,0xbf7fbec4,0x3ef1bf0e
.long 0x3f6da796,0xbec43f35,0xbf6d268d,0x3ec4bf35,0x3dc9bf6d,0x3ef13f7b,0xbf463ec4,0x3e95bf55,0xbf55bf35,0x3f7b3ec4,0xbf0e3f35,0x3e48bf6d,0xbf623ec4,0x3f46bf0e,0xbe953f6d,0x3dc9bf7b
.long 0x26d43f80,0x270dbf80,0x270d3f80,0x26d4bf80,0x3f623ec4,0xbf46bf0e,0x3e953f6d,0xbdc9bf7b,0x3f55bf35,0xbf7b3ec4,0x3f0e3f35,0xbe48bf6d,0xbdc9bf6d,0xbef13f7b,0x3f463ec4,0xbe95bf55
.long 0xbf6d2828,0x3ec43f35,0x3f6da7e5,0xbec4bf35,0xbf463f6d,0x3f75be48,0x3f7fbec4,0xbef1bf0e,0x3e483f35,0x3f55bf6d,0x3f7bbf35,0xbf0ebec4,0x3f75bec4,0x3dc9bf55,0x3f62bf6d,0xbf22be48
.long 0x3f35bf80,0xbf352839,0x3f35bf80,0xbf3528a3,0xbe95bec4,0xbf7f3f55,0x3ef1bf6d,0xbf463e48,0xbf7b3f35,0xbf0e3f6d,0x3e48bf35,0xbf553ec4,0xbf223f6d,0x3e953e48,0xbdc9bec4,0xbf623f0e
.long 0x3ec4a804,0x3f6dbf35,0xbec4a731,0xbf6d3f35,0x3f7fbf6d,0x3f62bf7b,0xbf223ec4,0xbf753f55,0x3f0ebf35,0x3e48bec4,0xbf553f35,0xbf7b3f6d,0xbef13ec4,0xbf223f0e,0xbf753f6d,0xbf7f3f7b
.long 0x80008000,0x80008000,0x80008000,0x80008000,0x3dc9a50d,0x3e953e48,0x3f463f35,0x3f623f55,0xbe48258d,0xbf0ebec4,0xbf7bbf80,0xbf55bf6d,0x3e95a5d4,0x3f463f0e,0x3ef13f35,0xbdc93e48
.long 0xbec4260d,0xbf6dbf35,0x3ec4a630,0x3f6d3f35,0x3ef1a630,0x3f7f3f55,0xbf75bf35,0xbf46bf7b,0xbf0e2654,0xbf7bbf6d,0x3f553f80,0xbe483ec4,0x3f22a677,0x3f623f7b,0xbdc9bf35,0x3f753f0e
.long 0xbf35268d,0xbf35bf80,0xbf3526b0,0xbf35bf80,0x3f46a69f,0x3ef13f7b,0x3f7f3f35,0xbe953f0e,0xbf5526b0,0xbe48bf6d,0xbf0ebf80,0x3f7b3ec4,0x3f62a7b1,0xbdc93f55,0xbe953f35,0xbf22bf7b
.long 0xbf6d26d4,0x3ec4bf35,0x3f6da7c2,0xbec43f35,0x3f75270d,0xbf223f0e,0xbf62bf35,0x3f7f3e48,0xbf7b26f7,0x3f55bec4,0x3e483f80,0xbf0ebf6d,0x3f7fa7c2,0xbf753e48,0x3f22bf35,0xbef13f55
.long 0xbf80270d,0x3f8026d4,0xbf802730,0x3f80268d,0x3f7f26d4,0xbf75be48,0x3f223f35,0xbef1bf55,0xbf7b271f,0x3f553ec4,0x3e48bf80,0xbf0e3f6d,0x3f75a7d4,0xbf22bf0e,0xbf623f35,0x3f7fbe48
.long 0xbf6d2730,0x3ec43f35,0x3f6d260e,0xbec4bf35,0x3f62268d,0xbdc9bf55,0xbe95bf35,0xbf223f7b,0xbf552831,0xbe483f6d,0xbf0e3f80,0x3f7bbec4,0x3f46a7e5,0x3ef1bf7b,0x3f7fbf35,0xbe95bf0e
.long 0xbf352754,0xbf353f80,0xbf352842,0xbf353f80,0x3f22260e,0x3f62bf7b,0xbdc93f35,0x3f75bf0e,0xbf0ea78d,0xbf7b3f6d,0x3f55bf80,0xbe48bec4,0x3ef1a7f7,0x3f7fbf55,0xbf753f35,0xbf463f7b
.long 0xbec42777,0xbf6d3f35,0x3ec4a80d,0x3f6dbf35,0x3e9521b7,0x3f46bf0e,0x3ef1bf35,0xbdc9be48,0xbe482842,0xbf0e3ec4,0xbf7b3f80,0xbf553f6d,0x3dc9a804,0x3e95be48,0x3f46bf35,0x3f62bf55
.long 0x80008000,0x80008000,0x80008000,0x80008000,0x3ef13ec4,0x3f223f0e,0x3f753f6d,0x3f7f3f7b,0xbf55bf35,0xbf7bbf6d,0xbf0ebf35,0xbe48bec4,0x3f7f3f6d,0x3f623f7b,0xbf22bec4,0xbf75bf55
.long 0xbf6dbf80,0xbec4bf35,0x3f6d3f80,0x3ec43f35,0x3f223f6d,0xbe953e48,0x3dc9bec4,0x3f623f0e,0xbe48bf35,0x3f553ec4,0xbf7bbf35,0xbf0ebf6d,0xbe953ec4,0xbf7fbf55,0x3ef13f6d,0xbf46be48
.long 0x3f35a69f,0x3f353f80,0x3f35a7b1,0x3f353f80,0xbf75bec4,0xbdc9bf55,0xbf62bf6d,0x3f22be48,0x3f7b3f35,0xbf0e3ec4,0xbe483f35,0xbf55bf6d,0xbf46bf6d,0x3f753e48,0x3f7f3ec4,0xbef13f0e
.long 0x3ec43f80,0xbf6dbf35,0xbec4bf80,0x3f6d3f35,0x3dc9bf6d,0x3ef13f7b,0xbf463ec4,0x3e95bf55,0xbf0e3f35,0x3e48bf6d,0x3f553f35,0xbf7bbec4,0x3f62bec4,0xbf463f0e,0x3e95bf6d,0xbdc93f7b
.long 0xbf80271f,0x3f80a7d4,0xbf802831,0x3f80a7e5,0x3f623ec4,0xbf46bf0e,0x3e953f6d,0xbdc9bf7b,0xbf0ebf35,0x3e483f6d,0x3f55bf35,0xbf7b3ec4,0x3dc93f6d,0x3ef1bf7b,0xbf46bec4,0x3e953f55
.long 0x3ec4bf80,0xbf6d3f35,0xbec43f80,0x3f6dbf35,0xbf463f6d,0x3f75be48,0x3f7fbec4,0xbef1bf0e,0x3f7bbf35,0xbf0ebec4,0xbe48bf35,0xbf553f6d,0xbf753ec4,0xbdc93f55,0xbf623f6d,0x3f223e48
.long 0x3f35a7f7,0x3f35bf80,0x3f35a60d,0x3f35bf80,0xbe95bec4,0xbf7f3f55,0x3ef1bf6d,0xbf463e48,0xbe483f35,0x3f55bec4,0xbf7b3f35,0xbf0e3f6d,0x3f22bf6d,0xbe95be48,0x3dc93ec4,0x3f62bf0e
.long 0xbf6d3f80,0xbec43f35,0x3f6dbf80,0x3ec4bf35,0x3f7fbf6d,0x3f62bf7b,0xbf223ec4,0xbf753f55,0xbf553f35,0xbf7b3f6d,0xbf0e3f35,0xbe483ec4,0x3ef1bec4,0x3f22bf0e,0x3f75bf6d,0x3f7fbf7b
.long 0x80008000,0x80008000,0x80008000,0x80008000,0x3f7f3f80,0x3f753f7b,0x3f223f35,0x3ef13f0e,0x3e48a5d4,0x3f0e3ec4,0x3f7b3f80,0x3f553f6d,0xbf75bf80,0xbf22bf55,0x3f623f35,0x3f7f3f7b
.long 0xbec42654,0xbf6dbf35,0x3ec4a677,0x3f6d3f35,0x3f623f80,0x3dc93f0e,0xbe95bf35,0x3f223e48,0x3f0ea69f,0x3f7b3f6d,0xbf55bf80,0x3e48bec4,0xbf46bf80,0x3ef1be48,0xbf7fbf35,0xbe95bf55
.long 0xbf3526d4,0xbf35bf80,0xbf3526f7,0xbf35bf80,0x3f223f80,0xbf62be48,0xbdc93f35,0xbf75bf55,0x3f55a7c2,0x3e483f6d,0x3f0e3f80,0xbf7bbec4,0xbef1bf80,0x3f7f3f0e,0x3f753f35,0xbf463e48
.long 0xbf6d271f,0x3ec4bf35,0x3f6d268d,0xbec43f35,0x3e953f80,0xbf46bf55,0x3ef1bf35,0x3dc93f7b,0x3f7b268d,0xbf553ec4,0xbe48bf80,0x3f0e3f6d,0xbdc9bf80,0x3e953f7b,0xbf46bf35,0x3f623f0e
.long 0xbf802754,0x3f80260e,0xbf802777,0x3f8021b7,0xbdc93f80,0x3e95bf7b,0xbf463f35,0x3f62bf0e,0x3f7ba7f7,0xbf55bec4,0xbe483f80,0x3f0ebf6d,0x3e95bf80,0xbf463f55,0x3ef13f35,0x3dc9bf7b
.long 0xbf6d2842,0x3ec43f35,0x3f6da80d,0xbec4bf35,0xbef13f80,0x3f7fbf0e,0x3f75bf35,0xbf46be48,0x3f55a884,0x3e48bf6d,0x3f0ebf80,0xbf7b3ec4,0x3f22bf80,0xbf623e48,0xbdc9bf35,0xbf753f55
.long 0xbf35279f,0xbf353f80,0xbf35a70d,0xbf353f80,0xbf463f80,0x3ef13e48,0xbf7f3f35,0xbe953f55,0x3f0e27d4,0x3f7bbf6d,0xbf553f80,0x3e483ec4,0x3f62bf80,0x3dc9bf0e,0xbe953f35,0x3f22be48
.long 0xbec4a70d,0xbf6d3f35,0x3ec4a896,0x3f6dbf35,0xbf753f80,0xbf223f55,0x3f62bf35,0x3f7fbf7b,0x3e48a909,0x3f0ebec4,0x3f7bbf80,0x3f55bf6d,0x3f7fbf80,0x3f75bf7b,0x3f22bf35,0x3ef1bf0e
.long 0x80008000,0x80008000,0x80008000,0x80008000,0x3f623f6d,0x3f463f55,0x3e953ec4,0x3dc93e48,0x3f553f35,0x3f7b3f6d,0x3f0e3f35,0x3e483ec4,0xbdc9bec4,0x3ef13e48,0x3f463f6d,0x3e953f0e
.long 0xbf6dbf80,0xbec4bf35,0x3f6d3f80,0x3ec43f35,0xbf46bec4,0xbf75bf7b,0x3f7f3f6d,0x3ef13f55,0x3e483f35,0xbf55bec4,0x3f7b3f35,0x3f0e3f6d,0x3f753f6d,0xbdc93f0e,0x3f623ec4,0x3f223f7b
.long 0x3f35270d,0x3f353f80,0x3f35a7c2,0x3f353f80,0xbe95bf6d,0x3f7f3f0e,0x3ef1bec4,0x3f463f7b,0xbf7bbf35,0x3f0ebec4,0x3e48bf35,0x3f553f6d,0xbf223ec4,0xbe95bf7b,0xbdc9bf6d,0x3f623f55
.long 0x3ec43f80,0xbf6dbf35,0xbec4bf80,0x3f6d3f35,0x3f7f3ec4,0xbf623e48,0xbf22bf6d,0x3f753f0e,0x3f0ebf35,0xbe483f6d,0xbf55bf35,0x3f7b3ec4,0xbef1bf6d,0x3f223f55,0xbf75bec4,0x3f7f3e48
.long 0xbf80a78d,0x3f80a7f7,0xbf802842,0x3f80a804,0xbef13f6d,0x3f22bf55,0xbf753ec4,0x3f7fbe48,0x3f0e3f35,0xbe48bf6d,0xbf553f35,0x3f7bbec4,0x3f7fbec4,0xbf62be48,0xbf223f6d,0x3f75bf0e
.long 0x3ec4bf80,0xbf6d3f35,0xbec43f80,0x3f6dbf35,0xbf22bec4,0xbe953f7b,0xbdc93f6d,0x3f62bf55,0xbf7b3f35,0x3f0e3ec4,0x3e483f35,0x3f55bf6d,0xbe953f6d,0x3f7fbf0e,0x3ef13ec4,0x3f46bf7b
.long 0x3f35a816,0x3f35bf80,0x3f35a70d,0x3f35bf80,0x3f75bf6d,0xbdc9bf0e,0x3f62bec4,0x3f22bf7b,0x3e48bf35,0xbf553ec4,0x3f7bbf35,0x3f0ebf6d,0xbf463ec4,0xbf753f7b,0x3f7fbf6d,0x3ef1bf55
.long 0xbf6d3f80,0xbec43f35,0x3f6dbf80,0x3ec4bf35,0xbdc93ec4,0x3ef1be48,0x3f46bf6d,0x3e95bf0e,0x3f55bf35,0x3f7bbf6d,0x3f0ebf35,0x3e48bec4,0x3f62bf6d,0x3f46bf55,0x3e95bec4,0x3dc9be48
.long 0xbf803f80,0xbf803f80,0xbf803f80,0xbf803f80,0xbf7f3f80,0xbf753f7b,0xbf223f35,0xbef13f0e,0xbf7b3f80,0xbf553f6d,0x3e48248d,0x3f0ebec4,0xbf753f80,0xbf223f55,0x3f62bf35,0x3f7fbf7b
.long 0xbf6d3f80,0xbec43f35,0x3f6dbf80,0x3ec4bf35,0xbf623f80,0xbdc93f0e,0x3e95bf35,0xbf223e48,0xbf553f80,0x3e483ec4,0xbf0ea554,0xbf7b3f6d,0xbf463f80,0x3ef13e48,0xbf7f3f35,0xbe953f55
.long 0xbf353f80,0x3f35248d,0xbf353f80,0x3f3525b0,0xbf223f80,0x3f62be48,0x3dc93f35,0x3f75bf55,0xbf0e3f80,0x3f7bbec4,0x3f5525b0,0x3e48bf6d,0xbef13f80,0x3f7fbf0e,0x3f75bf35,0xbf46be48
.long 0xbec43f80,0x3f6dbf35,0x3ec4bf80,0xbf6d3f35,0xbe953f80,0x3f46bf55,0xbef1bf35,0xbdc93f7b,0xbe483f80,0x3f0ebf6d,0xbf7ba5f7,0x3f553ec4,0xbdc93f80,0x3e95bf7b,0xbf463f35,0x3f62bf0e
.long 0xa48d3f80,0x2554bf80,0xa61f3f80,0x2731bf80,0x3dc93f80,0xbe95bf7b,0x3f463f35,0xbf62bf0e,0x3e483f80,0xbf0ebf6d,0x3f7b261f,0xbf553ec4,0x3e953f80,0xbf46bf55,0x3ef1bf35,0x3dc93f7b
.long 0x3ec43f80,0xbf6dbf35,0xbec4bf80,0x3f6d3f35,0x3ef13f80,0xbf7fbf0e,0xbf75bf35,0x3f46be48,0x3f0e3f80,0xbf7bbec4,0xbf55a731,0xbe48bf6d,0x3f223f80,0xbf62be48,0xbdc93f35,0xbf75bf55
.long 0x3f353f80,0xbf35a554,0x3f353f80,0xbf35a742,0x3f463f80,0xbef13e48,0x3f7f3f35,0x3e953f55,0x3f553f80,0xbe483ec4,0x3f0ea68d,0x3f7b3f6d,0x3f623f80,0x3dc93f0e,0xbe95bf35,0x3f223e48
.long 0x3f6d3f80,0x3ec43f35,0xbf6dbf80,0xbec4bf35,0x3f753f80,0x3f223f55,0xbf62bf35,0xbf7fbf7b,0x3f7b3f80,0x3f553f6d,0xbe48a742,0xbf0ebec4,0x3f7f3f80,0x3f753f7b,0x3f223f35,0x3ef13f0e
.long 0xbf803f80,0xbf803f80,0xbf803f80,0xbf803f80,0xbf623f6d,0xbf463f55,0xbe953ec4,0xbdc93e48,0xbf0e3f35,0xbe483ec4,0x3f55bf35,0x3f7bbf6d,0xbdc93ec4,0x3ef1be48,0x3f46bf6d,0x3e95bf0e
.long 0x3ec4248d,0x3f6dbf35,0xbec4a554,0xbf6d3f35,0x3f46bec4,0x3f75bf7b,0xbf7f3f6d,0xbef13f55,0x3f7bbf35,0x3f0ebf6d,0xbe483f35,0x3f55bec4,0x3f75bf6d,0xbdc9bf0e,0x3f62bec4,0x3f22bf7b
.long 0x3f35bf80,0xbf35a554,0x3f35bf80,0xbf35a5f7,0x3e95bf6d,0xbf7f3f0e,0xbef1bec4,0xbf463f7b,0xbe48bf35,0xbf553f6d,0xbf7b3f35,0x3f0e3ec4,0xbf22bec4,0xbe953f7b,0xbdc93f6d,0x3f62bf55
.long 0xbf6da554,0x3ec43f35,0x3f6d261f,0xbec4bf35,0xbf7f3ec4,0x3f623e48,0x3f22bf6d,0xbf753f0e,0xbf553f35,0x3f7bbec4,0xbf0ebf35,0x3e483f6d,0xbef13f6d,0x3f22bf55,0xbf753ec4,0x3f7fbe48
.long 0xa5b03f80,0x25f7bf80,0x268d3f80,0x2742bf80,0x3ef13f6d,0xbf22bf55,0x3f753ec4,0xbf7fbe48,0x3f553f35,0xbf7bbec4,0x3f0ebf35,0xbe483f6d,0x3f7f3ec4,0xbf623e48,0xbf22bf6d,0x3f753f0e
.long 0x3f6d25b0,0xbec43f35,0xbf6da742,0x3ec4bf35,0x3f22bec4,0x3e953f7b,0x3dc93f6d,0xbf62bf55,0x3e48bf35,0x3f553f6d,0x3f7b3f35,0xbf0e3ec4,0xbe95bf6d,0x3f7f3f0e,0x3ef1bec4,0x3f463f7b
.long 0xbf35bf80,0x3f35261f,0xbf35bf80,0x3f35a60d,0xbf75bf6d,0x3dc9bf0e,0xbf62bec4,0xbf22bf7b,0xbf7bbf35,0xbf0ebf6d,0x3e483f35,0xbf55bec4,0xbf46bec4,0xbf75bf7b,0x3f7f3f6d,0x3ef13f55
.long 0xbec4a5f7,0xbf6dbf35,0x3ec4a60d,0x3f6d3f35,0x3dc93ec4,0xbef1be48,0xbf46bf6d,0xbe95bf0e,0x3f0e3f35,0x3e483ec4,0xbf55bf35,0xbf7bbf6d,0x3f623f6d,0x3f463f55,0x3e953ec4,0x3dc93e48
.long 0xbf803f80,0xbf803f80,0xbf803f80,0xbf803f80,0x3dc9248d,0x3e95be48,0x3f46bf35,0x3f62bf55,0x3f7bbf80,0x3f55bf6d,0xbe48a554,0xbf0e3ec4,0xbe95a554,0xbf463f0e,0xbef13f35,0x3dc93e48
.long 0xbf6d3f80,0xbec43f35,0x3f6dbf80,0x3ec4bf35,0x3ef125b0,0x3f7fbf55,0xbf753f35,0xbf463f7b,0x3f55bf80,0xbe48bec4,0x3f0e261f,0x3f7bbf6d,0xbf22a5f7,0xbf623f7b,0x3dc9bf35,0xbf753f0e
.long 0xbf353f80,0x3f35261f,0xbf353f80,0x3f35a68d,0x3f46261f,0x3ef1bf7b,0x3f7fbf35,0xbe95bf0e,0x3f0ebf80,0xbf7b3ec4,0xbf55a742,0xbe483f6d,0xbf62a731,0x3dc93f55,0x3e953f35,0x3f22bf7b
.long 0xbec43f80,0x3f6dbf35,0x3ec4bf80,0xbf6d3f35,0x3f75a68d,0xbf22bf0e,0xbf623f35,0x3f7fbe48,0x3e48bf80,0xbf0e3f6d,0x3f7ba60d,0xbf55bec4,0xbf7fa742,0x3f753e48,0xbf22bf35,0x3ef13f55
.long 0x26543f80,0x2754bf80,0x258e3f80,0x2777bf80,0x3f7fa654,0xbf753e48,0x3f22bf35,0xbef13f55,0xbe48bf80,0x3f0e3f6d,0xbf7ba777,0x3f55bec4,0xbf75a754,0x3f22bf0e,0x3f623f35,0xbf7fbe48
.long 0x3ec43f80,0xbf6dbf35,0xbec4bf80,0x3f6d3f35,0x3f62a60d,0xbdc93f55,0xbe953f35,0xbf22bf7b,0xbf0ebf80,0x3f7b3ec4,0x3f552804,0x3e483f6d,0xbf46a765,0xbef1bf7b,0xbf7fbf35,0x3e95bf0e
.long 0x3f353f80,0xbf35a777,0x3f353f80,0xbf35a796,0x3f22a58e,0x3f623f7b,0xbdc9bf35,0x3f753f0e,0xbf55bf80,0x3e48bec4,0xbf0e2754,0xbf7bbf6d,0xbef1a777,0xbf7fbf55,0x3f753f35,0x3f463f7b
.long 0x3f6d3f80,0x3ec43f35,0xbf6dbf80,0xbec4bf35,0x3e95a137,0x3f463f0e,0x3ef13f35,0xbdc93e48,0xbf7bbf80,0xbf55bf6d,0x3e482889,0x3f0e3ec4,0xbdc9a784,0xbe95be48,0xbf46bf35,0xbf62bf55
.long 0xbf803f80,0xbf803f80,0xbf803f80,0xbf803f80,0x3ef1bec4,0x3f22bf0e,0x3f75bf6d,0x3f7fbf7b,0x3f0ebf35,0x3e48bec4,0xbf553f35,0xbf7b3f6d,0xbf7f3f6d,0xbf623f7b,0x3f22bec4,0x3f75bf55
.long 0x3ec425b0,0x3f6dbf35,0xbec4a5f7,0xbf6d3f35,0x3f22bf6d,0xbe95be48,0x3dc93ec4,0x3f62bf0e,0xbf7b3f35,0xbf0e3f6d,0x3e48bf35,0xbf553ec4,0x3e953ec4,0x3f7fbf55,0xbef13f6d,0x3f46be48
.long 0x3f35bf80,0xbf35a731,0x3f35bf80,0xbf35a742,0xbf753ec4,0xbdc93f55,0xbf623f6d,0x3f223e48,0x3e483f35,0x3f55bf6d,0x3f7bbf35,0xbf0ebec4,0x3f46bf6d,0xbf753e48,0xbf7f3ec4,0x3ef13f0e
.long 0xbf6da742,0x3ec43f35,0x3f6da60d,0xbec4bf35,0x3dc93f6d,0x3ef1bf7b,0xbf46bec4,0x3e953f55,0x3f55bf35,0xbf7b3ec4,0x3f0e3f35,0xbe48bf6d,0xbf62bec4,0x3f463f0e,0xbe95bf6d,0x3dc93f7b
.long 0x260d3f80,0x2765bf80,0x21373f80,0x2784bf80,0x3f62bec4,0xbf463f0e,0x3e95bf6d,0xbdc93f7b,0xbf55bf35,0x3f7b3ec4,0xbf0e3f35,0x3e48bf6d,0xbdc93f6d,0xbef1bf7b,0x3f46bec4,0xbe953f55
.long 0x3f6da58e,0xbec43f35,0xbf6da78d,0x3ec4bf35,0xbf46bf6d,0x3f753e48,0x3f7f3ec4,0xbef13f0e,0xbe483f35,0xbf55bf6d,0xbf7bbf35,0x3f0ebec4,0x3f753ec4,0x3dc93f55,0x3f623f6d,0xbf223e48
.long 0xbf35bf80,0x3f35258d,0xbf35bf80,0x3f35268d,0xbe953ec4,0xbf7fbf55,0x3ef13f6d,0xbf46be48,0x3f7b3f35,0x3f0e3f6d,0xbe48bf35,0x3f553ec4,0xbf22bf6d,0x3e95be48,0xbdc93ec4,0xbf62bf0e
.long 0xbec4a78d,0xbf6dbf35,0x3ec42816,0x3f6d3f35,0x3f7f3f6d,0x3f623f7b,0xbf22bec4,0xbf75bf55,0xbf0ebf35,0xbe48bec4,0x3f553f35,0x3f7b3f6d,0xbef1bec4,0xbf22bf0e,0xbf75bf6d,0xbf7fbf7b
.long 0x8000,0x8000,0x8000,0x8000,0x3dc98000,0x3e95be48,0x3f46bf35,0x3f62bf55,0x3e488000,0x3f0ebec4,0x3f7bbf80,0x3f55bf6d,0x3e958000,0x3f46bf0e,0x3ef1bf35,0xbdc9be48
.long 0x3ec48000,0x3f6dbf35,0xbec4a50d,0xbf6d3f35,0x3ef18000,0x3f7fbf55,0xbf753f35,0xbf463f7b,0x3f0e8000,0x3f7bbf6d,0xbf553f80,0x3e483ec4,0x3f228000,0x3f62bf7b,0xbdc93f35,0x3f75bf0e
.long 0x3f358000,0x3f35bf80,0x3f35258d,0x3f35bf80,0x3f468000,0x3ef1bf7b,0x3f7fbf35,0xbe95bf0e,0x3f558000,0x3e48bf6d,0x3f0ebf80,0xbf7b3ec4,0x3f628000,0xbdc9bf55,0xbe95bf35,0xbf223f7b
.long 0x3f6d8000,0xbec4bf35,0xbf6da5d4,0x3ec43f35,0x3f758000,0xbf22bf0e,0xbf623f35,0x3f7fbe48,0x3f7b8000,0xbf55bec4,0xbe483f80,0x3f0ebf6d,0x3f7f8000,0xbf75be48,0x3f223f35,0xbef1bf55
.long 0x3f808000,0xbf80a50d,0x3f80260d,0xbf80a630,0x3f7f8000,0xbf753e48,0x3f22bf35,0xbef13f55,0x3f7b8000,0xbf553ec4,0xbe48bf80,0x3f0e3f6d,0x3f758000,0xbf223f0e,0xbf62bf35,0x3f7f3e48
.long 0x3f6d8000,0xbec43f35,0xbf6da630,0x3ec4bf35,0x3f628000,0xbdc93f55,0xbe953f35,0xbf22bf7b,0x3f558000,0x3e483f6d,0x3f0e3f80,0xbf7bbec4,0x3f468000,0x3ef13f7b,0x3f7f3f35,0xbe953f0e
.long 0x3f358000,0x3f353f80,0x3f352654,0x3f353f80,0x3f228000,0x3f623f7b,0xbdc9bf35,0x3f753f0e,0x3f0e8000,0x3f7b3f6d,0xbf55bf80,0x3e48bec4,0x3ef18000,0x3f7f3f55,0xbf75bf35,0xbf46bf7b
.long 0x3ec48000,0x3f6d3f35,0xbec4a677,0xbf6dbf35,0x3e958000,0x3f463f0e,0x3ef13f35,0xbdc93e48,0x3e488000,0x3f0e3ec4,0x3f7b3f80,0x3f553f6d,0x3dc98000,0x3e953e48,0x3f463f35,0x3f623f55
.long 0x8000,0x8000,0x8000,0x8000,0x3ef1bec4,0x3f22bf0e,0x3f75bf6d,0x3f7fbf7b,0x3f55bf35,0x3f7bbf6d,0x3f0ebf35,0x3e48bec4,0x3f7fbf6d,0x3f62bf7b,0xbf223ec4,0xbf753f55
.long 0x3f6dbf80,0x3ec4bf35,0xbf6d3f80,0xbec43f35,0x3f22bf6d,0xbe95be48,0x3dc93ec4,0x3f62bf0e,0x3e48bf35,0xbf553ec4,0x3f7bbf35,0x3f0ebf6d,0xbe95bec4,0xbf7f3f55,0x3ef1bf6d,0xbf463e48
.long 0xbf35a50d,0xbf353f80,0xbf35a5d4,0xbf353f80,0xbf753ec4,0xbdc93f55,0xbf623f6d,0x3f223e48,0xbf7b3f35,0x3f0e3ec4,0x3e483f35,0x3f55bf6d,0xbf463f6d,0x3f75be48,0x3f7fbec4,0xbef1bf0e
.long 0xbec43f80,0x3f6dbf35,0x3ec4bf80,0xbf6d3f35,0x3dc93f6d,0x3ef1bf7b,0xbf46bec4,0x3e953f55,0x3f0e3f35,0xbe48bf6d,0xbf553f35,0x3f7bbec4,0x3f623ec4,0xbf46bf0e,0x3e953f6d,0xbdc9bf7b
.long 0x3f80258d,0xbf80a5d4,0x3f802654,0xbf80a677,0x3f62bec4,0xbf463f0e,0x3e95bf6d,0xbdc93f7b,0x3f0ebf35,0xbe483f6d,0xbf55bf35,0x3f7b3ec4,0x3dc9bf6d,0x3ef13f7b,0xbf463ec4,0x3e95bf55
.long 0xbec4bf80,0x3f6d3f35,0x3ec43f80,0xbf6dbf35,0xbf46bf6d,0x3f753e48,0x3f7f3ec4,0xbef13f0e,0xbf7bbf35,0x3f0ebec4,0x3e48bf35,0x3f553f6d,0xbf75bec4,0xbdc9bf55,0xbf62bf6d,0x3f22be48
.long 0xbf35a5d4,0xbf35bf80,0xbf35a69f,0xbf35bf80,0xbe953ec4,0xbf7fbf55,0x3ef13f6d,0xbf46be48,0x3e483f35,0xbf55bec4,0x3f7b3f35,0x3f0e3f6d,0x3f223f6d,0xbe953e48,0x3dc9bec4,0x3f623f0e
.long 0x3f6d3f80,0x3ec43f35,0xbf6dbf80,0xbec4bf35,0x3f7f3f6d,0x3f623f7b,0xbf22bec4,0xbf75bf55,0x3f553f35,0x3f7b3f6d,0x3f0e3f35,0x3e483ec4,0x3ef13ec4,0x3f223f0e,0x3f753f6d,0x3f7f3f7b
.long 0x8000,0x8000,0x8000,0x8000,0x3f7fbf80,0x3f75bf7b,0x3f22bf35,0x3ef1bf0e,0xbe48a50d,0xbf0e3ec4,0xbf7b3f80,0xbf553f6d,0xbf753f80,0xbf223f55,0x3f62bf35,0x3f7fbf7b
.long 0x3ec4258d,0x3f6dbf35,0xbec4a5d4,0xbf6d3f35,0x3f62bf80,0x3dc9bf0e,0xbe953f35,0x3f22be48,0xbf0ea5d4,0xbf7b3f6d,0x3f55bf80,0xbe48bec4,0xbf463f80,0x3ef13e48,0xbf7f3f35,0xbe953f55
.long 0x3f35260d,0x3f35bf80,0x3f352654,0x3f35bf80,0x3f22bf80,0xbf623e48,0xbdc9bf35,0xbf753f55,0xbf55a630,0xbe483f6d,0xbf0e3f80,0x3f7bbec4,0xbef13f80,0x3f7fbf0e,0x3f75bf35,0xbf46be48
.long 0x3f6d2654,0xbec4bf35,0xbf6da69f,0x3ec43f35,0x3e95bf80,0xbf463f55,0x3ef13f35,0x3dc9bf7b,0xbf7ba677,0x3f553ec4,0x3e48bf80,0xbf0e3f6d,0xbdc93f80,0x3e95bf7b,0xbf463f35,0x3f62bf0e
.long 0x3f80268d,0xbf80a69f,0x3f8026d4,0xbf80270d,0xbdc9bf80,0x3e953f7b,0xbf46bf35,0x3f623f0e,0xbf7ba69f,0x3f55bec4,0x3e483f80,0xbf0ebf6d,0x3e953f80,0xbf46bf55,0x3ef1bf35,0x3dc93f7b
.long 0x3f6d26b0,0xbec43f35,0xbf6da7c2,0x3ec4bf35,0xbef1bf80,0x3f7f3f0e,0x3f753f35,0xbf463e48,0xbf55a7b1,0xbe48bf6d,0xbf0ebf80,0x3f7b3ec4,0x3f223f80,0xbf62be48,0xbdc93f35,0xbf75bf55
.long 0x3f3526d4,0x3f353f80,0x3f35271f,0x3f353f80,0xbf46bf80,0x3ef1be48,0xbf7fbf35,0xbe95bf55,0xbf0e270d,0xbf7bbf6d,0x3f553f80,0xbe483ec4,0x3f623f80,0x3dc93f0e,0xbe95bf35,0x3f223e48
.long 0x3ec426f7,0x3f6d3f35,0xbec4268d,0xbf6dbf35,0xbf75bf80,0xbf22bf55,0x3f623f35,0x3f7f3f7b,0xbe48a7c2,0xbf0ebec4,0xbf7bbf80,0xbf55bf6d,0x3f7f3f80,0x3f753f7b,0x3f223f35,0x3ef13f0e
.long 0x8000,0x8000,0x8000,0x8000,0x3f62bf6d,0x3f46bf55,0x3e95bec4,0x3dc9be48,0xbf553f35,0xbf7b3f6d,0xbf0e3f35,0xbe483ec4,0xbdc93ec4,0x3ef1be48,0x3f46bf6d,0x3e95bf0e
.long 0x3f6dbf80,0x3ec4bf35,0xbf6d3f80,0xbec43f35,0xbf463ec4,0xbf753f7b,0x3f7fbf6d,0x3ef1bf55,0xbe483f35,0x3f55bec4,0xbf7b3f35,0xbf0e3f6d,0x3f75bf6d,0xbdc9bf0e,0x3f62bec4,0x3f22bf7b
.long 0xbf35a630,0xbf353f80,0xbf35a677,0xbf353f80,0xbe953f6d,0x3f7fbf0e,0x3ef13ec4,0x3f46bf7b,0x3f7bbf35,0xbf0ebec4,0xbe48bf35,0xbf553f6d,0xbf22bec4,0xbe953f7b,0xbdc93f6d,0x3f62bf55
.long 0xbec43f80,0x3f6dbf35,0x3ec4bf80,0xbf6d3f35,0x3f7fbec4,0xbf62be48,0xbf223f6d,0x3f75bf0e,0xbf0ebf35,0x3e483f6d,0x3f55bf35,0xbf7b3ec4,0xbef13f6d,0x3f22bf55,0xbf753ec4,0x3f7fbe48
.long 0x3f8026b0,0xbf80a7b1,0x3f8026f7,0xbf80a7c2,0xbef1bf6d,0x3f223f55,0xbf75bec4,0x3f7f3e48,0xbf0e3f35,0x3e48bf6d,0x3f553f35,0xbf7bbec4,0x3f7f3ec4,0xbf623e48,0xbf22bf6d,0x3f753f0e
.long 0xbec4bf80,0x3f6d3f35,0x3ec43f80,0xbf6dbf35,0xbf223ec4,0xbe95bf7b,0xbdc9bf6d,0x3f623f55,0x3f7b3f35,0xbf0e3ec4,0xbe483f35,0xbf55bf6d,0xbe95bf6d,0x3f7f3f0e,0x3ef1bec4,0x3f463f7b
.long 0xbf35a7c2,0xbf35bf80,0xbf35268d,0xbf35bf80,0x3f753f6d,0xbdc93f0e,0x3f623ec4,0x3f223f7b,0xbe48bf35,0x3f553ec4,0xbf7bbf35,0xbf0ebf6d,0xbf46bec4,0xbf75bf7b,0x3f7f3f6d,0x3ef13f55
.long 0x3f6d3f80,0x3ec43f35,0xbf6dbf80,0xbec4bf35,0xbdc9bec4,0x3ef13e48,0x3f463f6d,0x3e953f0e,0xbf55bf35,0xbf7bbf6d,0xbf0ebf35,0xbe48bec4,0x3f623f6d,0x3f463f55,0x3e953ec4,0x3dc93e48
.long 0xbf803f80,0xbf803f80,0xbf803f80,0xbf803f80,0x3f7fbf80,0x3f75bf7b,0x3f22bf35,0x3ef1bf0e,0xbf7b3f80,0xbf553f6d,0x3e4825b0,0x3f0ebec4,0x3f75bf80,0x3f22bf55,0xbf623f35,0xbf7f3f7b
.long 0xbf6d3f80,0xbec43f35,0x3f6dbf80,0x3ec4bf35,0x3f62bf80,0x3dc9bf0e,0xbe953f35,0x3f22be48,0xbf553f80,0x3e483ec4,0xbf0ea742,0xbf7b3f6d,0x3f46bf80,0xbef1be48,0x3f7fbf35,0x3e95bf55
.long 0xbf353f80,0x3f35a654,0xbf353f80,0x3f35a60d,0x3f22bf80,0xbf623e48,0xbdc9bf35,0xbf753f55,0xbf0e3f80,0x3f7bbec4,0x3f55a58e,0x3e48bf6d,0x3ef1bf80,0xbf7f3f0e,0xbf753f35,0x3f463e48
.long 0xbec43f80,0x3f6dbf35,0x3ec4bf80,0xbf6d3f35,0x3e95bf80,0xbf463f55,0x3ef13f35,0x3dc9bf7b,0xbe483f80,0x3f0ebf6d,0xbf7ba78d,0x3f553ec4,0x3dc9bf80,0xbe953f7b,0x3f46bf35,0xbf623f0e
.long 0xa58d3f80,0x278dbf80,0xa80d3f80,0x279fbf80,0xbdc9bf80,0x3e953f7b,0xbf46bf35,0x3f623f0e,0x3e483f80,0xbf0ebf6d,0x3f7b268d,0xbf553ec4,0xbe95bf80,0x3f463f55,0xbef13f35,0xbdc9bf7b
.long 0x3ec43f80,0xbf6dbf35,0xbec4bf80,0x3f6d3f35,0xbef1bf80,0x3f7f3f0e,0x3f753f35,0xbf463e48,0x3f0e3f80,0xbf7bbec4,0xbf55a85d,0xbe48bf6d,0xbf22bf80,0x3f623e48,0x3dc9bf35,0x3f753f55
.long 0x3f353f80,0xbf35a7b1,0x3f353f80,0xbf3526d4,0xbf46bf80,0x3ef1be48,0xbf7fbf35,0xbe95bf55,0x3f553f80,0xbe483ec4,0x3f0ea7b1,0x3f7b3f6d,0xbf62bf80,0xbdc9bf0e,0x3e953f35,0xbf22be48
.long 0x3f6d3f80,0x3ec43f35,0xbf6dbf80,0xbec4bf35,0xbf75bf80,0xbf22bf55,0x3f623f35,0x3f7f3f7b,0x3f7b3f80,0x3f553f6d,0xbe48a7e5,0xbf0ebec4,0xbf7fbf80,0xbf75bf7b,0xbf22bf35,0xbef1bf0e
.long 0xbf803f80,0xbf803f80,0xbf803f80,0xbf803f80,0x3f62bf6d,0x3f46bf55,0x3e95bec4,0x3dc9be48,0xbf0e3f35,0xbe483ec4,0x3f55bf35,0x3f7bbf6d,0x3dc9bec4,0xbef13e48,0xbf463f6d,0xbe953f0e
.long 0x3ec4261f,0x3f6dbf35,0xbec4a731,0xbf6d3f35,0xbf463ec4,0xbf753f7b,0x3f7fbf6d,0x3ef1bf55,0x3f7bbf35,0x3f0ebf6d,0xbe483f35,0x3f55bec4,0xbf753f6d,0x3dc93f0e,0xbf623ec4,0xbf223f7b
.long 0x3f35bf80,0xbf35a754,0x3f35bf80,0xbf35a765,0xbe953f6d,0x3f7fbf0e,0x3ef13ec4,0x3f46bf7b,0xbe48bf35,0xbf553f6d,0xbf7b3f35,0x3f0e3ec4,0x3f223ec4,0x3e95bf7b,0x3dc9bf6d,0xbf623f55
.long 0xbf6da777,0x3ec43f35,0x3f6d258d,0xbec4bf35,0x3f7fbec4,0xbf62be48,0xbf223f6d,0x3f75bf0e,0xbf553f35,0x3f7bbec4,0xbf0ebf35,0x3e483f6d,0x3ef1bf6d,0xbf223f55,0x3f75bec4,0xbf7f3e48
.long 0xa60d3f80,0x2796bf80,0xa68d3f80,0xa731bf80,0xbef1bf6d,0x3f223f55,0xbf75bec4,0x3f7f3e48,0x3f553f35,0xbf7bbec4,0x3f0ebf35,0xbe483f6d,0xbf7fbec4,0x3f62be48,0x3f223f6d,0xbf75bf0e
.long 0x3f6d268d,0xbec43f35,0xbf6d270d,0x3ec4bf35,0xbf223ec4,0xbe95bf7b,0xbdc9bf6d,0x3f623f55,0x3e48bf35,0x3f553f6d,0x3f7b3f35,0xbf0e3ec4,0x3e953f6d,0xbf7fbf0e,0xbef13ec4,0xbf46bf7b
.long 0xbf35bf80,0x3f35281f,0xbf35bf80,0x3f352730,0x3f753f6d,0xbdc93f0e,0x3f623ec4,0x3f223f7b,0xbf7bbf35,0xbf0ebf6d,0x3e483f35,0xbf55bec4,0x3f463ec4,0x3f753f7b,0xbf7fbf6d,0xbef1bf55
.long 0xbec426d4,0xbf6dbf35,0x3ec42754,0x3f6d3f35,0xbdc9bec4,0x3ef13e48,0x3f463f6d,0x3e953f0e,0x3f0e3f35,0x3e483ec4,0xbf55bf35,0xbf7bbf6d,0xbf62bf6d,0xbf46bf55,0xbe95bec4,0xbdc9be48
.long 0xbf803f80,0xbf803f80,0xbf803f80,0xbf803f80,0xbdc9a554,0xbe953e48,0xbf463f35,0xbf623f55,0x3f7bbf80,0x3f55bf6d,0xbe48a5f7,0xbf0e3ec4,0x3e95261f,0x3f46bf0e,0x3ef1bf35,0xbdc9be48
.long 0xbf6d3f80,0xbec43f35,0x3f6dbf80,0x3ec4bf35,0xbef1a742,0xbf7f3f55,0x3f75bf35,0x3f46bf7b,0x3f55bf80,0xbe48bec4,0x3f0ea60d,0x3f7bbf6d,0x3f22a60d,0x3f62bf7b,0xbdc93f35,0x3f75bf0e
.long 0xbf353f80,0x3f35a58e,0xbf353f80,0x3f35a137,0xbf46a777,0xbef13f7b,0xbf7f3f35,0x3e953f0e,0x3f0ebf80,0xbf7b3ec4,0xbf55a78d,0xbe483f6d,0x3f622804,0xbdc9bf55,0xbe95bf35,0xbf223f7b
.long 0xbec43f80,0x3f6dbf35,0x3ec4bf80,0xbf6d3f35,0xbf752754,0x3f223f0e,0x3f62bf35,0xbf7f3e48,0x3e48bf80,0xbf0e3f6d,0x3f7b2816,0xbf55bec4,0x3f7f2889,0xbf75be48,0x3f223f35,0xbef1bf55
.long 0xa8163f80,0x27b1bf80,0xa81f3f80,0x27c2bf80,0xbf7f2828,0x3f75be48,0xbf223f35,0x3ef1bf55,0xbe48bf80,0x3f0e3f6d,0xbf7b26d4,0x3f55bec4,0x3f75281f,0xbf223f0e,0xbf62bf35,0x3f7f3e48
.long 0x3ec43f80,0xbf6dbf35,0xbec4bf80,0x3f6d3f35,0xbf6226d4,0x3dc9bf55,0x3e95bf35,0x3f223f7b,0xbf0ebf80,0x3f7b3ec4,0x3f55289a,0x3e483f6d,0x3f462730,0x3ef13f7b,0x3f7f3f35,0xbe953f0e
.long 0x3f353f80,0xbf35a7e5,0x3f353f80,0xbf35a880,0xbf22a7e5,0xbf62bf7b,0x3dc93f35,0xbf75bf0e,0xbf55bf80,0x3e48bec4,0xbf0e28be,0xbf7bbf6d,0x3ef12839,0x3f7f3f55,0xbf75bf35,0xbf46bf7b
.long 0x3f6d3f80,0x3ec43f35,0xbf6dbf80,0xbec4bf35,0xbe95a880,0xbf46bf0e,0xbef1bf35,0x3dc9be48,0xbf7bbf80,0xbf55bf6d,0x3e4828ea,0x3f0e3ec4,0x3dc928a3,0x3e953e48,0x3f463f35,0x3f623f55
.long 0xbf803f80,0xbf803f80,0xbf803f80,0xbf803f80,0xbef13ec4,0xbf223f0e,0xbf753f6d,0xbf7f3f7b,0x3f0ebf35,0x3e48bec4,0xbf553f35,0xbf7b3f6d,0x3f7fbf6d,0x3f62bf7b,0xbf223ec4,0xbf753f55
.long 0x3ec4a68d,0x3f6dbf35,0xbec4a742,0xbf6d3f35,0xbf223f6d,0x3e953e48,0xbdc9bec4,0xbf623f0e,0xbf7b3f35,0xbf0e3f6d,0x3e48bf35,0xbf553ec4,0xbe95bec4,0xbf7f3f55,0x3ef1bf6d,0xbf463e48
.long 0x3f35bf80,0xbf35a777,0x3f35bf80,0xbf35a784,0x3f75bec4,0x3dc9bf55,0x3f62bf6d,0xbf22be48,0x3e483f35,0x3f55bf6d,0x3f7bbf35,0xbf0ebec4,0xbf463f6d,0x3f75be48,0x3f7fbec4,0xbef1bf0e
.long 0xbf6da796,0x3ec43f35,0x3f6d268d,0xbec4bf35,0xbdc9bf6d,0xbef13f7b,0x3f463ec4,0xbe95bf55,0x3f55bf35,0xbf7b3ec4,0x3f0e3f35,0xbe48bf6d,0x3f623ec4,0xbf46bf0e,0x3e953f6d,0xbdc9bf7b
.long 0xa6d43f80,0xa70dbf80,0xa70d3f80,0xa6d4bf80,0xbf623ec4,0x3f46bf0e,0xbe953f6d,0x3dc9bf7b,0xbf55bf35,0x3f7b3ec4,0xbf0e3f35,0x3e48bf6d,0x3dc9bf6d,0x3ef13f7b,0xbf463ec4,0x3e95bf55
.long 0x3f6d2828,0xbec43f35,0xbf6da7e5,0x3ec4bf35,0x3f463f6d,0xbf75be48,0xbf7fbec4,0x3ef1bf0e,0xbe483f35,0xbf55bf6d,0xbf7bbf35,0x3f0ebec4,0xbf75bec4,0xbdc9bf55,0xbf62bf6d,0x3f22be48
.long 0xbf35bf80,0x3f352839,0xbf35bf80,0x3f3528a3,0x3e95bec4,0x3f7f3f55,0xbef1bf6d,0x3f463e48,0x3f7b3f35,0x3f0e3f6d,0xbe48bf35,0x3f553ec4,0x3f223f6d,0xbe953e48,0x3dc9bec4,0x3f623f0e
.long 0xbec4a804,0xbf6dbf35,0x3ec4a731,0x3f6d3f35,0xbf7fbf6d,0xbf62bf7b,0x3f223ec4,0x3f753f55,0xbf0ebf35,0xbe48bec4,0x3f553f35,0x3f7b3f6d,0x3ef13ec4,0x3f223f0e,0x3f753f6d,0x3f7f3f7b
.long 0x8000,0x8000,0x8000,0x8000,0xbdc9a50d,0xbe953e48,0xbf463f35,0xbf623f55,0x3e48258d,0x3f0ebec4,0x3f7bbf80,0x3f55bf6d,0xbe95a5d4,0xbf463f0e,0xbef13f35,0x3dc93e48
.long 0x3ec4260d,0x3f6dbf35,0xbec4a630,0xbf6d3f35,0xbef1a630,0xbf7f3f55,0x3f75bf35,0x3f46bf7b,0x3f0e2654,0x3f7bbf6d,0xbf553f80,0x3e483ec4,0xbf22a677,0xbf623f7b,0x3dc9bf35,0xbf753f0e
.long 0x3f35268d,0x3f35bf80,0x3f3526b0,0x3f35bf80,0xbf46a69f,0xbef13f7b,0xbf7f3f35,0x3e953f0e,0x3f5526b0,0x3e48bf6d,0x3f0ebf80,0xbf7b3ec4,0xbf62a7b1,0x3dc93f55,0x3e953f35,0x3f22bf7b
.long 0x3f6d26d4,0xbec4bf35,0xbf6da7c2,0x3ec43f35,0xbf75270d,0x3f223f0e,0x3f62bf35,0xbf7f3e48,0x3f7b26f7,0xbf55bec4,0xbe483f80,0x3f0ebf6d,0xbf7fa7c2,0x3f753e48,0xbf22bf35,0x3ef13f55
.long 0x3f80270d,0xbf8026d4,0x3f802730,0xbf80268d,0xbf7f26d4,0x3f75be48,0xbf223f35,0x3ef1bf55,0x3f7b271f,0xbf553ec4,0xbe48bf80,0x3f0e3f6d,0xbf75a7d4,0x3f22bf0e,0x3f623f35,0xbf7fbe48
.long 0x3f6d2730,0xbec43f35,0xbf6d260e,0x3ec4bf35,0xbf62268d,0x3dc9bf55,0x3e95bf35,0x3f223f7b,0x3f552831,0x3e483f6d,0x3f0e3f80,0xbf7bbec4,0xbf46a7e5,0xbef1bf7b,0xbf7fbf35,0x3e95bf0e
.long 0x3f352754,0x3f353f80,0x3f352842,0x3f353f80,0xbf22260e,0xbf62bf7b,0x3dc93f35,0xbf75bf0e,0x3f0ea78d,0x3f7b3f6d,0xbf55bf80,0x3e48bec4,0xbef1a7f7,0xbf7fbf55,0x3f753f35,0x3f463f7b
.long 0x3ec42777,0x3f6d3f35,0xbec4a80d,0xbf6dbf35,0xbe9521b7,0xbf46bf0e,0xbef1bf35,0x3dc9be48,0x3e482842,0x3f0e3ec4,0x3f7b3f80,0x3f553f6d,0xbdc9a804,0xbe95be48,0xbf46bf35,0xbf62bf55
.long 0x8000,0x8000,0x8000,0x8000,0xbef13ec4,0xbf223f0e,0xbf753f6d,0xbf7f3f7b,0x3f55bf35,0x3f7bbf6d,0x3f0ebf35,0x3e48bec4,0xbf7f3f6d,0xbf623f7b,0x3f22bec4,0x3f75bf55
.long 0x3f6dbf80,0x3ec4bf35,0xbf6d3f80,0xbec43f35,0xbf223f6d,0x3e953e48,0xbdc9bec4,0xbf623f0e,0x3e48bf35,0xbf553ec4,0x3f7bbf35,0x3f0ebf6d,0x3e953ec4,0x3f7fbf55,0xbef13f6d,0x3f46be48
.long 0xbf35a69f,0xbf353f80,0xbf35a7b1,0xbf353f80,0x3f75bec4,0x3dc9bf55,0x3f62bf6d,0xbf22be48,0xbf7b3f35,0x3f0e3ec4,0x3e483f35,0x3f55bf6d,0x3f46bf6d,0xbf753e48,0xbf7f3ec4,0x3ef13f0e
.long 0xbec43f80,0x3f6dbf35,0x3ec4bf80,0xbf6d3f35,0xbdc9bf6d,0xbef13f7b,0x3f463ec4,0xbe95bf55,0x3f0e3f35,0xbe48bf6d,0xbf553f35,0x3f7bbec4,0xbf62bec4,0x3f463f0e,0xbe95bf6d,0x3dc93f7b
.long 0x3f80271f,0xbf80a7d4,0x3f802831,0xbf80a7e5,0xbf623ec4,0x3f46bf0e,0xbe953f6d,0x3dc9bf7b,0x3f0ebf35,0xbe483f6d,0xbf55bf35,0x3f7b3ec4,0xbdc93f6d,0xbef1bf7b,0x3f46bec4,0xbe953f55
.long 0xbec4bf80,0x3f6d3f35,0x3ec43f80,0xbf6dbf35,0x3f463f6d,0xbf75be48,0xbf7fbec4,0x3ef1bf0e,0xbf7bbf35,0x3f0ebec4,0x3e48bf35,0x3f553f6d,0x3f753ec4,0x3dc93f55,0x3f623f6d,0xbf223e48
.long 0xbf35a7f7,0xbf35bf80,0xbf35a60d,0xbf35bf80,0x3e95bec4,0x3f7f3f55,0xbef1bf6d,0x3f463e48,0x3e483f35,0xbf55bec4,0x3f7b3f35,0x3f0e3f6d,0xbf22bf6d,0x3e95be48,0xbdc93ec4,0xbf62bf0e
.long 0x3f6d3f80,0x3ec43f35,0xbf6dbf80,0xbec4bf35,0xbf7fbf6d,0xbf62bf7b,0x3f223ec4,0x3f753f55,0x3f553f35,0x3f7b3f6d,0x3f0e3f35,0x3e483ec4,0xbef1bec4,0xbf22bf0e,0xbf75bf6d,0xbf7fbf7b
.long 0x8000,0x8000,0x8000,0x8000,0xbf7f3f80,0xbf753f7b,0xbf223f35,0xbef13f0e,0xbe48a5d4,0xbf0e3ec4,0xbf7b3f80,0xbf553f6d,0x3f75bf80,0x3f22bf55,0xbf623f35,0xbf7f3f7b
.long 0x3ec42654,0x3f6dbf35,0xbec4a677,0xbf6d3f35,0xbf623f80,0xbdc93f0e,0x3e95bf35,0xbf223e48,0xbf0ea69f,0xbf7b3f6d,0x3f55bf80,0xbe48bec4,0x3f46bf80,0xbef1be48,0x3f7fbf35,0x3e95bf55
.long 0x3f3526d4,0x3f35bf80,0x3f3526f7,0x3f35bf80,0xbf223f80,0x3f62be48,0x3dc93f35,0x3f75bf55,0xbf55a7c2,0xbe483f6d,0xbf0e3f80,0x3f7bbec4,0x3ef1bf80,0xbf7f3f0e,0xbf753f35,0x3f463e48
.long 0x3f6d271f,0xbec4bf35,0xbf6d268d,0x3ec43f35,0xbe953f80,0x3f46bf55,0xbef1bf35,0xbdc93f7b,0xbf7b268d,0x3f553ec4,0x3e48bf80,0xbf0e3f6d,0x3dc9bf80,0xbe953f7b,0x3f46bf35,0xbf623f0e
.long 0x3f802754,0xbf80260e,0x3f802777,0xbf8021b7,0x3dc93f80,0xbe95bf7b,0x3f463f35,0xbf62bf0e,0xbf7ba7f7,0x3f55bec4,0x3e483f80,0xbf0ebf6d,0xbe95bf80,0x3f463f55,0xbef13f35,0xbdc9bf7b
.long 0x3f6d2842,0xbec43f35,0xbf6da80d,0x3ec4bf35,0x3ef13f80,0xbf7fbf0e,0xbf75bf35,0x3f46be48,0xbf55a884,0xbe48bf6d,0xbf0ebf80,0x3f7b3ec4,0xbf22bf80,0x3f623e48,0x3dc9bf35,0x3f753f55
.long 0x3f35279f,0x3f353f80,0x3f35a70d,0x3f353f80,0x3f463f80,0xbef13e48,0x3f7f3f35,0x3e953f55,0xbf0e27d4,0xbf7bbf6d,0x3f553f80,0xbe483ec4,0xbf62bf80,0xbdc9bf0e,0x3e953f35,0xbf22be48
.long 0x3ec4a70d,0x3f6d3f35,0xbec4a896,0xbf6dbf35,0x3f753f80,0x3f223f55,0xbf62bf35,0xbf7fbf7b,0xbe48a909,0xbf0ebec4,0xbf7bbf80,0xbf55bf6d,0xbf7fbf80,0xbf75bf7b,0xbf22bf35,0xbef1bf0e
.long 0x8000,0x8000,0x8000,0x8000,0xbf623f6d,0xbf463f55,0xbe953ec4,0xbdc93e48,0xbf553f35,0xbf7b3f6d,0xbf0e3f35,0xbe483ec4,0x3dc9bec4,0xbef13e48,0xbf463f6d,0xbe953f0e
.long 0x3f6dbf80,0x3ec4bf35,0xbf6d3f80,0xbec43f35,0x3f46bec4,0x3f75bf7b,0xbf7f3f6d,0xbef13f55,0xbe483f35,0x3f55bec4,0xbf7b3f35,0xbf0e3f6d,0xbf753f6d,0x3dc93f0e,0xbf623ec4,0xbf223f7b
.long 0xbf35270d,0xbf353f80,0xbf35a7c2,0xbf353f80,0x3e95bf6d,0xbf7f3f0e,0xbef1bec4,0xbf463f7b,0x3f7bbf35,0xbf0ebec4,0xbe48bf35,0xbf553f6d,0x3f223ec4,0x3e95bf7b,0x3dc9bf6d,0xbf623f55
.long 0xbec43f80,0x3f6dbf35,0x3ec4bf80,0xbf6d3f35,0xbf7f3ec4,0x3f623e48,0x3f22bf6d,0xbf753f0e,0xbf0ebf35,0x3e483f6d,0x3f55bf35,0xbf7b3ec4,0x3ef1bf6d,0xbf223f55,0x3f75bec4,0xbf7f3e48
.long 0x3f80a78d,0xbf80a7f7,0x3f802842,0xbf80a804,0x3ef13f6d,0xbf22bf55,0x3f753ec4,0xbf7fbe48,0xbf0e3f35,0x3e48bf6d,0x3f553f35,0xbf7bbec4,0xbf7fbec4,0x3f62be48,0x3f223f6d,0xbf75bf0e
.long 0xbec4bf80,0x3f6d3f35,0x3ec43f80,0xbf6dbf35,0x3f22bec4,0x3e953f7b,0x3dc93f6d,0xbf62bf55,0x3f7b3f35,0xbf0e3ec4,0xbe483f35,0xbf55bf6d,0x3e953f6d,0xbf7fbf0e,0xbef13ec4,0xbf46bf7b
.long 0xbf35a816,0xbf35bf80,0xbf35a70d,0xbf35bf80,0xbf75bf6d,0x3dc9bf0e,0xbf62bec4,0xbf22bf7b,0xbe48bf35,0x3f553ec4,0xbf7bbf35,0xbf0ebf6d,0x3f463ec4,0x3f753f7b,0xbf7fbf6d,0xbef1bf55
.long 0x3f6d3f80,0x3ec43f35,0xbf6dbf80,0xbec4bf35,0x3dc93ec4,0xbef1be48,0xbf46bf6d,0xbe95bf0e,0xbf55bf35,0xbf7bbf6d,0xbf0ebf35,0xbe48bec4,0xbf62bf6d,0xbf46bf55,0xbe95bec4,0xbdc9be48
.size tbl_blob, 145408
```
